```python
import torch

def _softmax(x, axis=-1):
    return torch.softmax(x, dim=axis)
def _gelu(x):
    return torch.nn.functional.gelu(x, approximate="tanh")
def _silu(x):
    return torch.nn.functional.silu(x)
def _sigmoid(x):
    return torch.sigmoid(x)
def _layernorm(x, axis=-1, eps=1e-5):
    m = x.mean(dim=axis, keepdim=True)
    v = x.var(dim=axis, keepdim=True, unbiased=False)
    return (x - m) / torch.sqrt(v + eps)
def _scatter_add(tgt, idx, src, axis=0):
    return tgt.clone().index_add_(axis, idx, src)
def _segment_sum(src, seg, n):
    out = torch.zeros((n,) + src.shape[1:], dtype=src.dtype)
    return out.index_add_(0, seg, src)
def _pad(x, pw):
    flat = tuple(v for pair in reversed(pw) for v in pair)
    return torch.nn.functional.pad(x, flat)

kernel_name = 'recurrent_scan__sliding_block_cached__glu_gated_bilinear__prompt'

def setup_inputs():

    _w = (lambda a: (lambda t: t.to(torch.bfloat16) if t.is_floating_point() else t)(torch.as_tensor(a)))
    def _A_setup():
        B, Sq, D = 1, 2048, 640
        Hq, Hkv, Sk, Dh = 32, 32, 2048, 192
        assert Hq % Hkv == 0, (Hq, Hkv)
        return {
            "x": _w((lambda *s: torch.randn(*s, dtype=torch.bfloat16) * 0.05)(B, Sq, D)),
            "k_cache": _w((lambda *s: torch.randn(*s, dtype=torch.bfloat16) * 1.6)(B, Hkv, Sk, Dh)),
            "v_cache": _w((lambda *s: torch.randn(*s, dtype=torch.bfloat16) * 1.6)(B, Hkv, Sk, Dh)),
            "wq": _w((lambda *s: torch.randn(*s, dtype=torch.bfloat16) * 1.6)(D, Hq * Dh) * (D ** -0.5)),
            "wo": _w((lambda *s: torch.randn(*s, dtype=torch.bfloat16) * 1.6)(Hq * Dh, D) * ((Hq * Dh) ** -0.5)),
        }
    _A_in = _A_setup()

    def _B_setup():
        B, S, D, F = 1, 2048, 640, 1536
        return {
            "x": _w((lambda *s: torch.randn(*s, dtype=torch.bfloat16) * 0.05)(B, S, D)),
            "w_gate": _w((lambda *s: torch.randn(*s, dtype=torch.bfloat16) * 0.2)(D, F) * (D ** -0.5)),
            "w_up": _w((lambda *s: torch.randn(*s, dtype=torch.bfloat16) * 0.2)(D, F) * (D ** -0.5)),
            "w_down": _w((lambda *s: torch.randn(*s, dtype=torch.bfloat16) * 0.2)(F, D) * (F ** -0.5)),
        }
    _B_in = _B_setup()

    return {
        "A_x": _A_in["x"],
        "A_k_cache": _A_in["k_cache"],
        "A_v_cache": _A_in["v_cache"],
        "A_wq": _A_in["wq"],
        "A_wo": _A_in["wo"],
        "B_x": _B_in["x"],
        "B_w_gate": _B_in["w_gate"],
        "B_w_up": _B_in["w_up"],
        "B_w_down": _B_in["w_down"],
    }

def reference(A_x, A_k_cache, A_v_cache, A_wq, A_wo, B_x, B_w_gate, B_w_up, B_w_down):
    def _A_ref(x, k_cache, v_cache, wq, wo):
        B, Sq, D = x.shape
        Hq, Dh = 32, 192
        Hkv, Sk = k_cache.shape[1], k_cache.shape[2]
        W = min(4096, max(256, Sk // 4))
        rep = Hq // Hkv
        q = (lambda x, *d: x.permute(*d))((x @ wq).reshape(B, Sq, Hq, Dh), 0, 2, 1, 3)
        k = (lambda x, n, axis: torch.repeat_interleave(x, n, dim=axis))(k_cache[:, :, Sk - W:, :], rep, axis=1)
        v = (lambda x, n, axis: torch.repeat_interleave(x, n, dim=axis))(v_cache[:, :, Sk - W:, :], rep, axis=1)
        scores = torch.einsum("bhqd,bhkd->bhqk", q, k) * (Dh ** -0.5)
        p = _softmax(scores, axis=-1)
        o = torch.einsum("bhqk,bhkd->bhqd", p, v)
        return (lambda x, *d: x.permute(*d))(o, 0, 2, 1, 3).reshape(B, Sq, Hq * Dh) @ wo

    def _B_ref(x, w_gate, w_up, w_down):
        g = torch.einsum("bsd,df->bsf", x, w_gate)
        u = torch.einsum("bsd,df->bsf", x, w_up)
        h = g * u
        return torch.einsum("bsf,fd->bsd", h, w_down)

    x = A_x
    xn = _layernorm(x, axis=-1)
    s = _A_ref(xn, A_k_cache, A_v_cache, A_wq, A_wo)
    g = _silu(_B_ref(xn, B_w_gate, B_w_up, B_w_down))
    return x + s * g
```

```asm
; @launch grid=(256,1,1) block=(256,1,1) lds=163840
.amdgcn_target "amdgcn-amd-amdhsa--gfx950"
.text
.globl recurrent_scan__sliding_block_cached__glu_gated_bilinear__prompt_kernel
.p2align 8
.type recurrent_scan__sliding_block_cached__glu_gated_bilinear__prompt_kernel,@function
recurrent_scan__sliding_block_cached__glu_gated_bilinear__prompt_kernel:
L_code_begin:
s_cmp_ge_u32 s2, 256
s_cbranch_scc1 L_end
s_load_dwordx16 s[64:79], s[0:1], 0
s_load_dwordx8 s[80:87], s[0:1], 64
s_memrealtime s[88:89]
s_getpc_b64 s[62:63]
v_lshrrev_b32 v30, 6, v0
v_and_b32 v0, 63, v0
v_readfirstlane_b32 s30, v30
v_lshlrev_b32 v1, 4, v0
v_lshlrev_b32 v13, 7, v0
v_and_b32 v48, 7, v0
v_lshrrev_b32 v49, 3, v0
v_mul_u32_u24 v60, 1280, v48
v_lshl_add_u32 v50, v49, 4, v60
v_lshl_add_u32 v50, v30, 7, v50
s_mul_i32 s31, s2, 10240
s_and_b32 s32, s2, 7
s_lshr_b32 s33, s2, 3
s_and_b32 s28, s33, 3
s_lshl2_add_u32 s28, s32, s28
s_lshr_b32 s29, s33, 2
s_lshr_b32 s47, s32, 1
s_and_b32 s32, s32, 1
s_lshl1_add_u32 s48, s29, s32
s_and_b32 s49, s33, 3
v_cmp_eq_u32 vcc, 0, v0
v_bfrev_b32 v51, 1
s_nop 0
v_cndmask_b32 v14, v51, 0, vcc
v_cmp_gt_u32 vcc, 2, v30
v_add_u32 v53, 1024, v50
s_nop 0
v_cndmask_b32 v53, v51, v53, vcc
s_lshl2_add_u32 s33, s33, s30
s_min_u32 s33, s33, CODE_SLICES*8-1
s_lshl_b32 s33, s33, 10
v_add_u32 v52, s33, v1
global_load_dword a255, v52, s[62:63]
v_lshrrev_b32 v54, 4, v0
v_and_b32 v55, 15, v0
v_and_b32 v61, 6, v49
v_xor_b32 v61, v61, v48
v_lshlrev_b32 v61, 4, v61
v_mul_u32_u24 v62, 1280, v49
v_add_u32 v12, v62, v61
v_and_b32 v62, 4, v49
v_add_u32 v62, v62, v49
v_mul_u32_u24 v62, 3072, v62
v_add_u32 v11, v62, v61
s_lshl_b32 s59, s30, 13
s_add_u32 s58, s59, 49152
s_lshl2_add_u32 s54, s29, s30
s_mul_i32 s57, s54, 81920
s_waitcnt lgkmcnt(0)
s_mov_b32 s96, s64
s_mov_b32 s97, s65
s_mov_b32 s98, 0x280000
s_mov_b32 s99, 0x20000
buffer_load_dwordx4 v[64:67], v50, s[96:99], s31 offen
buffer_load_dwordx4 v[68:71], v50, s[96:99], s31 offen offset:512
buffer_load_dwordx4 v[72:75], v53, s[96:99], s31 offen
buffer_load_ushort v76, v60, s[96:99], s31 offen
s_mov_b32 s16, s84
s_mov_b32 s17, s85
s_mov_b32 s18, 0x100
s_mov_b32 s19, 0x20000
s_or_b32 s40, s88, 1
v_mov_b32 v56, s40
v_mov_b32 v57, 0
s_or_b32 s32, s2, s30
s_cmp_eq_u32 s32, 0
s_cselect_b32 s32, 0, 0x100
buffer_atomic_cmpswap v[56:57], v14, s[16:19], s32 offen sc1
s_add_u32 m0, s59, 0
s_add_u32 s56, s57, 0
buffer_load_dwordx4 v12, s[96:99], s56 offen lds
v_add_u32 v61, 0, v0
v_mul_u32_u24 v62, 2731, v61
v_lshrrev_b32 v62, 16, v62
v_mul_u32_u24 v63, 24, v62
v_sub_u32 v63, v61, v63
v_and_b32 v57, 6, v62
v_xor_b32 v57, v63, v57
s_add_u32 m0, s59, 1024
s_add_u32 s56, s57, 10240
buffer_load_dwordx4 v12, s[96:99], s56 offen lds
v_lshlrev_b32 v57, 4, v57
v_subrev_u32 v57, 0, v57
v_and_b32 v59, 4, v62
v_add_u32 v59, v59, v62
v_mul_u32_u24 v59, 12288, v59
v_add_u32 v2, v59, v57
v_add_u32 v61, 64, v0
s_add_u32 m0, s59, 2048
s_add_u32 s56, s57, 20480
buffer_load_dwordx4 v12, s[96:99], s56 offen lds
v_mul_u32_u24 v62, 2731, v61
v_lshrrev_b32 v62, 16, v62
v_mul_u32_u24 v63, 24, v62
v_sub_u32 v63, v61, v63
v_and_b32 v57, 6, v62
v_xor_b32 v57, v63, v57
v_lshlrev_b32 v57, 4, v57
s_add_u32 m0, s59, 3072
s_add_u32 s56, s57, 30720
buffer_load_dwordx4 v12, s[96:99], s56 offen lds
v_subrev_u32 v57, 1024, v57
v_and_b32 v59, 4, v62
v_add_u32 v59, v59, v62
v_mul_u32_u24 v59, 12288, v59
v_add_u32 v3, v59, v57
v_add_u32 v61, 128, v0
v_mul_u32_u24 v62, 2731, v61
s_add_u32 m0, s59, 4096
s_add_u32 s56, s57, 40960
buffer_load_dwordx4 v12, s[96:99], s56 offen lds
v_lshrrev_b32 v62, 16, v62
v_mul_u32_u24 v63, 24, v62
v_sub_u32 v63, v61, v63
v_and_b32 v57, 6, v62
v_xor_b32 v57, v63, v57
v_lshlrev_b32 v57, 4, v57
v_subrev_u32 v57, 2048, v57
s_add_u32 m0, s59, 5120
s_add_u32 s56, s57, 51200
buffer_load_dwordx4 v12, s[96:99], s56 offen lds
v_and_b32 v59, 4, v62
v_add_u32 v59, v59, v62
v_mul_u32_u24 v59, 12288, v59
v_add_u32 v4, v59, v57
s_mov_b32 s4, s70
s_mov_b32 s5, s71
s_mov_b32 s6, 0x780000
s_add_u32 m0, s59, 6144
s_add_u32 s56, s57, 61440
buffer_load_dwordx4 v12, s[96:99], s56 offen lds
s_mov_b32 s7, 0x20000
s_mov_b32 s12, s86
s_mov_b32 s13, s87
s_mov_b32 s14, 0x4100000
s_mov_b32 s15, 0x20000
s_lshr_b32 s31, s30, 1
s_and_b32 s21, s30, 1
s_add_u32 m0, s59, 7168
s_add_u32 s56, s57, 71680
buffer_load_dwordx4 v12, s[96:99], s56 offen lds
s_lshl_b32 s33, s31, 5
s_lshl2_add_u32 s33, s21, s33
s_mul_i32 s20, s33, 12288
s_mul_i32 s33, s28, 384
s_add_u32 s20, s20, s33
s_mul_i32 s24, s30, 6144
s_add_u32 m0, s24, 114688
s_nop 0
buffer_load_dwordx4 v2, s[4:7], s20 offen offset:0  lds
v_lshrrev_b32 v56, 2, v55
v_and_b32 v57, 3, v0
v_lshl_add_u32 v58, v54, 2, v56
v_bfe_u32 v59, v58, 1, 2
v_mul_u32_u24 v62, 384, v58
v_add_u32 v62, 114688, v62
v_lshlrev_b32 v63, 1, v59
v_xor_b32 v63, v63, v57
v_lshl_add_u32 v17, v63, 4, v62
v_xor_b32 v63, 4, v63
buffer_load_dwordx4 v3, s[4:7], s20 offen offset:1024  lds
v_lshl_add_u32 v18, v63, 4, v62
v_bfe_u32 v42, v0, 2, 3
v_lshlrev_b32 v42, 7, v42
v_lshl_add_u32 v42, v57, 2, v42
v_lshlrev_b32 v32, 3, v55
v_lshlrev_b32 v62, 7, v55
v_and_b32 v63, 6, v55
v_xor_b32 v63, v63, v54
v_lshl_add_u32 v46, v63, 4, v62
v_xor_b32 v63, 4, v63
buffer_load_dwordx4 v4, s[4:7], s20 offen offset:2048  lds
v_lshl_add_u32 v47, v63, 4, v62
v_add_u32 v44, s59, v46
v_add_u32 v45, s59, v47
v_add_u32 v46, s58, v46
v_add_u32 v47, s58, v47
v_lshlrev_b32 v58, 3, v48
v_add_u32 v58, 86016, v58
v_lshl_add_u32 v59, v30, 6, v58
v_lshrrev_b32 v56, 2, v49
v_lshl_add_u32 v56, v30, 1, v56
s_add_u32 s20, s20, 196608
s_add_u32 m0, s24, 117760
s_nop 0
buffer_load_dwordx4 v2, s[4:7], s20 offen offset:0  lds
v_lshlrev_b32 v56, 12, v56
v_and_b32 v57, 3, v49
v_lshl_add_u32 v56, v57, 8, v56
v_lshl_add_u32 v56, v48, 4, v56
v_add_u32 v57, 65536, v56
v_cndmask_b32 v57, v51, v57, vcc
v_or_b32 v61, v49, v30
v_cmp_eq_u32 vcc, 0, v61
v_lshlrev_b32 v61, 3, v48
s_nop 0
v_cndmask_b32 v61, v51, v61, vcc
buffer_load_dwordx4 v3, s[4:7], s20 offen offset:1024  lds
s_lshr_b32 s33, s2, 3
s_mul_i32 s33, s33, 81920
s_bfe_u32 s22, s2, 0x20001
s_lshl_b32 s22, s22, 10
s_add_u32 s33, s33, s22
s_and_b32 s22, s2, 1
s_lshl_b32 s22, s22, 7
s_add_u32 s33, s33, s22
s_add_u32 s22, s33, 32768
s_lshl_b32 s53, s2, 6
buffer_load_dwordx4 v4, s[4:7], s20 offen offset:2048  lds
s_add_u32 s20, s20, 589824
s_add_u32 s53, s53, 0x3a30000
s_lshr_b32 s51, s30, 1
s_sub_u32 s51, s51, 1
s_and_b32 s51, s51, 0x3f800000
v_mov_b32 v48, 0x3f803f80
v_mov_b32 v49, 0x3f803f80
v_mov_b32 v50, 0x3f803f80
v_mov_b32 v51, 0x3f803f80
v_mov_b32 v60, 0
buffer_load_dword v15, v60, s[16:19], 0 offen sc1
s_mov_b32 s32, s21
s_mov_b32 s52, s22
s_waitcnt vmcnt(16)
v_lshlrev_b32 v76, 16, v76
v_mov_b32 v77, v76
v_lshlrev_b32 v80, 16, v64
v_and_b32 v81, 0xffff0000, v64
v_pk_add_f32 v[112:113], v[80:81], v[76:77] neg_lo:[0,1] neg_hi:[0,1]
v_lshlrev_b32 v82, 16, v65
v_and_b32 v83, 0xffff0000, v65
v_pk_add_f32 v[114:115], v[82:83], v[76:77] neg_lo:[0,1] neg_hi:[0,1]
v_lshlrev_b32 v84, 16, v66
v_and_b32 v85, 0xffff0000, v66
v_pk_add_f32 v[116:117], v[84:85], v[76:77] neg_lo:[0,1] neg_hi:[0,1]
v_lshlrev_b32 v86, 16, v67
v_and_b32 v87, 0xffff0000, v67
v_pk_add_f32 v[118:119], v[86:87], v[76:77] neg_lo:[0,1] neg_hi:[0,1]
v_lshlrev_b32 v88, 16, v68
v_and_b32 v89, 0xffff0000, v68
v_pk_add_f32 v[120:121], v[88:89], v[76:77] neg_lo:[0,1] neg_hi:[0,1]
v_lshlrev_b32 v90, 16, v69
v_and_b32 v91, 0xffff0000, v69
v_pk_add_f32 v[122:123], v[90:91], v[76:77] neg_lo:[0,1] neg_hi:[0,1]
v_lshlrev_b32 v92, 16, v70
v_and_b32 v93, 0xffff0000, v70
v_pk_add_f32 v[124:125], v[92:93], v[76:77] neg_lo:[0,1] neg_hi:[0,1]
v_lshlrev_b32 v94, 16, v71
v_and_b32 v95, 0xffff0000, v71
v_pk_add_f32 v[126:127], v[94:95], v[76:77] neg_lo:[0,1] neg_hi:[0,1]
v_lshlrev_b32 v96, 16, v72
v_and_b32 v97, 0xffff0000, v72
v_pk_add_f32 v[128:129], v[96:97], v[76:77] neg_lo:[0,1] neg_hi:[0,1]
v_lshlrev_b32 v98, 16, v73
v_and_b32 v99, 0xffff0000, v73
v_pk_add_f32 v[130:131], v[98:99], v[76:77] neg_lo:[0,1] neg_hi:[0,1]
v_lshlrev_b32 v100, 16, v74
v_and_b32 v101, 0xffff0000, v74
v_pk_add_f32 v[132:133], v[100:101], v[76:77] neg_lo:[0,1] neg_hi:[0,1]
v_lshlrev_b32 v102, 16, v75
v_and_b32 v103, 0xffff0000, v75
v_pk_add_f32 v[134:135], v[102:103], v[76:77] neg_lo:[0,1] neg_hi:[0,1]
v_pk_mul_f32 v[106:107], v[112:113], v[112:113]
v_mov_b32 v104, v112
v_mov_b32 v105, v113
v_pk_fma_f32 v[106:107], v[114:115], v[114:115], v[106:107]
v_pk_add_f32 v[104:105], v[104:105], v[114:115]
v_pk_fma_f32 v[106:107], v[116:117], v[116:117], v[106:107]
v_pk_add_f32 v[104:105], v[104:105], v[116:117]
v_pk_fma_f32 v[106:107], v[118:119], v[118:119], v[106:107]
v_pk_add_f32 v[104:105], v[104:105], v[118:119]
v_pk_fma_f32 v[106:107], v[120:121], v[120:121], v[106:107]
v_pk_add_f32 v[104:105], v[104:105], v[120:121]
v_pk_fma_f32 v[106:107], v[122:123], v[122:123], v[106:107]
v_pk_add_f32 v[104:105], v[104:105], v[122:123]
v_pk_fma_f32 v[106:107], v[124:125], v[124:125], v[106:107]
v_pk_add_f32 v[104:105], v[104:105], v[124:125]
v_pk_fma_f32 v[106:107], v[126:127], v[126:127], v[106:107]
v_pk_add_f32 v[104:105], v[104:105], v[126:127]
v_pk_mul_f32 v[110:111], v[128:129], v[128:129]
v_mov_b32 v108, v128
v_mov_b32 v109, v129
v_pk_fma_f32 v[110:111], v[130:131], v[130:131], v[110:111]
v_pk_add_f32 v[108:109], v[108:109], v[130:131]
v_pk_fma_f32 v[110:111], v[132:133], v[132:133], v[110:111]
v_pk_add_f32 v[108:109], v[108:109], v[132:133]
v_pk_fma_f32 v[110:111], v[134:135], v[134:135], v[110:111]
v_pk_add_f32 v[108:109], v[108:109], v[134:135]
v_add_f32 v104, v104, v105
v_add_f32 v105, v106, v107
v_add_f32 v108, v108, v109
v_add_f32 v109, v110, v111
v_fmac_f32 v104, s51, v108
v_fmac_f32 v105, s51, v109
s_nop 1
v_add_f32_dpp v104, v104, v104 row_ror:8 row_mask:0xf bank_mask:0xf
v_add_f32_dpp v105, v105, v105 row_ror:8 row_mask:0xf bank_mask:0xf
v_mov_b32 v106, v104
v_mov_b32 v107, v105
s_nop 0
v_permlane16_swap_b32 v104, v106
v_permlane16_swap_b32 v105, v107
v_add_f32 v104, v104, v106
v_add_f32 v105, v105, v107
v_mov_b32 v106, v104
v_mov_b32 v107, v105
s_nop 0
v_permlane32_swap_b32 v104, v106
v_permlane32_swap_b32 v105, v107
v_add_f32 v104, v104, v106
v_add_f32 v105, v105, v107
ds_write_b64 v59, v[104:105]
s_waitcnt lgkmcnt(0)
s_barrier
ds_read_b64 v[104:105], v58
ds_read_b64 v[106:107], v58 offset:64
ds_read_b64 v[108:109], v58 offset:128
ds_read_b64 v[110:111], v58 offset:192
s_waitcnt lgkmcnt(2)
v_pk_add_f32 v[104:105], v[104:105], v[106:107]
s_waitcnt lgkmcnt(0)
v_pk_add_f32 v[108:109], v[108:109], v[110:111]
v_pk_add_f32 v[104:105], v[104:105], v[108:109]
v_mul_f32 v104, 0x3acccccd, v104
v_mul_f32 v105, 0x3acccccd, v105
v_fma_f32 v105, -v104, v104, v105
v_max_f32 v105, 0, v105
v_add_f32 v104, v104, v76
v_cvt_pk_bf16_f32 v104, v105, v104
v_and_b32 v108, 0xffff0000, v104
v_mov_b32 v109, v108
v_pk_add_f32 v[80:81], v[80:81], v[108:109] neg_lo:[0,1] neg_hi:[0,1]
v_cvt_pk_bf16_f32 v64, v80, v81
v_pk_add_f32 v[82:83], v[82:83], v[108:109] neg_lo:[0,1] neg_hi:[0,1]
v_cvt_pk_bf16_f32 v65, v82, v83
v_pk_add_f32 v[84:85], v[84:85], v[108:109] neg_lo:[0,1] neg_hi:[0,1]
v_cvt_pk_bf16_f32 v66, v84, v85
v_pk_add_f32 v[86:87], v[86:87], v[108:109] neg_lo:[0,1] neg_hi:[0,1]
v_cvt_pk_bf16_f32 v67, v86, v87
buffer_store_dwordx4 v[64:67], v56, s[12:15], s33 offen sc1
v_pk_add_f32 v[88:89], v[88:89], v[108:109] neg_lo:[0,1] neg_hi:[0,1]
v_cvt_pk_bf16_f32 v68, v88, v89
v_pk_add_f32 v[90:91], v[90:91], v[108:109] neg_lo:[0,1] neg_hi:[0,1]
v_cvt_pk_bf16_f32 v69, v90, v91
v_pk_add_f32 v[92:93], v[92:93], v[108:109] neg_lo:[0,1] neg_hi:[0,1]
v_cvt_pk_bf16_f32 v70, v92, v93
v_pk_add_f32 v[94:95], v[94:95], v[108:109] neg_lo:[0,1] neg_hi:[0,1]
v_cvt_pk_bf16_f32 v71, v94, v95
buffer_store_dwordx4 v[68:71], v56, s[12:15], s52 offen sc1
v_pk_add_f32 v[96:97], v[96:97], v[108:109] neg_lo:[0,1] neg_hi:[0,1]
v_cvt_pk_bf16_f32 v72, v96, v97
v_pk_add_f32 v[98:99], v[98:99], v[108:109] neg_lo:[0,1] neg_hi:[0,1]
v_cvt_pk_bf16_f32 v73, v98, v99
v_pk_add_f32 v[100:101], v[100:101], v[108:109] neg_lo:[0,1] neg_hi:[0,1]
v_cvt_pk_bf16_f32 v74, v100, v101
v_pk_add_f32 v[102:103], v[102:103], v[108:109] neg_lo:[0,1] neg_hi:[0,1]
v_cvt_pk_bf16_f32 v75, v102, v103
buffer_store_dwordx4 v[72:75], v57, s[12:15], s33 offen sc1
v_lshlrev_b32 v104, 16, v104
v_add_f32 v104, 0x3727c5ac, v104
v_cvt_pk_bf16_f32 v104, v104, v104
v_lshlrev_b32 v104, 16, v104
v_sqrt_f32 v104, v104
v_xor_b32 v106, 0x80000000, v108
v_cvt_pk_bf16_f32 v104, v104, v104
v_lshlrev_b32 v104, 16, v104
v_rcp_f32 v104, v104
s_nop 0
v_mul_f32 v107, 0x3dd53b95, v104
buffer_store_dwordx2 v[106:107], v61, s[12:15], s53 offen sc1
s_waitcnt vmcnt(11)
ds_read_b128 a[0:3], v44 offset:0
ds_read_b128 a[16:19], v45 offset:0
ds_read_b128 a[4:7], v44 offset:2048
ds_read_b128 a[20:23], v45 offset:2048
ds_read_b128 a[8:11], v44 offset:4096
ds_read_b128 a[24:27], v45 offset:4096
ds_read_b128 a[12:15], v44 offset:6144
ds_read_b128 a[28:31], v45 offset:6144
s_waitcnt vmcnt(5) lgkmcnt(0)
s_barrier
ds_read_b64_tr_b16 a[128:129], v17 offset:0
ds_read_b64_tr_b16 a[130:131], v17 offset:6144
ds_read_b64_tr_b16 a[132:133], v17 offset:12288
ds_read_b64_tr_b16 a[134:135], v17 offset:18432
ds_read_b64_tr_b16 a[136:137], v17 offset:8
ds_read_b64_tr_b16 a[138:139], v17 offset:6152
ds_read_b64_tr_b16 a[140:141], v17 offset:12296
ds_read_b64_tr_b16 a[142:143], v17 offset:18440
s_waitcnt vmcnt(4)
v_readfirstlane_b32 s40, v15
s_nop 3
s_cmp_lg_u32 s40, 0
s_cbranch_scc0 L_nonce
L_nonce_ok:
s_waitcnt lgkmcnt(6)
v_mfma_f32_16x16x32_bf16 v[64:67], a[128:131], a[0:3], 0
s_waitcnt lgkmcnt(4)
s_add_u32 m0, s58, 0
ds_read_b64_tr_b16 a[144:145], v18 offset:0
v_add_u32 v61, 0, v0
v_mfma_f32_16x16x32_bf16 v[64:67], a[132:135], a[16:19], v[64:67]
s_add_u32 s56, s57, 128
ds_read_b64_tr_b16 a[146:147], v18 offset:6144
v_mul_u32_u24 v62, 2731, v61
v_mfma_f32_16x16x32_bf16 v[72:75], a[128:131], a[4:7], 0
s_mul_i32 s27, s54, 81920
buffer_load_dwordx4 v12, s[96:99], s56 offen lds
v_mfma_f32_16x16x32_bf16 v[72:75], a[132:135], a[20:23], v[72:75]
s_add_u32 m0, s58, 1024
ds_read_b64_tr_b16 a[148:149], v18 offset:12288
v_lshrrev_b32 v62, 16, v62
v_mfma_f32_16x16x32_bf16 v[80:83], a[128:131], a[8:11], 0
s_add_u32 s56, s57, 10368
ds_read_b64_tr_b16 a[150:151], v18 offset:18432
v_lshrrev_b32 v59, 1, v62
v_mfma_f32_16x16x32_bf16 v[80:83], a[132:135], a[24:27], v[80:83]
s_mul_i32 s22, s28, 786432
buffer_load_dwordx4 v12, s[96:99], s56 offen lds
v_mfma_f32_16x16x32_bf16 v[88:91], a[128:131], a[12:15], 0
s_add_u32 m0, s58, 2048
ds_read_b64_tr_b16 a[152:153], v18 offset:8
v_mul_u32_u24 v63, 24, v62
v_mfma_f32_16x16x32_bf16 v[88:91], a[132:135], a[28:31], v[88:91]
s_add_u32 s56, s57, 20608
ds_read_b64_tr_b16 a[154:155], v18 offset:6152
v_lshl_add_u32 v59, s30, 2, v59
v_mfma_f32_16x16x32_bf16 a[160:163], a[128:131], v[48:51], 0
s_mul_i32 s25, s30, 3072
buffer_load_dwordx4 v12, s[96:99], s56 offen lds
v_mfma_f32_16x16x32_bf16 a[160:163], a[132:135], v[48:51], a[160:163]
s_waitcnt lgkmcnt(8)
s_add_u32 m0, s58, 3072
ds_read_b64_tr_b16 a[156:157], v18 offset:12296
v_sub_u32 v63, v61, v63
v_mfma_f32_16x16x32_bf16 v[68:71], a[136:139], a[0:3], 0
s_waitcnt lgkmcnt(7)
s_add_u32 s56, s57, 30848
ds_read_b64_tr_b16 a[158:159], v18 offset:18440
v_and_b32 v59, 7, v59
v_mfma_f32_16x16x32_bf16 v[68:71], a[140:143], a[16:19], v[68:71]
s_mov_b32 s8, s66
buffer_load_dwordx4 v12, s[96:99], s56 offen lds
v_mfma_f32_16x16x32_bf16 v[76:79], a[136:139], a[4:7], 0
s_add_u32 m0, s58, 4096
ds_read_b64_tr_b16 a[128:129], v17 offset:128
v_xor_b32 v59, v63, v59
v_mfma_f32_16x16x32_bf16 v[76:79], a[140:143], a[20:23], v[76:79]
s_add_u32 s56, s57, 41088
ds_read_b64_tr_b16 a[130:131], v17 offset:6272
v_add_u32 v61, 64, v0
v_mfma_f32_16x16x32_bf16 v[84:87], a[136:139], a[8:11], 0
s_mov_b32 s9, s67
buffer_load_dwordx4 v12, s[96:99], s56 offen lds
v_mfma_f32_16x16x32_bf16 v[84:87], a[140:143], a[24:27], v[84:87]
s_add_u32 m0, s58, 5120
ds_read_b64_tr_b16 a[132:133], v17 offset:12416
v_and_b32 v57, 6, v62
v_mfma_f32_16x16x32_bf16 v[92:95], a[136:139], a[12:15], 0
s_add_u32 s56, s57, 51328
ds_read_b64_tr_b16 a[134:135], v17 offset:18560
v_mul_u32_u24 v58, 384, v62
v_mfma_f32_16x16x32_bf16 v[92:95], a[140:143], a[28:31], v[92:95]
s_mov_b32 s10, 0x1800000
buffer_load_dwordx4 v12, s[96:99], s56 offen lds
v_mfma_f32_16x16x32_bf16 a[164:167], a[136:139], v[48:51], 0
s_add_u32 m0, s58, 6144
ds_read_b64_tr_b16 a[136:137], v17 offset:136
v_lshlrev_b32 v59, 4, v59
v_mfma_f32_16x16x32_bf16 a[164:167], a[140:143], v[48:51], a[164:167]
s_waitcnt lgkmcnt(11)
ds_read_b64_tr_b16 a[138:139], v17 offset:6280
v_mul_u32_u24 v62, 2731, v61
v_mfma_f32_16x16x32_bf16 v[96:99], a[144:147], a[0:3], 0
s_waitcnt lgkmcnt(10)
ds_read_b64_tr_b16 a[140:141], v17 offset:12424
v_subrev_u32 v59, 0, v59
v_mfma_f32_16x16x32_bf16 v[96:99], a[148:151], a[16:19], v[96:99]
s_add_u32 s56, s57, 61568
ds_read_b64_tr_b16 a[142:143], v17 offset:18568
v_lshrrev_b32 v62, 16, v62
v_mfma_f32_16x16x32_bf16 v[104:107], a[144:147], a[4:7], 0
s_mov_b32 s11, 0x20000
buffer_load_dwordx4 v12, s[96:99], s56 offen lds
v_mfma_f32_16x16x32_bf16 v[104:107], a[148:151], a[20:23], v[104:107]
s_add_u32 m0, s58, 7168
v_add_u32 v5, v58, v59
v_lshrrev_b32 v59, 1, v62
v_mfma_f32_16x16x32_bf16 v[112:115], a[144:147], a[8:11], 0
s_add_u32 s56, s57, 71808
v_xor_b32 v57, v63, v57
v_mul_u32_u24 v63, 24, v62
v_mfma_f32_16x16x32_bf16 v[112:115], a[148:151], a[24:27], v[112:115]
s_mov_b32 s92, s68
buffer_load_dwordx4 v12, s[96:99], s56 offen lds
v_mfma_f32_16x16x32_bf16 v[120:123], a[144:147], a[12:15], 0
s_add_u32 m0, s24, 139264
v_lshl_add_u32 v59, s30, 2, v59
v_lshlrev_b32 v57, 4, v57
v_mfma_f32_16x16x32_bf16 v[120:123], a[148:151], a[28:31], v[120:123]
s_lshl_b32 s50, s2, 7
v_sub_u32 v63, v61, v63
v_and_b32 v59, 7, v59
v_mfma_f32_16x16x32_bf16 a[168:171], a[144:147], v[48:51], 0
s_lshl2_add_u32 s50, s30, s50
buffer_load_dwordx4 v2, s[4:7], s20 offen offset:0  lds
v_mfma_f32_16x16x32_bf16 a[168:171], a[148:151], v[48:51], a[168:171]
s_waitcnt lgkmcnt(10)
ds_read_b64_tr_b16 a[144:145], v18 offset:128
v_subrev_u32 v57, 0, v57
v_mfma_f32_16x16x32_bf16 v[100:103], a[152:155], a[0:3], 0
s_waitcnt lgkmcnt(9)
ds_read_b64_tr_b16 a[146:147], v18 offset:6272
v_xor_b32 v59, v63, v59
v_mfma_f32_16x16x32_bf16 v[100:103], a[156:159], a[16:19], v[100:103]
s_add_u32 s50, s50, 0x3a00000
buffer_load_dwordx4 v3, s[4:7], s20 offen offset:1024  lds
v_mfma_f32_16x16x32_bf16 v[108:111], a[152:155], a[4:7], 0
s_mov_b32 s93, s69
ds_read_b64_tr_b16 a[148:149], v18 offset:12416
v_add_u32 v61, 128, v0
v_mfma_f32_16x16x32_bf16 v[108:111], a[156:159], a[20:23], v[108:111]
s_mov_b32 s94, 0x1800000
ds_read_b64_tr_b16 a[150:151], v18 offset:18560
v_add_u32 v8, v58, v57
v_mfma_f32_16x16x32_bf16 v[116:119], a[152:155], a[8:11], 0
s_mov_b32 s95, 0x20000
buffer_load_dwordx4 v4, s[4:7], s20 offen offset:2048  lds
v_mfma_f32_16x16x32_bf16 v[116:119], a[156:159], a[24:27], v[116:119]
s_add_u32 s20, s20, 196608
v_and_b32 v57, 6, v62
v_mul_u32_u24 v58, 384, v62
v_mfma_f32_16x16x32_bf16 v[124:127], a[152:155], a[12:15], 0
s_add_u32 m0, s24, 142336
v_lshlrev_b32 v59, 4, v59
v_mul_u32_u24 v62, 2731, v61
v_mfma_f32_16x16x32_bf16 v[124:127], a[156:159], a[28:31], v[124:127]
s_lshl_b32 s55, s54, 10
buffer_load_dwordx4 v2, s[4:7], s20 offen offset:0  lds
v_mfma_f32_16x16x32_bf16 a[172:175], a[152:155], v[48:51], 0
s_add_u32 s55, s55, 0x3a00000
ds_read_b64_tr_b16 a[152:153], v18 offset:136
v_xor_b32 v57, v63, v57
v_mfma_f32_16x16x32_bf16 a[172:175], a[156:159], v[48:51], a[172:175]
s_waitcnt lgkmcnt(11)
ds_read_b64_tr_b16 a[154:155], v18 offset:6280
v_subrev_u32 v59, 1024, v59
v_mfma_f32_16x16x32_bf16 v[128:131], a[128:131], a[0:3], 0
s_waitcnt lgkmcnt(10)
buffer_load_dwordx4 v3, s[4:7], s20 offen offset:1024  lds
v_mfma_f32_16x16x32_bf16 v[128:131], a[132:135], a[16:19], v[128:131]
s_lshl_b32 s35, s54, 9
ds_read_b64_tr_b16 a[156:157], v18 offset:12424
v_lshrrev_b32 v62, 16, v62
v_mfma_f32_16x16x32_bf16 v[136:139], a[128:131], a[4:7], 0
ds_read_b64_tr_b16 a[158:159], v18 offset:18568
v_lshlrev_b32 v57, 4, v57
v_mfma_f32_16x16x32_bf16 v[136:139], a[132:135], a[20:23], v[136:139]
buffer_load_dwordx4 v4, s[4:7], s20 offen offset:2048  lds
v_mfma_f32_16x16x32_bf16 v[144:147], a[128:131], a[8:11], 0
s_add_u32 s20, s20, 589824
v_add_u32 v6, v58, v59
v_lshrrev_b32 v59, 1, v62
v_mfma_f32_16x16x32_bf16 v[144:147], a[132:135], a[24:27], v[144:147]
s_add_u32 m0, s24, 0
v_subrev_u32 v57, 1024, v57
v_mul_u32_u24 v63, 24, v62
v_mfma_f32_16x16x32_bf16 v[152:155], a[128:131], a[12:15], 0
s_add_u32 s35, s35, 0x3a30000
v_lshl_add_u32 v59, s30, 2, v59
v_add_u32 v9, v58, v57
v_mfma_f32_16x16x32_bf16 v[152:155], a[132:135], a[28:31], v[152:155]
s_add_u32 s27, s27, 16384
v_sub_u32 v63, v61, v63
v_and_b32 v57, 6, v62
v_mfma_f32_16x16x32_bf16 a[176:179], a[128:131], v[48:51], 0
s_add_u32 s22, s22, 589824
ds_read_b64_tr_b16 a[128:129], v17 offset:256
v_and_b32 v59, 7, v59
v_mfma_f32_16x16x32_bf16 a[176:179], a[132:135], v[48:51], a[176:179]
s_waitcnt lgkmcnt(11)
ds_read_b64_tr_b16 a[130:131], v17 offset:6400
v_xor_b32 v57, v63, v57
v_mfma_f32_16x16x32_bf16 v[132:135], a[136:139], a[0:3], 0
s_waitcnt vmcnt(14) lgkmcnt(10)
buffer_store_dword v15, v14, s[12:15], s50 offen sc1
v_mfma_f32_16x16x32_bf16 v[132:135], a[140:143], a[16:19], v[132:135]
s_add_u32 s22, s22, s25
ds_read_b64_tr_b16 a[132:133], v17 offset:12544
v_xor_b32 v59, v63, v59
v_mfma_f32_16x16x32_bf16 v[140:143], a[136:139], a[4:7], 0
s_lshr_b32 s60, s2, 3
ds_read_b64_tr_b16 a[134:135], v17 offset:18688
v_lshlrev_b32 v57, 4, v57
v_mfma_f32_16x16x32_bf16 v[140:143], a[140:143], a[20:23], v[140:143]
s_lshl2_add_u32 s60, s60, s30
v_lshlrev_b32 v59, 4, v59
v_subrev_u32 v57, 2048, v57
v_mfma_f32_16x16x32_bf16 v[148:151], a[136:139], a[8:11], 0
s_and_b32 s60, s60, 7
v_mul_u32_u24 v58, 384, v62
v_subrev_u32 v59, 2048, v59
v_mfma_f32_16x16x32_bf16 v[148:151], a[140:143], a[24:27], v[148:151]
s_lshl_b32 s60, s60, 10
v_lshrrev_b32 v56, 2, v55
v_add_u32 v10, v58, v57
v_mfma_f32_16x16x32_bf16 v[156:159], a[136:139], a[12:15], 0
s_add_u32 s60, s60, 24576
buffer_load_dwordx4 v2, s[4:7], s20 offen offset:0  lds
v_mfma_f32_16x16x32_bf16 v[156:159], a[140:143], a[28:31], v[156:159]
s_add_u32 s62, s62, s60
v_add_u32 v7, v58, v59
v_lshl_add_u32 v58, v54, 2, v56
v_mfma_f32_16x16x32_bf16 a[180:183], a[136:139], v[48:51], 0
s_addc_u32 s63, s63, 0
ds_read_b64_tr_b16 a[136:137], v17 offset:264
v_and_b32 v57, 3, v0
v_mfma_f32_16x16x32_bf16 a[180:183], a[140:143], v[48:51], a[180:183]
s_waitcnt lgkmcnt(11)
ds_read_b64_tr_b16 a[138:139], v17 offset:6408
v_bfe_u32 v59, v58, 1, 2
v_mfma_f32_16x16x32_bf16 v[160:163], a[144:147], a[0:3], 0
s_waitcnt lgkmcnt(10)
ds_read_b64_tr_b16 a[140:141], v17 offset:12552
v_mul_u32_u24 v62, 384, v58
v_mfma_f32_16x16x32_bf16 v[160:163], a[148:151], a[16:19], v[160:163]
s_mov_b32 s23, s22
ds_read_b64_tr_b16 a[142:143], v17 offset:18696
v_lshl_add_u32 v62, v57, 3, v62
v_mfma_f32_16x16x32_bf16 v[168:171], a[144:147], a[4:7], 0
v_xor_b32 v63, 0, v59
v_lshl_add_u32 v21, v63, 5, v62
v_mfma_f32_16x16x32_bf16 v[168:171], a[148:151], a[20:23], v[168:171]
buffer_load_dwordx4 v3, s[4:7], s20 offen offset:1024  lds
v_mfma_f32_16x16x32_bf16 v[176:179], a[144:147], a[8:11], 0
v_xor_b32 v63, 1, v59
v_lshl_add_u32 v22, v63, 5, v62
v_mfma_f32_16x16x32_bf16 v[176:179], a[148:151], a[24:27], v[176:179]
v_xor_b32 v63, 2, v59
v_lshl_add_u32 v23, v63, 5, v62
v_mfma_f32_16x16x32_bf16 v[184:187], a[144:147], a[12:15], 0
v_xor_b32 v63, 3, v59
v_lshl_add_u32 v24, v63, 5, v62
v_mfma_f32_16x16x32_bf16 v[184:187], a[148:151], a[28:31], v[184:187]
v_lshlrev_b32 v62, 7, v58
v_lshl_add_u32 v62, v57, 3, v62
v_mfma_f32_16x16x32_bf16 a[184:187], a[144:147], v[48:51], 0
v_xor_b32 v63, s30, v59
v_lshl_add_u32 v62, v63, 5, v62
v_mfma_f32_16x16x32_bf16 a[184:187], a[148:151], v[48:51], a[184:187]
s_waitcnt lgkmcnt(10)
v_lshrrev_b32 v63, 1, v55
v_add_u32 v16, 0, v62
v_mfma_f32_16x16x32_bf16 v[164:167], a[152:155], a[0:3], 0
s_waitcnt lgkmcnt(8)
v_mul_u32_u24 v62, 384, v55
v_xor_b32 v63, v63, v54
v_mfma_f32_16x16x32_bf16 v[164:167], a[156:159], a[16:19], v[164:167]
buffer_load_dwordx4 v4, s[4:7], s20 offen offset:2048  lds
v_mfma_f32_16x16x32_bf16 v[172:175], a[152:155], a[4:7], 0
s_add_u32 s20, s20, 196608
v_lshl_add_u32 v19, v63, 4, v62
v_xor_b32 v63, 4, v63
v_mfma_f32_16x16x32_bf16 v[172:175], a[156:159], a[20:23], v[172:175]
s_add_u32 m0, s24, 3072
v_add_u32 v25, 114688, v1
v_lshl_add_u32 v20, v63, 4, v62
v_mfma_f32_16x16x32_bf16 v[180:183], a[152:155], a[8:11], 0
v_mov_b32 v26, 0
v_mov_b32 v27, 0
v_mfma_f32_16x16x32_bf16 v[180:183], a[156:159], a[24:27], v[180:183]
v_mov_b32 v28, 0
v_mov_b32 v29, 0
v_mfma_f32_16x16x32_bf16 v[188:191], a[152:155], a[12:15], 0
v_mfma_f32_16x16x32_bf16 v[188:191], a[156:159], a[28:31], v[188:191]
v_mfma_f32_16x16x32_bf16 a[188:191], a[152:155], v[48:51], 0
v_mfma_f32_16x16x32_bf16 a[188:191], a[156:159], v[48:51], a[188:191]
s_waitcnt lgkmcnt(6)
buffer_load_dwordx4 v2, s[4:7], s20 offen offset:0  lds
v_mfma_f32_16x16x32_bf16 v[192:195], a[128:131], a[0:3], 0
s_waitcnt vmcnt(11) lgkmcnt(4)
ds_read_b128 a[32:35], v46 offset:0
v_mfma_f32_16x16x32_bf16 v[192:195], a[132:135], a[16:19], v[192:195]
ds_read_b128 a[48:51], v47 offset:0
v_mfma_f32_16x16x32_bf16 v[200:203], a[128:131], a[4:7], 0
ds_read_b128 a[36:39], v46 offset:2048
v_mfma_f32_16x16x32_bf16 v[200:203], a[132:135], a[20:23], v[200:203]
ds_read_b128 a[52:55], v47 offset:2048
v_mfma_f32_16x16x32_bf16 v[208:211], a[128:131], a[8:11], 0
ds_read_b128 a[40:43], v46 offset:4096
v_mfma_f32_16x16x32_bf16 v[208:211], a[132:135], a[24:27], v[208:211]
ds_read_b128 a[56:59], v47 offset:4096
v_mfma_f32_16x16x32_bf16 v[216:219], a[128:131], a[12:15], 0
buffer_load_dwordx4 v3, s[4:7], s20 offen offset:1024  lds
v_mfma_f32_16x16x32_bf16 v[216:219], a[132:135], a[28:31], v[216:219]
ds_read_b128 a[44:47], v46 offset:6144
v_mfma_f32_16x16x32_bf16 a[192:195], a[128:131], v[48:51], 0
ds_read_b128 a[60:63], v47 offset:6144
v_mfma_f32_16x16x32_bf16 a[192:195], a[132:135], v[48:51], a[192:195]
s_waitcnt lgkmcnt(10)
ds_read_b64_tr_b16 a[144:145], v18 offset:256
v_mfma_f32_16x16x32_bf16 v[196:199], a[136:139], a[0:3], 0
s_waitcnt lgkmcnt(9)
ds_read_b64_tr_b16 a[146:147], v18 offset:6400
v_mfma_f32_16x16x32_bf16 v[196:199], a[140:143], a[16:19], v[196:199]
ds_read_b64_tr_b16 a[148:149], v18 offset:12544
v_mfma_f32_16x16x32_bf16 v[204:207], a[136:139], a[4:7], 0
ds_read_b64_tr_b16 a[150:151], v18 offset:18688
v_mfma_f32_16x16x32_bf16 v[204:207], a[140:143], a[20:23], v[204:207]
ds_read_b64_tr_b16 a[152:153], v18 offset:264
v_mfma_f32_16x16x32_bf16 v[212:215], a[136:139], a[8:11], 0
buffer_load_dwordx4 v4, s[4:7], s20 offen offset:2048  lds
v_mfma_f32_16x16x32_bf16 v[212:215], a[140:143], a[24:27], v[212:215]
s_add_u32 s20, s20, 589824
ds_read_b64_tr_b16 a[154:155], v18 offset:6408
v_mfma_f32_16x16x32_bf16 v[220:223], a[136:139], a[12:15], 0
s_add_u32 m0, s24, 24576
ds_read_b64_tr_b16 a[156:157], v18 offset:12552
v_mfma_f32_16x16x32_bf16 v[220:223], a[140:143], a[28:31], v[220:223]
ds_read_b64_tr_b16 a[158:159], v18 offset:18696
v_mfma_f32_16x16x32_bf16 a[196:199], a[136:139], v[48:51], 0
s_waitcnt vmcnt(7)
s_barrier
v_mfma_f32_16x16x32_bf16 a[196:199], a[140:143], v[48:51], a[196:199]
s_waitcnt lgkmcnt(6)
ds_read_b64_tr_b16 a[128:129], v17 offset:24576
v_mfma_f32_16x16x32_bf16 v[224:227], a[144:147], a[0:3], 0
s_waitcnt lgkmcnt(5)
ds_read_b64_tr_b16 a[130:131], v17 offset:30720
v_mfma_f32_16x16x32_bf16 v[224:227], a[148:151], a[16:19], v[224:227]
ds_read_b64_tr_b16 a[132:133], v17 offset:36864
v_mfma_f32_16x16x32_bf16 v[232:235], a[144:147], a[4:7], 0
buffer_load_dwordx4 v2, s[4:7], s20 offen offset:0  lds
v_mfma_f32_16x16x32_bf16 v[232:235], a[148:151], a[20:23], v[232:235]
ds_read_b64_tr_b16 a[134:135], v17 offset:43008
v_mfma_f32_16x16x32_bf16 v[240:243], a[144:147], a[8:11], 0
ds_read_b64_tr_b16 a[136:137], v17 offset:24584
v_mfma_f32_16x16x32_bf16 v[240:243], a[148:151], a[24:27], v[240:243]
ds_read_b64_tr_b16 a[138:139], v17 offset:30728
v_mfma_f32_16x16x32_bf16 v[248:251], a[144:147], a[12:15], 0
ds_read_b64_tr_b16 a[140:141], v17 offset:36872
v_mfma_f32_16x16x32_bf16 v[248:251], a[148:151], a[28:31], v[248:251]
ds_read_b64_tr_b16 a[142:143], v17 offset:43016
v_mfma_f32_16x16x32_bf16 a[200:203], a[144:147], v[48:51], 0
ds_read_b64_tr_b16 a[144:145], v18 offset:24576
v_mfma_f32_16x16x32_bf16 a[200:203], a[148:151], v[48:51], a[200:203]
s_waitcnt lgkmcnt(11)
buffer_load_dwordx4 v3, s[4:7], s20 offen offset:1024  lds
v_mfma_f32_16x16x32_bf16 v[228:231], a[152:155], a[0:3], 0
s_waitcnt lgkmcnt(9)
ds_read_b64_tr_b16 a[146:147], v18 offset:30720
v_mfma_f32_16x16x32_bf16 v[228:231], a[156:159], a[16:19], v[228:231]
ds_read_b64_tr_b16 a[148:149], v18 offset:36864
v_mfma_f32_16x16x32_bf16 v[236:239], a[152:155], a[4:7], 0
buffer_load_dword v43, v42, s[12:15], s55 offen sc1
v_mfma_f32_16x16x32_bf16 v[236:239], a[156:159], a[20:23], v[236:239]
ds_read_b64_tr_b16 a[150:151], v18 offset:43008
v_mfma_f32_16x16x32_bf16 v[244:247], a[152:155], a[8:11], 0
v_mfma_f32_16x16x32_bf16 v[244:247], a[156:159], a[24:27], v[244:247]
v_mfma_f32_16x16x32_bf16 v[252:255], a[152:155], a[12:15], 0
v_mfma_f32_16x16x32_bf16 v[252:255], a[156:159], a[28:31], v[252:255]
buffer_load_dwordx4 v4, s[4:7], s20 offen offset:2048  lds
v_mfma_f32_16x16x32_bf16 a[204:207], a[152:155], v[48:51], 0
s_add_u32 s20, s20, 196608
ds_read_b64_tr_b16 a[152:153], v18 offset:24584
v_mfma_f32_16x16x32_bf16 a[204:207], a[156:159], v[48:51], a[204:207]
s_waitcnt lgkmcnt(11)
ds_read_b64_tr_b16 a[154:155], v18 offset:30728
v_mfma_f32_16x16x32_bf16 v[64:67], a[128:131], a[32:35], v[64:67]
s_waitcnt lgkmcnt(10)
ds_read_b64_tr_b16 a[156:157], v18 offset:36872
v_mfma_f32_16x16x32_bf16 v[64:67], a[132:135], a[48:51], v[64:67]
ds_read_b64_tr_b16 a[158:159], v18 offset:43016
v_mfma_f32_16x16x32_bf16 v[72:75], a[128:131], a[36:39], v[72:75]
v_mfma_f32_16x16x32_bf16 v[72:75], a[132:135], a[52:55], v[72:75]
v_mfma_f32_16x16x32_bf16 v[80:83], a[128:131], a[40:43], v[80:83]
v_mfma_f32_16x16x32_bf16 v[80:83], a[132:135], a[56:59], v[80:83]
v_mfma_f32_16x16x32_bf16 v[88:91], a[128:131], a[44:47], v[88:91]
v_mfma_f32_16x16x32_bf16 v[88:91], a[132:135], a[60:63], v[88:91]
s_add_u32 m0, s24, 27648
v_mfma_f32_16x16x32_bf16 a[160:163], a[128:131], v[48:51], a[160:163]
buffer_load_dwordx4 v2, s[4:7], s20 offen offset:0  lds
v_mfma_f32_16x16x32_bf16 a[160:163], a[132:135], v[48:51], a[160:163]
s_waitcnt lgkmcnt(10)
ds_read_b64_tr_b16 a[128:129], v17 offset:24704
v_mfma_f32_16x16x32_bf16 v[68:71], a[136:139], a[32:35], v[68:71]
s_waitcnt lgkmcnt(9)
ds_read_b64_tr_b16 a[130:131], v17 offset:30848
v_mfma_f32_16x16x32_bf16 v[68:71], a[140:143], a[48:51], v[68:71]
ds_read_b64_tr_b16 a[132:133], v17 offset:36992
v_mfma_f32_16x16x32_bf16 v[76:79], a[136:139], a[36:39], v[76:79]
buffer_load_dwordx4 v3, s[4:7], s20 offen offset:1024  lds
v_mfma_f32_16x16x32_bf16 v[76:79], a[140:143], a[52:55], v[76:79]
ds_read_b64_tr_b16 a[134:135], v17 offset:43136
v_mfma_f32_16x16x32_bf16 v[84:87], a[136:139], a[40:43], v[84:87]
v_mfma_f32_16x16x32_bf16 v[84:87], a[140:143], a[56:59], v[84:87]
v_mfma_f32_16x16x32_bf16 v[92:95], a[136:139], a[44:47], v[92:95]
v_mfma_f32_16x16x32_bf16 v[92:95], a[140:143], a[60:63], v[92:95]
v_mfma_f32_16x16x32_bf16 a[164:167], a[136:139], v[48:51], a[164:167]
v_mfma_f32_16x16x32_bf16 a[164:167], a[140:143], v[48:51], a[164:167]
s_waitcnt lgkmcnt(10)
v_mfma_f32_16x16x32_bf16 v[96:99], a[144:147], a[32:35], v[96:99]
s_waitcnt lgkmcnt(8)
buffer_load_dwordx4 v4, s[4:7], s20 offen offset:2048  lds
v_mfma_f32_16x16x32_bf16 v[96:99], a[148:151], a[48:51], v[96:99]
s_add_u32 s20, s20, 589824
v_mfma_f32_16x16x32_bf16 v[104:107], a[144:147], a[36:39], v[104:107]
v_mfma_f32_16x16x32_bf16 v[104:107], a[148:151], a[52:55], v[104:107]
v_mfma_f32_16x16x32_bf16 v[112:115], a[144:147], a[40:43], v[112:115]
v_mfma_f32_16x16x32_bf16 v[112:115], a[148:151], a[56:59], v[112:115]
v_mfma_f32_16x16x32_bf16 v[120:123], a[144:147], a[44:47], v[120:123]
v_mfma_f32_16x16x32_bf16 v[120:123], a[148:151], a[60:63], v[120:123]
v_mfma_f32_16x16x32_bf16 a[168:171], a[144:147], v[48:51], a[168:171]
v_mfma_f32_16x16x32_bf16 a[168:171], a[148:151], v[48:51], a[168:171]
s_waitcnt vmcnt(4)
v_cmp_ne_u32 vcc, s40, v43
s_nop 1
s_cbranch_vccnz L_spin_xn
L_back_xn:
s_waitcnt lgkmcnt(6)
v_mfma_f32_16x16x32_bf16 v[100:103], a[152:155], a[32:35], v[100:103]
s_waitcnt lgkmcnt(4)
buffer_load_dwordx4 a[64:67], v1, s[12:15], s27 offen offset:0 sc1
v_mfma_f32_16x16x32_bf16 v[100:103], a[156:159], a[48:51], v[100:103]
ds_read_b64_tr_b16 a[136:137], v17 offset:24712
v_mfma_f32_16x16x32_bf16 v[108:111], a[152:155], a[36:39], v[108:111]
ds_read_b64_tr_b16 a[138:139], v17 offset:30856
v_mfma_f32_16x16x32_bf16 v[108:111], a[156:159], a[52:55], v[108:111]
buffer_load_dwordx4 a[68:71], v1, s[12:15], s27 offen offset:1024 sc1
v_mfma_f32_16x16x32_bf16 v[116:119], a[152:155], a[40:43], v[116:119]
ds_read_b64_tr_b16 a[140:141], v17 offset:37000
v_mfma_f32_16x16x32_bf16 v[116:119], a[156:159], a[56:59], v[116:119]
ds_read_b64_tr_b16 a[142:143], v17 offset:43144
v_mfma_f32_16x16x32_bf16 v[124:127], a[152:155], a[44:47], v[124:127]
ds_read_b64_tr_b16 a[144:145], v18 offset:24704
v_mfma_f32_16x16x32_bf16 v[124:127], a[156:159], a[60:63], v[124:127]
buffer_load_dwordx4 a[72:75], v1, s[12:15], s27 offen offset:2048 sc1
v_mfma_f32_16x16x32_bf16 a[172:175], a[152:155], v[48:51], a[172:175]
ds_read_b64_tr_b16 a[146:147], v18 offset:30848
v_mfma_f32_16x16x32_bf16 a[172:175], a[156:159], v[48:51], a[172:175]
s_waitcnt lgkmcnt(8)
ds_read_b64_tr_b16 a[148:149], v18 offset:36992
v_mfma_f32_16x16x32_bf16 v[128:131], a[128:131], a[32:35], v[128:131]
s_waitcnt lgkmcnt(7)
buffer_load_dwordx4 a[76:79], v1, s[12:15], s27 offen offset:3072 sc1
v_mfma_f32_16x16x32_bf16 v[128:131], a[132:135], a[48:51], v[128:131]
s_add_u32 s27, s27, 4096
ds_read_b64_tr_b16 a[150:151], v18 offset:43136
v_mfma_f32_16x16x32_bf16 v[136:139], a[128:131], a[36:39], v[136:139]
ds_read_b64_tr_b16 a[152:153], v18 offset:24712
v_mfma_f32_16x16x32_bf16 v[136:139], a[132:135], a[52:55], v[136:139]
ds_read_b64_tr_b16 a[154:155], v18 offset:30856
v_mfma_f32_16x16x32_bf16 v[144:147], a[128:131], a[40:43], v[144:147]
buffer_load_dwordx4 a[80:83], v1, s[12:15], s27 offen offset:0 sc1
v_mfma_f32_16x16x32_bf16 v[144:147], a[132:135], a[56:59], v[144:147]
ds_read_b64_tr_b16 a[156:157], v18 offset:37000
v_mfma_f32_16x16x32_bf16 v[152:155], a[128:131], a[44:47], v[152:155]
ds_read_b64_tr_b16 a[158:159], v18 offset:43144
v_mfma_f32_16x16x32_bf16 v[152:155], a[132:135], a[60:63], v[152:155]
buffer_load_dwordx4 a[84:87], v1, s[12:15], s27 offen offset:1024 sc1
v_mfma_f32_16x16x32_bf16 a[176:179], a[128:131], v[48:51], a[176:179]
ds_read_b64_tr_b16 a[128:129], v17 offset:24832
v_mfma_f32_16x16x32_bf16 a[176:179], a[132:135], v[48:51], a[176:179]
s_waitcnt lgkmcnt(11)
ds_read_b64_tr_b16 a[130:131], v17 offset:30976
v_mfma_f32_16x16x32_bf16 v[132:135], a[136:139], a[32:35], v[132:135]
s_waitcnt lgkmcnt(10)
ds_read_b64_tr_b16 a[132:133], v17 offset:37120
v_mfma_f32_16x16x32_bf16 v[132:135], a[140:143], a[48:51], v[132:135]
buffer_load_dwordx4 a[88:91], v1, s[12:15], s27 offen offset:2048 sc1
v_mfma_f32_16x16x32_bf16 v[140:143], a[136:139], a[36:39], v[140:143]
ds_read_b64_tr_b16 a[134:135], v17 offset:43264
v_mfma_f32_16x16x32_bf16 v[140:143], a[140:143], a[52:55], v[140:143]
v_mfma_f32_16x16x32_bf16 v[148:151], a[136:139], a[40:43], v[148:151]
buffer_load_dwordx4 a[92:95], v1, s[12:15], s27 offen offset:3072 sc1
v_mfma_f32_16x16x32_bf16 v[148:151], a[140:143], a[56:59], v[148:151]
s_add_u32 s27, s27, 4096
v_mfma_f32_16x16x32_bf16 v[156:159], a[136:139], a[44:47], v[156:159]
v_mfma_f32_16x16x32_bf16 v[156:159], a[140:143], a[60:63], v[156:159]
v_mfma_f32_16x16x32_bf16 a[180:183], a[136:139], v[48:51], a[180:183]
buffer_load_dwordx4 a[96:99], v1, s[12:15], s27 offen offset:0 sc1
v_mfma_f32_16x16x32_bf16 a[180:183], a[140:143], v[48:51], a[180:183]
s_waitcnt lgkmcnt(10)
ds_read_b64_tr_b16 a[136:137], v17 offset:24840
v_mfma_f32_16x16x32_bf16 v[160:163], a[144:147], a[32:35], v[160:163]
s_waitcnt lgkmcnt(9)
ds_read_b64_tr_b16 a[138:139], v17 offset:30984
v_mfma_f32_16x16x32_bf16 v[160:163], a[148:151], a[48:51], v[160:163]
buffer_load_dwordx4 a[100:103], v1, s[12:15], s27 offen offset:1024 sc1
v_mfma_f32_16x16x32_bf16 v[168:171], a[144:147], a[36:39], v[168:171]
ds_read_b64_tr_b16 a[140:141], v17 offset:37128
v_mfma_f32_16x16x32_bf16 v[168:171], a[148:151], a[52:55], v[168:171]
ds_read_b64_tr_b16 a[142:143], v17 offset:43272
v_add_u32 v17, 0xfffe4000, v17
v_mfma_f32_16x16x32_bf16 v[176:179], a[144:147], a[40:43], v[176:179]
v_mfma_f32_16x16x32_bf16 v[176:179], a[148:151], a[56:59], v[176:179]
buffer_load_dwordx4 a[104:107], v1, s[12:15], s27 offen offset:2048 sc1
v_mfma_f32_16x16x32_bf16 v[184:187], a[144:147], a[44:47], v[184:187]
v_mfma_f32_16x16x32_bf16 v[184:187], a[148:151], a[60:63], v[184:187]
v_mfma_f32_16x16x32_bf16 a[184:187], a[144:147], v[48:51], a[184:187]
buffer_load_dwordx4 a[108:111], v1, s[12:15], s27 offen offset:3072 sc1
v_mfma_f32_16x16x32_bf16 a[184:187], a[148:151], v[48:51], a[184:187]
s_waitcnt lgkmcnt(10)
ds_read_b64_tr_b16 a[144:145], v18 offset:24832
v_mfma_f32_16x16x32_bf16 v[164:167], a[152:155], a[32:35], v[164:167]
s_waitcnt lgkmcnt(9)
ds_read_b64_tr_b16 a[146:147], v18 offset:30976
v_mfma_f32_16x16x32_bf16 v[164:167], a[156:159], a[48:51], v[164:167]
s_add_u32 s27, s27, 4096
ds_read_b64_tr_b16 a[148:149], v18 offset:37120
v_mfma_f32_16x16x32_bf16 v[172:175], a[152:155], a[36:39], v[172:175]
buffer_load_dwordx4 a[112:115], v1, s[12:15], s27 offen offset:0 sc1
v_mfma_f32_16x16x32_bf16 v[172:175], a[156:159], a[52:55], v[172:175]
ds_read_b64_tr_b16 a[150:151], v18 offset:43264
v_mfma_f32_16x16x32_bf16 v[180:183], a[152:155], a[40:43], v[180:183]
v_mfma_f32_16x16x32_bf16 v[180:183], a[156:159], a[56:59], v[180:183]
buffer_load_dwordx4 a[116:119], v1, s[12:15], s27 offen offset:1024 sc1
v_mfma_f32_16x16x32_bf16 v[188:191], a[152:155], a[44:47], v[188:191]
v_mfma_f32_16x16x32_bf16 v[188:191], a[156:159], a[60:63], v[188:191]
v_mfma_f32_16x16x32_bf16 a[188:191], a[152:155], v[48:51], a[188:191]
ds_read_b64_tr_b16 a[152:153], v18 offset:24840
v_mfma_f32_16x16x32_bf16 a[188:191], a[156:159], v[48:51], a[188:191]
s_waitcnt lgkmcnt(11)
buffer_load_dwordx4 a[120:123], v1, s[12:15], s27 offen offset:2048 sc1
v_mfma_f32_16x16x32_bf16 v[192:195], a[128:131], a[32:35], v[192:195]
s_waitcnt lgkmcnt(9)
ds_read_b64_tr_b16 a[154:155], v18 offset:30984
v_mfma_f32_16x16x32_bf16 v[192:195], a[132:135], a[48:51], v[192:195]
ds_read_b64_tr_b16 a[156:157], v18 offset:37128
v_mfma_f32_16x16x32_bf16 v[200:203], a[128:131], a[36:39], v[200:203]
buffer_load_dwordx4 a[124:127], v1, s[12:15], s27 offen offset:3072 sc1
v_mfma_f32_16x16x32_bf16 v[200:203], a[132:135], a[52:55], v[200:203]
s_add_u32 s27, s27, 4096
ds_read_b64_tr_b16 a[158:159], v18 offset:43272
v_mfma_f32_16x16x32_bf16 v[208:211], a[128:131], a[40:43], v[208:211]
v_mfma_f32_16x16x32_bf16 v[208:211], a[132:135], a[56:59], v[208:211]
v_mfma_f32_16x16x32_bf16 v[216:219], a[128:131], a[44:47], v[216:219]
v_mfma_f32_16x16x32_bf16 v[216:219], a[132:135], a[60:63], v[216:219]
v_mfma_f32_16x16x32_bf16 a[192:195], a[128:131], v[48:51], a[192:195]
v_mfma_f32_16x16x32_bf16 a[192:195], a[132:135], v[48:51], a[192:195]
s_waitcnt lgkmcnt(10)
v_mfma_f32_16x16x32_bf16 v[196:199], a[136:139], a[32:35], v[196:199]
s_waitcnt lgkmcnt(8)
v_mfma_f32_16x16x32_bf16 v[196:199], a[140:143], a[48:51], v[196:199]
v_mfma_f32_16x16x32_bf16 v[204:207], a[136:139], a[36:39], v[204:207]
v_mfma_f32_16x16x32_bf16 v[204:207], a[140:143], a[52:55], v[204:207]
v_mfma_f32_16x16x32_bf16 v[212:215], a[136:139], a[40:43], v[212:215]
v_mfma_f32_16x16x32_bf16 v[212:215], a[140:143], a[56:59], v[212:215]
v_mfma_f32_16x16x32_bf16 v[220:223], a[136:139], a[44:47], v[220:223]
v_mfma_f32_16x16x32_bf16 v[220:223], a[140:143], a[60:63], v[220:223]
v_mfma_f32_16x16x32_bf16 a[196:199], a[136:139], v[48:51], a[196:199]
v_mfma_f32_16x16x32_bf16 a[196:199], a[140:143], v[48:51], a[196:199]
s_waitcnt lgkmcnt(6)
v_mfma_f32_16x16x32_bf16 v[224:227], a[144:147], a[32:35], v[224:227]
s_waitcnt vmcnt(16) lgkmcnt(0)
s_barrier
v_mfma_f32_16x16x32_bf16 v[224:227], a[148:151], a[48:51], v[224:227]
ds_read_b64_tr_b16 a[128:129], v17 offset:0
v_mfma_f32_16x16x32_bf16 v[232:235], a[144:147], a[36:39], v[232:235]
ds_read_b64_tr_b16 a[130:131], v17 offset:6144
v_mfma_f32_16x16x32_bf16 v[232:235], a[148:151], a[52:55], v[232:235]
ds_read_b64_tr_b16 a[132:133], v17 offset:12288
v_mfma_f32_16x16x32_bf16 v[240:243], a[144:147], a[40:43], v[240:243]
ds_read_b64_tr_b16 a[134:135], v17 offset:18432
v_mfma_f32_16x16x32_bf16 v[240:243], a[148:151], a[56:59], v[240:243]
ds_read_b64_tr_b16 a[136:137], v17 offset:24576
v_mfma_f32_16x16x32_bf16 v[248:251], a[144:147], a[44:47], v[248:251]
ds_read_b64_tr_b16 a[138:139], v17 offset:30720
v_mfma_f32_16x16x32_bf16 v[248:251], a[148:151], a[60:63], v[248:251]
ds_read_b64_tr_b16 a[140:141], v17 offset:36864
v_mfma_f32_16x16x32_bf16 a[200:203], a[144:147], v[48:51], a[200:203]
ds_read_b64_tr_b16 a[142:143], v17 offset:43008
v_mfma_f32_16x16x32_bf16 a[200:203], a[148:151], v[48:51], a[200:203]
v_mfma_f32_16x16x32_bf16 v[228:231], a[152:155], a[32:35], v[228:231]
v_mfma_f32_16x16x32_bf16 v[228:231], a[156:159], a[48:51], v[228:231]
v_mfma_f32_16x16x32_bf16 v[236:239], a[152:155], a[36:39], v[236:239]
v_mfma_f32_16x16x32_bf16 v[236:239], a[156:159], a[52:55], v[236:239]
v_mfma_f32_16x16x32_bf16 v[244:247], a[152:155], a[40:43], v[244:247]
v_mfma_f32_16x16x32_bf16 v[244:247], a[156:159], a[56:59], v[244:247]
v_mfma_f32_16x16x32_bf16 v[252:255], a[152:155], a[44:47], v[252:255]
v_mfma_f32_16x16x32_bf16 v[252:255], a[156:159], a[60:63], v[252:255]
v_mfma_f32_16x16x32_bf16 a[204:207], a[152:155], v[48:51], a[204:207]
v_mfma_f32_16x16x32_bf16 a[204:207], a[156:159], v[48:51], a[204:207]
s_waitcnt vmcnt(15) lgkmcnt(6)
v_mfma_f32_16x16x32_bf16 v[64:67], a[128:131], a[64:67], v[64:67]
s_waitcnt vmcnt(11) lgkmcnt(4)
s_add_u32 m0, s24, 114688
ds_read_b64_tr_b16 a[144:145], v17 offset:8
v_add_u32 v18, 0xfffe4000, v18
v_mfma_f32_16x16x32_bf16 v[64:67], a[132:135], a[80:83], v[64:67]
s_waitcnt vmcnt(7) lgkmcnt(3)
s_and_b32 s33, s2, 7
buffer_load_dwordx4 v2, s[4:7], s20 offen offset:0  lds
v_mfma_f32_16x16x32_bf16 v[64:67], a[136:139], a[96:99], v[64:67]
s_waitcnt vmcnt(4) lgkmcnt(1)
s_lshr_b32 s52, s2, 3
ds_read_b64_tr_b16 a[146:147], v17 offset:6152
v_mfma_f32_16x16x32_bf16 v[64:67], a[140:143], a[112:115], v[64:67]
s_and_b32 s100, s33, 1
ds_read_b64_tr_b16 a[148:149], v17 offset:12296
v_mfma_f32_16x16x32_bf16 v[72:75], a[128:131], a[68:71], v[72:75]
s_lshl_b32 s100, s100, 2
ds_read_b64_tr_b16 a[150:151], v17 offset:18440
v_mfma_f32_16x16x32_bf16 v[72:75], a[132:135], a[84:87], v[72:75]
s_lshr_b32 s101, s52, 3
ds_read_b64_tr_b16 a[152:153], v17 offset:24584
v_mfma_f32_16x16x32_bf16 v[72:75], a[136:139], a[100:103], v[72:75]
s_waitcnt vmcnt(3)
s_add_u32 s100, s100, s101
buffer_load_dwordx4 v3, s[4:7], s20 offen offset:1024  lds
v_mfma_f32_16x16x32_bf16 v[72:75], a[140:143], a[116:119], v[72:75]
s_lshl2_add_u32 s100, s100, s30
ds_read_b64_tr_b16 a[154:155], v17 offset:30728
v_mfma_f32_16x16x32_bf16 v[80:83], a[128:131], a[72:75], v[80:83]
s_lshr_b32 s101, s33, 1
ds_read_b64_tr_b16 a[156:157], v17 offset:36872
v_mfma_f32_16x16x32_bf16 v[80:83], a[132:135], a[88:91], v[80:83]
s_lshl_b32 s101, s101, 3
ds_read_b64_tr_b16 a[158:159], v17 offset:43016
v_mfma_f32_16x16x32_bf16 v[80:83], a[136:139], a[104:107], v[80:83]
s_waitcnt vmcnt(3)
s_mul_i32 s33, s54, 983040
v_mfma_f32_16x16x32_bf16 v[80:83], a[140:143], a[120:123], v[80:83]
s_mul_i32 s58, s30, 5120
buffer_load_dwordx4 v4, s[4:7], s20 offen offset:2048  lds
v_mfma_f32_16x16x32_bf16 v[88:91], a[128:131], a[76:79], v[88:91]
s_add_u32 s20, s20, 196608
ds_read_b64_tr_b16 a[128:129], v18 offset:0
v_mfma_f32_16x16x32_bf16 v[88:91], a[132:135], a[92:95], v[88:91]
s_add_u32 m0, s24, 117760
ds_read_b64_tr_b16 a[130:131], v18 offset:6144
v_mfma_f32_16x16x32_bf16 v[88:91], a[136:139], a[108:111], v[88:91]
s_waitcnt vmcnt(3)
s_and_b32 s52, s52, 7
ds_read_b64_tr_b16 a[132:133], v18 offset:12288
v_mfma_f32_16x16x32_bf16 v[88:91], a[140:143], a[124:127], v[88:91]
s_waitcnt lgkmcnt(9)
ds_read_b64_tr_b16 a[134:135], v18 offset:18432
v_mfma_f32_16x16x32_bf16 v[68:71], a[144:147], a[64:67], v[68:71]
s_waitcnt lgkmcnt(8)
ds_read_b64_tr_b16 a[136:137], v18 offset:24576
v_mfma_f32_16x16x32_bf16 v[68:71], a[148:151], a[80:83], v[68:71]
s_waitcnt lgkmcnt(7)
buffer_load_dwordx4 v2, s[4:7], s20 offen offset:0  lds
v_mfma_f32_16x16x32_bf16 v[68:71], a[152:155], a[96:99], v[68:71]
s_waitcnt lgkmcnt(5)
ds_read_b64_tr_b16 a[138:139], v18 offset:30720
v_mfma_f32_16x16x32_bf16 v[68:71], a[156:159], a[112:115], v[68:71]
s_add_u32 s101, s101, s52
ds_read_b64_tr_b16 a[140:141], v18 offset:36864
v_mfma_f32_16x16x32_bf16 v[76:79], a[144:147], a[68:71], v[76:79]
s_mul_i32 s36, s101, 122880
ds_read_b64_tr_b16 a[142:143], v18 offset:43008
v_mfma_f32_16x16x32_bf16 v[76:79], a[148:151], a[84:87], v[76:79]
s_add_u32 s36, s36, s24
v_mfma_f32_16x16x32_bf16 v[76:79], a[152:155], a[100:103], v[76:79]
s_add_u32 s36, s36, 0x2200000
buffer_load_dwordx4 v3, s[4:7], s20 offen offset:1024  lds
v_mfma_f32_16x16x32_bf16 v[76:79], a[156:159], a[116:119], v[76:79]
s_lshl_b32 s26, s30, 10
v_mfma_f32_16x16x32_bf16 v[84:87], a[144:147], a[72:75], v[84:87]
s_lshl_b32 s59, s30, 12
v_mfma_f32_16x16x32_bf16 v[84:87], a[148:151], a[88:91], v[84:87]
s_mul_i32 s52, s28, 24576
v_mfma_f32_16x16x32_bf16 v[84:87], a[152:155], a[104:107], v[84:87]
v_mfma_f32_16x16x32_bf16 v[84:87], a[156:159], a[120:123], v[84:87]
buffer_load_dwordx4 v4, s[4:7], s20 offen offset:2048  lds
v_mfma_f32_16x16x32_bf16 v[92:95], a[144:147], a[76:79], v[92:95]
s_add_u32 s20, s20, 589824
ds_read_b64_tr_b16 a[144:145], v18 offset:8
v_mfma_f32_16x16x32_bf16 v[92:95], a[148:151], a[92:95], v[92:95]
s_add_u32 m0, s24, 139264
ds_read_b64_tr_b16 a[146:147], v18 offset:6152
v_mfma_f32_16x16x32_bf16 v[92:95], a[152:155], a[108:111], v[92:95]
s_add_u32 s33, s33, 0x400000
ds_read_b64_tr_b16 a[148:149], v18 offset:12296
v_mfma_f32_16x16x32_bf16 v[92:95], a[156:159], a[124:127], v[92:95]
s_waitcnt lgkmcnt(9)
ds_read_b64_tr_b16 a[150:151], v18 offset:18440
v_mfma_f32_16x16x32_bf16 v[96:99], a[128:131], a[64:67], v[96:99]
s_waitcnt lgkmcnt(8)
ds_read_b64_tr_b16 a[152:153], v18 offset:24584
v_mfma_f32_16x16x32_bf16 v[96:99], a[132:135], a[80:83], v[96:99]
s_waitcnt lgkmcnt(7)
buffer_load_dwordx4 v2, s[4:7], s20 offen offset:0  lds
v_mfma_f32_16x16x32_bf16 v[96:99], a[136:139], a[96:99], v[96:99]
s_waitcnt lgkmcnt(5)
ds_read_b64_tr_b16 a[154:155], v18 offset:30728
v_mfma_f32_16x16x32_bf16 v[96:99], a[140:143], a[112:115], v[96:99]
s_add_u32 s34, s33, s52
ds_read_b64_tr_b16 a[156:157], v18 offset:36872
v_mfma_f32_16x16x32_bf16 v[104:107], a[128:131], a[68:71], v[104:107]
s_mul_i32 s33, s100, 983040
ds_read_b64_tr_b16 a[158:159], v18 offset:43016
v_mfma_f32_16x16x32_bf16 v[104:107], a[132:135], a[84:87], v[104:107]
s_mul_i32 s52, s101, 3
v_mfma_f32_16x16x32_bf16 v[104:107], a[136:139], a[100:103], v[104:107]
s_add_u32 s33, s33, 0x4c0000
buffer_load_dwordx4 v3, s[4:7], s20 offen offset:1024  lds
v_mfma_f32_16x16x32_bf16 v[104:107], a[140:143], a[116:119], v[104:107]
s_lshr_b32 s51, s52, 1
v_mfma_f32_16x16x32_bf16 v[112:115], a[128:131], a[72:75], v[112:115]
s_lshl_b32 s51, s51, 12
v_mfma_f32_16x16x32_bf16 v[112:115], a[132:135], a[88:91], v[112:115]
s_add_u32 s37, s33, s51
v_mfma_f32_16x16x32_bf16 v[112:115], a[136:139], a[104:107], v[112:115]
v_mfma_f32_16x16x32_bf16 v[112:115], a[140:143], a[120:123], v[112:115]
buffer_load_dwordx4 v4, s[4:7], s20 offen offset:2048  lds
v_mfma_f32_16x16x32_bf16 v[120:123], a[128:131], a[76:79], v[120:123]
s_add_u32 s20, s20, 196608
ds_read_b64_tr_b16 a[128:129], v17 offset:128
v_mfma_f32_16x16x32_bf16 v[120:123], a[132:135], a[92:95], v[120:123]
s_add_u32 m0, s24, 142336
ds_read_b64_tr_b16 a[130:131], v17 offset:6272
v_mfma_f32_16x16x32_bf16 v[120:123], a[136:139], a[108:111], v[120:123]
s_and_b32 s51, s52, 1
ds_read_b64_tr_b16 a[132:133], v17 offset:12416
v_mfma_f32_16x16x32_bf16 v[120:123], a[140:143], a[124:127], v[120:123]
s_waitcnt lgkmcnt(9)
ds_read_b64_tr_b16 a[134:135], v17 offset:18560
v_mfma_f32_16x16x32_bf16 v[100:103], a[144:147], a[64:67], v[100:103]
s_waitcnt lgkmcnt(8)
ds_read_b64_tr_b16 a[136:137], v17 offset:24704
v_mfma_f32_16x16x32_bf16 v[100:103], a[148:151], a[80:83], v[100:103]
s_waitcnt lgkmcnt(7)
buffer_load_dwordx4 v2, s[4:7], s20 offen offset:0  lds
v_mfma_f32_16x16x32_bf16 v[100:103], a[152:155], a[96:99], v[100:103]
s_waitcnt lgkmcnt(5)
ds_read_b64_tr_b16 a[138:139], v17 offset:30848
v_mfma_f32_16x16x32_bf16 v[100:103], a[156:159], a[112:115], v[100:103]
s_lshl_b32 s51, s51, 9
ds_read_b64_tr_b16 a[140:141], v17 offset:36992
v_mfma_f32_16x16x32_bf16 v[108:111], a[144:147], a[68:71], v[108:111]
s_add_u32 s37, s37, s51
ds_read_b64_tr_b16 a[142:143], v17 offset:43136
v_mfma_f32_16x16x32_bf16 v[108:111], a[148:151], a[84:87], v[108:111]
s_add_u32 s52, s52, 1
v_mfma_f32_16x16x32_bf16 v[108:111], a[152:155], a[100:103], v[108:111]
s_lshr_b32 s51, s52, 1
buffer_load_dwordx4 v3, s[4:7], s20 offen offset:1024  lds
v_mfma_f32_16x16x32_bf16 v[108:111], a[156:159], a[116:119], v[108:111]
s_lshl_b32 s51, s51, 12
v_mfma_f32_16x16x32_bf16 v[116:119], a[144:147], a[72:75], v[116:119]
s_add_u32 s38, s33, s51
v_mfma_f32_16x16x32_bf16 v[116:119], a[148:151], a[88:91], v[116:119]
s_and_b32 s51, s52, 1
v_mfma_f32_16x16x32_bf16 v[116:119], a[152:155], a[104:107], v[116:119]
s_lshl_b32 s51, s51, 9
v_mfma_f32_16x16x32_bf16 v[116:119], a[156:159], a[120:123], v[116:119]
buffer_load_dwordx4 v4, s[4:7], s20 offen offset:2048  lds
v_mfma_f32_16x16x32_bf16 v[124:127], a[144:147], a[76:79], v[124:127]
s_add_u32 s20, s20, 589824
ds_read_b64_tr_b16 a[144:145], v17 offset:136
v_mfma_f32_16x16x32_bf16 v[124:127], a[148:151], a[92:95], v[124:127]
s_add_u32 s38, s38, s51
ds_read_b64_tr_b16 a[146:147], v17 offset:6280
v_mfma_f32_16x16x32_bf16 v[124:127], a[152:155], a[108:111], v[124:127]
s_add_u32 s52, s52, 1
ds_read_b64_tr_b16 a[148:149], v17 offset:12424
v_mfma_f32_16x16x32_bf16 v[124:127], a[156:159], a[124:127], v[124:127]
s_waitcnt lgkmcnt(9)
ds_read_b64_tr_b16 a[150:151], v17 offset:18568
v_mfma_f32_16x16x32_bf16 v[128:131], a[128:131], a[64:67], v[128:131]
s_waitcnt lgkmcnt(8)
ds_read_b64_tr_b16 a[152:153], v17 offset:24712
v_mfma_f32_16x16x32_bf16 v[128:131], a[132:135], a[80:83], v[128:131]
s_waitcnt lgkmcnt(7)
buffer_load_dwordx2 v[40:41], v32, s[12:15], s35 offen offset:0 sc1
v_mfma_f32_16x16x32_bf16 v[128:131], a[136:139], a[96:99], v[128:131]
s_waitcnt lgkmcnt(5)
ds_read_b64_tr_b16 a[154:155], v17 offset:30856
v_mfma_f32_16x16x32_bf16 v[128:131], a[140:143], a[112:115], v[128:131]
s_lshr_b32 s51, s52, 1
ds_read_b64_tr_b16 a[156:157], v17 offset:37000
v_mfma_f32_16x16x32_bf16 v[136:139], a[128:131], a[68:71], v[136:139]
s_lshl_b32 s51, s51, 12
ds_read_b64_tr_b16 a[158:159], v17 offset:43144
v_mfma_f32_16x16x32_bf16 v[136:139], a[132:135], a[84:87], v[136:139]
s_add_u32 s39, s33, s51
v_mfma_f32_16x16x32_bf16 v[136:139], a[136:139], a[100:103], v[136:139]
s_and_b32 s51, s52, 1
buffer_load_dwordx2 v[42:43], v32, s[12:15], s35 offen offset:128 sc1
v_mfma_f32_16x16x32_bf16 v[136:139], a[140:143], a[116:119], v[136:139]
s_lshl_b32 s51, s51, 9
v_mfma_f32_16x16x32_bf16 v[144:147], a[128:131], a[72:75], v[144:147]
s_add_u32 s39, s39, s51
v_mfma_f32_16x16x32_bf16 v[144:147], a[132:135], a[88:91], v[144:147]
s_add_u32 s52, s52, 1
v_mfma_f32_16x16x32_bf16 v[144:147], a[136:139], a[104:107], v[144:147]
s_sub_u32 s33, s2, 240
v_mfma_f32_16x16x32_bf16 v[144:147], a[140:143], a[120:123], v[144:147]
s_min_u32 s33, s2, s33
buffer_load_dwordx2 v[44:45], v32, s[12:15], s35 offen offset:256 sc1
v_mfma_f32_16x16x32_bf16 v[152:155], a[128:131], a[76:79], v[152:155]
s_mul_i32 s52, s33, 6554
ds_read_b64_tr_b16 a[128:129], v18 offset:128
v_mfma_f32_16x16x32_bf16 v[152:155], a[132:135], a[92:95], v[152:155]
s_lshr_b32 s52, s52, 16
ds_read_b64_tr_b16 a[130:131], v18 offset:6272
v_mfma_f32_16x16x32_bf16 v[152:155], a[136:139], a[108:111], v[152:155]
s_mul_i32 s51, s52, 10
ds_read_b64_tr_b16 a[132:133], v18 offset:12416
v_mfma_f32_16x16x32_bf16 v[152:155], a[140:143], a[124:127], v[152:155]
s_waitcnt lgkmcnt(9)
ds_read_b64_tr_b16 a[134:135], v18 offset:18560
v_mfma_f32_16x16x32_bf16 v[132:135], a[144:147], a[64:67], v[132:135]
s_waitcnt lgkmcnt(8)
ds_read_b64_tr_b16 a[136:137], v18 offset:24704
v_mfma_f32_16x16x32_bf16 v[132:135], a[148:151], a[80:83], v[132:135]
s_waitcnt lgkmcnt(7)
buffer_load_dwordx2 v[46:47], v32, s[12:15], s35 offen offset:384 sc1
v_mfma_f32_16x16x32_bf16 v[132:135], a[152:155], a[96:99], v[132:135]
s_waitcnt lgkmcnt(5)
ds_read_b64_tr_b16 a[138:139], v18 offset:30848
v_mfma_f32_16x16x32_bf16 v[132:135], a[156:159], a[112:115], v[132:135]
s_sub_u32 s51, s33, s51
ds_read_b64_tr_b16 a[140:141], v18 offset:36992
v_mfma_f32_16x16x32_bf16 v[140:143], a[144:147], a[68:71], v[140:143]
s_lshl_b32 s43, s52, 8
ds_read_b64_tr_b16 a[142:143], v18 offset:43136
v_mfma_f32_16x16x32_bf16 v[140:143], a[148:151], a[84:87], v[140:143]
s_lshl3_add_u32 s43, s30, s43
v_mfma_f32_16x16x32_bf16 v[140:143], a[152:155], a[100:103], v[140:143]
s_mul_i32 s43, s43, 1280
buffer_load_dwordx4 a[0:3], v1, s[12:15], s27 offen offset:0 sc1
v_mfma_f32_16x16x32_bf16 v[140:143], a[156:159], a[116:119], v[140:143]
s_lshl_b32 s50, s51, 7
v_mfma_f32_16x16x32_bf16 v[148:151], a[144:147], a[72:75], v[148:151]
s_add_u32 s43, s43, s50
v_mfma_f32_16x16x32_bf16 v[148:151], a[148:151], a[88:91], v[148:151]
s_lshl_b32 s44, s52, 6
v_mfma_f32_16x16x32_bf16 v[148:151], a[152:155], a[104:107], v[148:151]
s_lshl4_add_u32 s44, s32, s44
v_mfma_f32_16x16x32_bf16 v[148:151], a[156:159], a[120:123], v[148:151]
s_lshl3_add_u32 s44, s31, s44
buffer_load_dwordx4 a[4:7], v1, s[12:15], s27 offen offset:1024 sc1
v_mfma_f32_16x16x32_bf16 v[156:159], a[144:147], a[76:79], v[156:159]
s_mul_i32 s44, s44, 1280
ds_read_b64_tr_b16 a[144:145], v18 offset:136
v_mfma_f32_16x16x32_bf16 v[156:159], a[148:151], a[92:95], v[156:159]
ds_read_b64_tr_b16 a[146:147], v18 offset:6280
v_mfma_f32_16x16x32_bf16 v[156:159], a[152:155], a[108:111], v[156:159]
ds_read_b64_tr_b16 a[148:149], v18 offset:12424
v_mfma_f32_16x16x32_bf16 v[156:159], a[156:159], a[124:127], v[156:159]
s_waitcnt lgkmcnt(9)
ds_read_b64_tr_b16 a[150:151], v18 offset:18568
v_mfma_f32_16x16x32_bf16 v[160:163], a[128:131], a[64:67], v[160:163]
s_waitcnt lgkmcnt(8)
ds_read_b64_tr_b16 a[152:153], v18 offset:24712
v_mfma_f32_16x16x32_bf16 v[160:163], a[132:135], a[80:83], v[160:163]
s_waitcnt lgkmcnt(7)
buffer_load_dwordx4 a[8:11], v1, s[12:15], s27 offen offset:2048 sc1
v_mfma_f32_16x16x32_bf16 v[160:163], a[136:139], a[96:99], v[160:163]
s_waitcnt lgkmcnt(5)
ds_read_b64_tr_b16 a[154:155], v18 offset:30856
v_mfma_f32_16x16x32_bf16 v[160:163], a[140:143], a[112:115], v[160:163]
ds_read_b64_tr_b16 a[156:157], v18 offset:37000
v_mfma_f32_16x16x32_bf16 v[168:171], a[128:131], a[68:71], v[168:171]
ds_read_b64_tr_b16 a[158:159], v18 offset:43144
v_mfma_f32_16x16x32_bf16 v[168:171], a[132:135], a[84:87], v[168:171]
v_mfma_f32_16x16x32_bf16 v[168:171], a[136:139], a[100:103], v[168:171]
buffer_load_dwordx4 a[12:15], v1, s[12:15], s27 offen offset:3072 sc1
v_mfma_f32_16x16x32_bf16 v[168:171], a[140:143], a[116:119], v[168:171]
s_add_u32 s27, s27, 4096
v_mfma_f32_16x16x32_bf16 v[176:179], a[128:131], a[72:75], v[176:179]
s_add_u32 s44, s44, s50
v_mfma_f32_16x16x32_bf16 v[176:179], a[132:135], a[88:91], v[176:179]
s_lshl2_add_u32 s51, s51, s30
v_mfma_f32_16x16x32_bf16 v[176:179], a[136:139], a[104:107], v[176:179]
s_mul_i32 s50, s51, 6554
v_mfma_f32_16x16x32_bf16 v[176:179], a[140:143], a[120:123], v[176:179]
s_lshr_b32 s50, s50, 16
buffer_load_dwordx4 a[16:19], v1, s[12:15], s27 offen offset:0 sc1
v_mfma_f32_16x16x32_bf16 v[184:187], a[128:131], a[76:79], v[184:187]
s_mul_i32 s53, s50, 10
ds_read_b64_tr_b16 a[128:129], v17 offset:256
v_mfma_f32_16x16x32_bf16 v[184:187], a[132:135], a[92:95], v[184:187]
s_mul_i32 s50, s50, 192
ds_read_b64_tr_b16 a[130:131], v17 offset:6400
v_mfma_f32_16x16x32_bf16 v[184:187], a[136:139], a[108:111], v[184:187]
s_sub_u32 s53, s51, s53
ds_read_b64_tr_b16 a[132:133], v17 offset:12544
v_mfma_f32_16x16x32_bf16 v[184:187], a[140:143], a[124:127], v[184:187]
s_waitcnt lgkmcnt(9)
ds_read_b64_tr_b16 a[134:135], v17 offset:18688
v_mfma_f32_16x16x32_bf16 v[164:167], a[144:147], a[64:67], v[164:167]
s_waitcnt lgkmcnt(8)
ds_read_b64_tr_b16 a[136:137], v17 offset:24832
v_mfma_f32_16x16x32_bf16 v[164:167], a[148:151], a[80:83], v[164:167]
s_waitcnt lgkmcnt(7)
buffer_load_dwordx4 a[20:23], v1, s[12:15], s27 offen offset:1024 sc1
v_mfma_f32_16x16x32_bf16 v[164:167], a[152:155], a[96:99], v[164:167]
s_waitcnt lgkmcnt(5)
ds_read_b64_tr_b16 a[138:139], v17 offset:30976
v_mfma_f32_16x16x32_bf16 v[164:167], a[156:159], a[112:115], v[164:167]
s_lshl3_add_u32 s50, s52, s50
ds_read_b64_tr_b16 a[140:141], v17 offset:37120
v_mfma_f32_16x16x32_bf16 v[172:175], a[144:147], a[68:71], v[172:175]
s_mul_i32 s50, s50, 10
ds_read_b64_tr_b16 a[142:143], v17 offset:43264
v_mfma_f32_16x16x32_bf16 v[172:175], a[148:151], a[84:87], v[172:175]
s_add_u32 s50, s50, s53
v_mfma_f32_16x16x32_bf16 v[172:175], a[152:155], a[100:103], v[172:175]
s_lshl_b32 s50, s50, 10
buffer_load_dwordx4 a[24:27], v1, s[12:15], s27 offen offset:2048 sc1
v_mfma_f32_16x16x32_bf16 v[172:175], a[156:159], a[116:119], v[172:175]
s_add_u32 s45, s50, 0x2600000
v_mfma_f32_16x16x32_bf16 v[180:183], a[144:147], a[72:75], v[180:183]
s_mul_i32 s50, s51, 13108
v_mfma_f32_16x16x32_bf16 v[180:183], a[148:151], a[88:91], v[180:183]
v_mfma_f32_16x16x32_bf16 v[180:183], a[152:155], a[104:107], v[180:183]
v_mfma_f32_16x16x32_bf16 v[180:183], a[156:159], a[120:123], v[180:183]
buffer_load_dwordx4 a[28:31], v1, s[12:15], s27 offen offset:3072 sc1
v_mfma_f32_16x16x32_bf16 v[188:191], a[144:147], a[76:79], v[188:191]
s_add_u32 s27, s27, 4096
ds_read_b64_tr_b16 a[144:145], v17 offset:264
v_mfma_f32_16x16x32_bf16 v[188:191], a[148:151], a[92:95], v[188:191]
s_lshr_b32 s50, s50, 16
ds_read_b64_tr_b16 a[146:147], v17 offset:6408
v_mfma_f32_16x16x32_bf16 v[188:191], a[152:155], a[108:111], v[188:191]
s_mul_i32 s53, s50, 5
ds_read_b64_tr_b16 a[148:149], v17 offset:12552
v_mfma_f32_16x16x32_bf16 v[188:191], a[156:159], a[124:127], v[188:191]
s_waitcnt lgkmcnt(9)
ds_read_b64_tr_b16 a[150:151], v17 offset:18696
v_mfma_f32_16x16x32_bf16 v[192:195], a[128:131], a[64:67], v[192:195]
s_waitcnt lgkmcnt(8)
ds_read_b64_tr_b16 a[152:153], v17 offset:24840
v_mfma_f32_16x16x32_bf16 v[192:195], a[132:135], a[80:83], v[192:195]
s_waitcnt lgkmcnt(7)
buffer_load_dwordx4 a[32:35], v1, s[12:15], s27 offen offset:0 sc1
v_mfma_f32_16x16x32_bf16 v[192:195], a[136:139], a[96:99], v[192:195]
s_waitcnt lgkmcnt(5)
ds_read_b64_tr_b16 a[154:155], v17 offset:30984
v_mfma_f32_16x16x32_bf16 v[192:195], a[140:143], a[112:115], v[192:195]
s_mul_i32 s50, s50, 48
ds_read_b64_tr_b16 a[156:157], v17 offset:37128
v_mfma_f32_16x16x32_bf16 v[200:203], a[128:131], a[68:71], v[200:203]
s_sub_u32 s53, s51, s53
ds_read_b64_tr_b16 a[158:159], v17 offset:43272
v_add_u32 v17, 0x1c000, v17
v_mfma_f32_16x16x32_bf16 v[200:203], a[132:135], a[84:87], v[200:203]
s_lshl1_add_u32 s50, s52, s50
v_mfma_f32_16x16x32_bf16 v[200:203], a[136:139], a[100:103], v[200:203]
s_mul_i32 s50, s50, 5
buffer_load_dwordx4 a[36:39], v1, s[12:15], s27 offen offset:1024 sc1
v_mfma_f32_16x16x32_bf16 v[200:203], a[140:143], a[116:119], v[200:203]
s_add_u32 s50, s50, s53
v_mfma_f32_16x16x32_bf16 v[208:211], a[128:131], a[72:75], v[208:211]
s_lshl_b32 s50, s50, 10
v_mfma_f32_16x16x32_bf16 v[208:211], a[132:135], a[88:91], v[208:211]
s_add_u32 s46, s50, 0x2e00000
v_mfma_f32_16x16x32_bf16 v[208:211], a[136:139], a[104:107], v[208:211]
v_mfma_f32_16x16x32_bf16 v[208:211], a[140:143], a[120:123], v[208:211]
buffer_load_dwordx4 a[40:43], v1, s[12:15], s27 offen offset:2048 sc1
v_mfma_f32_16x16x32_bf16 v[216:219], a[128:131], a[76:79], v[216:219]
ds_read_b64_tr_b16 a[128:129], v18 offset:256
v_mfma_f32_16x16x32_bf16 v[216:219], a[132:135], a[92:95], v[216:219]
ds_read_b64_tr_b16 a[130:131], v18 offset:6400
v_mfma_f32_16x16x32_bf16 v[216:219], a[136:139], a[108:111], v[216:219]
ds_read_b64_tr_b16 a[132:133], v18 offset:12544
v_mfma_f32_16x16x32_bf16 v[216:219], a[140:143], a[124:127], v[216:219]
s_waitcnt lgkmcnt(9)
ds_read_b64_tr_b16 a[134:135], v18 offset:18688
v_mfma_f32_16x16x32_bf16 v[196:199], a[144:147], a[64:67], v[196:199]
s_waitcnt lgkmcnt(8)
ds_read_b64_tr_b16 a[136:137], v18 offset:24832
v_mfma_f32_16x16x32_bf16 v[196:199], a[148:151], a[80:83], v[196:199]
s_waitcnt lgkmcnt(7)
buffer_load_dwordx4 a[44:47], v1, s[12:15], s27 offen offset:3072 sc1
v_mfma_f32_16x16x32_bf16 v[196:199], a[152:155], a[96:99], v[196:199]
s_waitcnt lgkmcnt(5)
ds_read_b64_tr_b16 a[138:139], v18 offset:30976
v_mfma_f32_16x16x32_bf16 v[196:199], a[156:159], a[112:115], v[196:199]
s_add_u32 s27, s27, 4096
ds_read_b64_tr_b16 a[140:141], v18 offset:37120
v_mfma_f32_16x16x32_bf16 v[204:207], a[144:147], a[68:71], v[204:207]
ds_read_b64_tr_b16 a[142:143], v18 offset:43264
v_mfma_f32_16x16x32_bf16 v[204:207], a[148:151], a[84:87], v[204:207]
v_mfma_f32_16x16x32_bf16 v[204:207], a[152:155], a[100:103], v[204:207]
buffer_load_dwordx4 a[48:51], v1, s[12:15], s27 offen offset:0 sc1
v_mfma_f32_16x16x32_bf16 v[204:207], a[156:159], a[116:119], v[204:207]
v_mfma_f32_16x16x32_bf16 v[212:215], a[144:147], a[72:75], v[212:215]
v_mfma_f32_16x16x32_bf16 v[212:215], a[148:151], a[88:91], v[212:215]
v_mfma_f32_16x16x32_bf16 v[212:215], a[152:155], a[104:107], v[212:215]
v_mfma_f32_16x16x32_bf16 v[212:215], a[156:159], a[120:123], v[212:215]
buffer_load_dwordx4 a[52:55], v1, s[12:15], s27 offen offset:1024 sc1
v_mfma_f32_16x16x32_bf16 v[220:223], a[144:147], a[76:79], v[220:223]
ds_read_b64_tr_b16 a[144:145], v18 offset:264
v_mfma_f32_16x16x32_bf16 v[220:223], a[148:151], a[92:95], v[220:223]
ds_read_b64_tr_b16 a[146:147], v18 offset:6408
v_mfma_f32_16x16x32_bf16 v[220:223], a[152:155], a[108:111], v[220:223]
ds_read_b64_tr_b16 a[148:149], v18 offset:12552
v_mfma_f32_16x16x32_bf16 v[220:223], a[156:159], a[124:127], v[220:223]
s_waitcnt lgkmcnt(9)
ds_read_b64_tr_b16 a[150:151], v18 offset:18696
v_mfma_f32_16x16x32_bf16 v[224:227], a[128:131], a[64:67], v[224:227]
s_waitcnt lgkmcnt(8)
ds_read_b64_tr_b16 a[152:153], v18 offset:24840
v_mfma_f32_16x16x32_bf16 v[224:227], a[132:135], a[80:83], v[224:227]
s_waitcnt lgkmcnt(7)
buffer_load_dwordx4 a[56:59], v1, s[12:15], s27 offen offset:2048 sc1
v_mfma_f32_16x16x32_bf16 v[224:227], a[136:139], a[96:99], v[224:227]
s_waitcnt lgkmcnt(5)
ds_read_b64_tr_b16 a[154:155], v18 offset:30984
v_mfma_f32_16x16x32_bf16 v[224:227], a[140:143], a[112:115], v[224:227]
ds_read_b64_tr_b16 a[156:157], v18 offset:37128
v_mfma_f32_16x16x32_bf16 v[232:235], a[128:131], a[68:71], v[232:235]
ds_read_b64_tr_b16 a[158:159], v18 offset:43272
v_mfma_f32_16x16x32_bf16 v[232:235], a[132:135], a[84:87], v[232:235]
v_mfma_f32_16x16x32_bf16 v[232:235], a[136:139], a[100:103], v[232:235]
buffer_load_dwordx4 a[60:63], v1, s[12:15], s27 offen offset:3072 sc1
v_mfma_f32_16x16x32_bf16 v[232:235], a[140:143], a[116:119], v[232:235]
s_add_u32 s27, s27, 4096
v_mfma_f32_16x16x32_bf16 v[240:243], a[128:131], a[72:75], v[240:243]
v_mfma_f32_16x16x32_bf16 v[240:243], a[132:135], a[88:91], v[240:243]
v_mfma_f32_16x16x32_bf16 v[240:243], a[136:139], a[104:107], v[240:243]
v_mfma_f32_16x16x32_bf16 v[240:243], a[140:143], a[120:123], v[240:243]
v_mfma_f32_16x16x32_bf16 v[248:251], a[128:131], a[76:79], v[248:251]
v_mfma_f32_16x16x32_bf16 v[248:251], a[132:135], a[92:95], v[248:251]
v_mfma_f32_16x16x32_bf16 v[248:251], a[136:139], a[108:111], v[248:251]
v_mfma_f32_16x16x32_bf16 v[248:251], a[140:143], a[124:127], v[248:251]
s_waitcnt vmcnt(20) lgkmcnt(0)
s_barrier
v_mfma_f32_16x16x32_bf16 v[228:231], a[144:147], a[64:67], v[228:231]
ds_read_b64_tr_b16 a[128:129], v17 offset:0
v_mfma_f32_16x16x32_bf16 v[228:231], a[148:151], a[80:83], v[228:231]
ds_read_b64_tr_b16 a[130:131], v17 offset:6144
v_mfma_f32_16x16x32_bf16 v[228:231], a[152:155], a[96:99], v[228:231]
ds_read_b64_tr_b16 a[132:133], v17 offset:12288
v_mfma_f32_16x16x32_bf16 v[228:231], a[156:159], a[112:115], v[228:231]
ds_read_b64_tr_b16 a[134:135], v17 offset:18432
v_mfma_f32_16x16x32_bf16 v[236:239], a[144:147], a[68:71], v[236:239]
ds_read_b64_tr_b16 a[136:137], v17 offset:24576
v_mfma_f32_16x16x32_bf16 v[236:239], a[148:151], a[84:87], v[236:239]
ds_read_b64_tr_b16 a[138:139], v17 offset:30720
v_mfma_f32_16x16x32_bf16 v[236:239], a[152:155], a[100:103], v[236:239]
ds_read_b64_tr_b16 a[140:141], v17 offset:36864
v_mfma_f32_16x16x32_bf16 v[236:239], a[156:159], a[116:119], v[236:239]
ds_read_b64_tr_b16 a[142:143], v17 offset:43008
v_mfma_f32_16x16x32_bf16 v[244:247], a[144:147], a[72:75], v[244:247]
v_mfma_f32_16x16x32_bf16 v[244:247], a[148:151], a[88:91], v[244:247]
v_mfma_f32_16x16x32_bf16 v[244:247], a[152:155], a[104:107], v[244:247]
v_mfma_f32_16x16x32_bf16 v[244:247], a[156:159], a[120:123], v[244:247]
v_mfma_f32_16x16x32_bf16 v[252:255], a[144:147], a[76:79], v[252:255]
v_mfma_f32_16x16x32_bf16 v[252:255], a[148:151], a[92:95], v[252:255]
v_mfma_f32_16x16x32_bf16 v[252:255], a[152:155], a[108:111], v[252:255]
v_mfma_f32_16x16x32_bf16 v[252:255], a[156:159], a[124:127], v[252:255]
s_waitcnt vmcnt(15) lgkmcnt(6)
v_mfma_f32_16x16x32_bf16 v[64:67], a[128:131], a[0:3], v[64:67]
s_waitcnt vmcnt(11) lgkmcnt(4)
s_add_u32 m0, s24, 0
ds_read_b64_tr_b16 a[144:145], v17 offset:8
v_add_u32 v18, 0x1c000, v18
v_mfma_f32_16x16x32_bf16 v[64:67], a[132:135], a[16:19], v[64:67]
s_waitcnt vmcnt(7) lgkmcnt(3)
s_mul_i32 s52, s33, 1366
buffer_load_dwordx4 v2, s[4:7], s20 offen offset:0  lds
v_mfma_f32_16x16x32_bf16 v[64:67], a[136:139], a[32:35], v[64:67]
s_waitcnt vmcnt(4) lgkmcnt(1)
s_lshr_b32 s52, s52, 16
ds_read_b64_tr_b16 a[146:147], v17 offset:6152
v_accvgpr_read_b32 v52, a160
v_mfma_f32_16x16x32_bf16 v[64:67], a[140:143], a[48:51], v[64:67]
s_mul_i32 s51, s52, 48
ds_read_b64_tr_b16 a[148:149], v17 offset:12296
v_accvgpr_read_b32 v53, a161
v_mfma_f32_16x16x32_bf16 v[72:75], a[128:131], a[4:7], v[72:75]
s_sub_u32 s51, s33, s51
ds_read_b64_tr_b16 a[150:151], v17 offset:18440
v_accvgpr_read_b32 v54, a162
v_mfma_f32_16x16x32_bf16 v[72:75], a[132:135], a[20:23], v[72:75]
s_cmp_ge_u32 s51, 24
ds_read_b64_tr_b16 a[152:153], v17 offset:24584
v_accvgpr_read_b32 v55, a163
v_mfma_f32_16x16x32_bf16 v[72:75], a[136:139], a[36:39], v[72:75]
s_waitcnt vmcnt(3)
s_cselect_b32 s50, 24, 0
ds_read_b64_tr_b16 a[154:155], v17 offset:30728
v_accvgpr_read_b32 v56, a168
v_mfma_f32_16x16x32_bf16 v[72:75], a[140:143], a[52:55], v[72:75]
s_cselect_b32 s74, s78, s76
buffer_load_dwordx4 v3, s[4:7], s20 offen offset:1024  lds
v_mfma_f32_16x16x32_bf16 v[80:83], a[128:131], a[8:11], v[80:83]
s_cselect_b32 s75, s79, s77
ds_read_b64_tr_b16 a[156:157], v17 offset:36872
v_accvgpr_read_b32 v57, a169
v_mfma_f32_16x16x32_bf16 v[80:83], a[132:135], a[24:27], v[80:83]
s_cselect_b32 s33, 1, 0
ds_read_b64_tr_b16 a[158:159], v17 offset:43016
v_accvgpr_read_b32 v58, a170
v_mfma_f32_16x16x32_bf16 v[80:83], a[136:139], a[40:43], v[80:83]
s_waitcnt vmcnt(3)
s_sub_u32 s51, s51, s50
v_accvgpr_read_b32 v59, a171
v_fmac_f32 v64, v52, v40
v_mfma_f32_16x16x32_bf16 v[80:83], a[140:143], a[56:59], v[80:83]
s_mul_i32 s56, s49, 192
v_fmac_f32 v65, v53, v40
v_fmac_f32 v66, v54, v40
v_mfma_f32_16x16x32_bf16 v[88:91], a[128:131], a[12:15], v[88:91]
s_mov_b32 s16, s74
ds_read_b64_tr_b16 a[128:129], v18 offset:0
v_fmac_f32 v67, v55, v40
v_mfma_f32_16x16x32_bf16 v[88:91], a[132:135], a[28:31], v[88:91]
s_mov_b32 s17, s75
buffer_load_dwordx4 v4, s[4:7], s20 offen offset:2048  lds
v_mfma_f32_16x16x32_bf16 v[88:91], a[136:139], a[44:47], v[88:91]
s_waitcnt vmcnt(3)
s_add_u32 s20, s20, 196608
ds_read_b64_tr_b16 a[130:131], v18 offset:6144
v_fmac_f32 v72, v52, v42
v_mfma_f32_16x16x32_bf16 v[88:91], a[140:143], a[60:63], v[88:91]
s_waitcnt lgkmcnt(8)
ds_read_b64_tr_b16 a[132:133], v18 offset:12288
v_fmac_f32 v73, v53, v42
v_mfma_f32_16x16x32_bf16 v[68:71], a[144:147], a[0:3], v[68:71]
s_waitcnt lgkmcnt(7)
ds_read_b64_tr_b16 a[134:135], v18 offset:18432
v_fmac_f32 v74, v54, v42
v_mfma_f32_16x16x32_bf16 v[68:71], a[148:151], a[16:19], v[68:71]
s_waitcnt lgkmcnt(6)
ds_read_b64_tr_b16 a[136:137], v18 offset:24576
v_fmac_f32 v75, v55, v42
v_mfma_f32_16x16x32_bf16 v[68:71], a[152:155], a[32:35], v[68:71]
s_waitcnt lgkmcnt(5)
ds_read_b64_tr_b16 a[138:139], v18 offset:30720
v_fmac_f32 v80, v52, v44
v_mfma_f32_16x16x32_bf16 v[68:71], a[156:159], a[48:51], v[68:71]
s_add_u32 m0, s24, 3072
ds_read_b64_tr_b16 a[140:141], v18 offset:36864
v_fmac_f32 v81, v53, v44
v_mfma_f32_16x16x32_bf16 v[76:79], a[144:147], a[4:7], v[76:79]
s_lshl_b32 s41, s52, 7
buffer_load_dwordx4 v2, s[4:7], s20 offen offset:0  lds
v_mfma_f32_16x16x32_bf16 v[76:79], a[148:151], a[20:23], v[76:79]
s_lshl4_add_u32 s41, s32, s41
ds_read_b64_tr_b16 a[142:143], v18 offset:43008
v_fmac_f32 v82, v54, v44
v_mfma_f32_16x16x32_bf16 v[76:79], a[152:155], a[36:39], v[76:79]
s_lshl2_add_u32 s41, s31, s41
v_fmac_f32 v83, v55, v44
v_fmac_f32 v88, v52, v46
v_mfma_f32_16x16x32_bf16 v[76:79], a[156:159], a[52:55], v[76:79]
s_mul_i32 s41, s41, 3072
v_fmac_f32 v89, v53, v46
v_fmac_f32 v90, v54, v46
v_mfma_f32_16x16x32_bf16 v[84:87], a[144:147], a[8:11], v[84:87]
s_lshl_b32 s50, s51, 7
v_fmac_f32 v91, v55, v46
v_accvgpr_read_b32 v52, a176
v_mfma_f32_16x16x32_bf16 v[84:87], a[148:151], a[24:27], v[84:87]
s_add_u32 s41, s41, s50
buffer_load_dwordx4 v3, s[4:7], s20 offen offset:1024  lds
v_mfma_f32_16x16x32_bf16 v[84:87], a[152:155], a[40:43], v[84:87]
s_mov_b32 s18, 0x1e0000
v_accvgpr_read_b32 v53, a177
v_accvgpr_read_b32 v54, a178
v_mfma_f32_16x16x32_bf16 v[84:87], a[156:159], a[56:59], v[84:87]
s_mov_b32 s19, 0x20000
v_accvgpr_read_b32 v55, a179
v_mfma_f32_16x16x32_bf16 v[92:95], a[144:147], a[12:15], v[92:95]
ds_read_b64_tr_b16 a[144:145], v18 offset:8
v_mfma_f32_16x16x32_bf16 v[92:95], a[148:151], a[28:31], v[92:95]
ds_read_b64_tr_b16 a[146:147], v18 offset:6152
v_mfma_f32_16x16x32_bf16 v[92:95], a[152:155], a[44:47], v[92:95]
ds_read_b64_tr_b16 a[148:149], v18 offset:12296
v_mfma_f32_16x16x32_bf16 v[92:95], a[156:159], a[60:63], v[92:95]
s_waitcnt lgkmcnt(9)
buffer_load_dwordx4 v4, s[4:7], s20 offen offset:2048  lds
v_mfma_f32_16x16x32_bf16 v[96:99], a[128:131], a[0:3], v[96:99]
s_waitcnt lgkmcnt(7)
ds_read_b64_tr_b16 a[150:151], v18 offset:18440
v_mfma_f32_16x16x32_bf16 v[96:99], a[132:135], a[16:19], v[96:99]
s_waitcnt lgkmcnt(6)
ds_read_b64_tr_b16 a[152:153], v18 offset:24584
v_mfma_f32_16x16x32_bf16 v[96:99], a[136:139], a[32:35], v[96:99]
s_waitcnt lgkmcnt(5)
ds_read_b64_tr_b16 a[154:155], v18 offset:30728
v_mfma_f32_16x16x32_bf16 v[96:99], a[140:143], a[48:51], v[96:99]
s_add_u32 s20, s20, 589824
ds_read_b64_tr_b16 a[156:157], v18 offset:36872
v_mfma_f32_16x16x32_bf16 v[104:107], a[128:131], a[4:7], v[104:107]
s_add_u32 m0, s24, 24576
ds_read_b64_tr_b16 a[158:159], v18 offset:43016
v_mfma_f32_16x16x32_bf16 v[104:107], a[132:135], a[20:23], v[104:107]
s_lshl2_add_u32 s51, s51, s30
buffer_load_dwordx4 v2, s[4:7], s20 offen offset:0  lds
v_mfma_f32_16x16x32_bf16 v[104:107], a[136:139], a[36:39], v[104:107]
s_mul_i32 s50, s51, 21846
v_mfma_f32_16x16x32_bf16 v[104:107], a[140:143], a[52:55], v[104:107]
s_lshr_b32 s50, s50, 16
v_fmac_f32 v96, v56, v40
v_fmac_f32 v97, v57, v40
v_mfma_f32_16x16x32_bf16 v[112:115], a[128:131], a[8:11], v[112:115]
s_mul_i32 s53, s50, 3
v_fmac_f32 v98, v58, v40
v_fmac_f32 v99, v59, v40
v_mfma_f32_16x16x32_bf16 v[112:115], a[132:135], a[24:27], v[112:115]
s_sub_u32 s53, s51, s53
v_mfma_f32_16x16x32_bf16 v[112:115], a[136:139], a[40:43], v[112:115]
s_mul_i32 s50, s50, 20
v_mfma_f32_16x16x32_bf16 v[112:115], a[140:143], a[56:59], v[112:115]
buffer_load_dwordx4 v3, s[4:7], s20 offen offset:1024  lds
v_mfma_f32_16x16x32_bf16 v[120:123], a[128:131], a[12:15], v[120:123]
ds_read_b64_tr_b16 a[128:129], v17 offset:128
v_fmac_f32 v104, v56, v42
v_mfma_f32_16x16x32_bf16 v[120:123], a[132:135], a[28:31], v[120:123]
ds_read_b64_tr_b16 a[130:131], v17 offset:6272
v_fmac_f32 v105, v57, v42
v_mfma_f32_16x16x32_bf16 v[120:123], a[136:139], a[44:47], v[120:123]
ds_read_b64_tr_b16 a[132:133], v17 offset:12416
v_fmac_f32 v106, v58, v42
v_mfma_f32_16x16x32_bf16 v[120:123], a[140:143], a[60:63], v[120:123]
s_waitcnt lgkmcnt(9)
ds_read_b64_tr_b16 a[134:135], v17 offset:18560
v_fmac_f32 v107, v59, v42
v_mfma_f32_16x16x32_bf16 v[100:103], a[144:147], a[0:3], v[100:103]
s_waitcnt lgkmcnt(8)
ds_read_b64_tr_b16 a[136:137], v17 offset:24704
v_fmac_f32 v112, v56, v44
v_mfma_f32_16x16x32_bf16 v[100:103], a[148:151], a[16:19], v[100:103]
s_waitcnt lgkmcnt(7)
buffer_load_dwordx4 v4, s[4:7], s20 offen offset:2048  lds
v_mfma_f32_16x16x32_bf16 v[100:103], a[152:155], a[32:35], v[100:103]
s_waitcnt lgkmcnt(5)
ds_read_b64_tr_b16 a[138:139], v17 offset:30848
v_fmac_f32 v113, v57, v44
v_mfma_f32_16x16x32_bf16 v[100:103], a[156:159], a[48:51], v[100:103]
s_add_u32 s20, s20, 196608
ds_read_b64_tr_b16 a[140:141], v17 offset:36992
v_fmac_f32 v114, v58, v44
v_mfma_f32_16x16x32_bf16 v[108:111], a[144:147], a[4:7], v[108:111]
s_add_u32 m0, s24, 27648
ds_read_b64_tr_b16 a[142:143], v17 offset:43136
v_fmac_f32 v115, v59, v44
v_mfma_f32_16x16x32_bf16 v[108:111], a[148:151], a[20:23], v[108:111]
s_lshl2_add_u32 s50, s52, s50
v_fmac_f32 v120, v56, v46
v_fmac_f32 v121, v57, v46
v_mfma_f32_16x16x32_bf16 v[108:111], a[152:155], a[36:39], v[108:111]
s_mul_i32 s50, s50, 6
v_fmac_f32 v122, v58, v46
v_fmac_f32 v123, v59, v46
v_mfma_f32_16x16x32_bf16 v[108:111], a[156:159], a[52:55], v[108:111]
s_lshl1_add_u32 s50, s53, s50
buffer_load_dwordx4 v2, s[4:7], s20 offen offset:0  lds
v_mfma_f32_16x16x32_bf16 v[116:119], a[144:147], a[8:11], v[116:119]
s_add_u32 s50, s50, s33
v_accvgpr_read_b32 v56, a184
v_accvgpr_read_b32 v57, a185
v_mfma_f32_16x16x32_bf16 v[116:119], a[148:151], a[24:27], v[116:119]
s_lshl_b32 s50, s50, 10
v_accvgpr_read_b32 v58, a186
v_accvgpr_read_b32 v59, a187
v_mfma_f32_16x16x32_bf16 v[116:119], a[152:155], a[40:43], v[116:119]
s_add_u32 s42, s50, 0x2200000
v_mfma_f32_16x16x32_bf16 v[116:119], a[156:159], a[56:59], v[116:119]
v_mfma_f32_16x16x32_bf16 v[124:127], a[144:147], a[12:15], v[124:127]
ds_read_b64_tr_b16 a[144:145], v17 offset:136
v_mfma_f32_16x16x32_bf16 v[124:127], a[148:151], a[28:31], v[124:127]
ds_read_b64_tr_b16 a[146:147], v17 offset:6280
v_mfma_f32_16x16x32_bf16 v[124:127], a[152:155], a[44:47], v[124:127]
buffer_load_dwordx4 v3, s[4:7], s20 offen offset:1024  lds
v_mfma_f32_16x16x32_bf16 v[124:127], a[156:159], a[60:63], v[124:127]
s_waitcnt lgkmcnt(8)
ds_read_b64_tr_b16 a[148:149], v17 offset:12424
v_mfma_f32_16x16x32_bf16 v[128:131], a[128:131], a[0:3], v[128:131]
s_waitcnt lgkmcnt(7)
ds_read_b64_tr_b16 a[150:151], v17 offset:18568
v_mfma_f32_16x16x32_bf16 v[128:131], a[132:135], a[16:19], v[128:131]
s_waitcnt lgkmcnt(6)
ds_read_b64_tr_b16 a[152:153], v17 offset:24712
v_mfma_f32_16x16x32_bf16 v[128:131], a[136:139], a[32:35], v[128:131]
s_waitcnt lgkmcnt(5)
ds_read_b64_tr_b16 a[154:155], v17 offset:30856
v_mfma_f32_16x16x32_bf16 v[128:131], a[140:143], a[48:51], v[128:131]
ds_read_b64_tr_b16 a[156:157], v17 offset:37000
v_mfma_f32_16x16x32_bf16 v[136:139], a[128:131], a[4:7], v[136:139]
buffer_load_dwordx4 v4, s[4:7], s20 offen offset:2048  lds
v_mfma_f32_16x16x32_bf16 v[136:139], a[132:135], a[20:23], v[136:139]
s_add_u32 s20, s20, 589824
ds_read_b64_tr_b16 a[158:159], v17 offset:43144
v_mfma_f32_16x16x32_bf16 v[136:139], a[136:139], a[36:39], v[136:139]
s_lshl_b32 s55, s2, 2
v_mfma_f32_16x16x32_bf16 v[136:139], a[140:143], a[52:55], v[136:139]
s_add_u32 s55, s55, 0x3a20000
v_fmac_f32 v128, v52, v40
v_fmac_f32 v129, v53, v40
v_mfma_f32_16x16x32_bf16 v[144:147], a[128:131], a[8:11], v[144:147]
s_cmp_eq_u32 s30, 0
v_fmac_f32 v130, v54, v40
v_fmac_f32 v131, v55, v40
v_mfma_f32_16x16x32_bf16 v[144:147], a[132:135], a[24:27], v[144:147]
s_cselect_b32 s55, s55, 0x40000000
v_mfma_f32_16x16x32_bf16 v[144:147], a[136:139], a[40:43], v[144:147]
s_lshr_b32 s33, s28, 3
buffer_load_dwordx4 a[64:67], v1, s[12:15], s27 offen offset:0 sc1
v_mfma_f32_16x16x32_bf16 v[144:147], a[140:143], a[56:59], v[144:147]
s_lshl2_add_u32 s50, s54, s33
v_fmac_f32 v136, v52, v42
v_fmac_f32 v137, v53, v42
v_mfma_f32_16x16x32_bf16 v[152:155], a[128:131], a[12:15], v[152:155]
s_lshl_b32 s50, s50, 7
ds_read_b64_tr_b16 a[128:129], v18 offset:128
v_fmac_f32 v138, v54, v42
v_mfma_f32_16x16x32_bf16 v[152:155], a[132:135], a[28:31], v[152:155]
s_and_b32 s33, s28, 7
ds_read_b64_tr_b16 a[130:131], v18 offset:6272
v_fmac_f32 v139, v55, v42
v_mfma_f32_16x16x32_bf16 v[152:155], a[136:139], a[44:47], v[152:155]
s_lshl2_add_u32 s50, s33, s50
ds_read_b64_tr_b16 a[132:133], v18 offset:12416
v_mfma_f32_16x16x32_bf16 v[152:155], a[140:143], a[60:63], v[152:155]
s_waitcnt lgkmcnt(9)
ds_read_b64_tr_b16 a[134:135], v18 offset:18560
v_fmac_f32 v144, v52, v44
v_mfma_f32_16x16x32_bf16 v[132:135], a[144:147], a[0:3], v[132:135]
s_waitcnt lgkmcnt(8)
buffer_load_dwordx4 a[68:71], v1, s[12:15], s27 offen offset:1024 sc1
v_mfma_f32_16x16x32_bf16 v[132:135], a[148:151], a[16:19], v[132:135]
s_waitcnt lgkmcnt(6)
ds_read_b64_tr_b16 a[136:137], v18 offset:24704
v_fmac_f32 v145, v53, v44
v_mfma_f32_16x16x32_bf16 v[132:135], a[152:155], a[32:35], v[132:135]
s_waitcnt lgkmcnt(5)
ds_read_b64_tr_b16 a[138:139], v18 offset:30848
v_fmac_f32 v146, v54, v44
v_mfma_f32_16x16x32_bf16 v[132:135], a[156:159], a[48:51], v[132:135]
s_mul_i32 s33, s47, 48
ds_read_b64_tr_b16 a[140:141], v18 offset:36992
v_fmac_f32 v147, v55, v44
v_mfma_f32_16x16x32_bf16 v[140:143], a[144:147], a[4:7], v[140:143]
ds_read_b64_tr_b16 a[142:143], v18 offset:43136
v_fmac_f32 v152, v52, v46
v_mfma_f32_16x16x32_bf16 v[140:143], a[148:151], a[20:23], v[140:143]
v_fmac_f32 v153, v53, v46
v_fmac_f32 v154, v54, v46
v_mfma_f32_16x16x32_bf16 v[140:143], a[152:155], a[36:39], v[140:143]
buffer_load_dwordx4 a[72:75], v1, s[12:15], s27 offen offset:2048 sc1
v_mfma_f32_16x16x32_bf16 v[140:143], a[156:159], a[52:55], v[140:143]
v_fmac_f32 v155, v55, v46
v_accvgpr_read_b32 v52, a192
v_mfma_f32_16x16x32_bf16 v[148:151], a[144:147], a[8:11], v[148:151]
v_accvgpr_read_b32 v53, a193
v_accvgpr_read_b32 v54, a194
v_mfma_f32_16x16x32_bf16 v[148:151], a[148:151], a[24:27], v[148:151]
v_accvgpr_read_b32 v55, a195
v_mfma_f32_16x16x32_bf16 v[148:151], a[152:155], a[40:43], v[148:151]
v_mfma_f32_16x16x32_bf16 v[148:151], a[156:159], a[56:59], v[148:151]
v_mfma_f32_16x16x32_bf16 v[156:159], a[144:147], a[12:15], v[156:159]
buffer_load_dwordx4 a[76:79], v1, s[12:15], s27 offen offset:3072 sc1
v_mfma_f32_16x16x32_bf16 v[156:159], a[148:151], a[28:31], v[156:159]
s_add_u32 s27, s27, 4096
ds_read_b64_tr_b16 a[144:145], v18 offset:136
v_mfma_f32_16x16x32_bf16 v[156:159], a[152:155], a[44:47], v[156:159]
s_add_u32 s50, s50, 0x3a08000
ds_read_b64_tr_b16 a[146:147], v18 offset:6280
v_mfma_f32_16x16x32_bf16 v[156:159], a[156:159], a[60:63], v[156:159]
s_waitcnt lgkmcnt(8)
ds_read_b64_tr_b16 a[148:149], v18 offset:12424
v_mfma_f32_16x16x32_bf16 v[160:163], a[128:131], a[0:3], v[160:163]
s_waitcnt lgkmcnt(7)
ds_read_b64_tr_b16 a[150:151], v18 offset:18568
v_mfma_f32_16x16x32_bf16 v[160:163], a[132:135], a[16:19], v[160:163]
s_waitcnt lgkmcnt(6)
ds_read_b64_tr_b16 a[152:153], v18 offset:24712
v_mfma_f32_16x16x32_bf16 v[160:163], a[136:139], a[32:35], v[160:163]
s_waitcnt lgkmcnt(5)
buffer_load_dwordx4 a[80:83], v1, s[12:15], s27 offen offset:0 sc1
v_mfma_f32_16x16x32_bf16 v[160:163], a[140:143], a[48:51], v[160:163]
s_add_u32 s56, s56, s33
ds_read_b64_tr_b16 a[154:155], v18 offset:30856
v_mfma_f32_16x16x32_bf16 v[168:171], a[128:131], a[4:7], v[168:171]
s_mul_i32 s56, s56, 10240
ds_read_b64_tr_b16 a[156:157], v18 offset:37000
v_mfma_f32_16x16x32_bf16 v[168:171], a[132:135], a[20:23], v[168:171]
s_add_u32 s56, s56, s58
ds_read_b64_tr_b16 a[158:159], v18 offset:43144
v_mfma_f32_16x16x32_bf16 v[168:171], a[136:139], a[36:39], v[168:171]
s_add_u32 s56, s56, 0x2600000
v_mfma_f32_16x16x32_bf16 v[168:171], a[140:143], a[52:55], v[168:171]
s_lshl1_add_u32 s57, s48, s32
v_fmac_f32 v160, v56, v40
v_fmac_f32 v161, v57, v40
v_mfma_f32_16x16x32_bf16 v[176:179], a[128:131], a[8:11], v[176:179]
s_mul_i32 s57, s57, 240
buffer_load_dwordx4 a[84:87], v1, s[12:15], s27 offen offset:1024 sc1
v_mfma_f32_16x16x32_bf16 v[176:179], a[132:135], a[24:27], v[176:179]
v_fmac_f32 v162, v58, v40
v_fmac_f32 v163, v59, v40
v_mfma_f32_16x16x32_bf16 v[176:179], a[136:139], a[40:43], v[176:179]
v_mfma_f32_16x16x32_bf16 v[176:179], a[140:143], a[56:59], v[176:179]
v_fmac_f32 v168, v56, v42
v_fmac_f32 v169, v57, v42
v_mfma_f32_16x16x32_bf16 v[184:187], a[128:131], a[12:15], v[184:187]
ds_read_b64_tr_b16 a[128:129], v17 offset:256
v_fmac_f32 v170, v58, v42
v_mfma_f32_16x16x32_bf16 v[184:187], a[132:135], a[28:31], v[184:187]
ds_read_b64_tr_b16 a[130:131], v17 offset:6400
v_fmac_f32 v171, v59, v42
v_mfma_f32_16x16x32_bf16 v[184:187], a[136:139], a[44:47], v[184:187]
buffer_load_dwordx4 a[88:91], v1, s[12:15], s27 offen offset:2048 sc1
v_mfma_f32_16x16x32_bf16 v[184:187], a[140:143], a[60:63], v[184:187]
s_waitcnt lgkmcnt(8)
ds_read_b64_tr_b16 a[132:133], v17 offset:12544
v_fmac_f32 v176, v56, v44
v_mfma_f32_16x16x32_bf16 v[164:167], a[144:147], a[0:3], v[164:167]
s_waitcnt lgkmcnt(7)
ds_read_b64_tr_b16 a[134:135], v17 offset:18688
v_fmac_f32 v177, v57, v44
v_mfma_f32_16x16x32_bf16 v[164:167], a[148:151], a[16:19], v[164:167]
s_waitcnt lgkmcnt(6)
ds_read_b64_tr_b16 a[136:137], v17 offset:24832
v_fmac_f32 v178, v58, v44
v_mfma_f32_16x16x32_bf16 v[164:167], a[152:155], a[32:35], v[164:167]
s_waitcnt lgkmcnt(5)
ds_read_b64_tr_b16 a[138:139], v17 offset:30976
v_fmac_f32 v179, v59, v44
v_mfma_f32_16x16x32_bf16 v[164:167], a[156:159], a[48:51], v[164:167]
ds_read_b64_tr_b16 a[140:141], v17 offset:37120
v_fmac_f32 v184, v56, v46
v_mfma_f32_16x16x32_bf16 v[172:175], a[144:147], a[4:7], v[172:175]
ds_read_b64_tr_b16 a[142:143], v17 offset:43264
v_fmac_f32 v185, v57, v46
v_mfma_f32_16x16x32_bf16 v[172:175], a[148:151], a[20:23], v[172:175]
buffer_load_dwordx4 a[92:95], v1, s[12:15], s27 offen offset:3072 sc1
v_mfma_f32_16x16x32_bf16 v[172:175], a[152:155], a[36:39], v[172:175]
s_add_u32 s27, s27, 4096
v_fmac_f32 v186, v58, v46
v_fmac_f32 v187, v59, v46
v_mfma_f32_16x16x32_bf16 v[172:175], a[156:159], a[52:55], v[172:175]
s_add_u32 s57, s57, s33
v_accvgpr_read_b32 v56, a200
v_accvgpr_read_b32 v57, a201
v_mfma_f32_16x16x32_bf16 v[180:183], a[144:147], a[8:11], v[180:183]
s_add_u32 s57, s57, s31
v_accvgpr_read_b32 v58, a202
v_accvgpr_read_b32 v59, a203
v_mfma_f32_16x16x32_bf16 v[180:183], a[148:151], a[24:27], v[180:183]
s_lshl_b32 s57, s57, 12
v_mfma_f32_16x16x32_bf16 v[180:183], a[152:155], a[40:43], v[180:183]
s_add_u32 s57, s57, 0x400000
v_mfma_f32_16x16x32_bf16 v[180:183], a[156:159], a[56:59], v[180:183]
s_lshr_b32 s33, s47, 1
buffer_load_dwordx4 a[96:99], v1, s[12:15], s27 offen offset:0 sc1
v_mfma_f32_16x16x32_bf16 v[188:191], a[144:147], a[12:15], v[188:191]
s_lshl1_add_u32 s61, s48, s33
ds_read_b64_tr_b16 a[144:145], v17 offset:264
v_mfma_f32_16x16x32_bf16 v[188:191], a[148:151], a[28:31], v[188:191]
ds_read_b64_tr_b16 a[146:147], v17 offset:6408
v_mfma_f32_16x16x32_bf16 v[188:191], a[152:155], a[44:47], v[188:191]
ds_read_b64_tr_b16 a[148:149], v17 offset:12552
v_mfma_f32_16x16x32_bf16 v[188:191], a[156:159], a[60:63], v[188:191]
s_waitcnt lgkmcnt(9)
ds_read_b64_tr_b16 a[150:151], v17 offset:18696
v_mfma_f32_16x16x32_bf16 v[192:195], a[128:131], a[0:3], v[192:195]
s_waitcnt lgkmcnt(8)
ds_read_b64_tr_b16 a[152:153], v17 offset:24840
v_mfma_f32_16x16x32_bf16 v[192:195], a[132:135], a[16:19], v[192:195]
s_waitcnt lgkmcnt(7)
buffer_load_dwordx4 a[100:103], v1, s[12:15], s27 offen offset:1024 sc1
v_mfma_f32_16x16x32_bf16 v[192:195], a[136:139], a[32:35], v[192:195]
s_waitcnt lgkmcnt(5)
ds_read_b64_tr_b16 a[154:155], v17 offset:30984
v_mfma_f32_16x16x32_bf16 v[192:195], a[140:143], a[48:51], v[192:195]
ds_read_b64_tr_b16 a[156:157], v17 offset:37128
v_mfma_f32_16x16x32_bf16 v[200:203], a[128:131], a[4:7], v[200:203]
ds_read_b64_tr_b16 a[158:159], v17 offset:43272
v_add_u32 v17, 0xfffe4000, v17
v_mfma_f32_16x16x32_bf16 v[200:203], a[132:135], a[20:23], v[200:203]
v_mfma_f32_16x16x32_bf16 v[200:203], a[136:139], a[36:39], v[200:203]
v_mfma_f32_16x16x32_bf16 v[200:203], a[140:143], a[52:55], v[200:203]
buffer_load_dwordx4 a[104:107], v1, s[12:15], s27 offen offset:2048 sc1
v_mfma_f32_16x16x32_bf16 v[208:211], a[128:131], a[8:11], v[208:211]
v_fmac_f32 v192, v52, v40
v_fmac_f32 v193, v53, v40
v_mfma_f32_16x16x32_bf16 v[208:211], a[132:135], a[24:27], v[208:211]
v_fmac_f32 v194, v54, v40
v_fmac_f32 v195, v55, v40
v_mfma_f32_16x16x32_bf16 v[208:211], a[136:139], a[40:43], v[208:211]
v_mfma_f32_16x16x32_bf16 v[208:211], a[140:143], a[56:59], v[208:211]
v_fmac_f32 v200, v52, v42
v_fmac_f32 v201, v53, v42
v_mfma_f32_16x16x32_bf16 v[216:219], a[128:131], a[12:15], v[216:219]
ds_read_b64_tr_b16 a[128:129], v18 offset:256
v_fmac_f32 v202, v54, v42
v_mfma_f32_16x16x32_bf16 v[216:219], a[132:135], a[28:31], v[216:219]
buffer_load_dwordx4 a[108:111], v1, s[12:15], s27 offen offset:3072 sc1
v_mfma_f32_16x16x32_bf16 v[216:219], a[136:139], a[44:47], v[216:219]
s_add_u32 s27, s27, 4096
ds_read_b64_tr_b16 a[130:131], v18 offset:6400
v_fmac_f32 v203, v55, v42
v_mfma_f32_16x16x32_bf16 v[216:219], a[140:143], a[60:63], v[216:219]
s_waitcnt lgkmcnt(8)
ds_read_b64_tr_b16 a[132:133], v18 offset:12544
v_fmac_f32 v208, v52, v44
v_mfma_f32_16x16x32_bf16 v[196:199], a[144:147], a[0:3], v[196:199]
s_waitcnt lgkmcnt(7)
ds_read_b64_tr_b16 a[134:135], v18 offset:18688
v_fmac_f32 v209, v53, v44
v_mfma_f32_16x16x32_bf16 v[196:199], a[148:151], a[16:19], v[196:199]
s_waitcnt lgkmcnt(6)
ds_read_b64_tr_b16 a[136:137], v18 offset:24832
v_fmac_f32 v210, v54, v44
v_mfma_f32_16x16x32_bf16 v[196:199], a[152:155], a[32:35], v[196:199]
s_waitcnt lgkmcnt(5)
ds_read_b64_tr_b16 a[138:139], v18 offset:30976
v_fmac_f32 v211, v55, v44
v_mfma_f32_16x16x32_bf16 v[196:199], a[156:159], a[48:51], v[196:199]
buffer_load_dwordx4 a[112:115], v1, s[12:15], s27 offen offset:0 sc1
v_mfma_f32_16x16x32_bf16 v[204:207], a[144:147], a[4:7], v[204:207]
ds_read_b64_tr_b16 a[140:141], v18 offset:37120
v_fmac_f32 v216, v52, v46
v_mfma_f32_16x16x32_bf16 v[204:207], a[148:151], a[20:23], v[204:207]
ds_read_b64_tr_b16 a[142:143], v18 offset:43264
v_fmac_f32 v217, v53, v46
v_mfma_f32_16x16x32_bf16 v[204:207], a[152:155], a[36:39], v[204:207]
v_fmac_f32 v218, v54, v46
v_fmac_f32 v219, v55, v46
v_mfma_f32_16x16x32_bf16 v[204:207], a[156:159], a[52:55], v[204:207]
v_mfma_f32_16x16x32_bf16 v[212:215], a[144:147], a[8:11], v[212:215]
v_mfma_f32_16x16x32_bf16 v[212:215], a[148:151], a[24:27], v[212:215]
buffer_load_dwordx4 a[116:119], v1, s[12:15], s27 offen offset:1024 sc1
v_mfma_f32_16x16x32_bf16 v[212:215], a[152:155], a[40:43], v[212:215]
v_mfma_f32_16x16x32_bf16 v[212:215], a[156:159], a[56:59], v[212:215]
v_mfma_f32_16x16x32_bf16 v[220:223], a[144:147], a[12:15], v[220:223]
ds_read_b64_tr_b16 a[144:145], v18 offset:264
v_mfma_f32_16x16x32_bf16 v[220:223], a[148:151], a[28:31], v[220:223]
ds_read_b64_tr_b16 a[146:147], v18 offset:6408
v_mfma_f32_16x16x32_bf16 v[220:223], a[152:155], a[44:47], v[220:223]
ds_read_b64_tr_b16 a[148:149], v18 offset:12552
v_mfma_f32_16x16x32_bf16 v[220:223], a[156:159], a[60:63], v[220:223]
s_waitcnt lgkmcnt(9)
buffer_load_dwordx4 a[120:123], v1, s[12:15], s27 offen offset:2048 sc1
v_mfma_f32_16x16x32_bf16 v[224:227], a[128:131], a[0:3], v[224:227]
s_waitcnt lgkmcnt(7)
ds_read_b64_tr_b16 a[150:151], v18 offset:18696
v_mfma_f32_16x16x32_bf16 v[224:227], a[132:135], a[16:19], v[224:227]
s_waitcnt lgkmcnt(6)
ds_read_b64_tr_b16 a[152:153], v18 offset:24840
v_mfma_f32_16x16x32_bf16 v[224:227], a[136:139], a[32:35], v[224:227]
s_waitcnt lgkmcnt(5)
ds_read_b64_tr_b16 a[154:155], v18 offset:30984
v_mfma_f32_16x16x32_bf16 v[224:227], a[140:143], a[48:51], v[224:227]
ds_read_b64_tr_b16 a[156:157], v18 offset:37128
v_mfma_f32_16x16x32_bf16 v[232:235], a[128:131], a[4:7], v[232:235]
ds_read_b64_tr_b16 a[158:159], v18 offset:43272
v_mfma_f32_16x16x32_bf16 v[232:235], a[132:135], a[20:23], v[232:235]
buffer_load_dwordx4 a[124:127], v1, s[12:15], s27 offen offset:3072 sc1
v_mfma_f32_16x16x32_bf16 v[232:235], a[136:139], a[36:39], v[232:235]
s_add_u32 s27, s27, 4096
v_mfma_f32_16x16x32_bf16 v[232:235], a[140:143], a[52:55], v[232:235]
v_fmac_f32 v224, v56, v40
v_fmac_f32 v225, v57, v40
v_mfma_f32_16x16x32_bf16 v[240:243], a[128:131], a[8:11], v[240:243]
v_fmac_f32 v226, v58, v40
v_fmac_f32 v227, v59, v40
v_mfma_f32_16x16x32_bf16 v[240:243], a[132:135], a[24:27], v[240:243]
v_mfma_f32_16x16x32_bf16 v[240:243], a[136:139], a[40:43], v[240:243]
v_mfma_f32_16x16x32_bf16 v[240:243], a[140:143], a[56:59], v[240:243]
v_fmac_f32 v232, v56, v42
v_fmac_f32 v233, v57, v42
v_mfma_f32_16x16x32_bf16 v[248:251], a[128:131], a[12:15], v[248:251]
v_fmac_f32 v234, v58, v42
v_fmac_f32 v235, v59, v42
v_mfma_f32_16x16x32_bf16 v[248:251], a[132:135], a[28:31], v[248:251]
v_mfma_f32_16x16x32_bf16 v[248:251], a[136:139], a[44:47], v[248:251]
v_mfma_f32_16x16x32_bf16 v[248:251], a[140:143], a[60:63], v[248:251]
s_waitcnt vmcnt(16) lgkmcnt(0)
s_barrier
v_fmac_f32 v240, v56, v44
v_fmac_f32 v241, v57, v44
v_mfma_f32_16x16x32_bf16 v[228:231], a[144:147], a[0:3], v[228:231]
ds_read_b64_tr_b16 a[128:129], v17 offset:0
v_fmac_f32 v242, v58, v44
v_mfma_f32_16x16x32_bf16 v[228:231], a[148:151], a[16:19], v[228:231]
ds_read_b64_tr_b16 a[130:131], v17 offset:6144
v_fmac_f32 v243, v59, v44
v_mfma_f32_16x16x32_bf16 v[228:231], a[152:155], a[32:35], v[228:231]
ds_read_b64_tr_b16 a[132:133], v17 offset:12288
v_mfma_f32_16x16x32_bf16 v[228:231], a[156:159], a[48:51], v[228:231]
ds_read_b64_tr_b16 a[134:135], v17 offset:18432
v_fmac_f32 v248, v56, v46
v_mfma_f32_16x16x32_bf16 v[236:239], a[144:147], a[4:7], v[236:239]
ds_read_b64_tr_b16 a[136:137], v17 offset:24576
v_fmac_f32 v249, v57, v46
v_mfma_f32_16x16x32_bf16 v[236:239], a[148:151], a[20:23], v[236:239]
ds_read_b64_tr_b16 a[138:139], v17 offset:30720
v_fmac_f32 v250, v58, v46
v_mfma_f32_16x16x32_bf16 v[236:239], a[152:155], a[36:39], v[236:239]
ds_read_b64_tr_b16 a[140:141], v17 offset:36864
v_fmac_f32 v251, v59, v46
v_mfma_f32_16x16x32_bf16 v[236:239], a[156:159], a[52:55], v[236:239]
ds_read_b64_tr_b16 a[142:143], v17 offset:43008
v_mfma_f32_16x16x32_bf16 v[244:247], a[144:147], a[8:11], v[244:247]
v_mfma_f32_16x16x32_bf16 v[244:247], a[148:151], a[24:27], v[244:247]
v_mfma_f32_16x16x32_bf16 v[244:247], a[152:155], a[40:43], v[244:247]
v_mfma_f32_16x16x32_bf16 v[244:247], a[156:159], a[56:59], v[244:247]
v_mfma_f32_16x16x32_bf16 v[252:255], a[144:147], a[12:15], v[252:255]
v_mfma_f32_16x16x32_bf16 v[252:255], a[148:151], a[28:31], v[252:255]
v_mfma_f32_16x16x32_bf16 v[252:255], a[152:155], a[44:47], v[252:255]
v_mfma_f32_16x16x32_bf16 v[252:255], a[156:159], a[60:63], v[252:255]
s_waitcnt vmcnt(15) lgkmcnt(6)
v_mfma_f32_16x16x32_bf16 v[64:67], a[128:131], a[64:67], v[64:67]
s_waitcnt vmcnt(11) lgkmcnt(4)
s_add_u32 m0, s24, 114688
ds_read_b64_tr_b16 a[144:145], v17 offset:8
v_add_u32 v18, 0xfffe4000, v18
v_mfma_f32_16x16x32_bf16 v[64:67], a[132:135], a[80:83], v[64:67]
s_waitcnt vmcnt(7) lgkmcnt(3)
buffer_load_dwordx4 v2, s[4:7], s20 offen offset:0  lds
v_mfma_f32_16x16x32_bf16 v[64:67], a[136:139], a[96:99], v[64:67]
s_waitcnt vmcnt(4) lgkmcnt(1)
ds_read_b64_tr_b16 a[146:147], v17 offset:6152
v_accvgpr_read_b32 v52, a164
v_mfma_f32_16x16x32_bf16 v[64:67], a[140:143], a[112:115], v[64:67]
ds_read_b64_tr_b16 a[148:149], v17 offset:12296
v_accvgpr_read_b32 v53, a165
v_mfma_f32_16x16x32_bf16 v[72:75], a[128:131], a[68:71], v[72:75]
ds_read_b64_tr_b16 a[150:151], v17 offset:18440
v_accvgpr_read_b32 v54, a166
v_mfma_f32_16x16x32_bf16 v[72:75], a[132:135], a[84:87], v[72:75]
ds_read_b64_tr_b16 a[152:153], v17 offset:24584
v_accvgpr_read_b32 v55, a167
v_mfma_f32_16x16x32_bf16 v[72:75], a[136:139], a[100:103], v[72:75]
s_waitcnt vmcnt(3)
buffer_load_dwordx4 v3, s[4:7], s20 offen offset:1024  lds
v_mfma_f32_16x16x32_bf16 v[72:75], a[140:143], a[116:119], v[72:75]
ds_read_b64_tr_b16 a[154:155], v17 offset:30728
v_accvgpr_read_b32 v56, a172
v_mfma_f32_16x16x32_bf16 v[80:83], a[128:131], a[72:75], v[80:83]
ds_read_b64_tr_b16 a[156:157], v17 offset:36872
v_accvgpr_read_b32 v57, a173
v_mfma_f32_16x16x32_bf16 v[80:83], a[132:135], a[88:91], v[80:83]
ds_read_b64_tr_b16 a[158:159], v17 offset:43016
v_accvgpr_read_b32 v58, a174
v_mfma_f32_16x16x32_bf16 v[80:83], a[136:139], a[104:107], v[80:83]
s_waitcnt vmcnt(3)
v_accvgpr_read_b32 v59, a175
v_mfma_f32_16x16x32_bf16 v[80:83], a[140:143], a[120:123], v[80:83]
v_mfma_f32_16x16x32_bf16 v[88:91], a[128:131], a[76:79], v[88:91]
buffer_load_dwordx4 v4, s[4:7], s20 offen offset:2048  lds
v_mfma_f32_16x16x32_bf16 v[88:91], a[132:135], a[92:95], v[88:91]
s_add_u32 s20, s20, 196608
ds_read_b64_tr_b16 a[128:129], v18 offset:0
v_mfma_f32_16x16x32_bf16 v[88:91], a[136:139], a[108:111], v[88:91]
s_waitcnt vmcnt(3)
s_add_u32 m0, s24, 117760
ds_read_b64_tr_b16 a[130:131], v18 offset:6144
v_mfma_f32_16x16x32_bf16 v[88:91], a[140:143], a[124:127], v[88:91]
s_waitcnt lgkmcnt(8)
ds_read_b64_tr_b16 a[132:133], v18 offset:12288
v_mfma_f32_16x16x32_bf16 v[68:71], a[144:147], a[64:67], v[68:71]
s_waitcnt lgkmcnt(7)
ds_read_b64_tr_b16 a[134:135], v18 offset:18432
v_mfma_f32_16x16x32_bf16 v[68:71], a[148:151], a[80:83], v[68:71]
s_waitcnt lgkmcnt(6)
buffer_load_dwordx4 v2, s[4:7], s20 offen offset:0  lds
v_mfma_f32_16x16x32_bf16 v[68:71], a[152:155], a[96:99], v[68:71]
s_waitcnt lgkmcnt(4)
ds_read_b64_tr_b16 a[136:137], v18 offset:24576
v_mfma_f32_16x16x32_bf16 v[68:71], a[156:159], a[112:115], v[68:71]
ds_read_b64_tr_b16 a[138:139], v18 offset:30720
v_mfma_f32_16x16x32_bf16 v[76:79], a[144:147], a[68:71], v[76:79]
ds_read_b64_tr_b16 a[140:141], v18 offset:36864
v_mfma_f32_16x16x32_bf16 v[76:79], a[148:151], a[84:87], v[76:79]
ds_read_b64_tr_b16 a[142:143], v18 offset:43008
v_mfma_f32_16x16x32_bf16 v[76:79], a[152:155], a[100:103], v[76:79]
v_mfma_f32_16x16x32_bf16 v[76:79], a[156:159], a[116:119], v[76:79]
buffer_load_dwordx4 v3, s[4:7], s20 offen offset:1024  lds
v_mfma_f32_16x16x32_bf16 v[84:87], a[144:147], a[72:75], v[84:87]
v_fmac_f32 v68, v52, v40
v_fmac_f32 v69, v53, v40
v_mfma_f32_16x16x32_bf16 v[84:87], a[148:151], a[88:91], v[84:87]
v_fmac_f32 v70, v54, v40
v_fmac_f32 v71, v55, v40
v_mfma_f32_16x16x32_bf16 v[84:87], a[152:155], a[104:107], v[84:87]
v_mfma_f32_16x16x32_bf16 v[84:87], a[156:159], a[120:123], v[84:87]
v_fmac_f32 v76, v52, v42
v_fmac_f32 v77, v53, v42
v_mfma_f32_16x16x32_bf16 v[92:95], a[144:147], a[76:79], v[92:95]
buffer_load_dwordx4 v4, s[4:7], s20 offen offset:2048  lds
v_mfma_f32_16x16x32_bf16 v[92:95], a[148:151], a[92:95], v[92:95]
s_add_u32 s20, s20, 589824
ds_read_b64_tr_b16 a[144:145], v18 offset:8
v_fmac_f32 v78, v54, v42
v_mfma_f32_16x16x32_bf16 v[92:95], a[152:155], a[108:111], v[92:95]
s_add_u32 m0, s24, 139264
ds_read_b64_tr_b16 a[146:147], v18 offset:6152
v_fmac_f32 v79, v55, v42
v_mfma_f32_16x16x32_bf16 v[92:95], a[156:159], a[124:127], v[92:95]
s_waitcnt lgkmcnt(8)
ds_read_b64_tr_b16 a[148:149], v18 offset:12296
v_fmac_f32 v84, v52, v44
v_mfma_f32_16x16x32_bf16 v[96:99], a[128:131], a[64:67], v[96:99]
s_waitcnt lgkmcnt(7)
ds_read_b64_tr_b16 a[150:151], v18 offset:18440
v_fmac_f32 v85, v53, v44
v_mfma_f32_16x16x32_bf16 v[96:99], a[132:135], a[80:83], v[96:99]
s_waitcnt lgkmcnt(6)
ds_read_b64_tr_b16 a[152:153], v18 offset:24584
v_fmac_f32 v86, v54, v44
v_mfma_f32_16x16x32_bf16 v[96:99], a[136:139], a[96:99], v[96:99]
s_waitcnt lgkmcnt(5)
buffer_load_dwordx4 v2, s[4:7], s20 offen offset:0  lds
v_mfma_f32_16x16x32_bf16 v[96:99], a[140:143], a[112:115], v[96:99]
ds_read_b64_tr_b16 a[154:155], v18 offset:30728
v_fmac_f32 v87, v55, v44
v_mfma_f32_16x16x32_bf16 v[104:107], a[128:131], a[68:71], v[104:107]
ds_read_b64_tr_b16 a[156:157], v18 offset:36872
v_fmac_f32 v92, v52, v46
v_mfma_f32_16x16x32_bf16 v[104:107], a[132:135], a[84:87], v[104:107]
ds_read_b64_tr_b16 a[158:159], v18 offset:43016
v_fmac_f32 v93, v53, v46
v_mfma_f32_16x16x32_bf16 v[104:107], a[136:139], a[100:103], v[104:107]
v_fmac_f32 v94, v54, v46
v_fmac_f32 v95, v55, v46
v_mfma_f32_16x16x32_bf16 v[104:107], a[140:143], a[116:119], v[104:107]
buffer_load_dwordx4 v3, s[4:7], s20 offen offset:1024  lds
v_mfma_f32_16x16x32_bf16 v[112:115], a[128:131], a[72:75], v[112:115]
v_accvgpr_read_b32 v52, a180
v_accvgpr_read_b32 v53, a181
v_mfma_f32_16x16x32_bf16 v[112:115], a[132:135], a[88:91], v[112:115]
v_accvgpr_read_b32 v54, a182
v_accvgpr_read_b32 v55, a183
v_mfma_f32_16x16x32_bf16 v[112:115], a[136:139], a[104:107], v[112:115]
v_mfma_f32_16x16x32_bf16 v[112:115], a[140:143], a[120:123], v[112:115]
v_mfma_f32_16x16x32_bf16 v[120:123], a[128:131], a[76:79], v[120:123]
ds_read_b64_tr_b16 a[128:129], v17 offset:128
v_mfma_f32_16x16x32_bf16 v[120:123], a[132:135], a[92:95], v[120:123]
buffer_load_dwordx4 v4, s[4:7], s20 offen offset:2048  lds
v_mfma_f32_16x16x32_bf16 v[120:123], a[136:139], a[108:111], v[120:123]
s_add_u32 s20, s20, 196608
ds_read_b64_tr_b16 a[130:131], v17 offset:6272
v_mfma_f32_16x16x32_bf16 v[120:123], a[140:143], a[124:127], v[120:123]
s_waitcnt lgkmcnt(8)
ds_read_b64_tr_b16 a[132:133], v17 offset:12416
v_mfma_f32_16x16x32_bf16 v[100:103], a[144:147], a[64:67], v[100:103]
s_waitcnt lgkmcnt(7)
ds_read_b64_tr_b16 a[134:135], v17 offset:18560
v_mfma_f32_16x16x32_bf16 v[100:103], a[148:151], a[80:83], v[100:103]
s_waitcnt lgkmcnt(6)
ds_read_b64_tr_b16 a[136:137], v17 offset:24704
v_mfma_f32_16x16x32_bf16 v[100:103], a[152:155], a[96:99], v[100:103]
s_waitcnt lgkmcnt(5)
ds_read_b64_tr_b16 a[138:139], v17 offset:30848
v_mfma_f32_16x16x32_bf16 v[100:103], a[156:159], a[112:115], v[100:103]
s_add_u32 m0, s24, 142336
ds_read_b64_tr_b16 a[140:141], v17 offset:36992
v_mfma_f32_16x16x32_bf16 v[108:111], a[144:147], a[68:71], v[108:111]
buffer_load_dwordx4 v2, s[4:7], s20 offen offset:0  lds
v_mfma_f32_16x16x32_bf16 v[108:111], a[148:151], a[84:87], v[108:111]
ds_read_b64_tr_b16 a[142:143], v17 offset:43136
v_mfma_f32_16x16x32_bf16 v[108:111], a[152:155], a[100:103], v[108:111]
v_mfma_f32_16x16x32_bf16 v[108:111], a[156:159], a[116:119], v[108:111]
v_fmac_f32 v100, v56, v40
v_fmac_f32 v101, v57, v40
v_mfma_f32_16x16x32_bf16 v[116:119], a[144:147], a[72:75], v[116:119]
buffer_load_dwordx4 v3, s[4:7], s20 offen offset:1024  lds
v_mfma_f32_16x16x32_bf16 v[116:119], a[148:151], a[88:91], v[116:119]
v_fmac_f32 v102, v58, v40
v_fmac_f32 v103, v59, v40
v_mfma_f32_16x16x32_bf16 v[116:119], a[152:155], a[104:107], v[116:119]
v_mfma_f32_16x16x32_bf16 v[116:119], a[156:159], a[120:123], v[116:119]
v_fmac_f32 v108, v56, v42
v_fmac_f32 v109, v57, v42
v_mfma_f32_16x16x32_bf16 v[124:127], a[144:147], a[76:79], v[124:127]
ds_read_b64_tr_b16 a[144:145], v17 offset:136
v_fmac_f32 v110, v58, v42
v_mfma_f32_16x16x32_bf16 v[124:127], a[148:151], a[92:95], v[124:127]
buffer_load_dwordx4 v4, s[4:7], s20 offen offset:2048  lds
v_mfma_f32_16x16x32_bf16 v[124:127], a[152:155], a[108:111], v[124:127]
s_add_u32 s20, s20, 589824
ds_read_b64_tr_b16 a[146:147], v17 offset:6280
v_fmac_f32 v111, v59, v42
v_mfma_f32_16x16x32_bf16 v[124:127], a[156:159], a[124:127], v[124:127]
s_waitcnt lgkmcnt(8)
ds_read_b64_tr_b16 a[148:149], v17 offset:12424
v_fmac_f32 v116, v56, v44
v_mfma_f32_16x16x32_bf16 v[128:131], a[128:131], a[64:67], v[128:131]
s_waitcnt lgkmcnt(7)
ds_read_b64_tr_b16 a[150:151], v17 offset:18568
v_fmac_f32 v117, v57, v44
v_mfma_f32_16x16x32_bf16 v[128:131], a[132:135], a[80:83], v[128:131]
s_waitcnt lgkmcnt(6)
ds_read_b64_tr_b16 a[152:153], v17 offset:24712
v_fmac_f32 v118, v58, v44
v_mfma_f32_16x16x32_bf16 v[128:131], a[136:139], a[96:99], v[128:131]
s_waitcnt lgkmcnt(5)
ds_read_b64_tr_b16 a[154:155], v17 offset:30856
v_fmac_f32 v119, v59, v44
v_mfma_f32_16x16x32_bf16 v[128:131], a[140:143], a[112:115], v[128:131]
buffer_load_dwordx4 a[0:3], v1, s[12:15], s27 offen offset:0 sc1
v_mfma_f32_16x16x32_bf16 v[136:139], a[128:131], a[68:71], v[136:139]
ds_read_b64_tr_b16 a[156:157], v17 offset:37000
v_fmac_f32 v124, v56, v46
v_mfma_f32_16x16x32_bf16 v[136:139], a[132:135], a[84:87], v[136:139]
ds_read_b64_tr_b16 a[158:159], v17 offset:43144
v_fmac_f32 v125, v57, v46
v_mfma_f32_16x16x32_bf16 v[136:139], a[136:139], a[100:103], v[136:139]
v_fmac_f32 v126, v58, v46
v_fmac_f32 v127, v59, v46
v_mfma_f32_16x16x32_bf16 v[136:139], a[140:143], a[116:119], v[136:139]
global_load_dword v30, v1, s[62:63]
v_mfma_f32_16x16x32_bf16 v[144:147], a[128:131], a[72:75], v[144:147]
s_add_u32 s62, s62, 0x2000
v_accvgpr_read_b32 v56, a188
v_accvgpr_read_b32 v57, a189
v_mfma_f32_16x16x32_bf16 v[144:147], a[132:135], a[88:91], v[144:147]
s_addc_u32 s63, s63, 0
v_accvgpr_read_b32 v58, a190
v_accvgpr_read_b32 v59, a191
v_mfma_f32_16x16x32_bf16 v[144:147], a[136:139], a[104:107], v[144:147]
v_mfma_f32_16x16x32_bf16 v[144:147], a[140:143], a[120:123], v[144:147]
buffer_load_dwordx4 a[4:7], v1, s[12:15], s27 offen offset:1024 sc1
v_mfma_f32_16x16x32_bf16 v[152:155], a[128:131], a[76:79], v[152:155]
ds_read_b64_tr_b16 a[128:129], v18 offset:128
v_mfma_f32_16x16x32_bf16 v[152:155], a[132:135], a[92:95], v[152:155]
ds_read_b64_tr_b16 a[130:131], v18 offset:6272
v_mfma_f32_16x16x32_bf16 v[152:155], a[136:139], a[108:111], v[152:155]
ds_read_b64_tr_b16 a[132:133], v18 offset:12416
v_mfma_f32_16x16x32_bf16 v[152:155], a[140:143], a[124:127], v[152:155]
s_waitcnt lgkmcnt(9)
buffer_load_dwordx4 a[8:11], v1, s[12:15], s27 offen offset:2048 sc1
v_mfma_f32_16x16x32_bf16 v[132:135], a[144:147], a[64:67], v[132:135]
s_waitcnt lgkmcnt(7)
ds_read_b64_tr_b16 a[134:135], v18 offset:18560
v_mfma_f32_16x16x32_bf16 v[132:135], a[148:151], a[80:83], v[132:135]
s_waitcnt lgkmcnt(6)
ds_read_b64_tr_b16 a[136:137], v18 offset:24704
v_mfma_f32_16x16x32_bf16 v[132:135], a[152:155], a[96:99], v[132:135]
s_waitcnt lgkmcnt(5)
ds_read_b64_tr_b16 a[138:139], v18 offset:30848
v_mfma_f32_16x16x32_bf16 v[132:135], a[156:159], a[112:115], v[132:135]
buffer_load_dwordx4 a[12:15], v1, s[12:15], s27 offen offset:3072 sc1
v_mfma_f32_16x16x32_bf16 v[140:143], a[144:147], a[68:71], v[140:143]
s_add_u32 s27, s27, 4096
ds_read_b64_tr_b16 a[140:141], v18 offset:36992
v_mfma_f32_16x16x32_bf16 v[140:143], a[148:151], a[84:87], v[140:143]
ds_read_b64_tr_b16 a[142:143], v18 offset:43136
v_mfma_f32_16x16x32_bf16 v[140:143], a[152:155], a[100:103], v[140:143]
v_mfma_f32_16x16x32_bf16 v[140:143], a[156:159], a[116:119], v[140:143]
v_fmac_f32 v132, v52, v40
v_fmac_f32 v133, v53, v40
v_mfma_f32_16x16x32_bf16 v[148:151], a[144:147], a[72:75], v[148:151]
v_fmac_f32 v134, v54, v40
v_fmac_f32 v135, v55, v40
v_mfma_f32_16x16x32_bf16 v[148:151], a[148:151], a[88:91], v[148:151]
buffer_load_dwordx4 a[16:19], v1, s[12:15], s27 offen offset:0 sc1
v_mfma_f32_16x16x32_bf16 v[148:151], a[152:155], a[104:107], v[148:151]
v_mfma_f32_16x16x32_bf16 v[148:151], a[156:159], a[120:123], v[148:151]
v_fmac_f32 v140, v52, v42
v_fmac_f32 v141, v53, v42
v_mfma_f32_16x16x32_bf16 v[156:159], a[144:147], a[76:79], v[156:159]
ds_read_b64_tr_b16 a[144:145], v18 offset:136
v_fmac_f32 v142, v54, v42
v_mfma_f32_16x16x32_bf16 v[156:159], a[148:151], a[92:95], v[156:159]
ds_read_b64_tr_b16 a[146:147], v18 offset:6280
v_fmac_f32 v143, v55, v42
v_mfma_f32_16x16x32_bf16 v[156:159], a[152:155], a[108:111], v[156:159]
buffer_load_dwordx4 a[20:23], v1, s[12:15], s27 offen offset:1024 sc1
v_mfma_f32_16x16x32_bf16 v[156:159], a[156:159], a[124:127], v[156:159]
s_waitcnt lgkmcnt(8)
ds_read_b64_tr_b16 a[148:149], v18 offset:12424
v_fmac_f32 v148, v52, v44
v_mfma_f32_16x16x32_bf16 v[160:163], a[128:131], a[64:67], v[160:163]
s_waitcnt lgkmcnt(7)
ds_read_b64_tr_b16 a[150:151], v18 offset:18568
v_fmac_f32 v149, v53, v44
v_mfma_f32_16x16x32_bf16 v[160:163], a[132:135], a[80:83], v[160:163]
s_waitcnt lgkmcnt(6)
ds_read_b64_tr_b16 a[152:153], v18 offset:24712
v_fmac_f32 v150, v54, v44
v_mfma_f32_16x16x32_bf16 v[160:163], a[136:139], a[96:99], v[160:163]
s_waitcnt lgkmcnt(5)
ds_read_b64_tr_b16 a[154:155], v18 offset:30856
v_fmac_f32 v151, v55, v44
v_mfma_f32_16x16x32_bf16 v[160:163], a[140:143], a[112:115], v[160:163]
ds_read_b64_tr_b16 a[156:157], v18 offset:37000
v_fmac_f32 v156, v52, v46
v_mfma_f32_16x16x32_bf16 v[168:171], a[128:131], a[68:71], v[168:171]
buffer_load_dwordx4 a[24:27], v1, s[12:15], s27 offen offset:2048 sc1
v_mfma_f32_16x16x32_bf16 v[168:171], a[132:135], a[84:87], v[168:171]
ds_read_b64_tr_b16 a[158:159], v18 offset:43144
v_fmac_f32 v157, v53, v46
v_mfma_f32_16x16x32_bf16 v[168:171], a[136:139], a[100:103], v[168:171]
v_fmac_f32 v158, v54, v46
v_fmac_f32 v159, v55, v46
v_mfma_f32_16x16x32_bf16 v[168:171], a[140:143], a[116:119], v[168:171]
v_accvgpr_read_b32 v52, a196
v_accvgpr_read_b32 v53, a197
v_mfma_f32_16x16x32_bf16 v[176:179], a[128:131], a[72:75], v[176:179]
v_accvgpr_read_b32 v54, a198
v_accvgpr_read_b32 v55, a199
v_mfma_f32_16x16x32_bf16 v[176:179], a[132:135], a[88:91], v[176:179]
buffer_load_dwordx4 a[28:31], v1, s[12:15], s27 offen offset:3072 sc1
v_mfma_f32_16x16x32_bf16 v[176:179], a[136:139], a[104:107], v[176:179]
s_add_u32 s27, s27, 4096
v_mfma_f32_16x16x32_bf16 v[176:179], a[140:143], a[120:123], v[176:179]
v_mfma_f32_16x16x32_bf16 v[184:187], a[128:131], a[76:79], v[184:187]
ds_read_b64_tr_b16 a[128:129], v17 offset:256
v_mfma_f32_16x16x32_bf16 v[184:187], a[132:135], a[92:95], v[184:187]
ds_read_b64_tr_b16 a[130:131], v17 offset:6400
v_mfma_f32_16x16x32_bf16 v[184:187], a[136:139], a[108:111], v[184:187]
ds_read_b64_tr_b16 a[132:133], v17 offset:12544
v_mfma_f32_16x16x32_bf16 v[184:187], a[140:143], a[124:127], v[184:187]
s_waitcnt lgkmcnt(9)
buffer_load_dwordx4 a[32:35], v1, s[12:15], s27 offen offset:0 sc1
v_mfma_f32_16x16x32_bf16 v[164:167], a[144:147], a[64:67], v[164:167]
s_waitcnt lgkmcnt(7)
ds_read_b64_tr_b16 a[134:135], v17 offset:18688
v_mfma_f32_16x16x32_bf16 v[164:167], a[148:151], a[80:83], v[164:167]
s_waitcnt lgkmcnt(6)
ds_read_b64_tr_b16 a[136:137], v17 offset:24832
v_mfma_f32_16x16x32_bf16 v[164:167], a[152:155], a[96:99], v[164:167]
s_waitcnt lgkmcnt(5)
ds_read_b64_tr_b16 a[138:139], v17 offset:30976
v_mfma_f32_16x16x32_bf16 v[164:167], a[156:159], a[112:115], v[164:167]
ds_read_b64_tr_b16 a[140:141], v17 offset:37120
v_mfma_f32_16x16x32_bf16 v[172:175], a[144:147], a[68:71], v[172:175]
buffer_load_dwordx4 a[36:39], v1, s[12:15], s27 offen offset:1024 sc1
v_mfma_f32_16x16x32_bf16 v[172:175], a[148:151], a[84:87], v[172:175]
ds_read_b64_tr_b16 a[142:143], v17 offset:43264
v_mfma_f32_16x16x32_bf16 v[172:175], a[152:155], a[100:103], v[172:175]
v_mfma_f32_16x16x32_bf16 v[172:175], a[156:159], a[116:119], v[172:175]
s_nop 0
v_fmac_f32 v164, v56, v40
v_fmac_f32 v165, v57, v40
v_mfma_f32_16x16x32_bf16 v[180:183], a[144:147], a[72:75], v[180:183]
v_fmac_f32 v166, v58, v40
v_fmac_f32 v167, v59, v40
v_mfma_f32_16x16x32_bf16 v[180:183], a[148:151], a[88:91], v[180:183]
v_mfma_f32_16x16x32_bf16 v[180:183], a[152:155], a[104:107], v[180:183]
buffer_load_dwordx4 a[40:43], v1, s[12:15], s27 offen offset:2048 sc1
v_mfma_f32_16x16x32_bf16 v[180:183], a[156:159], a[120:123], v[180:183]
v_fmac_f32 v172, v56, v42
v_fmac_f32 v173, v57, v42
v_mfma_f32_16x16x32_bf16 v[188:191], a[144:147], a[76:79], v[188:191]
ds_read_b64_tr_b16 a[144:145], v17 offset:264
v_fmac_f32 v174, v58, v42
v_mfma_f32_16x16x32_bf16 v[188:191], a[148:151], a[92:95], v[188:191]
ds_read_b64_tr_b16 a[146:147], v17 offset:6408
v_fmac_f32 v175, v59, v42
v_mfma_f32_16x16x32_bf16 v[188:191], a[152:155], a[108:111], v[188:191]
ds_read_b64_tr_b16 a[148:149], v17 offset:12552
v_mfma_f32_16x16x32_bf16 v[188:191], a[156:159], a[124:127], v[188:191]
s_waitcnt lgkmcnt(9)
buffer_load_dwordx4 a[44:47], v1, s[12:15], s27 offen offset:3072 sc1
v_mfma_f32_16x16x32_bf16 v[192:195], a[128:131], a[64:67], v[192:195]
s_waitcnt lgkmcnt(7)
ds_read_b64_tr_b16 a[150:151], v17 offset:18696
v_fmac_f32 v180, v56, v44
v_mfma_f32_16x16x32_bf16 v[192:195], a[132:135], a[80:83], v[192:195]
s_waitcnt lgkmcnt(6)
ds_read_b64_tr_b16 a[152:153], v17 offset:24840
v_fmac_f32 v181, v57, v44
v_mfma_f32_16x16x32_bf16 v[192:195], a[136:139], a[96:99], v[192:195]
s_waitcnt lgkmcnt(5)
ds_read_b64_tr_b16 a[154:155], v17 offset:30984
v_fmac_f32 v182, v58, v44
v_mfma_f32_16x16x32_bf16 v[192:195], a[140:143], a[112:115], v[192:195]
s_add_u32 s27, s27, 4096
ds_read_b64_tr_b16 a[156:157], v17 offset:37128
v_fmac_f32 v183, v59, v44
v_mfma_f32_16x16x32_bf16 v[200:203], a[128:131], a[68:71], v[200:203]
ds_read_b64_tr_b16 a[158:159], v17 offset:43272
v_add_u32 v17, 0x1c000, v17
v_mfma_f32_16x16x32_bf16 v[200:203], a[132:135], a[84:87], v[200:203]
buffer_load_dwordx4 a[48:51], v1, s[12:15], s27 offen offset:0 sc1
v_mfma_f32_16x16x32_bf16 v[200:203], a[136:139], a[100:103], v[200:203]
v_fmac_f32 v188, v56, v46
v_fmac_f32 v189, v57, v46
v_mfma_f32_16x16x32_bf16 v[200:203], a[140:143], a[116:119], v[200:203]
v_fmac_f32 v190, v58, v46
v_fmac_f32 v191, v59, v46
v_mfma_f32_16x16x32_bf16 v[208:211], a[128:131], a[72:75], v[208:211]
v_accvgpr_read_b32 v56, a204
v_accvgpr_read_b32 v57, a205
v_mfma_f32_16x16x32_bf16 v[208:211], a[132:135], a[88:91], v[208:211]
v_accvgpr_read_b32 v58, a206
v_accvgpr_read_b32 v59, a207
v_mfma_f32_16x16x32_bf16 v[208:211], a[136:139], a[104:107], v[208:211]
buffer_load_dwordx4 a[52:55], v1, s[12:15], s27 offen offset:1024 sc1
v_mfma_f32_16x16x32_bf16 v[208:211], a[140:143], a[120:123], v[208:211]
v_mfma_f32_16x16x32_bf16 v[216:219], a[128:131], a[76:79], v[216:219]
ds_read_b64_tr_b16 a[128:129], v18 offset:256
v_mfma_f32_16x16x32_bf16 v[216:219], a[132:135], a[92:95], v[216:219]
ds_read_b64_tr_b16 a[130:131], v18 offset:6400
v_mfma_f32_16x16x32_bf16 v[216:219], a[136:139], a[108:111], v[216:219]
ds_read_b64_tr_b16 a[132:133], v18 offset:12544
v_mfma_f32_16x16x32_bf16 v[216:219], a[140:143], a[124:127], v[216:219]
s_waitcnt lgkmcnt(9)
ds_read_b64_tr_b16 a[134:135], v18 offset:18688
v_mfma_f32_16x16x32_bf16 v[196:199], a[144:147], a[64:67], v[196:199]
s_waitcnt lgkmcnt(8)
buffer_load_dwordx4 a[56:59], v1, s[12:15], s27 offen offset:2048 sc1
v_mfma_f32_16x16x32_bf16 v[196:199], a[148:151], a[80:83], v[196:199]
s_waitcnt lgkmcnt(6)
ds_read_b64_tr_b16 a[136:137], v18 offset:24832
v_mfma_f32_16x16x32_bf16 v[196:199], a[152:155], a[96:99], v[196:199]
s_waitcnt lgkmcnt(5)
ds_read_b64_tr_b16 a[138:139], v18 offset:30976
v_mfma_f32_16x16x32_bf16 v[196:199], a[156:159], a[112:115], v[196:199]
ds_read_b64_tr_b16 a[140:141], v18 offset:37120
v_mfma_f32_16x16x32_bf16 v[204:207], a[144:147], a[68:71], v[204:207]
ds_read_b64_tr_b16 a[142:143], v18 offset:43264
v_mfma_f32_16x16x32_bf16 v[204:207], a[148:151], a[84:87], v[204:207]
buffer_load_dwordx4 a[60:63], v1, s[12:15], s27 offen offset:3072 sc1
v_mfma_f32_16x16x32_bf16 v[204:207], a[152:155], a[100:103], v[204:207]
s_add_u32 s27, s27, 4096
v_mfma_f32_16x16x32_bf16 v[204:207], a[156:159], a[116:119], v[204:207]
s_add_u32 m0, s25, 57344
v_fmac_f32 v196, v52, v40
v_fmac_f32 v197, v53, v40
v_mfma_f32_16x16x32_bf16 v[212:215], a[144:147], a[72:75], v[212:215]
v_fmac_f32 v198, v54, v40
v_fmac_f32 v199, v55, v40
v_mfma_f32_16x16x32_bf16 v[212:215], a[148:151], a[88:91], v[212:215]
v_mfma_f32_16x16x32_bf16 v[212:215], a[152:155], a[104:107], v[212:215]
v_mfma_f32_16x16x32_bf16 v[212:215], a[156:159], a[120:123], v[212:215]
buffer_load_dwordx4 v5, s[8:11], s22 offen offset:0 nt lds
v_mfma_f32_16x16x32_bf16 v[220:223], a[144:147], a[76:79], v[220:223]
ds_read_b64_tr_b16 a[144:145], v18 offset:264
v_fmac_f32 v204, v52, v42
v_mfma_f32_16x16x32_bf16 v[220:223], a[148:151], a[92:95], v[220:223]
ds_read_b64_tr_b16 a[146:147], v18 offset:6408
v_fmac_f32 v205, v53, v42
v_mfma_f32_16x16x32_bf16 v[220:223], a[152:155], a[108:111], v[220:223]
ds_read_b64_tr_b16 a[148:149], v18 offset:12552
v_fmac_f32 v206, v54, v42
v_mfma_f32_16x16x32_bf16 v[220:223], a[156:159], a[124:127], v[220:223]
s_waitcnt lgkmcnt(9)
ds_read_b64_tr_b16 a[150:151], v18 offset:18696
v_fmac_f32 v207, v55, v42
v_mfma_f32_16x16x32_bf16 v[224:227], a[128:131], a[64:67], v[224:227]
s_waitcnt lgkmcnt(8)
buffer_load_dwordx4 v6, s[8:11], s22 offen offset:1024 nt lds
v_mfma_f32_16x16x32_bf16 v[224:227], a[132:135], a[80:83], v[224:227]
s_waitcnt lgkmcnt(6)
ds_read_b64_tr_b16 a[152:153], v18 offset:24840
v_fmac_f32 v212, v52, v44
v_mfma_f32_16x16x32_bf16 v[224:227], a[136:139], a[96:99], v[224:227]
s_waitcnt lgkmcnt(5)
ds_read_b64_tr_b16 a[154:155], v18 offset:30984
v_fmac_f32 v213, v53, v44
v_mfma_f32_16x16x32_bf16 v[224:227], a[140:143], a[112:115], v[224:227]
ds_read_b64_tr_b16 a[156:157], v18 offset:37128
v_fmac_f32 v214, v54, v44
v_mfma_f32_16x16x32_bf16 v[232:235], a[128:131], a[68:71], v[232:235]
ds_read_b64_tr_b16 a[158:159], v18 offset:43272
v_fmac_f32 v215, v55, v44
v_mfma_f32_16x16x32_bf16 v[232:235], a[132:135], a[84:87], v[232:235]
v_fmac_f32 v220, v52, v46
v_fmac_f32 v221, v53, v46
v_mfma_f32_16x16x32_bf16 v[232:235], a[136:139], a[100:103], v[232:235]
buffer_load_dwordx4 v7, s[8:11], s22 offen offset:2048 nt lds
v_mfma_f32_16x16x32_bf16 v[232:235], a[140:143], a[116:119], v[232:235]
s_add_u32 s22, s22, 12288
v_fmac_f32 v222, v54, v46
v_fmac_f32 v223, v55, v46
v_mfma_f32_16x16x32_bf16 v[240:243], a[128:131], a[72:75], v[240:243]
v_mfma_f32_16x16x32_bf16 v[240:243], a[132:135], a[88:91], v[240:243]
v_mfma_f32_16x16x32_bf16 v[240:243], a[136:139], a[104:107], v[240:243]
v_mfma_f32_16x16x32_bf16 v[240:243], a[140:143], a[120:123], v[240:243]
v_mfma_f32_16x16x32_bf16 v[248:251], a[128:131], a[76:79], v[248:251]
v_mfma_f32_16x16x32_bf16 v[248:251], a[132:135], a[92:95], v[248:251]
v_mfma_f32_16x16x32_bf16 v[248:251], a[136:139], a[108:111], v[248:251]
v_mfma_f32_16x16x32_bf16 v[248:251], a[140:143], a[124:127], v[248:251]
s_waitcnt vmcnt(20) lgkmcnt(0)
s_barrier
v_mfma_f32_16x16x32_bf16 v[228:231], a[144:147], a[64:67], v[228:231]
ds_read_b64_tr_b16 a[128:129], v17 offset:0
v_mfma_f32_16x16x32_bf16 v[228:231], a[148:151], a[80:83], v[228:231]
ds_read_b64_tr_b16 a[130:131], v17 offset:6144
v_mfma_f32_16x16x32_bf16 v[228:231], a[152:155], a[96:99], v[228:231]
ds_read_b64_tr_b16 a[132:133], v17 offset:12288
v_mfma_f32_16x16x32_bf16 v[228:231], a[156:159], a[112:115], v[228:231]
ds_read_b64_tr_b16 a[134:135], v17 offset:18432
v_mfma_f32_16x16x32_bf16 v[236:239], a[144:147], a[68:71], v[236:239]
ds_read_b64_tr_b16 a[136:137], v17 offset:24576
v_mfma_f32_16x16x32_bf16 v[236:239], a[148:151], a[84:87], v[236:239]
ds_read_b64_tr_b16 a[138:139], v17 offset:30720
v_mfma_f32_16x16x32_bf16 v[236:239], a[152:155], a[100:103], v[236:239]
ds_read_b64_tr_b16 a[140:141], v17 offset:36864
v_mfma_f32_16x16x32_bf16 v[236:239], a[156:159], a[116:119], v[236:239]
ds_read_b64_tr_b16 a[142:143], v17 offset:43008
v_fmac_f32 v228, v56, v40
v_mfma_f32_16x16x32_bf16 v[244:247], a[144:147], a[72:75], v[244:247]
v_fmac_f32 v229, v57, v40
v_fmac_f32 v230, v58, v40
v_mfma_f32_16x16x32_bf16 v[244:247], a[148:151], a[88:91], v[244:247]
v_fmac_f32 v231, v59, v40
v_mfma_f32_16x16x32_bf16 v[244:247], a[152:155], a[104:107], v[244:247]
v_mfma_f32_16x16x32_bf16 v[244:247], a[156:159], a[120:123], v[244:247]
v_fmac_f32 v236, v56, v42
v_fmac_f32 v237, v57, v42
v_mfma_f32_16x16x32_bf16 v[252:255], a[144:147], a[76:79], v[252:255]
v_fmac_f32 v238, v58, v42
v_fmac_f32 v239, v59, v42
v_mfma_f32_16x16x32_bf16 v[252:255], a[148:151], a[92:95], v[252:255]
v_mfma_f32_16x16x32_bf16 v[252:255], a[152:155], a[108:111], v[252:255]
v_mfma_f32_16x16x32_bf16 v[252:255], a[156:159], a[124:127], v[252:255]
v_fmac_f32 v244, v56, v44
v_fmac_f32 v245, v57, v44
v_fmac_f32 v246, v58, v44
v_fmac_f32 v247, v59, v44
s_nop 3
v_fmac_f32 v252, v56, v46
v_fmac_f32 v253, v57, v46
v_fmac_f32 v254, v58, v46
v_fmac_f32 v255, v59, v46
s_waitcnt vmcnt(19) lgkmcnt(6)
v_mfma_f32_16x16x32_bf16 v[64:67], a[128:131], a[0:3], v[64:67]
s_waitcnt vmcnt(14) lgkmcnt(4)
s_add_u32 m0, s25, 86016
ds_read_b64_tr_b16 a[144:145], v17 offset:8
v_add_u32 v18, 0x1c000, v18
v_mfma_f32_16x16x32_bf16 v[64:67], a[132:135], a[16:19], v[64:67]
s_waitcnt vmcnt(10) lgkmcnt(3)
s_mul_i32 s21, s2, 10240
buffer_load_dwordx4 v5, s[8:11], s22 offen offset:0 nt lds
v_mfma_f32_16x16x32_bf16 v[64:67], a[136:139], a[32:35], v[64:67]
s_waitcnt vmcnt(7) lgkmcnt(1)
s_mov_b32 s31, 0x3a20000
ds_read_b64_tr_b16 a[146:147], v17 offset:6152
v_add_u32 v21, 0x15000, v21
v_mfma_f32_16x16x32_bf16 v[64:67], a[140:143], a[48:51], v[64:67]
ds_read_b64_tr_b16 a[148:149], v17 offset:12296
v_add_u32 v22, 0x15000, v22
v_mfma_f32_16x16x32_bf16 v[72:75], a[128:131], a[4:7], v[72:75]
ds_read_b64_tr_b16 a[150:151], v17 offset:18440
v_add_u32 v23, 0x15000, v23
v_mfma_f32_16x16x32_bf16 v[72:75], a[132:135], a[20:23], v[72:75]
ds_read_b64_tr_b16 a[152:153], v17 offset:24584
v_add_u32 v24, 0x15000, v24
v_mfma_f32_16x16x32_bf16 v[72:75], a[136:139], a[36:39], v[72:75]
s_waitcnt vmcnt(6)
ds_read_b64_tr_b16 a[154:155], v17 offset:30728
v_mfma_f32_16x16x32_bf16 v[72:75], a[140:143], a[52:55], v[72:75]
ds_read_b64_tr_b16 a[156:157], v17 offset:36872
v_mul_f32 v64, v41, v64
v_mfma_f32_16x16x32_bf16 v[80:83], a[128:131], a[8:11], v[80:83]
ds_read_b64_tr_b16 a[158:159], v17 offset:43016
v_mul_f32 v65, v41, v65
v_mfma_f32_16x16x32_bf16 v[80:83], a[132:135], a[24:27], v[80:83]
v_mul_f32 v66, v41, v66
v_mul_f32 v67, v41, v67
v_mfma_f32_16x16x32_bf16 v[80:83], a[136:139], a[40:43], v[80:83]
s_waitcnt vmcnt(5)
v_cvt_pk_bf16_f32 v64, v64, v65
v_cvt_pk_bf16_f32 v65, v66, v67
v_mfma_f32_16x16x32_bf16 v[80:83], a[140:143], a[56:59], v[80:83]
v_mul_f32 v72, v43, v72
v_mul_f32 v73, v43, v73
v_mfma_f32_16x16x32_bf16 v[88:91], a[128:131], a[12:15], v[88:91]
ds_read_b64_tr_b16 a[128:129], v18 offset:0
v_mul_f32 v74, v43, v74
v_mfma_f32_16x16x32_bf16 v[88:91], a[132:135], a[28:31], v[88:91]
ds_read_b64_tr_b16 a[130:131], v18 offset:6144
v_mul_f32 v75, v43, v75
v_mfma_f32_16x16x32_bf16 v[88:91], a[136:139], a[44:47], v[88:91]
s_waitcnt vmcnt(4)
buffer_load_dwordx4 v6, s[8:11], s22 offen offset:1024 nt lds
v_mfma_f32_16x16x32_bf16 v[88:91], a[140:143], a[60:63], v[88:91]
s_waitcnt lgkmcnt(8)
ds_read_b64_tr_b16 a[132:133], v18 offset:12288
v_mul_f32 v80, v45, v80
v_mfma_f32_16x16x32_bf16 v[68:71], a[144:147], a[0:3], v[68:71]
s_waitcnt lgkmcnt(7)
ds_read_b64_tr_b16 a[134:135], v18 offset:18432
v_mul_f32 v81, v45, v81
v_mfma_f32_16x16x32_bf16 v[68:71], a[148:151], a[16:19], v[68:71]
s_waitcnt lgkmcnt(6)
ds_read_b64_tr_b16 a[136:137], v18 offset:24576
v_mul_f32 v82, v45, v82
v_mfma_f32_16x16x32_bf16 v[68:71], a[152:155], a[32:35], v[68:71]
s_waitcnt lgkmcnt(5)
ds_read_b64_tr_b16 a[138:139], v18 offset:30720
v_mul_f32 v83, v45, v83
v_mfma_f32_16x16x32_bf16 v[68:71], a[156:159], a[48:51], v[68:71]
ds_read_b64_tr_b16 a[140:141], v18 offset:36864
v_mul_f32 v88, v47, v88
v_mfma_f32_16x16x32_bf16 v[76:79], a[144:147], a[4:7], v[76:79]
ds_read_b64_tr_b16 a[142:143], v18 offset:43008
v_mul_f32 v89, v47, v89
v_mfma_f32_16x16x32_bf16 v[76:79], a[148:151], a[20:23], v[76:79]
v_mul_f32 v90, v47, v90
v_mul_f32 v91, v47, v91
v_mfma_f32_16x16x32_bf16 v[76:79], a[152:155], a[36:39], v[76:79]
v_mfma_f32_16x16x32_bf16 v[76:79], a[156:159], a[52:55], v[76:79]
v_mul_f32 v68, v41, v68
v_mul_f32 v69, v41, v69
v_mfma_f32_16x16x32_bf16 v[84:87], a[144:147], a[8:11], v[84:87]
v_mul_f32 v70, v41, v70
v_mul_f32 v71, v41, v71
v_mfma_f32_16x16x32_bf16 v[84:87], a[148:151], a[24:27], v[84:87]
v_cvt_pk_bf16_f32 v66, v68, v69
v_cvt_pk_bf16_f32 v67, v70, v71
v_mfma_f32_16x16x32_bf16 v[84:87], a[152:155], a[40:43], v[84:87]
v_cvt_pk_bf16_f32 v68, v72, v73
v_cvt_pk_bf16_f32 v72, v80, v81
v_mfma_f32_16x16x32_bf16 v[84:87], a[156:159], a[56:59], v[84:87]
buffer_load_dwordx4 v7, s[8:11], s22 offen offset:2048 nt lds
v_mfma_f32_16x16x32_bf16 v[92:95], a[144:147], a[12:15], v[92:95]
s_add_u32 s22, s22, 12288
ds_read_b64_tr_b16 a[144:145], v18 offset:8
v_cvt_pk_bf16_f32 v73, v82, v83
v_mfma_f32_16x16x32_bf16 v[92:95], a[148:151], a[28:31], v[92:95]
s_add_u32 m0, s25, 98304
ds_read_b64_tr_b16 a[146:147], v18 offset:6152
v_mul_f32 v76, v43, v76
v_mfma_f32_16x16x32_bf16 v[92:95], a[152:155], a[44:47], v[92:95]
ds_read_b64_tr_b16 a[148:149], v18 offset:12296
v_mul_f32 v77, v43, v77
v_mfma_f32_16x16x32_bf16 v[92:95], a[156:159], a[60:63], v[92:95]
s_waitcnt lgkmcnt(9)
ds_read_b64_tr_b16 a[150:151], v18 offset:18440
v_cvt_pk_bf16_f32 v70, v76, v77
v_mfma_f32_16x16x32_bf16 v[96:99], a[128:131], a[0:3], v[96:99]
s_waitcnt lgkmcnt(8)
ds_read_b64_tr_b16 a[152:153], v18 offset:24584
v_cvt_pk_bf16_f32 v76, v88, v89
v_mfma_f32_16x16x32_bf16 v[96:99], a[132:135], a[16:19], v[96:99]
s_waitcnt lgkmcnt(7)
ds_read_b64_tr_b16 a[154:155], v18 offset:30728
v_mul_f32 v84, v45, v84
v_mfma_f32_16x16x32_bf16 v[96:99], a[136:139], a[32:35], v[96:99]
s_waitcnt lgkmcnt(6)
ds_read_b64_tr_b16 a[156:157], v18 offset:36872
v_mul_f32 v85, v45, v85
v_mfma_f32_16x16x32_bf16 v[96:99], a[140:143], a[48:51], v[96:99]
ds_read_b64_tr_b16 a[158:159], v18 offset:43016
v_mul_f32 v78, v43, v78
v_mfma_f32_16x16x32_bf16 v[104:107], a[128:131], a[4:7], v[104:107]
v_mul_f32 v79, v43, v79
v_cvt_pk_bf16_f32 v69, v74, v75
v_mfma_f32_16x16x32_bf16 v[104:107], a[132:135], a[20:23], v[104:107]
v_cvt_pk_bf16_f32 v74, v84, v85
v_cvt_pk_bf16_f32 v71, v78, v79
v_mfma_f32_16x16x32_bf16 v[104:107], a[136:139], a[36:39], v[104:107]
v_mul_f32 v86, v45, v86
v_mul_f32 v87, v45, v87
v_mfma_f32_16x16x32_bf16 v[104:107], a[140:143], a[52:55], v[104:107]
v_mul_f32 v96, v41, v96
v_mul_f32 v97, v41, v97
v_mfma_f32_16x16x32_bf16 v[112:115], a[128:131], a[8:11], v[112:115]
buffer_load_dwordx4 v8, s[92:95], s23 offen offset:0 nt lds
v_mfma_f32_16x16x32_bf16 v[112:115], a[132:135], a[24:27], v[112:115]
v_mul_f32 v98, v41, v98
v_mul_f32 v99, v41, v99
v_mfma_f32_16x16x32_bf16 v[112:115], a[136:139], a[40:43], v[112:115]
v_cvt_pk_bf16_f32 v80, v96, v97
v_cvt_pk_bf16_f32 v81, v98, v99
v_mfma_f32_16x16x32_bf16 v[112:115], a[140:143], a[56:59], v[112:115]
v_mul_f32 v104, v43, v104
v_mul_f32 v105, v43, v105
v_mfma_f32_16x16x32_bf16 v[120:123], a[128:131], a[12:15], v[120:123]
ds_read_b64_tr_b16 a[128:129], v17 offset:128
v_cvt_pk_bf16_f32 v84, v104, v105
v_mfma_f32_16x16x32_bf16 v[120:123], a[132:135], a[28:31], v[120:123]
ds_read_b64_tr_b16 a[130:131], v17 offset:6272
v_mul_f32 v106, v43, v106
v_mfma_f32_16x16x32_bf16 v[120:123], a[136:139], a[44:47], v[120:123]
ds_read_b64_tr_b16 a[132:133], v17 offset:12416
v_mul_f32 v107, v43, v107
v_mfma_f32_16x16x32_bf16 v[120:123], a[140:143], a[60:63], v[120:123]
s_waitcnt lgkmcnt(9)
ds_read_b64_tr_b16 a[134:135], v17 offset:18560
v_mul_f32 v112, v45, v112
v_mfma_f32_16x16x32_bf16 v[100:103], a[144:147], a[0:3], v[100:103]
s_waitcnt lgkmcnt(8)
ds_read_b64_tr_b16 a[136:137], v17 offset:24704
v_mul_f32 v113, v45, v113
v_mfma_f32_16x16x32_bf16 v[100:103], a[148:151], a[16:19], v[100:103]
s_waitcnt lgkmcnt(7)
ds_read_b64_tr_b16 a[138:139], v17 offset:30848
v_mul_f32 v114, v45, v114
v_mfma_f32_16x16x32_bf16 v[100:103], a[152:155], a[32:35], v[100:103]
s_waitcnt lgkmcnt(6)
ds_read_b64_tr_b16 a[140:141], v17 offset:36992
v_mul_f32 v115, v45, v115
v_mfma_f32_16x16x32_bf16 v[100:103], a[156:159], a[48:51], v[100:103]
ds_read_b64_tr_b16 a[142:143], v17 offset:43136
v_cvt_pk_bf16_f32 v88, v112, v113
v_mfma_f32_16x16x32_bf16 v[108:111], a[144:147], a[4:7], v[108:111]
v_cvt_pk_bf16_f32 v89, v114, v115
v_cvt_pk_bf16_f32 v75, v86, v87
v_mfma_f32_16x16x32_bf16 v[108:111], a[148:151], a[20:23], v[108:111]
buffer_load_dwordx4 v9, s[92:95], s23 offen offset:1024 nt lds
v_mfma_f32_16x16x32_bf16 v[108:111], a[152:155], a[36:39], v[108:111]
v_cvt_pk_bf16_f32 v85, v106, v107
v_cvt_pk_bf16_f32 v77, v90, v91
v_mfma_f32_16x16x32_bf16 v[108:111], a[156:159], a[52:55], v[108:111]
v_mul_f32 v100, v41, v100
v_mul_f32 v101, v41, v101
v_mfma_f32_16x16x32_bf16 v[116:119], a[144:147], a[8:11], v[116:119]
v_mul_f32 v102, v41, v102
v_mul_f32 v103, v41, v103
v_mfma_f32_16x16x32_bf16 v[116:119], a[148:151], a[24:27], v[116:119]
v_cvt_pk_bf16_f32 v82, v100, v101
v_cvt_pk_bf16_f32 v83, v102, v103
v_mfma_f32_16x16x32_bf16 v[116:119], a[152:155], a[40:43], v[116:119]
v_mul_f32 v92, v47, v92
v_mul_f32 v93, v47, v93
v_mfma_f32_16x16x32_bf16 v[116:119], a[156:159], a[56:59], v[116:119]
v_mul_f32 v108, v43, v108
v_mul_f32 v109, v43, v109
v_mfma_f32_16x16x32_bf16 v[124:127], a[144:147], a[12:15], v[124:127]
ds_read_b64_tr_b16 a[144:145], v17 offset:136
v_mul_f32 v110, v43, v110
v_mfma_f32_16x16x32_bf16 v[124:127], a[148:151], a[28:31], v[124:127]
ds_read_b64_tr_b16 a[146:147], v17 offset:6280
v_mul_f32 v111, v43, v111
v_mfma_f32_16x16x32_bf16 v[124:127], a[152:155], a[44:47], v[124:127]
ds_read_b64_tr_b16 a[148:149], v17 offset:12424
v_cvt_pk_bf16_f32 v86, v108, v109
v_mfma_f32_16x16x32_bf16 v[124:127], a[156:159], a[60:63], v[124:127]
s_waitcnt lgkmcnt(9)
ds_read_b64_tr_b16 a[150:151], v17 offset:18568
v_cvt_pk_bf16_f32 v87, v110, v111
v_mfma_f32_16x16x32_bf16 v[128:131], a[128:131], a[0:3], v[128:131]
s_waitcnt lgkmcnt(8)
ds_read_b64_tr_b16 a[152:153], v17 offset:24712
v_mul_f32 v116, v45, v116
v_mfma_f32_16x16x32_bf16 v[128:131], a[132:135], a[16:19], v[128:131]
s_waitcnt lgkmcnt(7)
ds_read_b64_tr_b16 a[154:155], v17 offset:30856
v_mul_f32 v117, v45, v117
v_mfma_f32_16x16x32_bf16 v[128:131], a[136:139], a[32:35], v[128:131]
s_waitcnt lgkmcnt(6)
buffer_load_dwordx4 v10, s[92:95], s23 offen offset:2048 nt lds
v_mfma_f32_16x16x32_bf16 v[128:131], a[140:143], a[48:51], v[128:131]
s_add_u32 s23, s23, 12288
ds_read_b64_tr_b16 a[156:157], v17 offset:37000
v_mul_f32 v118, v45, v118
v_mfma_f32_16x16x32_bf16 v[136:139], a[128:131], a[4:7], v[136:139]
s_add_u32 m0, s25, 0
ds_read_b64_tr_b16 a[158:159], v17 offset:43144
v_mul_f32 v119, v45, v119
v_mfma_f32_16x16x32_bf16 v[136:139], a[132:135], a[20:23], v[136:139]
v_cvt_pk_bf16_f32 v90, v116, v117
v_cvt_pk_bf16_f32 v91, v118, v119
v_mfma_f32_16x16x32_bf16 v[136:139], a[136:139], a[36:39], v[136:139]
v_mul_f32 v120, v47, v120
v_mul_f32 v121, v47, v121
v_mfma_f32_16x16x32_bf16 v[136:139], a[140:143], a[52:55], v[136:139]
v_mul_f32 v128, v41, v128
v_mul_f32 v129, v41, v129
v_mfma_f32_16x16x32_bf16 v[144:147], a[128:131], a[8:11], v[144:147]
v_mul_f32 v130, v41, v130
v_mul_f32 v131, v41, v131
v_mfma_f32_16x16x32_bf16 v[144:147], a[132:135], a[24:27], v[144:147]
v_cvt_pk_bf16_f32 v96, v128, v129
v_cvt_pk_bf16_f32 v97, v130, v131
v_mfma_f32_16x16x32_bf16 v[144:147], a[136:139], a[40:43], v[144:147]
v_cvt_pk_bf16_f32 v78, v92, v93
v_cvt_pk_bf16_f32 v92, v120, v121
v_mfma_f32_16x16x32_bf16 v[144:147], a[140:143], a[56:59], v[144:147]
v_mul_f32 v136, v43, v136
v_mul_f32 v137, v43, v137
v_mfma_f32_16x16x32_bf16 v[152:155], a[128:131], a[12:15], v[152:155]
ds_read_b64_tr_b16 a[128:129], v18 offset:128
v_mul_f32 v138, v43, v138
v_mfma_f32_16x16x32_bf16 v[152:155], a[132:135], a[28:31], v[152:155]
ds_read_b64_tr_b16 a[130:131], v18 offset:6272
v_mul_f32 v139, v43, v139
v_mfma_f32_16x16x32_bf16 v[152:155], a[136:139], a[44:47], v[152:155]
ds_read_b64_tr_b16 a[132:133], v18 offset:12416
v_cvt_pk_bf16_f32 v100, v136, v137
v_mfma_f32_16x16x32_bf16 v[152:155], a[140:143], a[60:63], v[152:155]
s_waitcnt lgkmcnt(9)
buffer_load_dwordx4 v5, s[8:11], s22 offen offset:0 nt lds
v_mfma_f32_16x16x32_bf16 v[132:135], a[144:147], a[0:3], v[132:135]
s_waitcnt lgkmcnt(7)
ds_read_b64_tr_b16 a[134:135], v18 offset:18560
v_mul_f32 v144, v45, v144
v_mfma_f32_16x16x32_bf16 v[132:135], a[148:151], a[16:19], v[132:135]
s_waitcnt lgkmcnt(6)
ds_read_b64_tr_b16 a[136:137], v18 offset:24704
v_mul_f32 v145, v45, v145
v_mfma_f32_16x16x32_bf16 v[132:135], a[152:155], a[32:35], v[132:135]
s_waitcnt lgkmcnt(5)
ds_read_b64_tr_b16 a[138:139], v18 offset:30848
v_mul_f32 v146, v45, v146
v_mfma_f32_16x16x32_bf16 v[132:135], a[156:159], a[48:51], v[132:135]
ds_read_b64_tr_b16 a[140:141], v18 offset:36992
v_mul_f32 v147, v45, v147
v_mfma_f32_16x16x32_bf16 v[140:143], a[144:147], a[4:7], v[140:143]
ds_read_b64_tr_b16 a[142:143], v18 offset:43136
v_cvt_pk_bf16_f32 v104, v144, v145
v_mfma_f32_16x16x32_bf16 v[140:143], a[148:151], a[20:23], v[140:143]
v_cvt_pk_bf16_f32 v105, v146, v147
v_cvt_pk_bf16_f32 v101, v138, v139
v_mfma_f32_16x16x32_bf16 v[140:143], a[152:155], a[36:39], v[140:143]
v_mul_f32 v122, v47, v122
v_mul_f32 v123, v47, v123
v_mfma_f32_16x16x32_bf16 v[140:143], a[156:159], a[52:55], v[140:143]
v_mul_f32 v132, v41, v132
v_mul_f32 v133, v41, v133
v_mfma_f32_16x16x32_bf16 v[148:151], a[144:147], a[8:11], v[148:151]
v_mul_f32 v134, v41, v134
v_mul_f32 v135, v41, v135
v_mfma_f32_16x16x32_bf16 v[148:151], a[148:151], a[24:27], v[148:151]
v_cvt_pk_bf16_f32 v98, v132, v133
v_cvt_pk_bf16_f32 v99, v134, v135
v_mfma_f32_16x16x32_bf16 v[148:151], a[152:155], a[40:43], v[148:151]
v_cvt_pk_bf16_f32 v93, v122, v123
v_mul_f32 v152, v47, v152
v_mfma_f32_16x16x32_bf16 v[148:151], a[156:159], a[56:59], v[148:151]
v_mul_f32 v140, v43, v140
v_mul_f32 v141, v43, v141
v_mfma_f32_16x16x32_bf16 v[156:159], a[144:147], a[12:15], v[156:159]
ds_read_b64_tr_b16 a[144:145], v18 offset:136
v_mul_f32 v142, v43, v142
v_mfma_f32_16x16x32_bf16 v[156:159], a[148:151], a[28:31], v[156:159]
buffer_load_dwordx4 v6, s[8:11], s22 offen offset:1024 nt lds
v_mfma_f32_16x16x32_bf16 v[156:159], a[152:155], a[44:47], v[156:159]
ds_read_b64_tr_b16 a[146:147], v18 offset:6280
v_mul_f32 v143, v43, v143
v_mfma_f32_16x16x32_bf16 v[156:159], a[156:159], a[60:63], v[156:159]
s_waitcnt lgkmcnt(8)
ds_read_b64_tr_b16 a[148:149], v18 offset:12424
v_cvt_pk_bf16_f32 v102, v140, v141
v_mfma_f32_16x16x32_bf16 v[160:163], a[128:131], a[0:3], v[160:163]
s_waitcnt lgkmcnt(7)
ds_read_b64_tr_b16 a[150:151], v18 offset:18568
v_cvt_pk_bf16_f32 v103, v142, v143
v_mfma_f32_16x16x32_bf16 v[160:163], a[132:135], a[16:19], v[160:163]
s_waitcnt lgkmcnt(6)
ds_read_b64_tr_b16 a[152:153], v18 offset:24712
v_mul_f32 v148, v45, v148
v_mfma_f32_16x16x32_bf16 v[160:163], a[136:139], a[32:35], v[160:163]
s_waitcnt lgkmcnt(5)
ds_read_b64_tr_b16 a[154:155], v18 offset:30856
v_mul_f32 v149, v45, v149
v_mfma_f32_16x16x32_bf16 v[160:163], a[140:143], a[48:51], v[160:163]
ds_read_b64_tr_b16 a[156:157], v18 offset:37000
v_mul_f32 v150, v45, v150
v_mfma_f32_16x16x32_bf16 v[168:171], a[128:131], a[4:7], v[168:171]
ds_read_b64_tr_b16 a[158:159], v18 offset:43144
v_mul_f32 v151, v45, v151
v_mfma_f32_16x16x32_bf16 v[168:171], a[132:135], a[20:23], v[168:171]
v_cvt_pk_bf16_f32 v106, v148, v149
v_cvt_pk_bf16_f32 v107, v150, v151
v_mfma_f32_16x16x32_bf16 v[168:171], a[136:139], a[36:39], v[168:171]
v_mul_f32 v153, v47, v153
v_mul_f32 v154, v47, v154
v_mfma_f32_16x16x32_bf16 v[168:171], a[140:143], a[52:55], v[168:171]
v_mul_f32 v160, v41, v160
v_mul_f32 v161, v41, v161
v_mfma_f32_16x16x32_bf16 v[176:179], a[128:131], a[8:11], v[176:179]
v_mul_f32 v162, v41, v162
v_mul_f32 v163, v41, v163
v_mfma_f32_16x16x32_bf16 v[176:179], a[132:135], a[24:27], v[176:179]
v_cvt_pk_bf16_f32 v112, v160, v161
v_cvt_pk_bf16_f32 v113, v162, v163
v_mfma_f32_16x16x32_bf16 v[176:179], a[136:139], a[40:43], v[176:179]
buffer_load_dwordx4 v7, s[8:11], s22 offen offset:2048 nt lds
v_mfma_f32_16x16x32_bf16 v[176:179], a[140:143], a[56:59], v[176:179]
s_add_u32 s22, s22, 12288
v_mul_f32 v168, v43, v168
v_mul_f32 v169, v43, v169
v_mfma_f32_16x16x32_bf16 v[184:187], a[128:131], a[12:15], v[184:187]
s_add_u32 m0, s25, 12288
ds_read_b64_tr_b16 a[128:129], v17 offset:256
v_mul_f32 v170, v43, v170
v_mfma_f32_16x16x32_bf16 v[184:187], a[132:135], a[28:31], v[184:187]
ds_read_b64_tr_b16 a[130:131], v17 offset:6400
v_mul_f32 v171, v43, v171
v_mfma_f32_16x16x32_bf16 v[184:187], a[136:139], a[44:47], v[184:187]
ds_read_b64_tr_b16 a[132:133], v17 offset:12544
v_cvt_pk_bf16_f32 v116, v168, v169
v_mfma_f32_16x16x32_bf16 v[184:187], a[140:143], a[60:63], v[184:187]
s_waitcnt lgkmcnt(9)
ds_read_b64_tr_b16 a[134:135], v17 offset:18688
v_cvt_pk_bf16_f32 v117, v170, v171
v_mfma_f32_16x16x32_bf16 v[164:167], a[144:147], a[0:3], v[164:167]
s_waitcnt lgkmcnt(8)
ds_read_b64_tr_b16 a[136:137], v17 offset:24832
v_mul_f32 v176, v45, v176
v_mfma_f32_16x16x32_bf16 v[164:167], a[148:151], a[16:19], v[164:167]
s_waitcnt lgkmcnt(7)
ds_read_b64_tr_b16 a[138:139], v17 offset:30976
v_mul_f32 v177, v45, v177
v_mfma_f32_16x16x32_bf16 v[164:167], a[152:155], a[32:35], v[164:167]
s_waitcnt lgkmcnt(6)
ds_read_b64_tr_b16 a[140:141], v17 offset:37120
v_mul_f32 v178, v45, v178
v_mfma_f32_16x16x32_bf16 v[164:167], a[156:159], a[48:51], v[164:167]
ds_read_b64_tr_b16 a[142:143], v17 offset:43264
v_mul_f32 v179, v45, v179
v_mfma_f32_16x16x32_bf16 v[172:175], a[144:147], a[4:7], v[172:175]
v_cvt_pk_bf16_f32 v120, v176, v177
v_cvt_pk_bf16_f32 v121, v178, v179
v_mfma_f32_16x16x32_bf16 v[172:175], a[148:151], a[20:23], v[172:175]
v_mul_f32 v155, v47, v155
v_mul_f32 v94, v47, v94
v_mfma_f32_16x16x32_bf16 v[172:175], a[152:155], a[36:39], v[172:175]
v_mul_f32 v95, v47, v95
v_cvt_pk_bf16_f32 v108, v152, v153
v_mfma_f32_16x16x32_bf16 v[172:175], a[156:159], a[52:55], v[172:175]
buffer_load_dwordx4 v8, s[92:95], s23 offen offset:0 nt lds
v_mfma_f32_16x16x32_bf16 v[180:183], a[144:147], a[8:11], v[180:183]
v_mul_f32 v164, v41, v164
v_mul_f32 v165, v41, v165
v_mfma_f32_16x16x32_bf16 v[180:183], a[148:151], a[24:27], v[180:183]
v_mul_f32 v166, v41, v166
v_mul_f32 v167, v41, v167
v_mfma_f32_16x16x32_bf16 v[180:183], a[152:155], a[40:43], v[180:183]
v_cvt_pk_bf16_f32 v114, v164, v165
v_cvt_pk_bf16_f32 v115, v166, v167
v_mfma_f32_16x16x32_bf16 v[180:183], a[156:159], a[56:59], v[180:183]
v_mul_f32 v172, v43, v172
v_mul_f32 v173, v43, v173
v_mfma_f32_16x16x32_bf16 v[188:191], a[144:147], a[12:15], v[188:191]
ds_read_b64_tr_b16 a[144:145], v17 offset:264
v_mul_f32 v174, v43, v174
v_mfma_f32_16x16x32_bf16 v[188:191], a[148:151], a[28:31], v[188:191]
ds_read_b64_tr_b16 a[146:147], v17 offset:6408
v_mul_f32 v175, v43, v175
v_mfma_f32_16x16x32_bf16 v[188:191], a[152:155], a[44:47], v[188:191]
ds_read_b64_tr_b16 a[148:149], v17 offset:12552
v_cvt_pk_bf16_f32 v118, v172, v173
v_mfma_f32_16x16x32_bf16 v[188:191], a[156:159], a[60:63], v[188:191]
s_waitcnt lgkmcnt(9)
ds_read_b64_tr_b16 a[150:151], v17 offset:18696
v_cvt_pk_bf16_f32 v119, v174, v175
v_mfma_f32_16x16x32_bf16 v[192:195], a[128:131], a[0:3], v[192:195]
s_waitcnt lgkmcnt(8)
ds_read_b64_tr_b16 a[152:153], v17 offset:24840
v_mul_f32 v180, v45, v180
v_mfma_f32_16x16x32_bf16 v[192:195], a[132:135], a[16:19], v[192:195]
s_waitcnt lgkmcnt(7)
ds_read_b64_tr_b16 a[154:155], v17 offset:30984
v_mul_f32 v181, v45, v181
v_mfma_f32_16x16x32_bf16 v[192:195], a[136:139], a[32:35], v[192:195]
s_waitcnt lgkmcnt(6)
ds_read_b64_tr_b16 a[156:157], v17 offset:37128
v_mul_f32 v182, v45, v182
v_mfma_f32_16x16x32_bf16 v[192:195], a[140:143], a[48:51], v[192:195]
ds_read_b64_tr_b16 a[158:159], v17 offset:43272
v_mul_f32 v183, v45, v183
v_mfma_f32_16x16x32_bf16 v[200:203], a[128:131], a[4:7], v[200:203]
buffer_load_dwordx4 v9, s[92:95], s23 offen offset:1024 nt lds
v_mfma_f32_16x16x32_bf16 v[200:203], a[132:135], a[20:23], v[200:203]
v_cvt_pk_bf16_f32 v122, v180, v181
v_cvt_pk_bf16_f32 v123, v182, v183
v_mfma_f32_16x16x32_bf16 v[200:203], a[136:139], a[36:39], v[200:203]
v_cvt_pk_bf16_f32 v109, v154, v155
v_cvt_pk_bf16_f32 v79, v94, v95
v_mfma_f32_16x16x32_bf16 v[200:203], a[140:143], a[52:55], v[200:203]
v_mul_f32 v192, v41, v192
v_mul_f32 v193, v41, v193
v_mfma_f32_16x16x32_bf16 v[208:211], a[128:131], a[8:11], v[208:211]
v_mul_f32 v194, v41, v194
v_mul_f32 v195, v41, v195
v_mfma_f32_16x16x32_bf16 v[208:211], a[132:135], a[24:27], v[208:211]
v_cvt_pk_bf16_f32 v128, v192, v193
v_cvt_pk_bf16_f32 v129, v194, v195
v_mfma_f32_16x16x32_bf16 v[208:211], a[136:139], a[40:43], v[208:211]
v_mul_f32 v124, v47, v124
v_mul_f32 v125, v47, v125
v_mfma_f32_16x16x32_bf16 v[208:211], a[140:143], a[56:59], v[208:211]
v_mul_f32 v200, v43, v200
v_mul_f32 v201, v43, v201
v_mfma_f32_16x16x32_bf16 v[216:219], a[128:131], a[12:15], v[216:219]
ds_read_b64_tr_b16 a[128:129], v18 offset:256
v_mul_f32 v202, v43, v202
v_mfma_f32_16x16x32_bf16 v[216:219], a[132:135], a[28:31], v[216:219]
ds_read_b64_tr_b16 a[130:131], v18 offset:6400
v_mul_f32 v203, v43, v203
v_mfma_f32_16x16x32_bf16 v[216:219], a[136:139], a[44:47], v[216:219]
ds_read_b64_tr_b16 a[132:133], v18 offset:12544
v_cvt_pk_bf16_f32 v132, v200, v201
v_mfma_f32_16x16x32_bf16 v[216:219], a[140:143], a[60:63], v[216:219]
s_waitcnt lgkmcnt(9)
ds_read_b64_tr_b16 a[134:135], v18 offset:18688
v_cvt_pk_bf16_f32 v133, v202, v203
v_mfma_f32_16x16x32_bf16 v[196:199], a[144:147], a[0:3], v[196:199]
s_waitcnt lgkmcnt(8)
ds_read_b64_tr_b16 a[136:137], v18 offset:24832
v_mul_f32 v208, v45, v208
v_mfma_f32_16x16x32_bf16 v[196:199], a[148:151], a[16:19], v[196:199]
s_waitcnt lgkmcnt(7)
buffer_load_dwordx4 v10, s[92:95], s23 offen offset:2048 nt lds
v_mfma_f32_16x16x32_bf16 v[196:199], a[152:155], a[32:35], v[196:199]
s_waitcnt lgkmcnt(5)
ds_read_b64_tr_b16 a[138:139], v18 offset:30976
v_mul_f32 v209, v45, v209
v_mfma_f32_16x16x32_bf16 v[196:199], a[156:159], a[48:51], v[196:199]
s_add_u32 s23, s23, 12288
ds_read_b64_tr_b16 a[140:141], v18 offset:37120
v_mul_f32 v210, v45, v210
v_mfma_f32_16x16x32_bf16 v[204:207], a[144:147], a[4:7], v[204:207]
s_add_u32 m0, s26, 24576
ds_read_b64_tr_b16 a[142:143], v18 offset:43264
v_mul_f32 v211, v45, v211
v_mfma_f32_16x16x32_bf16 v[204:207], a[148:151], a[20:23], v[204:207]
v_cvt_pk_bf16_f32 v136, v208, v209
v_cvt_pk_bf16_f32 v137, v210, v211
v_mfma_f32_16x16x32_bf16 v[204:207], a[152:155], a[36:39], v[204:207]
v_mul_f32 v126, v47, v126
v_mul_f32 v127, v47, v127
v_mfma_f32_16x16x32_bf16 v[204:207], a[156:159], a[52:55], v[204:207]
v_mul_f32 v196, v41, v196
v_mul_f32 v197, v41, v197
v_mfma_f32_16x16x32_bf16 v[212:215], a[144:147], a[8:11], v[212:215]
v_mul_f32 v198, v41, v198
v_mul_f32 v199, v41, v199
v_mfma_f32_16x16x32_bf16 v[212:215], a[148:151], a[24:27], v[212:215]
v_cvt_pk_bf16_f32 v130, v196, v197
v_cvt_pk_bf16_f32 v131, v198, v199
v_mfma_f32_16x16x32_bf16 v[212:215], a[152:155], a[40:43], v[212:215]
v_mul_f32 v184, v47, v184
v_mul_f32 v185, v47, v185
v_mfma_f32_16x16x32_bf16 v[212:215], a[156:159], a[56:59], v[212:215]
v_mul_f32 v204, v43, v204
v_mul_f32 v205, v43, v205
v_mfma_f32_16x16x32_bf16 v[220:223], a[144:147], a[12:15], v[220:223]
ds_read_b64_tr_b16 a[144:145], v18 offset:264
v_mul_f32 v206, v43, v206
v_mfma_f32_16x16x32_bf16 v[220:223], a[148:151], a[28:31], v[220:223]
ds_read_b64_tr_b16 a[146:147], v18 offset:6408
v_mul_f32 v207, v43, v207
v_mfma_f32_16x16x32_bf16 v[220:223], a[152:155], a[44:47], v[220:223]
buffer_load_dwordx4 v11, s[16:19], s41 offen nt lds
v_mfma_f32_16x16x32_bf16 v[220:223], a[156:159], a[60:63], v[220:223]
s_waitcnt lgkmcnt(8)
ds_read_b64_tr_b16 a[148:149], v18 offset:12552
v_cvt_pk_bf16_f32 v134, v204, v205
v_mfma_f32_16x16x32_bf16 v[224:227], a[128:131], a[0:3], v[224:227]
s_waitcnt lgkmcnt(7)
ds_read_b64_tr_b16 a[150:151], v18 offset:18696
v_cvt_pk_bf16_f32 v135, v206, v207
v_mfma_f32_16x16x32_bf16 v[224:227], a[132:135], a[16:19], v[224:227]
s_waitcnt lgkmcnt(6)
ds_read_b64_tr_b16 a[152:153], v18 offset:24840
v_mul_f32 v212, v45, v212
v_mfma_f32_16x16x32_bf16 v[224:227], a[136:139], a[32:35], v[224:227]
s_waitcnt lgkmcnt(5)
ds_read_b64_tr_b16 a[154:155], v18 offset:30984
v_mul_f32 v213, v45, v213
v_mfma_f32_16x16x32_bf16 v[224:227], a[140:143], a[48:51], v[224:227]
s_add_u32 s41, s41, 98304
ds_read_b64_tr_b16 a[156:157], v18 offset:37128
v_mul_f32 v214, v45, v214
v_mfma_f32_16x16x32_bf16 v[232:235], a[128:131], a[4:7], v[232:235]
s_add_u32 m0, s25, 28672
ds_read_b64_tr_b16 a[158:159], v18 offset:43272
v_mul_f32 v215, v45, v215
v_mfma_f32_16x16x32_bf16 v[232:235], a[132:135], a[20:23], v[232:235]
v_cvt_pk_bf16_f32 v138, v212, v213
v_cvt_pk_bf16_f32 v139, v214, v215
v_mfma_f32_16x16x32_bf16 v[232:235], a[136:139], a[36:39], v[232:235]
v_mul_f32 v186, v47, v186
v_mul_f32 v187, v47, v187
v_mfma_f32_16x16x32_bf16 v[232:235], a[140:143], a[52:55], v[232:235]
v_mul_f32 v224, v41, v224
v_mul_f32 v225, v41, v225
v_mfma_f32_16x16x32_bf16 v[240:243], a[128:131], a[8:11], v[240:243]
v_mul_f32 v226, v41, v226
v_mul_f32 v227, v41, v227
v_mfma_f32_16x16x32_bf16 v[240:243], a[132:135], a[24:27], v[240:243]
v_cvt_pk_bf16_f32 v144, v224, v225
v_cvt_pk_bf16_f32 v145, v226, v227
v_mfma_f32_16x16x32_bf16 v[240:243], a[136:139], a[40:43], v[240:243]
v_cvt_pk_bf16_f32 v94, v124, v125
v_cvt_pk_bf16_f32 v95, v126, v127
v_mfma_f32_16x16x32_bf16 v[240:243], a[140:143], a[56:59], v[240:243]
v_mul_f32 v232, v43, v232
v_mul_f32 v233, v43, v233
v_mfma_f32_16x16x32_bf16 v[248:251], a[128:131], a[12:15], v[248:251]
v_mul_f32 v234, v43, v234
v_mul_f32 v235, v43, v235
v_mfma_f32_16x16x32_bf16 v[248:251], a[132:135], a[28:31], v[248:251]
v_cvt_pk_bf16_f32 v148, v232, v233
v_cvt_pk_bf16_f32 v149, v234, v235
v_mfma_f32_16x16x32_bf16 v[248:251], a[136:139], a[44:47], v[248:251]
v_mul_f32 v156, v47, v156
v_mul_f32 v157, v47, v157
v_mfma_f32_16x16x32_bf16 v[248:251], a[140:143], a[60:63], v[248:251]
s_waitcnt vmcnt(13) lgkmcnt(0)
s_barrier
v_mul_f32 v240, v45, v240
v_mul_f32 v241, v45, v241
v_mfma_f32_16x16x32_bf16 v[228:231], a[144:147], a[0:3], v[228:231]
ds_read_b128 a[192:195], v19 offset:57344
v_mul_f32 v242, v45, v242
v_mfma_f32_16x16x32_bf16 v[228:231], a[148:151], a[16:19], v[228:231]
ds_read_b128 a[196:199], v20 offset:57344
v_mul_f32 v243, v45, v243
v_mfma_f32_16x16x32_bf16 v[228:231], a[152:155], a[32:35], v[228:231]
ds_read_b128 a[200:203], v19 offset:57472
v_cvt_pk_bf16_f32 v152, v240, v241
v_mfma_f32_16x16x32_bf16 v[228:231], a[156:159], a[48:51], v[228:231]
ds_read_b128 a[204:207], v20 offset:57472
v_cvt_pk_bf16_f32 v153, v242, v243
v_mfma_f32_16x16x32_bf16 v[236:239], a[144:147], a[4:7], v[236:239]
ds_read_b128 a[208:211], v19 offset:57600
v_mul_f32 v158, v47, v158
v_mfma_f32_16x16x32_bf16 v[236:239], a[148:151], a[20:23], v[236:239]
ds_read_b128 a[212:215], v20 offset:57600
v_mul_f32 v159, v47, v159
v_mfma_f32_16x16x32_bf16 v[236:239], a[152:155], a[36:39], v[236:239]
ds_read_b128 a[216:219], v19 offset:63488
v_cvt_pk_bf16_f32 v124, v184, v185
v_mfma_f32_16x16x32_bf16 v[236:239], a[156:159], a[52:55], v[236:239]
ds_read_b128 a[220:223], v20 offset:63488
v_mul_f32 v228, v41, v228
v_mfma_f32_16x16x32_bf16 v[244:247], a[144:147], a[8:11], v[244:247]
ds_read_b128 a[224:227], v19 offset:63616
v_mul_f32 v229, v41, v229
v_mfma_f32_16x16x32_bf16 v[244:247], a[148:151], a[24:27], v[244:247]
ds_read_b128 a[228:231], v20 offset:63616
v_mul_f32 v230, v41, v230
v_mfma_f32_16x16x32_bf16 v[244:247], a[152:155], a[40:43], v[244:247]
ds_read_b128 a[232:235], v19 offset:63744
v_mul_f32 v231, v41, v231
v_mfma_f32_16x16x32_bf16 v[244:247], a[156:159], a[56:59], v[244:247]
ds_read_b128 a[236:239], v20 offset:63744
v_cvt_pk_bf16_f32 v146, v228, v229
v_mfma_f32_16x16x32_bf16 v[252:255], a[144:147], a[12:15], v[252:255]
v_cvt_pk_bf16_f32 v147, v230, v231
v_mul_f32 v236, v43, v236
v_mfma_f32_16x16x32_bf16 v[252:255], a[148:151], a[28:31], v[252:255]
v_mul_f32 v237, v43, v237
v_mul_f32 v238, v43, v238
v_mfma_f32_16x16x32_bf16 v[252:255], a[152:155], a[44:47], v[252:255]
v_mul_f32 v239, v43, v239
v_cvt_pk_bf16_f32 v150, v236, v237
v_mfma_f32_16x16x32_bf16 v[252:255], a[156:159], a[60:63], v[252:255]
s_waitcnt lgkmcnt(11)
v_cvt_pk_bf16_f32 v151, v238, v239
v_mul_f32 v244, v45, v244
v_mfma_f32_16x16x32_bf16 v[48:51], a[192:195], v[64:67], 0
s_waitcnt lgkmcnt(10)
v_mul_f32 v245, v45, v245
v_mul_f32 v246, v45, v246
v_mfma_f32_16x16x32_bf16 v[48:51], a[196:199], v[80:83], v[48:51]
s_waitcnt lgkmcnt(9)
v_mul_f32 v247, v45, v247
v_cvt_pk_bf16_f32 v154, v244, v245
v_mfma_f32_16x16x32_bf16 v[48:51], a[200:203], v[96:99], v[48:51]
s_waitcnt lgkmcnt(8)
buffer_load_dwordx4 v5, s[8:11], s22 offen offset:0 nt lds
v_mfma_f32_16x16x32_bf16 v[48:51], a[204:207], v[112:115], v[48:51]
s_waitcnt lgkmcnt(7)
v_cvt_pk_bf16_f32 v155, v246, v247
v_cvt_pk_bf16_f32 v125, v186, v187
v_mfma_f32_16x16x32_bf16 v[48:51], a[208:211], v[128:131], v[48:51]
s_waitcnt lgkmcnt(6)
v_cvt_pk_bf16_f32 v110, v156, v157
v_cvt_pk_bf16_f32 v111, v158, v159
v_mfma_f32_16x16x32_bf16 v[48:51], a[212:215], v[144:147], v[48:51]
v_mul_f32 v188, v47, v188
v_mul_f32 v189, v47, v189
v_mfma_f32_16x16x32_bf16 v[56:59], a[192:195], v[68:71], 0
buffer_load_dwordx4 v6, s[8:11], s22 offen offset:1024 nt lds
v_mfma_f32_16x16x32_bf16 v[56:59], a[196:199], v[84:87], v[56:59]
v_mul_f32 v190, v47, v190
v_mul_f32 v191, v47, v191
v_mfma_f32_16x16x32_bf16 v[56:59], a[200:203], v[100:103], v[56:59]
v_cvt_pk_bf16_f32 v126, v188, v189
v_cvt_pk_bf16_f32 v127, v190, v191
v_mfma_f32_16x16x32_bf16 v[56:59], a[204:207], v[116:119], v[56:59]
v_max3_f32 v32, v48, v49, v50
v_max_f32 v32, v32, v51
v_mfma_f32_16x16x32_bf16 v[56:59], a[208:211], v[132:135], v[56:59]
buffer_load_dwordx4 v7, s[8:11], s22 offen offset:2048 nt lds
v_mfma_f32_16x16x32_bf16 v[56:59], a[212:215], v[148:151], v[56:59]
s_add_u32 s22, s22, 12288
v_mov_b32 v33, v32
s_nop 1
v_permlane16_swap_b32 v32, v33
v_mfma_f32_16x16x32_bf16 v[176:179], a[192:195], v[72:75], 0
s_add_u32 m0, s25, 40960
v_max_f32 v32, v32, v33
v_mul_f32 v216, v47, v216
v_mfma_f32_16x16x32_bf16 v[176:179], a[196:199], v[88:91], v[176:179]
v_mul_f32 v217, v47, v217
v_mul_f32 v218, v47, v218
v_mfma_f32_16x16x32_bf16 v[176:179], a[200:203], v[104:107], v[176:179]
buffer_load_dwordx4 v8, s[92:95], s23 offen offset:0 nt lds
v_mfma_f32_16x16x32_bf16 v[176:179], a[204:207], v[120:123], v[176:179]
v_mul_f32 v219, v47, v219
v_mul_f32 v220, v47, v220
v_mfma_f32_16x16x32_bf16 v[176:179], a[208:211], v[136:139], v[176:179]
v_mul_f32 v221, v47, v221
v_mul_f32 v222, v47, v222
v_mfma_f32_16x16x32_bf16 v[176:179], a[212:215], v[152:155], v[176:179]
v_mul_f32 v223, v47, v223
v_mov_b32 v33, v32
v_mfma_f32_16x16x32_bf16 v[184:187], a[192:195], v[76:79], 0
buffer_load_dwordx4 v9, s[92:95], s23 offen offset:1024 nt lds
v_mfma_f32_16x16x32_bf16 v[184:187], a[196:199], v[92:95], v[184:187]
v_cvt_pk_bf16_f32 v140, v216, v217
v_cvt_pk_bf16_f32 v141, v218, v219
v_mfma_f32_16x16x32_bf16 v[184:187], a[200:203], v[108:111], v[184:187]
v_cvt_pk_bf16_f32 v142, v220, v221
v_cvt_pk_bf16_f32 v143, v222, v223
v_mfma_f32_16x16x32_bf16 v[184:187], a[204:207], v[124:127], v[184:187]
v_mul_f32 v248, v47, v248
v_mul_f32 v249, v47, v249
v_mfma_f32_16x16x32_bf16 v[184:187], a[208:211], v[140:143], v[184:187]
buffer_load_dwordx4 v10, s[92:95], s23 offen offset:2048 nt lds
v_mul_f32 v250, v47, v250
v_mul_f32 v251, v47, v251
v_mul_f32 v252, v47, v252
v_mul_f32 v253, v47, v253
v_mul_f32 v254, v47, v254
v_mul_f32 v255, v47, v255
v_cvt_pk_bf16_f32 v156, v248, v249
v_cvt_pk_bf16_f32 v157, v250, v251
v_cvt_pk_bf16_f32 v158, v252, v253
v_cvt_pk_bf16_f32 v159, v254, v255
s_nop 1
v_mfma_f32_16x16x32_bf16 v[184:187], a[212:215], v[156:159], v[184:187]
s_waitcnt lgkmcnt(5)
v_permlane32_swap_b32 v32, v33
v_max3_f32 v36, v56, v57, v58
v_max_f32 v32, v32, v33
v_sub_f32 v33, 0, v32
v_sub_f32 v34, 0, v32
v_sub_f32 v35, 0, v32
v_sub_f32 v32, 0, v32
s_nop 1
v_mfma_f32_16x16x32_bf16 v[52:55], a[216:219], v[64:67], v[32:35]
s_waitcnt lgkmcnt(4)
v_max_f32 v36, v36, v59
v_mov_b32 v37, v36
v_mfma_f32_16x16x32_bf16 v[52:55], a[220:223], v[80:83], v[52:55]
s_waitcnt lgkmcnt(3)
v_permlane16_swap_b32 v36, v37
v_max_f32 v36, v36, v37
v_mfma_f32_16x16x32_bf16 v[52:55], a[224:227], v[96:99], v[52:55]
s_waitcnt lgkmcnt(2)
v_mov_b32 v37, v36
s_nop 1
v_permlane32_swap_b32 v36, v37
v_mfma_f32_16x16x32_bf16 v[52:55], a[228:231], v[112:115], v[52:55]
s_waitcnt lgkmcnt(1)
v_max3_f32 v40, v176, v177, v178
v_max_f32 v36, v36, v37
v_mfma_f32_16x16x32_bf16 v[52:55], a[232:235], v[128:131], v[52:55]
s_waitcnt lgkmcnt(0)
v_max_f32 v40, v40, v179
v_sub_f32 v37, 0, v36
v_mfma_f32_16x16x32_bf16 v[52:55], a[236:239], v[144:147], v[52:55]
s_add_u32 s23, s23, 12288
v_sub_f32 v38, 0, v36
v_sub_f32 v39, 0, v36
v_sub_f32 v36, 0, v36
s_nop 1
v_mfma_f32_16x16x32_bf16 v[60:63], a[216:219], v[68:71], v[36:39]
s_add_u32 m0, s26, 53248
v_mov_b32 v41, v40
s_nop 1
v_permlane16_swap_b32 v40, v41
v_mfma_f32_16x16x32_bf16 v[60:63], a[220:223], v[84:87], v[60:63]
buffer_load_dwordx4 v11, s[16:19], s41 offen nt lds
v_mfma_f32_16x16x32_bf16 v[60:63], a[224:227], v[100:103], v[60:63]
s_waitcnt vmcnt(14)
s_barrier
v_max_f32 v40, v40, v41
v_mov_b32 v41, v40
v_mfma_f32_16x16x32_bf16 v[60:63], a[228:231], v[116:119], v[60:63]
s_add_u32 s41, s41, 98304
v_permlane32_swap_b32 v40, v41
v_max3_f32 v44, v184, v185, v186
v_mfma_f32_16x16x32_bf16 v[60:63], a[232:235], v[132:135], v[60:63]
s_add_u32 m0, s25, 57344
v_max_f32 v40, v40, v41
v_max_f32 v44, v44, v187
v_mfma_f32_16x16x32_bf16 v[60:63], a[236:239], v[148:151], v[60:63]
v_sub_f32 v41, 0, v40
v_sub_f32 v42, 0, v40
v_sub_f32 v43, 0, v40
v_sub_f32 v40, 0, v40
s_nop 1
v_mfma_f32_16x16x32_bf16 v[180:183], a[216:219], v[72:75], v[40:43]
v_mov_b32 v45, v44
s_nop 1
v_permlane16_swap_b32 v44, v45
v_mfma_f32_16x16x32_bf16 v[180:183], a[220:223], v[88:91], v[180:183]
v_max_f32 v44, v44, v45
v_mov_b32 v45, v44
v_mfma_f32_16x16x32_bf16 v[180:183], a[224:227], v[104:107], v[180:183]
s_nop 0
v_permlane32_swap_b32 v44, v45
v_add_u32 v19, 0x15000, v19
v_mfma_f32_16x16x32_bf16 v[180:183], a[228:231], v[120:123], v[180:183]
ds_read_b128 a[192:195], v19 offset:0
v_max_f32 v44, v44, v45
v_mfma_f32_16x16x32_bf16 v[180:183], a[232:235], v[136:139], v[180:183]
v_add_u32 v20, 0x15000, v20
v_sub_f32 v45, 0, v44
v_mfma_f32_16x16x32_bf16 v[180:183], a[236:239], v[152:155], v[180:183]
ds_read_b128 a[196:199], v20 offset:0
v_sub_f32 v46, 0, v44
v_sub_f32 v47, 0, v44
v_sub_f32 v44, 0, v44
s_nop 1
v_mfma_f32_16x16x32_bf16 v[188:191], a[216:219], v[76:79], v[44:47]
ds_read_b128 a[200:203], v19 offset:128
v_add_f32 v48, v48, v32
v_mfma_f32_16x16x32_bf16 v[188:191], a[220:223], v[92:95], v[188:191]
ds_read_b128 a[204:207], v20 offset:128
v_add_f32 v49, v49, v32
v_mfma_f32_16x16x32_bf16 v[188:191], a[224:227], v[108:111], v[188:191]
ds_read_b128 a[208:211], v19 offset:256
v_add_f32 v50, v50, v32
v_mfma_f32_16x16x32_bf16 v[188:191], a[228:231], v[124:127], v[188:191]
ds_read_b128 a[212:215], v20 offset:256
v_add_f32 v51, v51, v32
v_mfma_f32_16x16x32_bf16 v[188:191], a[232:235], v[140:143], v[188:191]
ds_read_b128 a[216:219], v19 offset:6144
v_add_f32 v56, v56, v36
v_mfma_f32_16x16x32_bf16 v[188:191], a[236:239], v[156:159], v[188:191]
s_waitcnt lgkmcnt(6)
ds_read_b128 a[220:223], v20 offset:6144
v_add_f32 v57, v57, v36
v_mfma_f32_16x16x32_bf16 v[160:163], a[192:195], v[64:67], v[32:35]
s_waitcnt lgkmcnt(6)
ds_read_b128 a[224:227], v19 offset:6272
v_add_f32 v58, v58, v36
v_mfma_f32_16x16x32_bf16 v[160:163], a[196:199], v[80:83], v[160:163]
s_waitcnt lgkmcnt(6)
ds_read_b128 a[228:231], v20 offset:6272
v_add_f32 v59, v59, v36
v_mfma_f32_16x16x32_bf16 v[160:163], a[200:203], v[96:99], v[160:163]
s_waitcnt lgkmcnt(6)
buffer_load_dwordx4 v5, s[8:11], s22 offen offset:0 nt lds
v_mfma_f32_16x16x32_bf16 v[160:163], a[204:207], v[112:115], v[160:163]
s_waitcnt lgkmcnt(5)
ds_read_b128 a[232:235], v19 offset:6400
v_add_f32 v176, v176, v40
v_mfma_f32_16x16x32_bf16 v[160:163], a[208:211], v[128:131], v[160:163]
s_waitcnt lgkmcnt(5)
ds_read_b128 a[236:239], v20 offset:6400
v_add_f32 v177, v177, v40
v_mfma_f32_16x16x32_bf16 v[160:163], a[212:215], v[144:147], v[160:163]
ds_read_b64_tr_b16 v[232:233], v21 offset:12288
v_add_f32 v178, v178, v40
v_mfma_f32_16x16x32_bf16 v[168:171], a[192:195], v[68:71], v[36:39]
ds_read_b64_tr_b16 v[234:235], v21 offset:18432
v_add_f32 v179, v179, v40
v_mfma_f32_16x16x32_bf16 v[168:171], a[196:199], v[84:87], v[168:171]
ds_read_b64_tr_b16 v[236:237], v22 offset:12288
v_add_f32 v184, v184, v44
v_mfma_f32_16x16x32_bf16 v[168:171], a[200:203], v[100:103], v[168:171]
ds_read_b64_tr_b16 v[238:239], v22 offset:18432
v_add_f32 v185, v185, v44
v_mfma_f32_16x16x32_bf16 v[168:171], a[204:207], v[116:119], v[168:171]
v_exp_f32 v48, v48
v_mfma_f32_16x16x32_bf16 v[168:171], a[208:211], v[132:135], v[168:171]
v_exp_f32 v49, v49
v_mfma_f32_16x16x32_bf16 v[168:171], a[212:215], v[148:151], v[168:171]
v_exp_f32 v50, v50
v_mfma_f32_16x16x32_bf16 v[192:195], a[192:195], v[72:75], v[40:43]
buffer_load_dwordx4 v6, s[8:11], s22 offen offset:1024 nt lds
v_mfma_f32_16x16x32_bf16 v[192:195], a[196:199], v[88:91], v[192:195]
v_exp_f32 v51, v51
v_mfma_f32_16x16x32_bf16 v[192:195], a[200:203], v[104:107], v[192:195]
v_exp_f32 v52, v52
v_mfma_f32_16x16x32_bf16 v[192:195], a[204:207], v[120:123], v[192:195]
v_exp_f32 v53, v53
v_mfma_f32_16x16x32_bf16 v[192:195], a[208:211], v[136:139], v[192:195]
v_exp_f32 v54, v54
v_mfma_f32_16x16x32_bf16 v[192:195], a[212:215], v[152:155], v[192:195]
v_exp_f32 v55, v55
v_mfma_f32_16x16x32_bf16 v[200:203], a[192:195], v[76:79], v[44:47]
ds_read_b64_tr_b16 v[240:241], v23 offset:12288
v_cvt_pk_bf16_f32 v208, v48, v49
v_mfma_f32_16x16x32_bf16 v[200:203], a[196:199], v[92:95], v[200:203]
ds_read_b64_tr_b16 v[242:243], v23 offset:18432
v_cvt_pk_bf16_f32 v209, v50, v51
v_mfma_f32_16x16x32_bf16 v[200:203], a[200:203], v[108:111], v[200:203]
ds_read_b64_tr_b16 v[244:245], v24 offset:12288
v_cvt_pk_bf16_f32 v210, v52, v53
v_mfma_f32_16x16x32_bf16 v[200:203], a[204:207], v[124:127], v[200:203]
ds_read_b64_tr_b16 v[246:247], v24 offset:18432
v_cvt_pk_bf16_f32 v211, v54, v55
v_mfma_f32_16x16x32_bf16 v[200:203], a[208:211], v[140:143], v[200:203]
buffer_load_dwordx4 v7, s[8:11], s22 offen offset:2048 nt lds
v_mfma_f32_16x16x32_bf16 v[200:203], a[212:215], v[156:159], v[200:203]
s_waitcnt lgkmcnt(13)
v_exp_f32 v56, v56
v_mfma_f32_16x16x32_bf16 v[164:167], a[216:219], v[64:67], v[32:35]
s_waitcnt lgkmcnt(12)
v_exp_f32 v57, v57
v_mfma_f32_16x16x32_bf16 v[164:167], a[220:223], v[80:83], v[164:167]
s_waitcnt lgkmcnt(11)
v_exp_f32 v58, v58
v_mfma_f32_16x16x32_bf16 v[164:167], a[224:227], v[96:99], v[164:167]
s_waitcnt lgkmcnt(10)
v_exp_f32 v59, v59
v_mfma_f32_16x16x32_bf16 v[164:167], a[228:231], v[112:115], v[164:167]
s_waitcnt lgkmcnt(9)
v_exp_f32 v60, v60
v_mfma_f32_16x16x32_bf16 v[164:167], a[232:235], v[128:131], v[164:167]
s_waitcnt lgkmcnt(8)
v_exp_f32 v61, v61
v_mfma_f32_16x16x32_bf16 v[164:167], a[236:239], v[144:147], v[164:167]
s_add_u32 s22, s22, 12288
v_exp_f32 v62, v62
v_mfma_f32_16x16x32_bf16 v[172:175], a[216:219], v[68:71], v[36:39]
s_add_u32 m0, s25, 69632
v_exp_f32 v63, v63
v_mfma_f32_16x16x32_bf16 v[172:175], a[220:223], v[84:87], v[172:175]
ds_read_b64_tr_b16 v[248:249], v21 offset:12416
v_add_f32 v186, v186, v44
v_mfma_f32_16x16x32_bf16 v[172:175], a[224:227], v[100:103], v[172:175]
buffer_load_dwordx4 v8, s[92:95], s23 offen offset:0 nt lds
v_mfma_f32_16x16x32_bf16 v[172:175], a[228:231], v[116:119], v[172:175]
ds_read_b64_tr_b16 v[250:251], v21 offset:18560
v_add_f32 v187, v187, v44
v_mfma_f32_16x16x32_bf16 v[172:175], a[232:235], v[132:135], v[172:175]
ds_read_b64_tr_b16 v[252:253], v22 offset:12416
v_cvt_pk_bf16_f32 v212, v56, v57
v_mfma_f32_16x16x32_bf16 v[172:175], a[236:239], v[148:151], v[172:175]
ds_read_b64_tr_b16 v[254:255], v22 offset:18560
v_cvt_pk_bf16_f32 v213, v58, v59
v_mfma_f32_16x16x32_bf16 v[196:199], a[216:219], v[72:75], v[40:43]
v_exp_f32 v176, v176
v_mfma_f32_16x16x32_bf16 v[196:199], a[220:223], v[88:91], v[196:199]
v_exp_f32 v177, v177
v_mfma_f32_16x16x32_bf16 v[196:199], a[224:227], v[104:107], v[196:199]
v_exp_f32 v178, v178
v_mfma_f32_16x16x32_bf16 v[196:199], a[228:231], v[120:123], v[196:199]
v_exp_f32 v179, v179
v_mfma_f32_16x16x32_bf16 v[196:199], a[232:235], v[136:139], v[196:199]
v_exp_f32 v180, v180
v_mfma_f32_16x16x32_bf16 v[196:199], a[236:239], v[152:155], v[196:199]
v_exp_f32 v181, v181
v_mfma_f32_16x16x32_bf16 v[204:207], a[216:219], v[76:79], v[44:47]
buffer_load_dwordx4 v9, s[92:95], s23 offen offset:1024 nt lds
v_mfma_f32_16x16x32_bf16 v[204:207], a[220:223], v[92:95], v[204:207]
v_exp_f32 v182, v182
v_mfma_f32_16x16x32_bf16 v[204:207], a[224:227], v[108:111], v[204:207]
v_cvt_pk_bf16_f32 v214, v60, v61
v_cvt_pk_bf16_f32 v215, v62, v63
v_mfma_f32_16x16x32_bf16 v[204:207], a[228:231], v[124:127], v[204:207]
v_exp_f32 v183, v183
v_mfma_f32_16x16x32_bf16 v[204:207], a[232:235], v[140:143], v[204:207]
v_cvt_pk_bf16_f32 v224, v176, v177
v_cvt_pk_bf16_f32 v225, v178, v179
v_mfma_f32_16x16x32_bf16 v[204:207], a[236:239], v[156:159], v[204:207]
s_waitcnt lgkmcnt(10)
v_cvt_pk_bf16_f32 v226, v180, v181
v_cvt_pk_bf16_f32 v227, v182, v183
v_mfma_f32_16x16x32_bf16 a[0:3], v[232:235], v[208:211], 0
v_exp_f32 v184, v184
v_mfma_f32_16x16x32_bf16 a[4:7], v[232:235], v[212:215], 0
v_exp_f32 v185, v185
v_mfma_f32_16x16x32_bf16 a[8:11], v[232:235], v[224:227], 0
v_exp_f32 v186, v186
v_exp_f32 v187, v187
v_exp_f32 v188, v188
v_exp_f32 v189, v189
v_exp_f32 v190, v190
v_exp_f32 v191, v191
v_cvt_pk_bf16_f32 v228, v184, v185
v_cvt_pk_bf16_f32 v229, v186, v187
v_cvt_pk_bf16_f32 v230, v188, v189
v_cvt_pk_bf16_f32 v231, v190, v191
s_nop 1
v_mfma_f32_16x16x32_bf16 a[12:15], v[232:235], v[228:231], 0
s_waitcnt lgkmcnt(8)
ds_read_b64_tr_b16 v[232:233], v23 offset:12416
v_add_f32 v26, v26, v48
v_mfma_f32_16x16x32_bf16 a[16:19], v[236:239], v[208:211], 0
buffer_load_dwordx4 v10, s[92:95], s23 offen offset:2048 nt lds
v_mfma_f32_16x16x32_bf16 a[20:23], v[236:239], v[212:215], 0
s_add_u32 s23, s23, 12288
ds_read_b64_tr_b16 v[234:235], v23 offset:18560
v_add_f32 v26, v26, v49
v_mfma_f32_16x16x32_bf16 a[24:27], v[236:239], v[224:227], 0
s_add_u32 m0, s26, 81920
v_exp_f32 v160, v160
v_mfma_f32_16x16x32_bf16 a[28:31], v[236:239], v[228:231], 0
s_waitcnt lgkmcnt(8)
ds_read_b64_tr_b16 v[236:237], v24 offset:12416
v_add_f32 v26, v26, v50
v_mfma_f32_16x16x32_bf16 a[32:35], v[240:243], v[208:211], 0
ds_read_b64_tr_b16 v[238:239], v24 offset:18560
v_add_u32 v19, 0xfffeb000, v19
v_mfma_f32_16x16x32_bf16 a[36:39], v[240:243], v[212:215], 0
v_exp_f32 v161, v161
v_mfma_f32_16x16x32_bf16 a[40:43], v[240:243], v[224:227], 0
v_exp_f32 v162, v162
v_mfma_f32_16x16x32_bf16 a[44:47], v[240:243], v[228:231], 0
s_waitcnt lgkmcnt(8)
ds_read_b64_tr_b16 v[240:241], v21 offset:12544
v_add_f32 v26, v26, v51
v_mfma_f32_16x16x32_bf16 a[48:51], v[244:247], v[208:211], 0
ds_read_b64_tr_b16 v[242:243], v21 offset:18688
v_add_u32 v20, 0xfffeb000, v20
v_mfma_f32_16x16x32_bf16 a[52:55], v[244:247], v[212:215], 0
v_exp_f32 v163, v163
v_mfma_f32_16x16x32_bf16 a[56:59], v[244:247], v[224:227], 0
buffer_load_dwordx4 v11, s[16:19], s41 offen nt lds
v_mfma_f32_16x16x32_bf16 a[60:63], v[244:247], v[228:231], 0
s_waitcnt lgkmcnt(8)
ds_read_b64_tr_b16 v[244:245], v22 offset:12544
v_add_f32 v26, v26, v52
v_mfma_f32_16x16x32_bf16 a[64:67], v[248:251], v[208:211], 0
s_add_u32 s41, s41, 98304
ds_read_b64_tr_b16 v[246:247], v22 offset:18688
v_add_f32 v26, v26, v53
v_mfma_f32_16x16x32_bf16 a[68:71], v[248:251], v[212:215], 0
s_add_u32 m0, s25, 86016
v_exp_f32 v168, v168
v_mfma_f32_16x16x32_bf16 a[72:75], v[248:251], v[224:227], 0
v_exp_f32 v169, v169
v_mfma_f32_16x16x32_bf16 a[76:79], v[248:251], v[228:231], 0
s_waitcnt lgkmcnt(8)
ds_read_b64_tr_b16 v[248:249], v23 offset:12544
v_add_f32 v26, v26, v54
v_mfma_f32_16x16x32_bf16 a[80:83], v[252:255], v[208:211], 0
ds_read_b64_tr_b16 v[250:251], v23 offset:18688
v_add_f32 v27, v27, v56
v_mfma_f32_16x16x32_bf16 a[84:87], v[252:255], v[212:215], 0
v_exp_f32 v170, v170
v_mfma_f32_16x16x32_bf16 a[88:91], v[252:255], v[224:227], 0
v_exp_f32 v171, v171
v_mfma_f32_16x16x32_bf16 a[92:95], v[252:255], v[228:231], 0
s_waitcnt lgkmcnt(8)
ds_read_b64_tr_b16 v[252:253], v24 offset:12544
v_add_f32 v26, v26, v55
v_mfma_f32_16x16x32_bf16 a[96:99], v[232:235], v[208:211], 0
ds_read_b64_tr_b16 v[254:255], v24 offset:18688
v_add_f32 v27, v27, v57
v_mfma_f32_16x16x32_bf16 a[100:103], v[232:235], v[212:215], 0
v_exp_f32 v164, v164
v_mfma_f32_16x16x32_bf16 a[104:107], v[232:235], v[224:227], 0
v_exp_f32 v165, v165
v_mfma_f32_16x16x32_bf16 a[108:111], v[232:235], v[228:231], 0
s_waitcnt lgkmcnt(8)
v_exp_f32 v166, v166
v_mfma_f32_16x16x32_bf16 a[112:115], v[236:239], v[208:211], 0
v_exp_f32 v167, v167
v_mfma_f32_16x16x32_bf16 a[116:119], v[236:239], v[212:215], 0
v_exp_f32 v172, v172
v_mfma_f32_16x16x32_bf16 a[120:123], v[236:239], v[224:227], 0
s_waitcnt vmcnt(14) lgkmcnt(0)
s_barrier
v_exp_f32 v173, v173
v_mfma_f32_16x16x32_bf16 a[124:127], v[236:239], v[228:231], 0
ds_read_b128 a[192:195], v19 offset:0
v_add_f32 v27, v27, v58
v_mfma_f32_16x16x32_bf16 a[128:131], v[240:243], v[208:211], 0
ds_read_b128 a[196:199], v20 offset:0
v_add_f32 v26, v26, v160
v_mfma_f32_16x16x32_bf16 a[132:135], v[240:243], v[212:215], 0
ds_read_b128 a[200:203], v19 offset:128
v_add_f32 v27, v27, v59
v_mfma_f32_16x16x32_bf16 a[136:139], v[240:243], v[224:227], 0
ds_read_b128 a[204:207], v20 offset:128
v_add_f32 v26, v26, v161
v_mfma_f32_16x16x32_bf16 a[140:143], v[240:243], v[228:231], 0
ds_read_b128 a[208:211], v19 offset:256
v_add_f32 v27, v27, v60
v_mfma_f32_16x16x32_bf16 a[144:147], v[244:247], v[208:211], 0
ds_read_b128 a[212:215], v20 offset:256
v_add_f32 v26, v26, v162
v_mfma_f32_16x16x32_bf16 a[148:151], v[244:247], v[212:215], 0
ds_read_b128 a[216:219], v19 offset:6144
v_add_f32 v27, v27, v61
v_mfma_f32_16x16x32_bf16 a[152:155], v[244:247], v[224:227], 0
ds_read_b128 a[220:223], v20 offset:6144
v_add_f32 v26, v26, v163
v_mfma_f32_16x16x32_bf16 a[156:159], v[244:247], v[228:231], 0
ds_read_b128 a[224:227], v19 offset:6272
v_cvt_pk_bf16_f32 v216, v160, v161
v_mfma_f32_16x16x32_bf16 a[160:163], v[248:251], v[208:211], 0
ds_read_b128 a[228:231], v20 offset:6272
v_cvt_pk_bf16_f32 v217, v162, v163
v_mfma_f32_16x16x32_bf16 a[164:167], v[248:251], v[212:215], 0
global_load_dword v30, v1, s[62:63]
v_mfma_f32_16x16x32_bf16 a[168:171], v[248:251], v[224:227], 0
s_add_u32 s62, s62, 0x2000
ds_read_b128 a[232:235], v19 offset:6400
v_add_f32 v27, v27, v62
v_mfma_f32_16x16x32_bf16 a[172:175], v[248:251], v[228:231], 0
ds_read_b128 a[236:239], v20 offset:6400
v_add_f32 v27, v27, v63
v_mfma_f32_16x16x32_bf16 a[176:179], v[252:255], v[208:211], 0
s_addc_u32 s63, s63, 0
ds_read_b64_tr_b16 a[240:241], v16 offset:24576
v_add_f32 v27, v27, v168
v_mfma_f32_16x16x32_bf16 a[180:183], v[252:255], v[212:215], 0
ds_read_b64_tr_b16 a[242:243], v16 offset:26624
v_add_f32 v27, v27, v169
v_mfma_f32_16x16x32_bf16 a[184:187], v[252:255], v[224:227], 0
v_exp_f32 v174, v174
v_mfma_f32_16x16x32_bf16 a[188:191], v[252:255], v[228:231], 0
s_waitcnt lgkmcnt(13)
v_exp_f32 v175, v175
v_mfma_f32_16x16x32_bf16 v[160:163], a[192:195], v[64:67], v[32:35]
s_waitcnt lgkmcnt(12)
v_exp_f32 v192, v192
v_mfma_f32_16x16x32_bf16 v[160:163], a[196:199], v[80:83], v[160:163]
s_waitcnt lgkmcnt(11)
v_add_f32 v27, v27, v170
v_add_f32 v27, v27, v171
v_mfma_f32_16x16x32_bf16 v[160:163], a[200:203], v[96:99], v[160:163]
s_waitcnt lgkmcnt(10)
buffer_load_dwordx4 v5, s[8:11], s22 offen offset:0 nt lds
v_mfma_f32_16x16x32_bf16 v[160:163], a[204:207], v[112:115], v[160:163]
s_waitcnt lgkmcnt(9)
v_cvt_pk_bf16_f32 v220, v168, v169
v_cvt_pk_bf16_f32 v221, v170, v171
v_mfma_f32_16x16x32_bf16 v[160:163], a[208:211], v[128:131], v[160:163]
s_waitcnt lgkmcnt(8)
v_exp_f32 v193, v193
v_mfma_f32_16x16x32_bf16 v[160:163], a[212:215], v[144:147], v[160:163]
v_add_f32 v28, v28, v176
v_add_f32 v28, v28, v177
v_mfma_f32_16x16x32_bf16 v[168:171], a[192:195], v[68:71], v[36:39]
v_exp_f32 v194, v194
v_mfma_f32_16x16x32_bf16 v[168:171], a[196:199], v[84:87], v[168:171]
v_add_f32 v28, v28, v178
v_add_f32 v28, v28, v179
v_mfma_f32_16x16x32_bf16 v[168:171], a[200:203], v[100:103], v[168:171]
v_exp_f32 v195, v195
v_mfma_f32_16x16x32_bf16 v[168:171], a[204:207], v[116:119], v[168:171]
buffer_load_dwordx4 v6, s[8:11], s22 offen offset:1024 nt lds
v_mfma_f32_16x16x32_bf16 v[168:171], a[208:211], v[132:135], v[168:171]
v_exp_f32 v196, v196
v_mfma_f32_16x16x32_bf16 v[168:171], a[212:215], v[148:151], v[168:171]
v_add_f32 v29, v29, v184
v_add_f32 v29, v29, v185
v_mfma_f32_16x16x32_bf16 v[176:179], a[192:195], v[72:75], v[40:43]
v_exp_f32 v197, v197
v_mfma_f32_16x16x32_bf16 v[176:179], a[196:199], v[88:91], v[176:179]
v_add_f32 v29, v29, v186
v_add_f32 v29, v29, v187
v_mfma_f32_16x16x32_bf16 v[176:179], a[200:203], v[104:107], v[176:179]
v_exp_f32 v198, v198
v_mfma_f32_16x16x32_bf16 v[176:179], a[204:207], v[120:123], v[176:179]
v_exp_f32 v199, v199
v_mfma_f32_16x16x32_bf16 v[176:179], a[208:211], v[136:139], v[176:179]
buffer_load_dwordx4 v7, s[8:11], s22 offen offset:2048 nt lds
v_mfma_f32_16x16x32_bf16 v[176:179], a[212:215], v[152:155], v[176:179]
s_add_u32 s22, s22, 12288
v_add_f32 v26, v26, v164
v_add_f32 v26, v26, v165
v_mfma_f32_16x16x32_bf16 v[184:187], a[192:195], v[76:79], v[44:47]
s_add_u32 m0, s25, 98304
v_exp_f32 v200, v200
v_mfma_f32_16x16x32_bf16 v[184:187], a[196:199], v[92:95], v[184:187]
v_add_f32 v26, v26, v166
v_add_f32 v26, v26, v167
v_mfma_f32_16x16x32_bf16 v[184:187], a[200:203], v[108:111], v[184:187]
v_cvt_pk_bf16_f32 v218, v164, v165
v_cvt_pk_bf16_f32 v219, v166, v167
v_mfma_f32_16x16x32_bf16 v[184:187], a[204:207], v[124:127], v[184:187]
v_exp_f32 v201, v201
v_mfma_f32_16x16x32_bf16 v[184:187], a[208:211], v[140:143], v[184:187]
v_exp_f32 v202, v202
v_mfma_f32_16x16x32_bf16 v[184:187], a[212:215], v[156:159], v[184:187]
s_waitcnt lgkmcnt(7)
buffer_load_dwordx4 v8, s[92:95], s23 offen offset:0 nt lds
v_mfma_f32_16x16x32_bf16 v[164:167], a[216:219], v[64:67], v[32:35]
s_waitcnt lgkmcnt(6)
v_add_f32 v27, v27, v172
v_add_f32 v27, v27, v173
v_mfma_f32_16x16x32_bf16 v[164:167], a[220:223], v[80:83], v[164:167]
s_waitcnt lgkmcnt(5)
v_add_f32 v27, v27, v174
v_add_f32 v27, v27, v175
v_mfma_f32_16x16x32_bf16 v[164:167], a[224:227], v[96:99], v[164:167]
s_waitcnt lgkmcnt(4)
v_cvt_pk_bf16_f32 v222, v172, v173
v_cvt_pk_bf16_f32 v223, v174, v175
v_mfma_f32_16x16x32_bf16 v[164:167], a[228:231], v[112:115], v[164:167]
s_waitcnt lgkmcnt(3)
v_exp_f32 v203, v203
v_mfma_f32_16x16x32_bf16 v[164:167], a[232:235], v[128:131], v[164:167]
s_waitcnt lgkmcnt(2)
v_exp_f32 v204, v204
v_mfma_f32_16x16x32_bf16 v[164:167], a[236:239], v[144:147], v[164:167]
v_add_f32 v28, v28, v180
v_add_f32 v28, v28, v181
v_mfma_f32_16x16x32_bf16 v[172:175], a[216:219], v[68:71], v[36:39]
buffer_load_dwordx4 v9, s[92:95], s23 offen offset:1024 nt lds
v_mfma_f32_16x16x32_bf16 v[172:175], a[220:223], v[84:87], v[172:175]
v_add_f32 v28, v28, v182
v_add_f32 v28, v28, v183
v_mfma_f32_16x16x32_bf16 v[172:175], a[224:227], v[100:103], v[172:175]
v_exp_f32 v205, v205
v_mfma_f32_16x16x32_bf16 v[172:175], a[228:231], v[116:119], v[172:175]
v_exp_f32 v206, v206
v_mfma_f32_16x16x32_bf16 v[172:175], a[232:235], v[132:135], v[172:175]
v_add_u32 v21, 0xfffeb000, v21
v_add_f32 v29, v29, v188
v_mfma_f32_16x16x32_bf16 v[172:175], a[236:239], v[148:151], v[172:175]
ds_read_b64_tr_b16 v[232:233], v21 offset:12288
v_add_f32 v29, v29, v189
v_mfma_f32_16x16x32_bf16 v[180:183], a[216:219], v[72:75], v[40:43]
ds_read_b64_tr_b16 v[234:235], v21 offset:18432
v_add_f32 v29, v29, v190
v_mfma_f32_16x16x32_bf16 v[180:183], a[220:223], v[88:91], v[180:183]
buffer_load_dwordx4 v10, s[92:95], s23 offen offset:2048 nt lds
v_mfma_f32_16x16x32_bf16 v[180:183], a[224:227], v[104:107], v[180:183]
s_add_u32 s23, s23, 12288
v_add_f32 v29, v29, v191
v_add_u32 v22, 0xfffeb000, v22
v_mfma_f32_16x16x32_bf16 v[180:183], a[228:231], v[120:123], v[180:183]
s_add_u32 m0, s26, 110592
ds_read_b64_tr_b16 v[236:237], v22 offset:12288
v_and_b32 v61, 7, v0
v_mfma_f32_16x16x32_bf16 v[180:183], a[232:235], v[136:139], v[180:183]
v_lshrrev_b32 v62, 3, v0
v_mul_u32_u24 v63, 1280, v61
v_mfma_f32_16x16x32_bf16 v[180:183], a[236:239], v[152:155], v[180:183]
ds_read_b64_tr_b16 v[238:239], v22 offset:18432
v_lshl_add_u32 v63, v62, 4, v63
v_mfma_f32_16x16x32_bf16 v[188:191], a[216:219], v[76:79], v[44:47]
v_add_u32 v23, 0xfffeb000, v23
v_cvt_pk_bf16_f32 v224, v192, v193
v_mfma_f32_16x16x32_bf16 v[188:191], a[220:223], v[92:95], v[188:191]
ds_read_b64_tr_b16 v[240:241], v23 offset:12288
v_cvt_pk_bf16_f32 v225, v194, v195
v_mfma_f32_16x16x32_bf16 v[188:191], a[224:227], v[108:111], v[188:191]
buffer_load_dwordx4 v11, s[16:19], s41 offen nt lds
v_mfma_f32_16x16x32_bf16 v[188:191], a[228:231], v[124:127], v[188:191]
s_add_u32 s41, s41, 98304
ds_read_b64_tr_b16 v[242:243], v23 offset:18432
v_cvt_pk_bf16_f32 v226, v196, v197
v_mfma_f32_16x16x32_bf16 v[188:191], a[232:235], v[140:143], v[188:191]
s_lshl_b32 s60, s30, 7
v_cvt_pk_bf16_f32 v227, v198, v199
v_cvt_pk_bf16_f32 v228, v200, v201
v_mfma_f32_16x16x32_bf16 v[188:191], a[236:239], v[156:159], v[188:191]
s_waitcnt lgkmcnt(4)
v_exp_f32 v207, v207
v_mfma_f32_16x16x32_bf16 a[0:3], v[232:235], v[216:219], a[0:3]
s_add_u32 s21, s21, s60
v_cvt_pk_bf16_f32 v229, v202, v203
v_cvt_pk_bf16_f32 v230, v204, v205
v_mfma_f32_16x16x32_bf16 a[4:7], v[232:235], v[220:223], a[4:7]
s_mov_b32 s16, s72
v_cvt_pk_bf16_f32 v231, v206, v207
v_add_u32 v24, 0xfffeb000, v24
v_mfma_f32_16x16x32_bf16 a[8:11], v[232:235], v[224:227], a[8:11]
s_mov_b32 s17, s73
ds_read_b64_tr_b16 v[244:245], v24 offset:12288
v_add_f32 v28, v28, v192
v_mfma_f32_16x16x32_bf16 a[12:15], v[232:235], v[228:231], a[12:15]
s_waitcnt lgkmcnt(3)
ds_read_b64_tr_b16 v[246:247], v24 offset:18432
v_add_f32 v28, v28, v193
v_mfma_f32_16x16x32_bf16 a[16:19], v[236:239], v[216:219], a[16:19]
s_mov_b32 s18, 0x780000
buffer_load_dwordx4 a[244:247], v63, s[96:99], s21 offen
v_mfma_f32_16x16x32_bf16 a[20:23], v[236:239], v[220:223], a[20:23]
s_mov_b32 s41, s43
ds_read_b64_tr_b16 v[248:249], v21 offset:12416
v_add_f32 v28, v28, v194
v_mfma_f32_16x16x32_bf16 a[24:27], v[236:239], v[224:227], a[24:27]
ds_read_b64_tr_b16 v[250:251], v21 offset:18560
v_add_f32 v28, v28, v195
v_mfma_f32_16x16x32_bf16 a[28:31], v[236:239], v[228:231], a[28:31]
s_waitcnt lgkmcnt(4)
ds_read_b64_tr_b16 v[252:253], v22 offset:12416
v_add_f32 v29, v29, v200
v_mfma_f32_16x16x32_bf16 a[32:35], v[240:243], v[216:219], a[32:35]
ds_read_b64_tr_b16 v[254:255], v22 offset:18560
v_add_f32 v29, v29, v201
v_mfma_f32_16x16x32_bf16 a[36:39], v[240:243], v[220:223], a[36:39]
ds_read_b64_tr_b16 v[232:233], v23 offset:12416
v_add_f32 v29, v29, v202
v_mfma_f32_16x16x32_bf16 a[40:43], v[240:243], v[224:227], a[40:43]
buffer_load_dwordx4 a[248:251], v63, s[96:99], s21 offen offset:512
v_mfma_f32_16x16x32_bf16 a[44:47], v[240:243], v[228:231], a[44:47]
s_waitcnt lgkmcnt(5)
ds_read_b64_tr_b16 v[234:235], v23 offset:18560
v_add_f32 v29, v29, v203
v_mfma_f32_16x16x32_bf16 a[48:51], v[244:247], v[216:219], a[48:51]
ds_read_b64_tr_b16 v[236:237], v24 offset:12416
v_add_f32 v28, v28, v196
v_mfma_f32_16x16x32_bf16 a[52:55], v[244:247], v[220:223], a[52:55]
ds_read_b64_tr_b16 v[238:239], v24 offset:18560
v_add_f32 v28, v28, v197
v_mfma_f32_16x16x32_bf16 a[56:59], v[244:247], v[224:227], a[56:59]
ds_read_b64_tr_b16 v[240:241], v21 offset:12544
v_add_f32 v28, v28, v198
v_mfma_f32_16x16x32_bf16 a[60:63], v[244:247], v[228:231], a[60:63]
s_waitcnt lgkmcnt(7)
ds_read_b64_tr_b16 v[242:243], v21 offset:18688
v_add_f32 v28, v28, v199
v_mfma_f32_16x16x32_bf16 a[64:67], v[248:251], v[216:219], a[64:67]
ds_read_b64_tr_b16 v[244:245], v22 offset:12544
v_add_f32 v29, v29, v204
v_mfma_f32_16x16x32_bf16 a[68:71], v[248:251], v[220:223], a[68:71]
buffer_load_dwordx4 a[252:255], v63, s[96:99], s21 offen offset:1024
v_mfma_f32_16x16x32_bf16 a[72:75], v[248:251], v[224:227], a[72:75]
ds_read_b64_tr_b16 v[246:247], v22 offset:18688
v_add_f32 v29, v29, v205
v_mfma_f32_16x16x32_bf16 a[76:79], v[248:251], v[228:231], a[76:79]
s_waitcnt lgkmcnt(8)
ds_read_b64_tr_b16 v[248:249], v23 offset:12544
v_add_f32 v29, v29, v206
v_mfma_f32_16x16x32_bf16 a[80:83], v[252:255], v[216:219], a[80:83]
ds_read_b64_tr_b16 v[250:251], v23 offset:18688
v_add_f32 v29, v29, v207
v_mfma_f32_16x16x32_bf16 a[84:87], v[252:255], v[220:223], a[84:87]
v_exp_f32 v160, v160
v_mfma_f32_16x16x32_bf16 a[88:91], v[252:255], v[224:227], a[88:91]
v_exp_f32 v161, v161
v_mfma_f32_16x16x32_bf16 a[92:95], v[252:255], v[228:231], a[92:95]
s_waitcnt lgkmcnt(8)
ds_read_b64_tr_b16 v[252:253], v24 offset:12544
v_add_f32 v26, v26, v160
v_mfma_f32_16x16x32_bf16 a[96:99], v[232:235], v[216:219], a[96:99]
ds_read_b64_tr_b16 v[254:255], v24 offset:18688
v_add_f32 v26, v26, v161
v_mfma_f32_16x16x32_bf16 a[100:103], v[232:235], v[220:223], a[100:103]
v_exp_f32 v162, v162
v_mfma_f32_16x16x32_bf16 a[104:107], v[232:235], v[224:227], a[104:107]
v_exp_f32 v163, v163
v_mfma_f32_16x16x32_bf16 a[108:111], v[232:235], v[228:231], a[108:111]
s_waitcnt lgkmcnt(8)
v_exp_f32 v168, v168
v_mfma_f32_16x16x32_bf16 a[112:115], v[236:239], v[216:219], a[112:115]
v_exp_f32 v169, v169
v_mfma_f32_16x16x32_bf16 a[116:119], v[236:239], v[220:223], a[116:119]
v_exp_f32 v170, v170
v_mfma_f32_16x16x32_bf16 a[120:123], v[236:239], v[224:227], a[120:123]
s_waitcnt vmcnt(18) lgkmcnt(0)
s_barrier
v_exp_f32 v171, v171
v_mfma_f32_16x16x32_bf16 a[124:127], v[236:239], v[228:231], a[124:127]
ds_read_b128 a[192:195], v19 offset:28672
v_add_f32 v26, v26, v162
v_mfma_f32_16x16x32_bf16 a[128:131], v[240:243], v[216:219], a[128:131]
ds_read_b128 a[196:199], v20 offset:28672
v_add_f32 v26, v26, v163
v_mfma_f32_16x16x32_bf16 a[132:135], v[240:243], v[220:223], a[132:135]
ds_read_b128 a[200:203], v19 offset:28800
v_cvt_pk_bf16_f32 v208, v160, v161
v_mfma_f32_16x16x32_bf16 a[136:139], v[240:243], v[224:227], a[136:139]
ds_read_b128 a[204:207], v20 offset:28800
v_cvt_pk_bf16_f32 v209, v162, v163
v_mfma_f32_16x16x32_bf16 a[140:143], v[240:243], v[228:231], a[140:143]
ds_read_b128 a[208:211], v19 offset:28928
v_add_f32 v27, v27, v168
v_mfma_f32_16x16x32_bf16 a[144:147], v[244:247], v[216:219], a[144:147]
buffer_store_dwordx4 a[240:243], v1, s[12:15], s42 offen sc1
v_mfma_f32_16x16x32_bf16 a[148:151], v[244:247], v[220:223], a[148:151]
s_add_u32 s42, s42, 6144
ds_read_b128 a[212:215], v20 offset:28928
v_add_f32 v27, v27, v169
v_mfma_f32_16x16x32_bf16 a[152:155], v[244:247], v[224:227], a[152:155]
s_add_u32 m0, s25, 0
ds_read_b128 a[216:219], v19 offset:34816
v_add_f32 v27, v27, v170
v_mfma_f32_16x16x32_bf16 a[156:159], v[244:247], v[228:231], a[156:159]
ds_read_b128 a[220:223], v20 offset:34816
v_add_f32 v27, v27, v171
v_mfma_f32_16x16x32_bf16 a[160:163], v[248:251], v[216:219], a[160:163]
ds_read_b128 a[224:227], v19 offset:34944
v_cvt_pk_bf16_f32 v212, v168, v169
v_mfma_f32_16x16x32_bf16 a[164:167], v[248:251], v[220:223], a[164:167]
ds_read_b128 a[228:231], v20 offset:34944
v_cvt_pk_bf16_f32 v213, v170, v171
v_mfma_f32_16x16x32_bf16 a[168:171], v[248:251], v[224:227], a[168:171]
v_exp_f32 v164, v164
v_mfma_f32_16x16x32_bf16 a[172:175], v[248:251], v[228:231], a[172:175]
ds_read_b128 a[232:235], v19 offset:35072
v_add_f32 v26, v26, v164
v_mfma_f32_16x16x32_bf16 a[176:179], v[252:255], v[216:219], a[176:179]
v_exp_f32 v165, v165
v_mfma_f32_16x16x32_bf16 a[180:183], v[252:255], v[220:223], a[180:183]
ds_read_b128 a[236:239], v20 offset:35072
v_add_f32 v26, v26, v165
v_mfma_f32_16x16x32_bf16 a[184:187], v[252:255], v[224:227], a[184:187]
v_exp_f32 v166, v166
v_mfma_f32_16x16x32_bf16 a[188:191], v[252:255], v[228:231], a[188:191]
s_waitcnt lgkmcnt(11)
v_exp_f32 v167, v167
v_mfma_f32_16x16x32_bf16 v[160:163], a[192:195], v[64:67], v[32:35]
s_waitcnt lgkmcnt(10)
ds_read_b64_tr_b16 a[240:241], v16 offset:53248
v_add_f32 v26, v26, v166
v_mfma_f32_16x16x32_bf16 v[160:163], a[196:199], v[80:83], v[160:163]
s_waitcnt lgkmcnt(10)
ds_read_b64_tr_b16 a[242:243], v16 offset:55296
v_add_f32 v26, v26, v167
v_mfma_f32_16x16x32_bf16 v[160:163], a[200:203], v[96:99], v[160:163]
s_waitcnt lgkmcnt(10)
buffer_load_dwordx4 v5, s[8:11], s22 offen offset:0 nt lds
v_mfma_f32_16x16x32_bf16 v[160:163], a[204:207], v[112:115], v[160:163]
s_waitcnt lgkmcnt(9)
ds_read_b64_tr_b16 v[232:233], v21 offset:40960
v_cvt_pk_bf16_f32 v210, v164, v165
v_mfma_f32_16x16x32_bf16 v[160:163], a[208:211], v[128:131], v[160:163]
s_waitcnt lgkmcnt(9)
ds_read_b64_tr_b16 v[234:235], v21 offset:47104
v_cvt_pk_bf16_f32 v211, v166, v167
v_mfma_f32_16x16x32_bf16 v[160:163], a[212:215], v[144:147], v[160:163]
v_exp_f32 v172, v172
v_mfma_f32_16x16x32_bf16 v[168:171], a[192:195], v[68:71], v[36:39]
v_exp_f32 v173, v173
v_mfma_f32_16x16x32_bf16 v[168:171], a[196:199], v[84:87], v[168:171]
ds_read_b64_tr_b16 v[236:237], v22 offset:40960
v_add_f32 v27, v27, v172
v_mfma_f32_16x16x32_bf16 v[168:171], a[200:203], v[100:103], v[168:171]
v_exp_f32 v174, v174
v_mfma_f32_16x16x32_bf16 v[168:171], a[204:207], v[116:119], v[168:171]
ds_read_b64_tr_b16 v[238:239], v22 offset:47104
v_add_f32 v27, v27, v173
v_mfma_f32_16x16x32_bf16 v[168:171], a[208:211], v[132:135], v[168:171]
v_exp_f32 v175, v175
v_mfma_f32_16x16x32_bf16 v[168:171], a[212:215], v[148:151], v[168:171]
ds_read_b64_tr_b16 v[240:241], v23 offset:40960
v_add_f32 v27, v27, v174
v_mfma_f32_16x16x32_bf16 v[192:195], a[192:195], v[72:75], v[40:43]
buffer_load_dwordx4 v6, s[8:11], s22 offen offset:1024 nt lds
v_mfma_f32_16x16x32_bf16 v[192:195], a[196:199], v[88:91], v[192:195]
ds_read_b64_tr_b16 v[242:243], v23 offset:47104
v_add_f32 v27, v27, v175
v_mfma_f32_16x16x32_bf16 v[192:195], a[200:203], v[104:107], v[192:195]
ds_read_b64_tr_b16 v[244:245], v24 offset:40960
v_cvt_pk_bf16_f32 v214, v172, v173
v_mfma_f32_16x16x32_bf16 v[192:195], a[204:207], v[120:123], v[192:195]
ds_read_b64_tr_b16 v[246:247], v24 offset:47104
v_cvt_pk_bf16_f32 v215, v174, v175
v_mfma_f32_16x16x32_bf16 v[192:195], a[208:211], v[136:139], v[192:195]
v_exp_f32 v176, v176
v_mfma_f32_16x16x32_bf16 v[192:195], a[212:215], v[152:155], v[192:195]
v_exp_f32 v177, v177
v_mfma_f32_16x16x32_bf16 v[200:203], a[192:195], v[76:79], v[44:47]
v_exp_f32 v178, v178
v_mfma_f32_16x16x32_bf16 v[200:203], a[196:199], v[92:95], v[200:203]
v_exp_f32 v179, v179
v_mfma_f32_16x16x32_bf16 v[200:203], a[200:203], v[108:111], v[200:203]
v_exp_f32 v180, v180
v_mfma_f32_16x16x32_bf16 v[200:203], a[204:207], v[124:127], v[200:203]
v_exp_f32 v181, v181
v_mfma_f32_16x16x32_bf16 v[200:203], a[208:211], v[140:143], v[200:203]
buffer_load_dwordx4 v7, s[8:11], s22 offen offset:2048 nt lds
v_mfma_f32_16x16x32_bf16 v[200:203], a[212:215], v[156:159], v[200:203]
s_waitcnt lgkmcnt(15)
v_exp_f32 v182, v182
v_mfma_f32_16x16x32_bf16 v[164:167], a[216:219], v[64:67], v[32:35]
s_waitcnt lgkmcnt(14)
v_exp_f32 v183, v183
v_mfma_f32_16x16x32_bf16 v[164:167], a[220:223], v[80:83], v[164:167]
s_waitcnt lgkmcnt(13)
ds_read_b64_tr_b16 v[248:249], v21 offset:41088
v_cvt_pk_bf16_f32 v224, v176, v177
v_mfma_f32_16x16x32_bf16 v[164:167], a[224:227], v[96:99], v[164:167]
s_waitcnt lgkmcnt(13)
ds_read_b64_tr_b16 v[250:251], v21 offset:47232
v_cvt_pk_bf16_f32 v225, v178, v179
v_mfma_f32_16x16x32_bf16 v[164:167], a[228:231], v[112:115], v[164:167]
s_waitcnt lgkmcnt(13)
ds_read_b64_tr_b16 v[252:253], v22 offset:41088
v_cvt_pk_bf16_f32 v226, v180, v181
v_mfma_f32_16x16x32_bf16 v[164:167], a[232:235], v[128:131], v[164:167]
s_waitcnt lgkmcnt(13)
ds_read_b64_tr_b16 v[254:255], v22 offset:47232
v_cvt_pk_bf16_f32 v227, v182, v183
v_mfma_f32_16x16x32_bf16 v[164:167], a[236:239], v[144:147], v[164:167]
s_add_u32 s22, s22, 12288
v_exp_f32 v184, v184
v_mfma_f32_16x16x32_bf16 v[172:175], a[216:219], v[68:71], v[36:39]
s_add_u32 m0, s25, 12288
v_exp_f32 v185, v185
v_mfma_f32_16x16x32_bf16 v[172:175], a[220:223], v[84:87], v[172:175]
v_exp_f32 v186, v186
v_mfma_f32_16x16x32_bf16 v[172:175], a[224:227], v[100:103], v[172:175]
buffer_load_dwordx4 v8, s[92:95], s23 offen offset:0 nt lds
v_mfma_f32_16x16x32_bf16 v[172:175], a[228:231], v[116:119], v[172:175]
v_exp_f32 v187, v187
v_mfma_f32_16x16x32_bf16 v[172:175], a[232:235], v[132:135], v[172:175]
v_exp_f32 v188, v188
v_mfma_f32_16x16x32_bf16 v[172:175], a[236:239], v[148:151], v[172:175]
v_exp_f32 v189, v189
v_mfma_f32_16x16x32_bf16 v[196:199], a[216:219], v[72:75], v[40:43]
v_exp_f32 v190, v190
v_mfma_f32_16x16x32_bf16 v[196:199], a[220:223], v[88:91], v[196:199]
v_exp_f32 v191, v191
v_mfma_f32_16x16x32_bf16 v[196:199], a[224:227], v[104:107], v[196:199]
v_exp_f32 v160, v160
v_mfma_f32_16x16x32_bf16 v[196:199], a[228:231], v[120:123], v[196:199]
v_exp_f32 v161, v161
v_mfma_f32_16x16x32_bf16 v[196:199], a[232:235], v[136:139], v[196:199]
v_exp_f32 v162, v162
v_mfma_f32_16x16x32_bf16 v[196:199], a[236:239], v[152:155], v[196:199]
v_exp_f32 v163, v163
v_mfma_f32_16x16x32_bf16 v[204:207], a[216:219], v[76:79], v[44:47]
buffer_load_dwordx4 v9, s[92:95], s23 offen offset:1024 nt lds
v_mfma_f32_16x16x32_bf16 v[204:207], a[220:223], v[92:95], v[204:207]
v_exp_f32 v168, v168
v_mfma_f32_16x16x32_bf16 v[204:207], a[224:227], v[108:111], v[204:207]
v_exp_f32 v169, v169
v_mfma_f32_16x16x32_bf16 v[204:207], a[228:231], v[124:127], v[204:207]
v_exp_f32 v170, v170
v_mfma_f32_16x16x32_bf16 v[204:207], a[232:235], v[140:143], v[204:207]
v_cvt_pk_bf16_f32 v228, v184, v185
v_cvt_pk_bf16_f32 v229, v186, v187
v_mfma_f32_16x16x32_bf16 v[204:207], a[236:239], v[156:159], v[204:207]
s_waitcnt lgkmcnt(10)
v_cvt_pk_bf16_f32 v230, v188, v189
v_cvt_pk_bf16_f32 v231, v190, v191
v_mfma_f32_16x16x32_bf16 a[0:3], v[232:235], v[208:211], a[0:3]
v_exp_f32 v171, v171
v_mfma_f32_16x16x32_bf16 a[4:7], v[232:235], v[212:215], a[4:7]
v_exp_f32 v164, v164
v_mfma_f32_16x16x32_bf16 a[8:11], v[232:235], v[224:227], a[8:11]
v_exp_f32 v165, v165
v_mfma_f32_16x16x32_bf16 a[12:15], v[232:235], v[228:231], a[12:15]
s_waitcnt lgkmcnt(8)
ds_read_b64_tr_b16 v[232:233], v23 offset:41088
v_add_f32 v26, v26, v160
v_mfma_f32_16x16x32_bf16 a[16:19], v[236:239], v[208:211], a[16:19]
buffer_load_dwordx4 v10, s[92:95], s23 offen offset:2048 nt lds
v_mfma_f32_16x16x32_bf16 a[20:23], v[236:239], v[212:215], a[20:23]
s_add_u32 s23, s23, 12288
ds_read_b64_tr_b16 v[234:235], v23 offset:47232
v_add_f32 v26, v26, v161
v_mfma_f32_16x16x32_bf16 a[24:27], v[236:239], v[224:227], a[24:27]
s_add_u32 m0, s26, 24576
v_exp_f32 v166, v166
v_mfma_f32_16x16x32_bf16 a[28:31], v[236:239], v[228:231], a[28:31]
s_waitcnt lgkmcnt(8)
ds_read_b64_tr_b16 v[236:237], v24 offset:41088
v_add_f32 v26, v26, v162
v_mfma_f32_16x16x32_bf16 a[32:35], v[240:243], v[208:211], a[32:35]
ds_read_b64_tr_b16 v[238:239], v24 offset:47232
v_add_f32 v26, v26, v163
v_mfma_f32_16x16x32_bf16 a[36:39], v[240:243], v[212:215], a[36:39]
v_exp_f32 v167, v167
v_mfma_f32_16x16x32_bf16 a[40:43], v[240:243], v[224:227], a[40:43]
v_exp_f32 v172, v172
v_mfma_f32_16x16x32_bf16 a[44:47], v[240:243], v[228:231], a[44:47]
s_waitcnt lgkmcnt(8)
ds_read_b64_tr_b16 v[240:241], v21 offset:41216
v_cvt_pk_bf16_f32 v216, v160, v161
v_mfma_f32_16x16x32_bf16 a[48:51], v[244:247], v[208:211], a[48:51]
ds_read_b64_tr_b16 v[242:243], v21 offset:47360
v_cvt_pk_bf16_f32 v217, v162, v163
v_mfma_f32_16x16x32_bf16 a[52:55], v[244:247], v[212:215], a[52:55]
v_exp_f32 v173, v173
v_mfma_f32_16x16x32_bf16 a[56:59], v[244:247], v[224:227], a[56:59]
buffer_load_dwordx4 v12, s[16:19], s41 offen nt lds
v_mfma_f32_16x16x32_bf16 a[60:63], v[244:247], v[228:231], a[60:63]
s_waitcnt lgkmcnt(8)
ds_read_b64_tr_b16 v[244:245], v22 offset:41216
v_add_f32 v27, v27, v168
v_mfma_f32_16x16x32_bf16 a[64:67], v[248:251], v[208:211], a[64:67]
s_add_u32 s41, s41, 40960
ds_read_b64_tr_b16 v[246:247], v22 offset:47360
v_add_f32 v27, v27, v169
v_mfma_f32_16x16x32_bf16 a[68:71], v[248:251], v[212:215], a[68:71]
v_exp_f32 v174, v174
v_mfma_f32_16x16x32_bf16 a[72:75], v[248:251], v[224:227], a[72:75]
v_exp_f32 v175, v175
v_mfma_f32_16x16x32_bf16 a[76:79], v[248:251], v[228:231], a[76:79]
s_waitcnt lgkmcnt(8)
ds_read_b64_tr_b16 v[248:249], v23 offset:41216
v_add_f32 v27, v27, v170
v_mfma_f32_16x16x32_bf16 a[80:83], v[252:255], v[208:211], a[80:83]
ds_read_b64_tr_b16 v[250:251], v23 offset:47360
v_add_f32 v27, v27, v171
v_mfma_f32_16x16x32_bf16 a[84:87], v[252:255], v[212:215], a[84:87]
v_exp_f32 v192, v192
v_mfma_f32_16x16x32_bf16 a[88:91], v[252:255], v[224:227], a[88:91]
v_exp_f32 v193, v193
v_mfma_f32_16x16x32_bf16 a[92:95], v[252:255], v[228:231], a[92:95]
s_waitcnt lgkmcnt(8)
ds_read_b64_tr_b16 v[252:253], v24 offset:41216
v_cvt_pk_bf16_f32 v220, v168, v169
v_mfma_f32_16x16x32_bf16 a[96:99], v[232:235], v[208:211], a[96:99]
ds_read_b64_tr_b16 v[254:255], v24 offset:47360
v_cvt_pk_bf16_f32 v221, v170, v171
v_mfma_f32_16x16x32_bf16 a[100:103], v[232:235], v[212:215], a[100:103]
v_exp_f32 v194, v194
v_mfma_f32_16x16x32_bf16 a[104:107], v[232:235], v[224:227], a[104:107]
v_exp_f32 v195, v195
v_mfma_f32_16x16x32_bf16 a[108:111], v[232:235], v[228:231], a[108:111]
s_waitcnt lgkmcnt(8)
v_exp_f32 v196, v196
v_mfma_f32_16x16x32_bf16 a[112:115], v[236:239], v[208:211], a[112:115]
v_exp_f32 v197, v197
v_mfma_f32_16x16x32_bf16 a[116:119], v[236:239], v[212:215], a[116:119]
v_exp_f32 v198, v198
v_mfma_f32_16x16x32_bf16 a[120:123], v[236:239], v[224:227], a[120:123]
s_waitcnt vmcnt(19) lgkmcnt(0)
s_barrier
v_exp_f32 v199, v199
v_mfma_f32_16x16x32_bf16 a[124:127], v[236:239], v[228:231], a[124:127]
ds_read_b128 a[192:195], v19 offset:57344
v_add_f32 v28, v28, v176
v_mfma_f32_16x16x32_bf16 a[128:131], v[240:243], v[208:211], a[128:131]
ds_read_b128 a[196:199], v20 offset:57344
v_add_f32 v28, v28, v177
v_mfma_f32_16x16x32_bf16 a[132:135], v[240:243], v[212:215], a[132:135]
ds_read_b128 a[200:203], v19 offset:57472
v_add_f32 v28, v28, v178
v_mfma_f32_16x16x32_bf16 a[136:139], v[240:243], v[224:227], a[136:139]
ds_read_b128 a[204:207], v20 offset:57472
v_add_f32 v28, v28, v179
v_mfma_f32_16x16x32_bf16 a[140:143], v[240:243], v[228:231], a[140:143]
ds_read_b128 a[208:211], v19 offset:57600
v_add_f32 v29, v29, v184
v_mfma_f32_16x16x32_bf16 a[144:147], v[244:247], v[208:211], a[144:147]
buffer_store_dwordx4 a[240:243], v1, s[12:15], s42 offen sc1
v_mfma_f32_16x16x32_bf16 a[148:151], v[244:247], v[212:215], a[148:151]
s_add_u32 s42, s42, 6144
ds_read_b128 a[212:215], v20 offset:57600
v_add_f32 v29, v29, v185
v_mfma_f32_16x16x32_bf16 a[152:155], v[244:247], v[224:227], a[152:155]
s_add_u32 m0, s25, 28672
ds_read_b128 a[216:219], v19 offset:63488
v_add_f32 v29, v29, v186
v_mfma_f32_16x16x32_bf16 a[156:159], v[244:247], v[228:231], a[156:159]
ds_read_b128 a[220:223], v20 offset:63488
v_add_f32 v29, v29, v187
v_mfma_f32_16x16x32_bf16 a[160:163], v[248:251], v[208:211], a[160:163]
ds_read_b128 a[224:227], v19 offset:63616
v_add_f32 v26, v26, v164
v_mfma_f32_16x16x32_bf16 a[164:167], v[248:251], v[212:215], a[164:167]
ds_read_b128 a[228:231], v20 offset:63616
v_add_f32 v26, v26, v165
v_mfma_f32_16x16x32_bf16 a[168:171], v[248:251], v[224:227], a[168:171]
ds_read_b128 a[232:235], v19 offset:63744
v_add_f32 v26, v26, v166
v_mfma_f32_16x16x32_bf16 a[172:175], v[248:251], v[228:231], a[172:175]
ds_read_b128 a[236:239], v20 offset:63744
v_add_f32 v26, v26, v167
v_mfma_f32_16x16x32_bf16 a[176:179], v[252:255], v[208:211], a[176:179]
v_exp_f32 v200, v200
v_mfma_f32_16x16x32_bf16 a[180:183], v[252:255], v[212:215], a[180:183]
v_exp_f32 v201, v201
v_mfma_f32_16x16x32_bf16 a[184:187], v[252:255], v[224:227], a[184:187]
v_exp_f32 v202, v202
v_mfma_f32_16x16x32_bf16 a[188:191], v[252:255], v[228:231], a[188:191]
s_waitcnt lgkmcnt(11)
v_exp_f32 v203, v203
v_mfma_f32_16x16x32_bf16 v[160:163], a[192:195], v[64:67], v[32:35]
s_waitcnt lgkmcnt(10)
v_exp_f32 v204, v204
v_mfma_f32_16x16x32_bf16 v[160:163], a[196:199], v[80:83], v[160:163]
s_waitcnt lgkmcnt(9)
v_exp_f32 v205, v205
v_mfma_f32_16x16x32_bf16 v[160:163], a[200:203], v[96:99], v[160:163]
s_waitcnt lgkmcnt(8)
buffer_load_dwordx4 v5, s[8:11], s22 offen offset:0 nt lds
v_mfma_f32_16x16x32_bf16 v[160:163], a[204:207], v[112:115], v[160:163]
s_waitcnt lgkmcnt(7)
v_exp_f32 v206, v206
v_mfma_f32_16x16x32_bf16 v[160:163], a[208:211], v[128:131], v[160:163]
s_waitcnt lgkmcnt(6)
v_exp_f32 v207, v207
v_mfma_f32_16x16x32_bf16 v[160:163], a[212:215], v[144:147], v[160:163]
v_cvt_pk_bf16_f32 v218, v164, v165
v_cvt_pk_bf16_f32 v219, v166, v167
v_mfma_f32_16x16x32_bf16 v[168:171], a[192:195], v[68:71], v[36:39]
v_add_f32 v27, v27, v172
v_add_f32 v27, v27, v173
v_mfma_f32_16x16x32_bf16 v[168:171], a[196:199], v[84:87], v[168:171]
v_add_f32 v27, v27, v174
v_add_f32 v27, v27, v175
v_mfma_f32_16x16x32_bf16 v[168:171], a[200:203], v[100:103], v[168:171]
v_cvt_pk_bf16_f32 v222, v172, v173
v_cvt_pk_bf16_f32 v223, v174, v175
v_mfma_f32_16x16x32_bf16 v[168:171], a[204:207], v[116:119], v[168:171]
buffer_load_dwordx4 v6, s[8:11], s22 offen offset:1024 nt lds
v_mfma_f32_16x16x32_bf16 v[168:171], a[208:211], v[132:135], v[168:171]
v_exp_f32 v160, v160
v_mfma_f32_16x16x32_bf16 v[168:171], a[212:215], v[148:151], v[168:171]
v_exp_f32 v161, v161
v_mfma_f32_16x16x32_bf16 v[176:179], a[192:195], v[72:75], v[40:43]
v_exp_f32 v162, v162
v_mfma_f32_16x16x32_bf16 v[176:179], a[196:199], v[88:91], v[176:179]
v_exp_f32 v163, v163
v_mfma_f32_16x16x32_bf16 v[176:179], a[200:203], v[104:107], v[176:179]
v_add_f32 v28, v28, v180
v_add_f32 v28, v28, v181
v_mfma_f32_16x16x32_bf16 v[176:179], a[204:207], v[120:123], v[176:179]
v_exp_f32 v168, v168
v_mfma_f32_16x16x32_bf16 v[176:179], a[208:211], v[136:139], v[176:179]
buffer_load_dwordx4 v7, s[8:11], s22 offen offset:2048 nt lds
v_mfma_f32_16x16x32_bf16 v[176:179], a[212:215], v[152:155], v[176:179]
s_add_u32 s22, s22, 12288
v_exp_f32 v169, v169
v_mfma_f32_16x16x32_bf16 v[184:187], a[192:195], v[76:79], v[44:47]
s_add_u32 m0, s25, 40960
v_exp_f32 v170, v170
v_mfma_f32_16x16x32_bf16 v[184:187], a[196:199], v[92:95], v[184:187]
v_exp_f32 v171, v171
v_mfma_f32_16x16x32_bf16 v[184:187], a[200:203], v[108:111], v[184:187]
v_add_f32 v28, v28, v182
v_add_f32 v28, v28, v183
v_mfma_f32_16x16x32_bf16 v[184:187], a[204:207], v[124:127], v[184:187]
v_exp_f32 v176, v176
v_mfma_f32_16x16x32_bf16 v[184:187], a[208:211], v[140:143], v[184:187]
v_exp_f32 v177, v177
v_mfma_f32_16x16x32_bf16 v[184:187], a[212:215], v[156:159], v[184:187]
s_waitcnt lgkmcnt(5)
buffer_load_dwordx4 v8, s[92:95], s23 offen offset:0 nt lds
v_mfma_f32_16x16x32_bf16 v[164:167], a[216:219], v[64:67], v[32:35]
s_waitcnt lgkmcnt(4)
v_exp_f32 v178, v178
v_mfma_f32_16x16x32_bf16 v[164:167], a[220:223], v[80:83], v[164:167]
s_waitcnt lgkmcnt(3)
v_exp_f32 v179, v179
v_mfma_f32_16x16x32_bf16 v[164:167], a[224:227], v[96:99], v[164:167]
s_waitcnt lgkmcnt(2)
v_add_u32 v16, 0xe000, v16
v_add_u32 v21, 0xe000, v21
v_mfma_f32_16x16x32_bf16 v[164:167], a[228:231], v[112:115], v[164:167]
s_waitcnt lgkmcnt(1)
ds_read_b64_tr_b16 a[240:241], v16 offset:24576
v_add_f32 v29, v29, v188
v_mfma_f32_16x16x32_bf16 v[164:167], a[232:235], v[128:131], v[164:167]
s_waitcnt lgkmcnt(1)
ds_read_b64_tr_b16 a[242:243], v16 offset:26624
v_add_f32 v29, v29, v189
v_mfma_f32_16x16x32_bf16 v[164:167], a[236:239], v[144:147], v[164:167]
ds_read_b64_tr_b16 v[232:233], v21 offset:12288
v_add_f32 v29, v29, v190
v_mfma_f32_16x16x32_bf16 v[172:175], a[216:219], v[68:71], v[36:39]
buffer_load_dwordx4 v9, s[92:95], s23 offen offset:1024 nt lds
v_mfma_f32_16x16x32_bf16 v[172:175], a[220:223], v[84:87], v[172:175]
ds_read_b64_tr_b16 v[234:235], v21 offset:18432
v_lshrrev_b32 v63, 2, v62
v_mfma_f32_16x16x32_bf16 v[172:175], a[224:227], v[100:103], v[172:175]
v_exp_f32 v184, v184
v_mfma_f32_16x16x32_bf16 v[172:175], a[228:231], v[116:119], v[172:175]
v_exp_f32 v164, v164
v_mfma_f32_16x16x32_bf16 v[172:175], a[232:235], v[132:135], v[172:175]
v_exp_f32 v165, v165
v_mfma_f32_16x16x32_bf16 v[172:175], a[236:239], v[148:151], v[172:175]
v_exp_f32 v166, v166
v_mfma_f32_16x16x32_bf16 v[180:183], a[216:219], v[72:75], v[40:43]
v_exp_f32 v167, v167
v_mfma_f32_16x16x32_bf16 v[180:183], a[220:223], v[88:91], v[180:183]
buffer_load_dwordx4 v10, s[92:95], s23 offen offset:2048 nt lds
v_mfma_f32_16x16x32_bf16 v[180:183], a[224:227], v[104:107], v[180:183]
s_add_u32 s23, s23, 12288
v_add_f32 v29, v29, v191
v_add_u32 v22, 0xe000, v22
v_mfma_f32_16x16x32_bf16 v[180:183], a[228:231], v[120:123], v[180:183]
s_add_u32 m0, s26, 53248
v_lshlrev_b32 v63, 12, v63
v_and_b32 v62, 3, v62
v_mfma_f32_16x16x32_bf16 v[180:183], a[232:235], v[136:139], v[180:183]
ds_read_b64_tr_b16 v[236:237], v22 offset:12288
v_lshl_add_u32 v63, v62, 8, v63
v_mfma_f32_16x16x32_bf16 v[180:183], a[236:239], v[152:155], v[180:183]
ds_read_b64_tr_b16 v[238:239], v22 offset:18432
v_lshl_add_u32 v63, v61, 4, v63
v_mfma_f32_16x16x32_bf16 v[188:191], a[216:219], v[76:79], v[44:47]
v_add_u32 v23, 0xe000, v23
v_cvt_pk_bf16_f32 v224, v192, v193
v_mfma_f32_16x16x32_bf16 v[188:191], a[220:223], v[92:95], v[188:191]
ds_read_b64_tr_b16 v[240:241], v23 offset:12288
v_cvt_pk_bf16_f32 v225, v194, v195
v_mfma_f32_16x16x32_bf16 v[188:191], a[224:227], v[108:111], v[188:191]
buffer_load_dwordx4 v12, s[16:19], s41 offen nt lds
v_mfma_f32_16x16x32_bf16 v[188:191], a[228:231], v[124:127], v[188:191]
s_add_u32 s41, s41, 40960
ds_read_b64_tr_b16 v[242:243], v23 offset:18432
v_cvt_pk_bf16_f32 v226, v196, v197
v_mfma_f32_16x16x32_bf16 v[188:191], a[232:235], v[140:143], v[188:191]
s_lshr_b32 s21, s2, 3
v_cvt_pk_bf16_f32 v227, v198, v199
v_cvt_pk_bf16_f32 v228, v200, v201
v_mfma_f32_16x16x32_bf16 v[188:191], a[236:239], v[156:159], v[188:191]
s_waitcnt lgkmcnt(4)
v_cvt_pk_bf16_f32 v229, v202, v203
v_cvt_pk_bf16_f32 v230, v204, v205
v_mfma_f32_16x16x32_bf16 a[0:3], v[232:235], v[216:219], a[0:3]
s_bfe_u32 s60, s2, 0x20001
v_cvt_pk_bf16_f32 v231, v206, v207
v_add_u32 v24, 0xe000, v24
v_mfma_f32_16x16x32_bf16 a[4:7], v[232:235], v[220:223], a[4:7]
s_mul_i32 s21, s21, 81920
ds_read_b64_tr_b16 v[244:245], v24 offset:12288
v_add_u32 v19, 0x15000, v19
v_mfma_f32_16x16x32_bf16 a[8:11], v[232:235], v[224:227], a[8:11]
s_lshl_b32 s60, s60, 10
ds_read_b64_tr_b16 v[246:247], v24 offset:18432
v_add_u32 v20, 0x15000, v20
v_mfma_f32_16x16x32_bf16 a[12:15], v[232:235], v[228:231], a[12:15]
s_waitcnt lgkmcnt(4)
ds_read_b64_tr_b16 v[248:249], v21 offset:12416
v_add_f32 v26, v26, v160
v_mfma_f32_16x16x32_bf16 a[16:19], v[236:239], v[216:219], a[16:19]
s_add_u32 s21, s21, s60
ds_read_b64_tr_b16 v[250:251], v21 offset:18560
v_add_f32 v26, v26, v161
v_mfma_f32_16x16x32_bf16 a[20:23], v[236:239], v[220:223], a[20:23]
s_and_b32 s60, s2, 1
ds_read_b64_tr_b16 v[252:253], v22 offset:12416
v_add_f32 v26, v26, v162
v_mfma_f32_16x16x32_bf16 a[24:27], v[236:239], v[224:227], a[24:27]
s_lshl_b32 s60, s60, 7
ds_read_b64_tr_b16 v[254:255], v22 offset:18560
v_add_f32 v26, v26, v163
v_mfma_f32_16x16x32_bf16 a[28:31], v[236:239], v[228:231], a[28:31]
s_waitcnt lgkmcnt(6)
ds_read_b64_tr_b16 v[232:233], v23 offset:12416
v_cvt_pk_bf16_f32 v208, v160, v161
v_mfma_f32_16x16x32_bf16 a[32:35], v[240:243], v[216:219], a[32:35]
s_add_u32 s21, s21, s60
ds_read_b64_tr_b16 v[234:235], v23 offset:18560
v_cvt_pk_bf16_f32 v209, v162, v163
v_mfma_f32_16x16x32_bf16 a[36:39], v[240:243], v[220:223], a[36:39]
s_lshl_b32 s60, s30, 13
ds_read_b64_tr_b16 v[236:237], v24 offset:12416
v_add_f32 v27, v27, v168
v_mfma_f32_16x16x32_bf16 a[40:43], v[240:243], v[224:227], a[40:43]
s_add_u32 s21, s21, s60
ds_read_b64_tr_b16 v[238:239], v24 offset:18560
v_add_f32 v27, v27, v169
v_mfma_f32_16x16x32_bf16 a[44:47], v[240:243], v[228:231], a[44:47]
s_waitcnt lgkmcnt(8)
ds_read_b64_tr_b16 v[240:241], v21 offset:12544
v_add_f32 v27, v27, v170
v_mfma_f32_16x16x32_bf16 a[48:51], v[244:247], v[216:219], a[48:51]
s_add_u32 s21, s21, 0x3b00000
ds_read_b64_tr_b16 v[242:243], v21 offset:18688
v_add_f32 v27, v27, v171
v_mfma_f32_16x16x32_bf16 a[52:55], v[244:247], v[220:223], a[52:55]
s_waitcnt vmcnt(18)
buffer_store_dwordx4 a[244:247], v63, s[12:15], s21 offen sc1
v_mfma_f32_16x16x32_bf16 a[56:59], v[244:247], v[224:227], a[56:59]
s_add_u32 s21, s21, 32768
v_exp_f32 v172, v172
v_mfma_f32_16x16x32_bf16 a[60:63], v[244:247], v[228:231], a[60:63]
s_waitcnt lgkmcnt(8)
ds_read_b64_tr_b16 v[244:245], v22 offset:12544
v_cvt_pk_bf16_f32 v212, v168, v169
v_mfma_f32_16x16x32_bf16 a[64:67], v[248:251], v[216:219], a[64:67]
ds_read_b64_tr_b16 v[246:247], v22 offset:18688
v_cvt_pk_bf16_f32 v213, v170, v171
v_mfma_f32_16x16x32_bf16 a[68:71], v[248:251], v[220:223], a[68:71]
s_waitcnt vmcnt(18)
buffer_store_dwordx4 a[248:251], v63, s[12:15], s21 offen sc1
v_mfma_f32_16x16x32_bf16 a[72:75], v[248:251], v[224:227], a[72:75]
s_add_u32 s21, s21, 32768
v_exp_f32 v173, v173
v_mfma_f32_16x16x32_bf16 a[76:79], v[248:251], v[228:231], a[76:79]
s_waitcnt lgkmcnt(8)
ds_read_b64_tr_b16 v[248:249], v23 offset:12544
v_add_f32 v28, v28, v192
v_mfma_f32_16x16x32_bf16 a[80:83], v[252:255], v[216:219], a[80:83]
s_cmp_lt_u32 s30, 2
ds_read_b64_tr_b16 v[250:251], v23 offset:18688
v_add_f32 v28, v28, v193
v_mfma_f32_16x16x32_bf16 a[84:87], v[252:255], v[220:223], a[84:87]
s_cselect_b32 s21, s21, 0x40000000
v_exp_f32 v174, v174
v_mfma_f32_16x16x32_bf16 a[88:91], v[252:255], v[224:227], a[88:91]
s_waitcnt vmcnt(18)
buffer_store_dwordx4 a[252:255], v63, s[12:15], s21 offen sc1
v_mfma_f32_16x16x32_bf16 a[92:95], v[252:255], v[228:231], a[92:95]
s_waitcnt lgkmcnt(8)
ds_read_b64_tr_b16 v[252:253], v24 offset:12544
v_add_f32 v28, v28, v194
v_mfma_f32_16x16x32_bf16 a[96:99], v[232:235], v[216:219], a[96:99]
ds_read_b64_tr_b16 v[254:255], v24 offset:18688
v_add_f32 v28, v28, v195
v_mfma_f32_16x16x32_bf16 a[100:103], v[232:235], v[220:223], a[100:103]
v_exp_f32 v175, v175
v_mfma_f32_16x16x32_bf16 a[104:107], v[232:235], v[224:227], a[104:107]
v_exp_f32 v180, v180
v_mfma_f32_16x16x32_bf16 a[108:111], v[232:235], v[228:231], a[108:111]
s_waitcnt lgkmcnt(8)
v_exp_f32 v181, v181
v_mfma_f32_16x16x32_bf16 a[112:115], v[236:239], v[216:219], a[112:115]
v_exp_f32 v182, v182
v_mfma_f32_16x16x32_bf16 a[116:119], v[236:239], v[220:223], a[116:119]
v_exp_f32 v183, v183
v_mfma_f32_16x16x32_bf16 a[120:123], v[236:239], v[224:227], a[120:123]
s_waitcnt lgkmcnt(0)
s_barrier
v_exp_f32 v185, v185
v_mfma_f32_16x16x32_bf16 a[124:127], v[236:239], v[228:231], a[124:127]
ds_read_b128 a[192:195], v19 offset:0
v_add_f32 v29, v29, v200
v_mfma_f32_16x16x32_bf16 a[128:131], v[240:243], v[216:219], a[128:131]
ds_read_b128 a[196:199], v20 offset:0
v_add_f32 v29, v29, v201
v_mfma_f32_16x16x32_bf16 a[132:135], v[240:243], v[220:223], a[132:135]
ds_read_b128 a[200:203], v19 offset:128
v_add_f32 v29, v29, v202
v_mfma_f32_16x16x32_bf16 a[136:139], v[240:243], v[224:227], a[136:139]
ds_read_b128 a[204:207], v20 offset:128
v_add_f32 v29, v29, v203
v_mfma_f32_16x16x32_bf16 a[140:143], v[240:243], v[228:231], a[140:143]
ds_read_b128 a[208:211], v19 offset:256
v_add_f32 v26, v26, v164
v_mfma_f32_16x16x32_bf16 a[144:147], v[244:247], v[216:219], a[144:147]
buffer_store_dwordx4 a[240:243], v1, s[12:15], s42 offen sc1
v_mfma_f32_16x16x32_bf16 a[148:151], v[244:247], v[220:223], a[148:151]
s_add_u32 s42, s42, 6144
ds_read_b128 a[212:215], v20 offset:256
v_add_f32 v26, v26, v165
v_mfma_f32_16x16x32_bf16 a[152:155], v[244:247], v[224:227], a[152:155]
s_add_u32 m0, s25, 57344
ds_read_b128 a[216:219], v19 offset:6144
v_add_f32 v26, v26, v166
v_mfma_f32_16x16x32_bf16 a[156:159], v[244:247], v[228:231], a[156:159]
ds_read_b128 a[220:223], v20 offset:6144
v_add_f32 v26, v26, v167
v_mfma_f32_16x16x32_bf16 a[160:163], v[248:251], v[216:219], a[160:163]
ds_read_b128 a[224:227], v19 offset:6272
v_cvt_pk_bf16_f32 v210, v164, v165
v_mfma_f32_16x16x32_bf16 a[164:167], v[248:251], v[220:223], a[164:167]
ds_read_b128 a[228:231], v20 offset:6272
v_cvt_pk_bf16_f32 v211, v166, v167
v_mfma_f32_16x16x32_bf16 a[168:171], v[248:251], v[224:227], a[168:171]
ds_read_b128 a[232:235], v19 offset:6400
v_add_f32 v27, v27, v172
v_mfma_f32_16x16x32_bf16 a[172:175], v[248:251], v[228:231], a[172:175]
ds_read_b128 a[236:239], v20 offset:6400
v_add_f32 v27, v27, v173
v_mfma_f32_16x16x32_bf16 a[176:179], v[252:255], v[216:219], a[176:179]
ds_read_b64_tr_b16 a[240:241], v16 offset:53248
v_add_f32 v27, v27, v174
v_mfma_f32_16x16x32_bf16 a[180:183], v[252:255], v[220:223], a[180:183]
ds_read_b64_tr_b16 a[242:243], v16 offset:55296
v_add_f32 v27, v27, v175
v_mfma_f32_16x16x32_bf16 a[184:187], v[252:255], v[224:227], a[184:187]
ds_read_b64_tr_b16 v[232:233], v21 offset:40960
v_cvt_pk_bf16_f32 v214, v172, v173
v_mfma_f32_16x16x32_bf16 a[188:191], v[252:255], v[228:231], a[188:191]
s_waitcnt lgkmcnt(14)
ds_read_b64_tr_b16 v[234:235], v21 offset:47104
v_cvt_pk_bf16_f32 v215, v174, v175
v_mfma_f32_16x16x32_bf16 v[160:163], a[192:195], v[64:67], v[32:35]
s_waitcnt lgkmcnt(14)
ds_read_b64_tr_b16 v[236:237], v22 offset:40960
v_add_f32 v28, v28, v196
v_mfma_f32_16x16x32_bf16 v[160:163], a[196:199], v[80:83], v[160:163]
s_waitcnt lgkmcnt(14)
ds_read_b64_tr_b16 v[238:239], v22 offset:47104
v_add_f32 v28, v28, v197
v_mfma_f32_16x16x32_bf16 v[160:163], a[200:203], v[96:99], v[160:163]
s_waitcnt lgkmcnt(14)
buffer_load_dwordx4 v5, s[8:11], s22 offen offset:0 nt lds
v_mfma_f32_16x16x32_bf16 v[160:163], a[204:207], v[112:115], v[160:163]
s_waitcnt lgkmcnt(13)
ds_read_b64_tr_b16 v[240:241], v23 offset:40960
v_add_f32 v28, v28, v198
v_mfma_f32_16x16x32_bf16 v[160:163], a[208:211], v[128:131], v[160:163]
s_waitcnt lgkmcnt(13)
ds_read_b64_tr_b16 v[242:243], v23 offset:47104
v_add_f32 v28, v28, v199
v_mfma_f32_16x16x32_bf16 v[160:163], a[212:215], v[144:147], v[160:163]
ds_read_b64_tr_b16 v[244:245], v24 offset:40960
v_add_f32 v29, v29, v204
v_mfma_f32_16x16x32_bf16 v[168:171], a[192:195], v[68:71], v[36:39]
ds_read_b64_tr_b16 v[246:247], v24 offset:47104
v_add_f32 v29, v29, v205
v_mfma_f32_16x16x32_bf16 v[168:171], a[196:199], v[84:87], v[168:171]
ds_read_b64_tr_b16 v[248:249], v21 offset:41088
v_add_f32 v29, v29, v206
v_mfma_f32_16x16x32_bf16 v[168:171], a[200:203], v[100:103], v[168:171]
ds_read_b64_tr_b16 v[250:251], v21 offset:47232
v_add_f32 v29, v29, v207
v_mfma_f32_16x16x32_bf16 v[168:171], a[204:207], v[116:119], v[168:171]
ds_read_b64_tr_b16 v[252:253], v22 offset:41088
v_cvt_pk_bf16_f32 v224, v176, v177
v_mfma_f32_16x16x32_bf16 v[168:171], a[208:211], v[132:135], v[168:171]
ds_read_b64_tr_b16 v[254:255], v22 offset:47232
v_cvt_pk_bf16_f32 v225, v178, v179
v_mfma_f32_16x16x32_bf16 v[168:171], a[212:215], v[148:151], v[168:171]
v_exp_f32 v186, v186
v_mfma_f32_16x16x32_bf16 v[192:195], a[192:195], v[72:75], v[40:43]
buffer_load_dwordx4 v6, s[8:11], s22 offen offset:1024 nt lds
v_mfma_f32_16x16x32_bf16 v[192:195], a[196:199], v[88:91], v[192:195]
v_exp_f32 v187, v187
v_mfma_f32_16x16x32_bf16 v[192:195], a[200:203], v[104:107], v[192:195]
v_exp_f32 v188, v188
v_mfma_f32_16x16x32_bf16 v[192:195], a[204:207], v[120:123], v[192:195]
v_exp_f32 v189, v189
v_mfma_f32_16x16x32_bf16 v[192:195], a[208:211], v[136:139], v[192:195]
v_exp_f32 v190, v190
v_mfma_f32_16x16x32_bf16 v[192:195], a[212:215], v[152:155], v[192:195]
v_exp_f32 v191, v191
v_mfma_f32_16x16x32_bf16 v[200:203], a[192:195], v[76:79], v[44:47]
v_exp_f32 v160, v160
v_mfma_f32_16x16x32_bf16 v[200:203], a[196:199], v[92:95], v[200:203]
v_exp_f32 v161, v161
v_mfma_f32_16x16x32_bf16 v[200:203], a[200:203], v[108:111], v[200:203]
v_exp_f32 v162, v162
v_mfma_f32_16x16x32_bf16 v[200:203], a[204:207], v[124:127], v[200:203]
v_exp_f32 v163, v163
v_mfma_f32_16x16x32_bf16 v[200:203], a[208:211], v[140:143], v[200:203]
buffer_load_dwordx4 v7, s[8:11], s22 offen offset:2048 nt lds
v_mfma_f32_16x16x32_bf16 v[200:203], a[212:215], v[156:159], v[200:203]
s_waitcnt lgkmcnt(15)
v_exp_f32 v168, v168
v_mfma_f32_16x16x32_bf16 v[164:167], a[216:219], v[64:67], v[32:35]
s_waitcnt lgkmcnt(15)
v_exp_f32 v169, v169
v_mfma_f32_16x16x32_bf16 v[164:167], a[220:223], v[80:83], v[164:167]
s_waitcnt lgkmcnt(15)
v_exp_f32 v170, v170
v_mfma_f32_16x16x32_bf16 v[164:167], a[224:227], v[96:99], v[164:167]
s_waitcnt lgkmcnt(15)
v_exp_f32 v171, v171
v_mfma_f32_16x16x32_bf16 v[164:167], a[228:231], v[112:115], v[164:167]
s_waitcnt lgkmcnt(15)
v_exp_f32 v192, v192
v_mfma_f32_16x16x32_bf16 v[164:167], a[232:235], v[128:131], v[164:167]
s_waitcnt lgkmcnt(14)
v_exp_f32 v193, v193
v_mfma_f32_16x16x32_bf16 v[164:167], a[236:239], v[144:147], v[164:167]
s_add_u32 s22, s22, 12288
v_exp_f32 v194, v194
v_mfma_f32_16x16x32_bf16 v[172:175], a[216:219], v[68:71], v[36:39]
s_add_u32 m0, s25, 69632
v_exp_f32 v195, v195
v_mfma_f32_16x16x32_bf16 v[172:175], a[220:223], v[84:87], v[172:175]
v_exp_f32 v200, v200
v_mfma_f32_16x16x32_bf16 v[172:175], a[224:227], v[100:103], v[172:175]
buffer_load_dwordx4 v8, s[92:95], s23 offen offset:0 nt lds
v_mfma_f32_16x16x32_bf16 v[172:175], a[228:231], v[116:119], v[172:175]
v_exp_f32 v164, v164
v_mfma_f32_16x16x32_bf16 v[172:175], a[232:235], v[132:135], v[172:175]
v_exp_f32 v165, v165
v_mfma_f32_16x16x32_bf16 v[172:175], a[236:239], v[148:151], v[172:175]
v_exp_f32 v166, v166
v_mfma_f32_16x16x32_bf16 v[196:199], a[216:219], v[72:75], v[40:43]
v_exp_f32 v167, v167
v_mfma_f32_16x16x32_bf16 v[196:199], a[220:223], v[88:91], v[196:199]
v_exp_f32 v201, v201
v_mfma_f32_16x16x32_bf16 v[196:199], a[224:227], v[104:107], v[196:199]
v_exp_f32 v202, v202
v_mfma_f32_16x16x32_bf16 v[196:199], a[228:231], v[120:123], v[196:199]
v_exp_f32 v172, v172
v_mfma_f32_16x16x32_bf16 v[196:199], a[232:235], v[136:139], v[196:199]
v_exp_f32 v173, v173
v_mfma_f32_16x16x32_bf16 v[196:199], a[236:239], v[152:155], v[196:199]
v_exp_f32 v174, v174
v_mfma_f32_16x16x32_bf16 v[204:207], a[216:219], v[76:79], v[44:47]
buffer_load_dwordx4 v9, s[92:95], s23 offen offset:1024 nt lds
v_mfma_f32_16x16x32_bf16 v[204:207], a[220:223], v[92:95], v[204:207]
v_exp_f32 v175, v175
v_mfma_f32_16x16x32_bf16 v[204:207], a[224:227], v[108:111], v[204:207]
v_exp_f32 v203, v203
v_mfma_f32_16x16x32_bf16 v[204:207], a[228:231], v[124:127], v[204:207]
v_cvt_pk_bf16_f32 v226, v180, v181
v_cvt_pk_bf16_f32 v227, v182, v183
v_mfma_f32_16x16x32_bf16 v[204:207], a[232:235], v[140:143], v[204:207]
v_cvt_pk_bf16_f32 v228, v184, v185
v_cvt_pk_bf16_f32 v229, v186, v187
v_mfma_f32_16x16x32_bf16 v[204:207], a[236:239], v[156:159], v[204:207]
s_waitcnt lgkmcnt(10)
v_cvt_pk_bf16_f32 v230, v188, v189
v_cvt_pk_bf16_f32 v231, v190, v191
v_mfma_f32_16x16x32_bf16 a[0:3], v[232:235], v[208:211], a[0:3]
v_exp_f32 v196, v196
v_mfma_f32_16x16x32_bf16 a[4:7], v[232:235], v[212:215], a[4:7]
v_exp_f32 v197, v197
v_mfma_f32_16x16x32_bf16 a[8:11], v[232:235], v[224:227], a[8:11]
v_exp_f32 v198, v198
v_mfma_f32_16x16x32_bf16 a[12:15], v[232:235], v[228:231], a[12:15]
s_waitcnt lgkmcnt(8)
ds_read_b64_tr_b16 v[232:233], v23 offset:41088
v_add_u32 v19, 0xfffeb000, v19
v_mfma_f32_16x16x32_bf16 a[16:19], v[236:239], v[208:211], a[16:19]
buffer_load_dwordx4 v10, s[92:95], s23 offen offset:2048 nt lds
v_mfma_f32_16x16x32_bf16 a[20:23], v[236:239], v[212:215], a[20:23]
s_add_u32 s23, s23, 12288
ds_read_b64_tr_b16 v[234:235], v23 offset:47232
v_add_u32 v20, 0xfffeb000, v20
v_mfma_f32_16x16x32_bf16 a[24:27], v[236:239], v[224:227], a[24:27]
s_add_u32 m0, s26, 81920
v_exp_f32 v199, v199
v_mfma_f32_16x16x32_bf16 a[28:31], v[236:239], v[228:231], a[28:31]
s_waitcnt lgkmcnt(8)
ds_read_b64_tr_b16 v[236:237], v24 offset:41088
v_add_f32 v26, v26, v160
v_mfma_f32_16x16x32_bf16 a[32:35], v[240:243], v[208:211], a[32:35]
ds_read_b64_tr_b16 v[238:239], v24 offset:47232
v_add_f32 v26, v26, v161
v_mfma_f32_16x16x32_bf16 a[36:39], v[240:243], v[212:215], a[36:39]
v_exp_f32 v204, v204
v_mfma_f32_16x16x32_bf16 a[40:43], v[240:243], v[224:227], a[40:43]
v_exp_f32 v205, v205
v_mfma_f32_16x16x32_bf16 a[44:47], v[240:243], v[228:231], a[44:47]
s_waitcnt lgkmcnt(8)
ds_read_b64_tr_b16 v[240:241], v21 offset:41216
v_add_f32 v26, v26, v162
v_mfma_f32_16x16x32_bf16 a[48:51], v[244:247], v[208:211], a[48:51]
ds_read_b64_tr_b16 v[242:243], v21 offset:47360
v_add_f32 v26, v26, v163
v_mfma_f32_16x16x32_bf16 a[52:55], v[244:247], v[212:215], a[52:55]
v_exp_f32 v206, v206
v_mfma_f32_16x16x32_bf16 a[56:59], v[244:247], v[224:227], a[56:59]
buffer_load_dwordx4 v12, s[16:19], s41 offen nt lds
v_mfma_f32_16x16x32_bf16 a[60:63], v[244:247], v[228:231], a[60:63]
s_waitcnt lgkmcnt(8)
ds_read_b64_tr_b16 v[244:245], v22 offset:41216
v_cvt_pk_bf16_f32 v216, v160, v161
v_mfma_f32_16x16x32_bf16 a[64:67], v[248:251], v[208:211], a[64:67]
s_add_u32 s41, s41, 40960
ds_read_b64_tr_b16 v[246:247], v22 offset:47360
v_cvt_pk_bf16_f32 v217, v162, v163
v_mfma_f32_16x16x32_bf16 a[68:71], v[248:251], v[212:215], a[68:71]
v_exp_f32 v207, v207
v_mfma_f32_16x16x32_bf16 a[72:75], v[248:251], v[224:227], a[72:75]
v_add_f32 v27, v27, v168
v_add_f32 v27, v27, v169
v_mfma_f32_16x16x32_bf16 a[76:79], v[248:251], v[228:231], a[76:79]
s_waitcnt lgkmcnt(8)
ds_read_b64_tr_b16 v[248:249], v23 offset:41216
v_add_f32 v27, v27, v170
v_mfma_f32_16x16x32_bf16 a[80:83], v[252:255], v[208:211], a[80:83]
ds_read_b64_tr_b16 v[250:251], v23 offset:47360
v_add_f32 v27, v27, v171
v_mfma_f32_16x16x32_bf16 a[84:87], v[252:255], v[212:215], a[84:87]
v_cvt_pk_bf16_f32 v220, v168, v169
v_cvt_pk_bf16_f32 v221, v170, v171
v_mfma_f32_16x16x32_bf16 a[88:91], v[252:255], v[224:227], a[88:91]
v_add_f32 v28, v28, v176
v_add_f32 v28, v28, v177
v_mfma_f32_16x16x32_bf16 a[92:95], v[252:255], v[228:231], a[92:95]
s_waitcnt lgkmcnt(8)
ds_read_b64_tr_b16 v[252:253], v24 offset:41216
v_add_f32 v28, v28, v178
v_mfma_f32_16x16x32_bf16 a[96:99], v[232:235], v[208:211], a[96:99]
ds_read_b64_tr_b16 v[254:255], v24 offset:47360
v_add_f32 v28, v28, v179
v_mfma_f32_16x16x32_bf16 a[100:103], v[232:235], v[212:215], a[100:103]
v_add_f32 v29, v29, v184
v_add_f32 v29, v29, v185
v_mfma_f32_16x16x32_bf16 a[104:107], v[232:235], v[224:227], a[104:107]
v_add_f32 v29, v29, v186
v_add_f32 v29, v29, v187
v_mfma_f32_16x16x32_bf16 a[108:111], v[232:235], v[228:231], a[108:111]
s_waitcnt lgkmcnt(8)
v_add_f32 v26, v26, v164
v_add_f32 v26, v26, v165
v_mfma_f32_16x16x32_bf16 a[112:115], v[236:239], v[208:211], a[112:115]
v_add_f32 v26, v26, v166
v_add_f32 v26, v26, v167
v_mfma_f32_16x16x32_bf16 a[116:119], v[236:239], v[212:215], a[116:119]
v_cvt_pk_bf16_f32 v218, v164, v165
v_cvt_pk_bf16_f32 v219, v166, v167
v_mfma_f32_16x16x32_bf16 a[120:123], v[236:239], v[224:227], a[120:123]
s_waitcnt vmcnt(19) lgkmcnt(0)
s_barrier
v_add_f32 v27, v27, v172
v_add_f32 v27, v27, v173
v_mfma_f32_16x16x32_bf16 a[124:127], v[236:239], v[228:231], a[124:127]
ds_read_b128 a[192:195], v19 offset:0
v_add_f32 v27, v27, v174
v_mfma_f32_16x16x32_bf16 a[128:131], v[240:243], v[208:211], a[128:131]
ds_read_b128 a[196:199], v20 offset:0
v_add_f32 v27, v27, v175
v_mfma_f32_16x16x32_bf16 a[132:135], v[240:243], v[212:215], a[132:135]
ds_read_b128 a[200:203], v19 offset:128
v_cvt_pk_bf16_f32 v222, v172, v173
v_mfma_f32_16x16x32_bf16 a[136:139], v[240:243], v[224:227], a[136:139]
ds_read_b128 a[204:207], v20 offset:128
v_cvt_pk_bf16_f32 v223, v174, v175
v_mfma_f32_16x16x32_bf16 a[140:143], v[240:243], v[228:231], a[140:143]
ds_read_b128 a[208:211], v19 offset:256
v_add_f32 v28, v28, v180
v_mfma_f32_16x16x32_bf16 a[144:147], v[244:247], v[208:211], a[144:147]
buffer_store_dwordx4 a[240:243], v1, s[12:15], s42 offen sc1
v_mfma_f32_16x16x32_bf16 a[148:151], v[244:247], v[212:215], a[148:151]
s_add_u32 s42, s42, 6144
ds_read_b128 a[212:215], v20 offset:256
v_add_f32 v28, v28, v181
v_mfma_f32_16x16x32_bf16 a[152:155], v[244:247], v[224:227], a[152:155]
s_add_u32 m0, s25, 86016
ds_read_b128 a[216:219], v19 offset:6144
v_add_f32 v28, v28, v182
v_mfma_f32_16x16x32_bf16 a[156:159], v[244:247], v[228:231], a[156:159]
ds_read_b128 a[220:223], v20 offset:6144
v_add_f32 v28, v28, v183
v_mfma_f32_16x16x32_bf16 a[160:163], v[248:251], v[208:211], a[160:163]
s_mov_b32 s42, s45
ds_read_b128 a[224:227], v19 offset:6272
v_add_u32 v16, 0xffff2000, v16
v_mfma_f32_16x16x32_bf16 a[164:167], v[248:251], v[212:215], a[164:167]
ds_read_b128 a[228:231], v20 offset:6272
v_add_u32 v21, 0xffff2000, v21
v_mfma_f32_16x16x32_bf16 a[168:171], v[248:251], v[224:227], a[168:171]
ds_read_b128 a[232:235], v19 offset:6400
v_add_f32 v29, v29, v188
v_mfma_f32_16x16x32_bf16 a[172:175], v[248:251], v[228:231], a[172:175]
ds_read_b128 a[236:239], v20 offset:6400
v_add_f32 v29, v29, v189
v_mfma_f32_16x16x32_bf16 a[176:179], v[252:255], v[208:211], a[176:179]
ds_read_b64_tr_b16 a[240:241], v16 offset:24576
v_add_f32 v29, v29, v190
v_mfma_f32_16x16x32_bf16 a[180:183], v[252:255], v[212:215], a[180:183]
ds_read_b64_tr_b16 a[242:243], v16 offset:26624
v_add_f32 v29, v29, v191
v_mfma_f32_16x16x32_bf16 a[184:187], v[252:255], v[224:227], a[184:187]
ds_read_b64_tr_b16 v[232:233], v21 offset:12288
v_add_u32 v22, 0xffff2000, v22
v_mfma_f32_16x16x32_bf16 a[188:191], v[252:255], v[228:231], a[188:191]
s_waitcnt lgkmcnt(14)
ds_read_b64_tr_b16 v[234:235], v21 offset:18432
v_add_u32 v23, 0xffff2000, v23
v_mfma_f32_16x16x32_bf16 v[160:163], a[192:195], v[64:67], v[32:35]
s_waitcnt lgkmcnt(14)
ds_read_b64_tr_b16 v[236:237], v22 offset:12288
v_cvt_pk_bf16_f32 v224, v192, v193
v_mfma_f32_16x16x32_bf16 v[160:163], a[196:199], v[80:83], v[160:163]
s_waitcnt lgkmcnt(14)
ds_read_b64_tr_b16 v[238:239], v22 offset:18432
v_cvt_pk_bf16_f32 v225, v194, v195
v_mfma_f32_16x16x32_bf16 v[160:163], a[200:203], v[96:99], v[160:163]
s_waitcnt lgkmcnt(14)
buffer_load_dwordx4 v5, s[8:11], s22 offen offset:0 nt lds
v_mfma_f32_16x16x32_bf16 v[160:163], a[204:207], v[112:115], v[160:163]
s_waitcnt lgkmcnt(13)
ds_read_b64_tr_b16 v[240:241], v23 offset:12288
v_cvt_pk_bf16_f32 v226, v196, v197
v_mfma_f32_16x16x32_bf16 v[160:163], a[208:211], v[128:131], v[160:163]
s_waitcnt lgkmcnt(13)
ds_read_b64_tr_b16 v[242:243], v23 offset:18432
v_cvt_pk_bf16_f32 v227, v198, v199
v_mfma_f32_16x16x32_bf16 v[160:163], a[212:215], v[144:147], v[160:163]
v_cvt_pk_bf16_f32 v228, v200, v201
v_cvt_pk_bf16_f32 v229, v202, v203
v_mfma_f32_16x16x32_bf16 v[168:171], a[192:195], v[68:71], v[36:39]
v_cvt_pk_bf16_f32 v230, v204, v205
v_cvt_pk_bf16_f32 v231, v206, v207
v_mfma_f32_16x16x32_bf16 v[168:171], a[196:199], v[84:87], v[168:171]
v_add_u32 v24, 0xffff2000, v24
v_add_f32 v28, v28, v192
v_mfma_f32_16x16x32_bf16 v[168:171], a[200:203], v[100:103], v[168:171]
ds_read_b64_tr_b16 v[244:245], v24 offset:12288
v_add_f32 v28, v28, v193
v_mfma_f32_16x16x32_bf16 v[168:171], a[204:207], v[116:119], v[168:171]
ds_read_b64_tr_b16 v[246:247], v24 offset:18432
v_add_f32 v28, v28, v194
v_mfma_f32_16x16x32_bf16 v[168:171], a[208:211], v[132:135], v[168:171]
ds_read_b64_tr_b16 v[248:249], v21 offset:12416
v_add_f32 v28, v28, v195
v_mfma_f32_16x16x32_bf16 v[168:171], a[212:215], v[148:151], v[168:171]
ds_read_b64_tr_b16 v[250:251], v21 offset:18560
v_add_f32 v29, v29, v200
v_mfma_f32_16x16x32_bf16 v[176:179], a[192:195], v[72:75], v[40:43]
buffer_load_dwordx4 v6, s[8:11], s22 offen offset:1024 nt lds
v_mfma_f32_16x16x32_bf16 v[176:179], a[196:199], v[88:91], v[176:179]
ds_read_b64_tr_b16 v[252:253], v22 offset:12416
v_add_f32 v29, v29, v201
v_mfma_f32_16x16x32_bf16 v[176:179], a[200:203], v[104:107], v[176:179]
ds_read_b64_tr_b16 v[254:255], v22 offset:18560
v_add_f32 v29, v29, v202
v_mfma_f32_16x16x32_bf16 v[176:179], a[204:207], v[120:123], v[176:179]
v_exp_f32 v160, v160
v_mfma_f32_16x16x32_bf16 v[176:179], a[208:211], v[136:139], v[176:179]
v_exp_f32 v161, v161
v_mfma_f32_16x16x32_bf16 v[176:179], a[212:215], v[152:155], v[176:179]
v_exp_f32 v162, v162
v_mfma_f32_16x16x32_bf16 v[184:187], a[192:195], v[76:79], v[44:47]
v_exp_f32 v163, v163
v_mfma_f32_16x16x32_bf16 v[184:187], a[196:199], v[92:95], v[184:187]
v_exp_f32 v168, v168
v_mfma_f32_16x16x32_bf16 v[184:187], a[200:203], v[108:111], v[184:187]
v_exp_f32 v169, v169
v_mfma_f32_16x16x32_bf16 v[184:187], a[204:207], v[124:127], v[184:187]
v_exp_f32 v170, v170
v_mfma_f32_16x16x32_bf16 v[184:187], a[208:211], v[140:143], v[184:187]
buffer_load_dwordx4 v7, s[8:11], s22 offen offset:2048 nt lds
v_mfma_f32_16x16x32_bf16 v[184:187], a[212:215], v[156:159], v[184:187]
s_waitcnt lgkmcnt(15)
v_exp_f32 v171, v171
v_mfma_f32_16x16x32_bf16 v[164:167], a[216:219], v[64:67], v[32:35]
s_waitcnt lgkmcnt(15)
v_exp_f32 v176, v176
v_mfma_f32_16x16x32_bf16 v[164:167], a[220:223], v[80:83], v[164:167]
s_waitcnt lgkmcnt(15)
v_exp_f32 v177, v177
v_mfma_f32_16x16x32_bf16 v[164:167], a[224:227], v[96:99], v[164:167]
s_waitcnt lgkmcnt(15)
v_exp_f32 v178, v178
v_mfma_f32_16x16x32_bf16 v[164:167], a[228:231], v[112:115], v[164:167]
s_waitcnt lgkmcnt(15)
v_exp_f32 v179, v179
v_mfma_f32_16x16x32_bf16 v[164:167], a[232:235], v[128:131], v[164:167]
s_waitcnt lgkmcnt(14)
v_exp_f32 v184, v184
v_mfma_f32_16x16x32_bf16 v[164:167], a[236:239], v[144:147], v[164:167]
s_add_u32 s22, s22, 12288
v_exp_f32 v185, v185
v_mfma_f32_16x16x32_bf16 v[172:175], a[216:219], v[68:71], v[36:39]
s_add_u32 m0, s25, 98304
v_exp_f32 v186, v186
v_mfma_f32_16x16x32_bf16 v[172:175], a[220:223], v[84:87], v[172:175]
v_exp_f32 v187, v187
v_mfma_f32_16x16x32_bf16 v[172:175], a[224:227], v[100:103], v[172:175]
buffer_load_dwordx4 v8, s[92:95], s23 offen offset:0 nt lds
v_mfma_f32_16x16x32_bf16 v[172:175], a[228:231], v[116:119], v[172:175]
v_exp_f32 v164, v164
v_mfma_f32_16x16x32_bf16 v[172:175], a[232:235], v[132:135], v[172:175]
v_exp_f32 v165, v165
v_mfma_f32_16x16x32_bf16 v[172:175], a[236:239], v[148:151], v[172:175]
v_exp_f32 v166, v166
v_mfma_f32_16x16x32_bf16 v[180:183], a[216:219], v[72:75], v[40:43]
v_exp_f32 v167, v167
v_mfma_f32_16x16x32_bf16 v[180:183], a[220:223], v[88:91], v[180:183]
v_add_f32 v26, v26, v160
v_add_f32 v26, v26, v161
v_mfma_f32_16x16x32_bf16 v[180:183], a[224:227], v[104:107], v[180:183]
v_add_f32 v26, v26, v162
v_add_f32 v26, v26, v163
v_mfma_f32_16x16x32_bf16 v[180:183], a[228:231], v[120:123], v[180:183]
v_exp_f32 v172, v172
v_mfma_f32_16x16x32_bf16 v[180:183], a[232:235], v[136:139], v[180:183]
v_exp_f32 v173, v173
v_mfma_f32_16x16x32_bf16 v[180:183], a[236:239], v[152:155], v[180:183]
v_exp_f32 v174, v174
v_mfma_f32_16x16x32_bf16 v[188:191], a[216:219], v[76:79], v[44:47]
buffer_load_dwordx4 v9, s[92:95], s23 offen offset:1024 nt lds
v_mfma_f32_16x16x32_bf16 v[188:191], a[220:223], v[92:95], v[188:191]
v_exp_f32 v175, v175
v_mfma_f32_16x16x32_bf16 v[188:191], a[224:227], v[108:111], v[188:191]
v_cvt_pk_bf16_f32 v208, v160, v161
v_cvt_pk_bf16_f32 v209, v162, v163
v_mfma_f32_16x16x32_bf16 v[188:191], a[228:231], v[124:127], v[188:191]
v_exp_f32 v180, v180
v_mfma_f32_16x16x32_bf16 v[188:191], a[232:235], v[140:143], v[188:191]
v_exp_f32 v181, v181
v_mfma_f32_16x16x32_bf16 v[188:191], a[236:239], v[156:159], v[188:191]
s_waitcnt lgkmcnt(10)
v_exp_f32 v182, v182
v_mfma_f32_16x16x32_bf16 a[0:3], v[232:235], v[216:219], a[0:3]
v_exp_f32 v183, v183
v_mfma_f32_16x16x32_bf16 a[4:7], v[232:235], v[220:223], a[4:7]
v_add_f32 v27, v27, v168
v_add_f32 v27, v27, v169
v_mfma_f32_16x16x32_bf16 a[8:11], v[232:235], v[224:227], a[8:11]
v_add_f32 v27, v27, v170
v_add_f32 v27, v27, v171
v_mfma_f32_16x16x32_bf16 a[12:15], v[232:235], v[228:231], a[12:15]
s_waitcnt lgkmcnt(8)
ds_read_b64_tr_b16 v[232:233], v23 offset:12416
v_cvt_pk_bf16_f32 v212, v168, v169
v_mfma_f32_16x16x32_bf16 a[16:19], v[236:239], v[216:219], a[16:19]
buffer_load_dwordx4 v10, s[92:95], s23 offen offset:2048 nt lds
v_mfma_f32_16x16x32_bf16 a[20:23], v[236:239], v[220:223], a[20:23]
s_add_u32 s23, s23, 12288
ds_read_b64_tr_b16 v[234:235], v23 offset:18560
v_cvt_pk_bf16_f32 v213, v170, v171
v_mfma_f32_16x16x32_bf16 a[24:27], v[236:239], v[224:227], a[24:27]
s_add_u32 m0, s26, 110592
v_add_f32 v29, v29, v203
v_add_f32 v26, v26, v164
v_mfma_f32_16x16x32_bf16 a[28:31], v[236:239], v[228:231], a[28:31]
s_waitcnt lgkmcnt(8)
ds_read_b64_tr_b16 v[236:237], v24 offset:12416
v_add_f32 v26, v26, v165
v_mfma_f32_16x16x32_bf16 a[32:35], v[240:243], v[216:219], a[32:35]
global_load_dword v30, v1, s[62:63]
v_mfma_f32_16x16x32_bf16 a[36:39], v[240:243], v[220:223], a[36:39]
s_add_u32 s62, s62, 0x2000
ds_read_b64_tr_b16 v[238:239], v24 offset:18560
v_add_f32 v26, v26, v166
v_mfma_f32_16x16x32_bf16 a[40:43], v[240:243], v[224:227], a[40:43]
s_addc_u32 s63, s63, 0
v_exp_f32 v188, v188
v_mfma_f32_16x16x32_bf16 a[44:47], v[240:243], v[228:231], a[44:47]
s_waitcnt lgkmcnt(8)
ds_read_b64_tr_b16 v[240:241], v21 offset:12544
v_add_f32 v26, v26, v167
v_mfma_f32_16x16x32_bf16 a[48:51], v[244:247], v[216:219], a[48:51]
ds_read_b64_tr_b16 v[242:243], v21 offset:18688
v_cvt_pk_bf16_f32 v210, v164, v165
v_mfma_f32_16x16x32_bf16 a[52:55], v[244:247], v[220:223], a[52:55]
v_exp_f32 v189, v189
v_mfma_f32_16x16x32_bf16 a[56:59], v[244:247], v[224:227], a[56:59]
buffer_load_dwordx4 v12, s[16:19], s41 offen nt lds
v_mfma_f32_16x16x32_bf16 a[60:63], v[244:247], v[228:231], a[60:63]
s_waitcnt lgkmcnt(8)
ds_read_b64_tr_b16 v[244:245], v22 offset:12544
v_cvt_pk_bf16_f32 v211, v166, v167
v_mfma_f32_16x16x32_bf16 a[64:67], v[248:251], v[216:219], a[64:67]
s_add_u32 s41, s41, 40960
ds_read_b64_tr_b16 v[246:247], v22 offset:18688
v_add_f32 v27, v27, v172
v_mfma_f32_16x16x32_bf16 a[68:71], v[248:251], v[220:223], a[68:71]
v_exp_f32 v190, v190
v_mfma_f32_16x16x32_bf16 a[72:75], v[248:251], v[224:227], a[72:75]
v_exp_f32 v191, v191
v_mfma_f32_16x16x32_bf16 a[76:79], v[248:251], v[228:231], a[76:79]
s_waitcnt lgkmcnt(8)
ds_read_b64_tr_b16 v[248:249], v23 offset:12544
v_add_f32 v27, v27, v173
v_mfma_f32_16x16x32_bf16 a[80:83], v[252:255], v[216:219], a[80:83]
ds_read_b64_tr_b16 v[250:251], v23 offset:18688
v_add_f32 v27, v27, v174
v_mfma_f32_16x16x32_bf16 a[84:87], v[252:255], v[220:223], a[84:87]
v_add_f32 v27, v27, v175
v_cvt_pk_bf16_f32 v214, v172, v173
v_mfma_f32_16x16x32_bf16 a[88:91], v[252:255], v[224:227], a[88:91]
v_cvt_pk_bf16_f32 v215, v174, v175
v_add_f32 v28, v28, v196
v_mfma_f32_16x16x32_bf16 a[92:95], v[252:255], v[228:231], a[92:95]
s_waitcnt lgkmcnt(8)
ds_read_b64_tr_b16 v[252:253], v24 offset:12544
v_add_f32 v28, v28, v197
v_mfma_f32_16x16x32_bf16 a[96:99], v[232:235], v[216:219], a[96:99]
ds_read_b64_tr_b16 v[254:255], v24 offset:18688
v_add_f32 v28, v28, v198
v_mfma_f32_16x16x32_bf16 a[100:103], v[232:235], v[220:223], a[100:103]
v_add_f32 v28, v28, v199
v_add_f32 v29, v29, v204
v_mfma_f32_16x16x32_bf16 a[104:107], v[232:235], v[224:227], a[104:107]
v_add_f32 v29, v29, v205
v_add_f32 v29, v29, v206
v_mfma_f32_16x16x32_bf16 a[108:111], v[232:235], v[228:231], a[108:111]
s_waitcnt lgkmcnt(8)
v_add_f32 v29, v29, v207
v_add_f32 v28, v28, v176
v_mfma_f32_16x16x32_bf16 a[112:115], v[236:239], v[216:219], a[112:115]
v_add_f32 v28, v28, v177
v_add_f32 v28, v28, v178
v_mfma_f32_16x16x32_bf16 a[116:119], v[236:239], v[220:223], a[116:119]
v_add_f32 v28, v28, v179
v_add_f32 v29, v29, v184
v_mfma_f32_16x16x32_bf16 a[120:123], v[236:239], v[224:227], a[120:123]
s_waitcnt vmcnt(8) lgkmcnt(0)
s_barrier
v_add_f32 v29, v29, v185
v_add_f32 v29, v29, v186
v_mfma_f32_16x16x32_bf16 a[124:127], v[236:239], v[228:231], a[124:127]
ds_read_b128 a[192:195], v19 offset:28672
v_add_f32 v29, v29, v187
v_mfma_f32_16x16x32_bf16 a[128:131], v[240:243], v[216:219], a[128:131]
ds_read_b128 a[196:199], v20 offset:28672
v_add_f32 v28, v28, v180
v_mfma_f32_16x16x32_bf16 a[132:135], v[240:243], v[220:223], a[132:135]
ds_read_b128 a[200:203], v19 offset:28800
v_add_f32 v28, v28, v181
v_mfma_f32_16x16x32_bf16 a[136:139], v[240:243], v[224:227], a[136:139]
ds_read_b128 a[204:207], v20 offset:28800
v_add_f32 v28, v28, v182
v_mfma_f32_16x16x32_bf16 a[140:143], v[240:243], v[228:231], a[140:143]
ds_read_b128 a[208:211], v19 offset:28928
v_add_f32 v28, v28, v183
v_mfma_f32_16x16x32_bf16 a[144:147], v[244:247], v[216:219], a[144:147]
buffer_store_dwordx4 a[240:243], v1, s[12:15], s42 offen sc1
v_mfma_f32_16x16x32_bf16 a[148:151], v[244:247], v[220:223], a[148:151]
s_add_u32 s42, s42, 10240
ds_read_b128 a[212:215], v20 offset:28928
v_add_f32 v29, v29, v188
v_mfma_f32_16x16x32_bf16 a[152:155], v[244:247], v[224:227], a[152:155]
s_add_u32 m0, s25, 0
ds_read_b128 a[216:219], v19 offset:34816
v_add_f32 v29, v29, v189
v_mfma_f32_16x16x32_bf16 a[156:159], v[244:247], v[228:231], a[156:159]
ds_read_b128 a[220:223], v20 offset:34816
v_add_f32 v29, v29, v190
v_mfma_f32_16x16x32_bf16 a[160:163], v[248:251], v[216:219], a[160:163]
ds_read_b128 a[224:227], v19 offset:34944
v_add_f32 v29, v29, v191
v_mfma_f32_16x16x32_bf16 a[164:167], v[248:251], v[220:223], a[164:167]
ds_read_b128 a[228:231], v20 offset:34944
v_mfma_f32_16x16x32_bf16 a[168:171], v[248:251], v[224:227], a[168:171]
ds_read_b128 a[232:235], v19 offset:35072
v_mfma_f32_16x16x32_bf16 a[172:175], v[248:251], v[228:231], a[172:175]
ds_read_b128 a[236:239], v20 offset:35072
v_mfma_f32_16x16x32_bf16 a[176:179], v[252:255], v[216:219], a[176:179]
ds_read_b64_tr_b16 a[240:241], v16 offset:53248
v_mfma_f32_16x16x32_bf16 a[180:183], v[252:255], v[220:223], a[180:183]
ds_read_b64_tr_b16 a[242:243], v16 offset:55296
v_add_u32 v16, 0xe000, v16
v_mfma_f32_16x16x32_bf16 a[184:187], v[252:255], v[224:227], a[184:187]
ds_read_b64_tr_b16 v[232:233], v21 offset:40960
v_cvt_pk_bf16_f32 v224, v176, v177
v_mfma_f32_16x16x32_bf16 a[188:191], v[252:255], v[228:231], a[188:191]
s_waitcnt lgkmcnt(14)
ds_read_b64_tr_b16 v[234:235], v21 offset:47104
v_cvt_pk_bf16_f32 v225, v178, v179
v_mfma_f32_16x16x32_bf16 v[160:163], a[192:195], v[64:67], v[32:35]
s_waitcnt lgkmcnt(14)
ds_read_b64_tr_b16 v[236:237], v22 offset:40960
v_cvt_pk_bf16_f32 v226, v180, v181
v_mfma_f32_16x16x32_bf16 v[160:163], a[196:199], v[80:83], v[160:163]
s_waitcnt lgkmcnt(14)
ds_read_b64_tr_b16 v[238:239], v22 offset:47104
v_cvt_pk_bf16_f32 v227, v182, v183
v_mfma_f32_16x16x32_bf16 v[160:163], a[200:203], v[96:99], v[160:163]
s_waitcnt lgkmcnt(14)
buffer_load_dwordx4 v5, s[8:11], s22 offen offset:0 nt lds
v_mfma_f32_16x16x32_bf16 v[160:163], a[204:207], v[112:115], v[160:163]
s_waitcnt lgkmcnt(13)
ds_read_b64_tr_b16 v[240:241], v23 offset:40960
v_cvt_pk_bf16_f32 v228, v184, v185
v_mfma_f32_16x16x32_bf16 v[160:163], a[208:211], v[128:131], v[160:163]
s_waitcnt lgkmcnt(13)
ds_read_b64_tr_b16 v[242:243], v23 offset:47104
v_cvt_pk_bf16_f32 v229, v186, v187
v_mfma_f32_16x16x32_bf16 v[160:163], a[212:215], v[144:147], v[160:163]
ds_read_b64_tr_b16 v[244:245], v24 offset:40960
v_cvt_pk_bf16_f32 v230, v188, v189
v_mfma_f32_16x16x32_bf16 v[168:171], a[192:195], v[68:71], v[36:39]
ds_read_b64_tr_b16 v[246:247], v24 offset:47104
v_cvt_pk_bf16_f32 v231, v190, v191
v_mfma_f32_16x16x32_bf16 v[168:171], a[196:199], v[84:87], v[168:171]
ds_read_b64_tr_b16 v[248:249], v21 offset:41088
v_mfma_f32_16x16x32_bf16 v[168:171], a[200:203], v[100:103], v[168:171]
ds_read_b64_tr_b16 v[250:251], v21 offset:47232
v_mfma_f32_16x16x32_bf16 v[168:171], a[204:207], v[116:119], v[168:171]
v_exp_f32 v160, v160
v_mfma_f32_16x16x32_bf16 v[168:171], a[208:211], v[132:135], v[168:171]
buffer_load_dwordx4 v6, s[8:11], s22 offen offset:1024 nt lds
v_mfma_f32_16x16x32_bf16 v[168:171], a[212:215], v[148:151], v[168:171]
ds_read_b64_tr_b16 v[252:253], v22 offset:41088
v_add_f32 v26, v26, v160
v_mfma_f32_16x16x32_bf16 v[192:195], a[192:195], v[72:75], v[40:43]
v_exp_f32 v161, v161
v_mfma_f32_16x16x32_bf16 v[192:195], a[196:199], v[88:91], v[192:195]
ds_read_b64_tr_b16 v[254:255], v22 offset:47232
v_add_f32 v26, v26, v161
v_mfma_f32_16x16x32_bf16 v[192:195], a[200:203], v[104:107], v[192:195]
v_exp_f32 v162, v162
v_mfma_f32_16x16x32_bf16 v[192:195], a[204:207], v[120:123], v[192:195]
v_exp_f32 v163, v163
v_mfma_f32_16x16x32_bf16 v[192:195], a[208:211], v[136:139], v[192:195]
v_exp_f32 v168, v168
v_mfma_f32_16x16x32_bf16 v[192:195], a[212:215], v[152:155], v[192:195]
v_exp_f32 v169, v169
v_mfma_f32_16x16x32_bf16 v[200:203], a[192:195], v[76:79], v[44:47]
v_exp_f32 v170, v170
v_mfma_f32_16x16x32_bf16 v[200:203], a[196:199], v[92:95], v[200:203]
buffer_load_dwordx4 v7, s[8:11], s22 offen offset:2048 nt lds
v_mfma_f32_16x16x32_bf16 v[200:203], a[200:203], v[108:111], v[200:203]
s_add_u32 s22, s22, 12288
v_exp_f32 v171, v171
v_mfma_f32_16x16x32_bf16 v[200:203], a[204:207], v[124:127], v[200:203]
s_add_u32 m0, s25, 12288
v_exp_f32 v192, v192
v_mfma_f32_16x16x32_bf16 v[200:203], a[208:211], v[140:143], v[200:203]
v_exp_f32 v193, v193
v_mfma_f32_16x16x32_bf16 v[200:203], a[212:215], v[156:159], v[200:203]
s_waitcnt lgkmcnt(15)
v_exp_f32 v194, v194
v_mfma_f32_16x16x32_bf16 v[164:167], a[216:219], v[64:67], v[32:35]
s_waitcnt lgkmcnt(15)
v_exp_f32 v195, v195
v_mfma_f32_16x16x32_bf16 v[164:167], a[220:223], v[80:83], v[164:167]
s_waitcnt lgkmcnt(15)
v_add_f32 v26, v26, v162
v_add_f32 v26, v26, v163
v_mfma_f32_16x16x32_bf16 v[164:167], a[224:227], v[96:99], v[164:167]
s_waitcnt lgkmcnt(15)
v_cvt_pk_bf16_f32 v216, v160, v161
v_cvt_pk_bf16_f32 v217, v162, v163
v_mfma_f32_16x16x32_bf16 v[164:167], a[228:231], v[112:115], v[164:167]
s_waitcnt lgkmcnt(15)
v_exp_f32 v200, v200
v_mfma_f32_16x16x32_bf16 v[164:167], a[232:235], v[128:131], v[164:167]
s_waitcnt lgkmcnt(14)
buffer_load_dwordx4 v8, s[92:95], s23 offen offset:0 nt lds
v_mfma_f32_16x16x32_bf16 v[164:167], a[236:239], v[144:147], v[164:167]
v_exp_f32 v201, v201
v_mfma_f32_16x16x32_bf16 v[172:175], a[216:219], v[68:71], v[36:39]
v_exp_f32 v202, v202
v_mfma_f32_16x16x32_bf16 v[172:175], a[220:223], v[84:87], v[172:175]
v_exp_f32 v203, v203
v_mfma_f32_16x16x32_bf16 v[172:175], a[224:227], v[100:103], v[172:175]
v_add_f32 v27, v27, v168
v_add_f32 v27, v27, v169
v_mfma_f32_16x16x32_bf16 v[172:175], a[228:231], v[116:119], v[172:175]
v_exp_f32 v164, v164
v_mfma_f32_16x16x32_bf16 v[172:175], a[232:235], v[132:135], v[172:175]
v_exp_f32 v165, v165
v_mfma_f32_16x16x32_bf16 v[172:175], a[236:239], v[148:151], v[172:175]
v_exp_f32 v166, v166
v_mfma_f32_16x16x32_bf16 v[196:199], a[216:219], v[72:75], v[40:43]
v_exp_f32 v167, v167
v_mfma_f32_16x16x32_bf16 v[196:199], a[220:223], v[88:91], v[196:199]
buffer_load_dwordx4 v9, s[92:95], s23 offen offset:1024 nt lds
v_mfma_f32_16x16x32_bf16 v[196:199], a[224:227], v[104:107], v[196:199]
v_add_f32 v27, v27, v170
v_add_f32 v27, v27, v171
v_mfma_f32_16x16x32_bf16 v[196:199], a[228:231], v[120:123], v[196:199]
v_exp_f32 v172, v172
v_mfma_f32_16x16x32_bf16 v[196:199], a[232:235], v[136:139], v[196:199]
v_exp_f32 v173, v173
v_mfma_f32_16x16x32_bf16 v[196:199], a[236:239], v[152:155], v[196:199]
v_exp_f32 v174, v174
v_mfma_f32_16x16x32_bf16 v[204:207], a[216:219], v[76:79], v[44:47]
v_exp_f32 v175, v175
v_mfma_f32_16x16x32_bf16 v[204:207], a[220:223], v[92:95], v[204:207]
v_cvt_pk_bf16_f32 v220, v168, v169
v_cvt_pk_bf16_f32 v221, v170, v171
v_mfma_f32_16x16x32_bf16 v[204:207], a[224:227], v[108:111], v[204:207]
v_add_f32 v26, v26, v164
v_add_f32 v26, v26, v165
v_mfma_f32_16x16x32_bf16 v[204:207], a[228:231], v[124:127], v[204:207]
buffer_load_dwordx4 v10, s[92:95], s23 offen offset:2048 nt lds
v_mfma_f32_16x16x32_bf16 v[204:207], a[232:235], v[140:143], v[204:207]
s_add_u32 s23, s23, 12288
v_exp_f32 v196, v196
v_mfma_f32_16x16x32_bf16 v[204:207], a[236:239], v[156:159], v[204:207]
s_waitcnt lgkmcnt(10)
v_exp_f32 v197, v197
v_mfma_f32_16x16x32_bf16 a[0:3], v[232:235], v[208:211], a[0:3]
s_add_u32 m0, s26, 24576
v_exp_f32 v198, v198
v_mfma_f32_16x16x32_bf16 a[4:7], v[232:235], v[212:215], a[4:7]
v_exp_f32 v199, v199
v_mfma_f32_16x16x32_bf16 a[8:11], v[232:235], v[224:227], a[8:11]
v_add_f32 v26, v26, v166
v_add_f32 v26, v26, v167
v_mfma_f32_16x16x32_bf16 a[12:15], v[232:235], v[228:231], a[12:15]
s_waitcnt lgkmcnt(8)
ds_read_b64_tr_b16 v[232:233], v23 offset:41088
v_cvt_pk_bf16_f32 v218, v164, v165
v_mfma_f32_16x16x32_bf16 a[16:19], v[236:239], v[208:211], a[16:19]
ds_read_b64_tr_b16 v[234:235], v23 offset:47232
v_cvt_pk_bf16_f32 v219, v166, v167
v_mfma_f32_16x16x32_bf16 a[20:23], v[236:239], v[212:215], a[20:23]
v_exp_f32 v204, v204
v_mfma_f32_16x16x32_bf16 a[24:27], v[236:239], v[224:227], a[24:27]
buffer_load_dwordx4 v12, s[16:19], s41 offen nt lds
v_mfma_f32_16x16x32_bf16 a[28:31], v[236:239], v[228:231], a[28:31]
s_waitcnt lgkmcnt(8)
ds_read_b64_tr_b16 v[236:237], v24 offset:41088
v_add_f32 v27, v27, v172
v_mfma_f32_16x16x32_bf16 a[32:35], v[240:243], v[208:211], a[32:35]
s_add_u32 s41, s41, 40960
ds_read_b64_tr_b16 v[238:239], v24 offset:47232
v_add_f32 v27, v27, v173
v_mfma_f32_16x16x32_bf16 a[36:39], v[240:243], v[212:215], a[36:39]
v_exp_f32 v205, v205
v_mfma_f32_16x16x32_bf16 a[40:43], v[240:243], v[224:227], a[40:43]
v_exp_f32 v206, v206
v_mfma_f32_16x16x32_bf16 a[44:47], v[240:243], v[228:231], a[44:47]
s_waitcnt lgkmcnt(8)
ds_read_b64_tr_b16 v[240:241], v21 offset:41216
v_add_f32 v27, v27, v174
v_mfma_f32_16x16x32_bf16 a[48:51], v[244:247], v[208:211], a[48:51]
ds_read_b64_tr_b16 v[242:243], v21 offset:47360
v_add_f32 v27, v27, v175
v_mfma_f32_16x16x32_bf16 a[52:55], v[244:247], v[212:215], a[52:55]
v_exp_f32 v207, v207
v_mfma_f32_16x16x32_bf16 a[56:59], v[244:247], v[224:227], a[56:59]
v_cvt_pk_bf16_f32 v222, v172, v173
v_cvt_pk_bf16_f32 v223, v174, v175
v_mfma_f32_16x16x32_bf16 a[60:63], v[244:247], v[228:231], a[60:63]
s_waitcnt lgkmcnt(8)
buffer_store_dword v15, v14, s[12:15], s55 offen sc1
v_mfma_f32_16x16x32_bf16 a[64:67], v[248:251], v[208:211], a[64:67]
s_add_u32 s55, s55, 4096
ds_read_b64_tr_b16 v[244:245], v22 offset:41216
v_add_u32 v21, 0xe000, v21
v_mfma_f32_16x16x32_bf16 a[68:71], v[248:251], v[212:215], a[68:71]
ds_read_b64_tr_b16 v[246:247], v22 offset:47360
v_add_u32 v22, 0xe000, v22
v_mfma_f32_16x16x32_bf16 a[72:75], v[248:251], v[224:227], a[72:75]
v_add_f32 v28, v28, v192
v_add_f32 v28, v28, v193
v_mfma_f32_16x16x32_bf16 a[76:79], v[248:251], v[228:231], a[76:79]
s_waitcnt lgkmcnt(8)
ds_read_b64_tr_b16 v[248:249], v23 offset:41216
v_add_f32 v28, v28, v194
v_mfma_f32_16x16x32_bf16 a[80:83], v[252:255], v[208:211], a[80:83]
ds_read_b64_tr_b16 v[250:251], v23 offset:47360
v_add_u32 v23, 0xe000, v23
v_mfma_f32_16x16x32_bf16 a[84:87], v[252:255], v[212:215], a[84:87]
v_add_f32 v28, v28, v195
v_add_f32 v29, v29, v200
v_mfma_f32_16x16x32_bf16 a[88:91], v[252:255], v[224:227], a[88:91]
v_add_f32 v29, v29, v201
v_add_f32 v29, v29, v202
v_mfma_f32_16x16x32_bf16 a[92:95], v[252:255], v[228:231], a[92:95]
s_waitcnt lgkmcnt(8)
ds_read_b64_tr_b16 v[252:253], v24 offset:41216
v_add_f32 v29, v29, v203
v_mfma_f32_16x16x32_bf16 a[96:99], v[232:235], v[208:211], a[96:99]
ds_read_b64_tr_b16 v[254:255], v24 offset:47360
v_add_u32 v24, 0xe000, v24
v_mfma_f32_16x16x32_bf16 a[100:103], v[232:235], v[212:215], a[100:103]
v_add_f32 v28, v28, v196
v_add_f32 v28, v28, v197
v_mfma_f32_16x16x32_bf16 a[104:107], v[232:235], v[224:227], a[104:107]
v_add_f32 v28, v28, v198
v_add_f32 v28, v28, v199
v_mfma_f32_16x16x32_bf16 a[108:111], v[232:235], v[228:231], a[108:111]
s_waitcnt lgkmcnt(8)
v_add_f32 v29, v29, v204
v_add_f32 v29, v29, v205
v_mfma_f32_16x16x32_bf16 a[112:115], v[236:239], v[208:211], a[112:115]
v_add_f32 v29, v29, v206
v_add_f32 v29, v29, v207
v_mfma_f32_16x16x32_bf16 a[116:119], v[236:239], v[212:215], a[116:119]
v_mfma_f32_16x16x32_bf16 a[120:123], v[236:239], v[224:227], a[120:123]
s_waitcnt lgkmcnt(0)
s_barrier
v_mfma_f32_16x16x32_bf16 a[124:127], v[236:239], v[228:231], a[124:127]
ds_read_b128 a[192:195], v19 offset:57344
v_mfma_f32_16x16x32_bf16 a[128:131], v[240:243], v[208:211], a[128:131]
ds_read_b128 a[196:199], v20 offset:57344
v_mfma_f32_16x16x32_bf16 a[132:135], v[240:243], v[212:215], a[132:135]
ds_read_b128 a[200:203], v19 offset:57472
v_mfma_f32_16x16x32_bf16 a[136:139], v[240:243], v[224:227], a[136:139]
ds_read_b128 a[204:207], v20 offset:57472
v_mfma_f32_16x16x32_bf16 a[140:143], v[240:243], v[228:231], a[140:143]
ds_read_b128 a[208:211], v19 offset:57600
v_mfma_f32_16x16x32_bf16 a[144:147], v[244:247], v[208:211], a[144:147]
buffer_store_dwordx4 a[240:243], v1, s[12:15], s42 offen sc1
v_mfma_f32_16x16x32_bf16 a[148:151], v[244:247], v[212:215], a[148:151]
s_add_u32 s42, s42, 10240
ds_read_b128 a[212:215], v20 offset:57600
v_mfma_f32_16x16x32_bf16 a[152:155], v[244:247], v[224:227], a[152:155]
s_add_u32 m0, s25, 28672
ds_read_b128 a[216:219], v19 offset:63488
v_mfma_f32_16x16x32_bf16 a[156:159], v[244:247], v[228:231], a[156:159]
ds_read_b128 a[220:223], v20 offset:63488
v_mfma_f32_16x16x32_bf16 a[160:163], v[248:251], v[208:211], a[160:163]
ds_read_b128 a[224:227], v19 offset:63616
v_mfma_f32_16x16x32_bf16 a[164:167], v[248:251], v[212:215], a[164:167]
ds_read_b128 a[228:231], v20 offset:63616
v_mfma_f32_16x16x32_bf16 a[168:171], v[248:251], v[224:227], a[168:171]
ds_read_b128 a[232:235], v19 offset:63744
v_add_u32 v19, 0x15000, v19
v_mfma_f32_16x16x32_bf16 a[172:175], v[248:251], v[228:231], a[172:175]
ds_read_b128 a[236:239], v20 offset:63744
v_add_u32 v20, 0x15000, v20
v_mfma_f32_16x16x32_bf16 a[176:179], v[252:255], v[208:211], a[176:179]
ds_read_b64_tr_b16 a[240:241], v16 offset:24576
v_mfma_f32_16x16x32_bf16 a[180:183], v[252:255], v[212:215], a[180:183]
ds_read_b64_tr_b16 a[242:243], v16 offset:26624
v_mfma_f32_16x16x32_bf16 a[184:187], v[252:255], v[224:227], a[184:187]
ds_read_b64_tr_b16 v[232:233], v21 offset:12288
v_cvt_pk_bf16_f32 v224, v192, v193
v_mfma_f32_16x16x32_bf16 a[188:191], v[252:255], v[228:231], a[188:191]
s_waitcnt lgkmcnt(14)
ds_read_b64_tr_b16 v[234:235], v21 offset:18432
v_cvt_pk_bf16_f32 v225, v194, v195
v_mfma_f32_16x16x32_bf16 v[160:163], a[192:195], v[64:67], v[32:35]
s_waitcnt lgkmcnt(14)
ds_read_b64_tr_b16 v[236:237], v22 offset:12288
v_cvt_pk_bf16_f32 v226, v196, v197
v_mfma_f32_16x16x32_bf16 v[160:163], a[196:199], v[80:83], v[160:163]
s_waitcnt lgkmcnt(14)
ds_read_b64_tr_b16 v[238:239], v22 offset:18432
v_cvt_pk_bf16_f32 v227, v198, v199
v_mfma_f32_16x16x32_bf16 v[160:163], a[200:203], v[96:99], v[160:163]
s_waitcnt lgkmcnt(14)
buffer_load_dwordx4 v5, s[8:11], s22 offen offset:0 nt lds
v_mfma_f32_16x16x32_bf16 v[160:163], a[204:207], v[112:115], v[160:163]
s_waitcnt lgkmcnt(13)
ds_read_b64_tr_b16 v[240:241], v23 offset:12288
v_cvt_pk_bf16_f32 v228, v200, v201
v_mfma_f32_16x16x32_bf16 v[160:163], a[208:211], v[128:131], v[160:163]
s_waitcnt lgkmcnt(13)
ds_read_b64_tr_b16 v[242:243], v23 offset:18432
v_cvt_pk_bf16_f32 v229, v202, v203
v_mfma_f32_16x16x32_bf16 v[160:163], a[212:215], v[144:147], v[160:163]
ds_read_b64_tr_b16 v[244:245], v24 offset:12288
v_cvt_pk_bf16_f32 v230, v204, v205
v_mfma_f32_16x16x32_bf16 v[168:171], a[192:195], v[68:71], v[36:39]
ds_read_b64_tr_b16 v[246:247], v24 offset:18432
v_cvt_pk_bf16_f32 v231, v206, v207
v_mfma_f32_16x16x32_bf16 v[168:171], a[196:199], v[84:87], v[168:171]
ds_read_b64_tr_b16 v[248:249], v21 offset:12416
v_mfma_f32_16x16x32_bf16 v[168:171], a[200:203], v[100:103], v[168:171]
ds_read_b64_tr_b16 v[250:251], v21 offset:18560
v_mfma_f32_16x16x32_bf16 v[168:171], a[204:207], v[116:119], v[168:171]
v_exp_f32 v160, v160
v_mfma_f32_16x16x32_bf16 v[168:171], a[208:211], v[132:135], v[168:171]
ds_read_b64_tr_b16 v[252:253], v22 offset:12416
v_add_f32 v26, v26, v160
v_mfma_f32_16x16x32_bf16 v[168:171], a[212:215], v[148:151], v[168:171]
v_exp_f32 v161, v161
v_mfma_f32_16x16x32_bf16 v[176:179], a[192:195], v[72:75], v[40:43]
buffer_load_dwordx4 v6, s[8:11], s22 offen offset:1024 nt lds
v_mfma_f32_16x16x32_bf16 v[176:179], a[196:199], v[88:91], v[176:179]
ds_read_b64_tr_b16 v[254:255], v22 offset:18560
v_add_f32 v26, v26, v161
v_mfma_f32_16x16x32_bf16 v[176:179], a[200:203], v[104:107], v[176:179]
v_exp_f32 v162, v162
v_mfma_f32_16x16x32_bf16 v[176:179], a[204:207], v[120:123], v[176:179]
v_exp_f32 v163, v163
v_mfma_f32_16x16x32_bf16 v[176:179], a[208:211], v[136:139], v[176:179]
v_exp_f32 v168, v168
v_mfma_f32_16x16x32_bf16 v[176:179], a[212:215], v[152:155], v[176:179]
v_exp_f32 v169, v169
v_mfma_f32_16x16x32_bf16 v[184:187], a[192:195], v[76:79], v[44:47]
v_exp_f32 v170, v170
v_mfma_f32_16x16x32_bf16 v[184:187], a[196:199], v[92:95], v[184:187]
v_exp_f32 v171, v171
v_mfma_f32_16x16x32_bf16 v[184:187], a[200:203], v[108:111], v[184:187]
v_add_f32 v26, v26, v162
v_add_f32 v26, v26, v163
v_mfma_f32_16x16x32_bf16 v[184:187], a[204:207], v[124:127], v[184:187]
v_exp_f32 v176, v176
v_mfma_f32_16x16x32_bf16 v[184:187], a[208:211], v[140:143], v[184:187]
buffer_load_dwordx4 v7, s[8:11], s22 offen offset:2048 nt lds
v_mfma_f32_16x16x32_bf16 v[184:187], a[212:215], v[156:159], v[184:187]
s_waitcnt lgkmcnt(15)
v_exp_f32 v177, v177
v_mfma_f32_16x16x32_bf16 v[164:167], a[216:219], v[64:67], v[32:35]
s_waitcnt lgkmcnt(15)
v_exp_f32 v178, v178
v_mfma_f32_16x16x32_bf16 v[164:167], a[220:223], v[80:83], v[164:167]
s_waitcnt lgkmcnt(15)
v_exp_f32 v179, v179
v_mfma_f32_16x16x32_bf16 v[164:167], a[224:227], v[96:99], v[164:167]
s_waitcnt lgkmcnt(15)
v_cvt_pk_bf16_f32 v208, v160, v161
v_cvt_pk_bf16_f32 v209, v162, v163
v_mfma_f32_16x16x32_bf16 v[164:167], a[228:231], v[112:115], v[164:167]
s_waitcnt lgkmcnt(15)
v_exp_f32 v184, v184
v_mfma_f32_16x16x32_bf16 v[164:167], a[232:235], v[128:131], v[164:167]
s_waitcnt lgkmcnt(14)
v_exp_f32 v185, v185
v_mfma_f32_16x16x32_bf16 v[164:167], a[236:239], v[144:147], v[164:167]
s_add_u32 s22, s22, 12288
v_exp_f32 v186, v186
v_mfma_f32_16x16x32_bf16 v[172:175], a[216:219], v[68:71], v[36:39]
s_add_u32 m0, s25, 40960
v_exp_f32 v187, v187
v_mfma_f32_16x16x32_bf16 v[172:175], a[220:223], v[84:87], v[172:175]
v_add_f32 v27, v27, v168
v_add_f32 v27, v27, v169
v_mfma_f32_16x16x32_bf16 v[172:175], a[224:227], v[100:103], v[172:175]
buffer_load_dwordx4 v8, s[92:95], s23 offen offset:0 nt lds
v_mfma_f32_16x16x32_bf16 v[172:175], a[228:231], v[116:119], v[172:175]
v_exp_f32 v164, v164
v_mfma_f32_16x16x32_bf16 v[172:175], a[232:235], v[132:135], v[172:175]
v_exp_f32 v165, v165
v_mfma_f32_16x16x32_bf16 v[172:175], a[236:239], v[148:151], v[172:175]
v_exp_f32 v166, v166
v_mfma_f32_16x16x32_bf16 v[180:183], a[216:219], v[72:75], v[40:43]
v_exp_f32 v167, v167
v_mfma_f32_16x16x32_bf16 v[180:183], a[220:223], v[88:91], v[180:183]
v_add_f32 v27, v27, v170
v_add_f32 v27, v27, v171
v_mfma_f32_16x16x32_bf16 v[180:183], a[224:227], v[104:107], v[180:183]
v_cvt_pk_bf16_f32 v212, v168, v169
v_cvt_pk_bf16_f32 v213, v170, v171
v_mfma_f32_16x16x32_bf16 v[180:183], a[228:231], v[120:123], v[180:183]
v_exp_f32 v172, v172
v_mfma_f32_16x16x32_bf16 v[180:183], a[232:235], v[136:139], v[180:183]
v_exp_f32 v173, v173
v_mfma_f32_16x16x32_bf16 v[180:183], a[236:239], v[152:155], v[180:183]
v_exp_f32 v174, v174
v_mfma_f32_16x16x32_bf16 v[188:191], a[216:219], v[76:79], v[44:47]
buffer_load_dwordx4 v9, s[92:95], s23 offen offset:1024 nt lds
v_mfma_f32_16x16x32_bf16 v[188:191], a[220:223], v[92:95], v[188:191]
v_exp_f32 v175, v175
v_mfma_f32_16x16x32_bf16 v[188:191], a[224:227], v[108:111], v[188:191]
v_add_f32 v26, v26, v164
v_add_f32 v26, v26, v165
v_mfma_f32_16x16x32_bf16 v[188:191], a[228:231], v[124:127], v[188:191]
v_exp_f32 v180, v180
v_mfma_f32_16x16x32_bf16 v[188:191], a[232:235], v[140:143], v[188:191]
v_exp_f32 v181, v181
v_mfma_f32_16x16x32_bf16 v[188:191], a[236:239], v[156:159], v[188:191]
s_waitcnt lgkmcnt(10)
v_exp_f32 v182, v182
v_mfma_f32_16x16x32_bf16 a[0:3], v[232:235], v[216:219], a[0:3]
v_exp_f32 v183, v183
v_mfma_f32_16x16x32_bf16 a[4:7], v[232:235], v[220:223], a[4:7]
v_add_f32 v26, v26, v166
v_add_f32 v26, v26, v167
v_mfma_f32_16x16x32_bf16 a[8:11], v[232:235], v[224:227], a[8:11]
v_cvt_pk_bf16_f32 v210, v164, v165
v_cvt_pk_bf16_f32 v211, v166, v167
v_mfma_f32_16x16x32_bf16 a[12:15], v[232:235], v[228:231], a[12:15]
s_waitcnt lgkmcnt(8)
ds_read_b64_tr_b16 v[232:233], v23 offset:12416
v_add_f32 v27, v27, v172
v_mfma_f32_16x16x32_bf16 a[16:19], v[236:239], v[216:219], a[16:19]
buffer_load_dwordx4 v10, s[92:95], s23 offen offset:2048 nt lds
v_mfma_f32_16x16x32_bf16 a[20:23], v[236:239], v[220:223], a[20:23]
s_add_u32 s23, s23, 12288
ds_read_b64_tr_b16 v[234:235], v23 offset:18560
v_add_f32 v27, v27, v173
v_mfma_f32_16x16x32_bf16 a[24:27], v[236:239], v[224:227], a[24:27]
s_add_u32 m0, s26, 53248
v_exp_f32 v188, v188
v_mfma_f32_16x16x32_bf16 a[28:31], v[236:239], v[228:231], a[28:31]
s_waitcnt lgkmcnt(8)
ds_read_b64_tr_b16 v[236:237], v24 offset:12416
v_add_f32 v27, v27, v174
v_mfma_f32_16x16x32_bf16 a[32:35], v[240:243], v[216:219], a[32:35]
ds_read_b64_tr_b16 v[238:239], v24 offset:18560
v_add_f32 v27, v27, v175
v_mfma_f32_16x16x32_bf16 a[36:39], v[240:243], v[220:223], a[36:39]
v_exp_f32 v189, v189
v_mfma_f32_16x16x32_bf16 a[40:43], v[240:243], v[224:227], a[40:43]
v_exp_f32 v190, v190
v_mfma_f32_16x16x32_bf16 a[44:47], v[240:243], v[228:231], a[44:47]
s_waitcnt lgkmcnt(8)
ds_read_b64_tr_b16 v[240:241], v21 offset:12544
v_cvt_pk_bf16_f32 v214, v172, v173
v_mfma_f32_16x16x32_bf16 a[48:51], v[244:247], v[216:219], a[48:51]
ds_read_b64_tr_b16 v[242:243], v21 offset:18688
v_cvt_pk_bf16_f32 v215, v174, v175
v_mfma_f32_16x16x32_bf16 a[52:55], v[244:247], v[220:223], a[52:55]
v_exp_f32 v191, v191
v_mfma_f32_16x16x32_bf16 a[56:59], v[244:247], v[224:227], a[56:59]
buffer_load_dwordx4 v12, s[16:19], s41 offen nt lds
v_mfma_f32_16x16x32_bf16 a[60:63], v[244:247], v[228:231], a[60:63]
s_waitcnt lgkmcnt(8)
ds_read_b64_tr_b16 v[244:245], v22 offset:12544
v_add_f32 v28, v28, v176
v_mfma_f32_16x16x32_bf16 a[64:67], v[248:251], v[216:219], a[64:67]
s_add_u32 s41, s41, 40960
ds_read_b64_tr_b16 v[246:247], v22 offset:18688
v_add_f32 v28, v28, v177
v_mfma_f32_16x16x32_bf16 a[68:71], v[248:251], v[220:223], a[68:71]
v_add_f32 v28, v28, v178
v_add_f32 v28, v28, v179
v_mfma_f32_16x16x32_bf16 a[72:75], v[248:251], v[224:227], a[72:75]
v_add_f32 v29, v29, v184
v_add_f32 v29, v29, v185
v_mfma_f32_16x16x32_bf16 a[76:79], v[248:251], v[228:231], a[76:79]
s_waitcnt lgkmcnt(8)
ds_read_b64_tr_b16 v[248:249], v23 offset:12544
v_add_f32 v29, v29, v186
v_mfma_f32_16x16x32_bf16 a[80:83], v[252:255], v[216:219], a[80:83]
ds_read_b64_tr_b16 v[250:251], v23 offset:18688
v_add_f32 v29, v29, v187
v_mfma_f32_16x16x32_bf16 a[84:87], v[252:255], v[220:223], a[84:87]
v_add_f32 v28, v28, v180
v_add_f32 v28, v28, v181
v_mfma_f32_16x16x32_bf16 a[88:91], v[252:255], v[224:227], a[88:91]
v_add_f32 v28, v28, v182
v_add_f32 v28, v28, v183
v_mfma_f32_16x16x32_bf16 a[92:95], v[252:255], v[228:231], a[92:95]
s_waitcnt lgkmcnt(8)
ds_read_b64_tr_b16 v[252:253], v24 offset:12544
v_add_f32 v29, v29, v188
v_mfma_f32_16x16x32_bf16 a[96:99], v[232:235], v[216:219], a[96:99]
ds_read_b64_tr_b16 v[254:255], v24 offset:18688
v_add_f32 v29, v29, v189
v_mfma_f32_16x16x32_bf16 a[100:103], v[232:235], v[220:223], a[100:103]
v_add_f32 v29, v29, v190
v_add_f32 v29, v29, v191
v_mfma_f32_16x16x32_bf16 a[104:107], v[232:235], v[224:227], a[104:107]
v_mfma_f32_16x16x32_bf16 a[108:111], v[232:235], v[228:231], a[108:111]
s_waitcnt lgkmcnt(8)
v_mfma_f32_16x16x32_bf16 a[112:115], v[236:239], v[216:219], a[112:115]
v_mfma_f32_16x16x32_bf16 a[116:119], v[236:239], v[220:223], a[116:119]
v_mfma_f32_16x16x32_bf16 a[120:123], v[236:239], v[224:227], a[120:123]
s_waitcnt vmcnt(17) lgkmcnt(0)
s_barrier
v_mfma_f32_16x16x32_bf16 a[124:127], v[236:239], v[228:231], a[124:127]
ds_read_b128 a[192:195], v19 offset:0
v_mfma_f32_16x16x32_bf16 a[128:131], v[240:243], v[216:219], a[128:131]
ds_read_b128 a[196:199], v20 offset:0
v_mfma_f32_16x16x32_bf16 a[132:135], v[240:243], v[220:223], a[132:135]
ds_read_b128 a[200:203], v19 offset:128
v_mfma_f32_16x16x32_bf16 a[136:139], v[240:243], v[224:227], a[136:139]
ds_read_b128 a[204:207], v20 offset:128
v_mfma_f32_16x16x32_bf16 a[140:143], v[240:243], v[228:231], a[140:143]
ds_read_b128 a[208:211], v19 offset:256
v_mfma_f32_16x16x32_bf16 a[144:147], v[244:247], v[216:219], a[144:147]
buffer_store_dwordx4 a[240:243], v1, s[12:15], s42 offen sc1
v_mfma_f32_16x16x32_bf16 a[148:151], v[244:247], v[220:223], a[148:151]
s_add_u32 s42, s42, 10240
ds_read_b128 a[212:215], v20 offset:256
v_mfma_f32_16x16x32_bf16 a[152:155], v[244:247], v[224:227], a[152:155]
s_add_u32 m0, s25, 57344
ds_read_b128 a[216:219], v19 offset:6144
v_mfma_f32_16x16x32_bf16 a[156:159], v[244:247], v[228:231], a[156:159]
ds_read_b128 a[220:223], v20 offset:6144
v_mfma_f32_16x16x32_bf16 a[160:163], v[248:251], v[216:219], a[160:163]
ds_read_b128 a[224:227], v19 offset:6272
v_mfma_f32_16x16x32_bf16 a[164:167], v[248:251], v[220:223], a[164:167]
ds_read_b128 a[228:231], v20 offset:6272
v_mfma_f32_16x16x32_bf16 a[168:171], v[248:251], v[224:227], a[168:171]
ds_read_b128 a[232:235], v19 offset:6400
v_add_u32 v19, 0xfffeb000, v19
v_mfma_f32_16x16x32_bf16 a[172:175], v[248:251], v[228:231], a[172:175]
ds_read_b128 a[236:239], v20 offset:6400
v_add_u32 v20, 0xfffeb000, v20
v_mfma_f32_16x16x32_bf16 a[176:179], v[252:255], v[216:219], a[176:179]
ds_read_b64_tr_b16 a[240:241], v16 offset:53248
v_mfma_f32_16x16x32_bf16 a[180:183], v[252:255], v[220:223], a[180:183]
ds_read_b64_tr_b16 a[242:243], v16 offset:55296
v_add_u32 v16, 0xffff2000, v16
v_mfma_f32_16x16x32_bf16 a[184:187], v[252:255], v[224:227], a[184:187]
ds_read_b64_tr_b16 v[232:233], v21 offset:40960
v_cvt_pk_bf16_f32 v224, v176, v177
v_mfma_f32_16x16x32_bf16 a[188:191], v[252:255], v[228:231], a[188:191]
s_waitcnt lgkmcnt(14)
ds_read_b64_tr_b16 v[234:235], v21 offset:47104
v_cvt_pk_bf16_f32 v225, v178, v179
v_mfma_f32_16x16x32_bf16 v[160:163], a[192:195], v[64:67], v[32:35]
s_waitcnt lgkmcnt(14)
ds_read_b64_tr_b16 v[236:237], v22 offset:40960
v_cvt_pk_bf16_f32 v226, v180, v181
v_mfma_f32_16x16x32_bf16 v[160:163], a[196:199], v[80:83], v[160:163]
s_waitcnt lgkmcnt(14)
ds_read_b64_tr_b16 v[238:239], v22 offset:47104
v_cvt_pk_bf16_f32 v227, v182, v183
v_mfma_f32_16x16x32_bf16 v[160:163], a[200:203], v[96:99], v[160:163]
s_waitcnt lgkmcnt(14)
buffer_load_dwordx4 v5, s[8:11], s22 offen offset:0 nt lds
v_mfma_f32_16x16x32_bf16 v[160:163], a[204:207], v[112:115], v[160:163]
s_waitcnt lgkmcnt(13)
ds_read_b64_tr_b16 v[240:241], v23 offset:40960
v_cvt_pk_bf16_f32 v228, v184, v185
v_mfma_f32_16x16x32_bf16 v[160:163], a[208:211], v[128:131], v[160:163]
s_waitcnt lgkmcnt(13)
ds_read_b64_tr_b16 v[242:243], v23 offset:47104
v_cvt_pk_bf16_f32 v229, v186, v187
v_mfma_f32_16x16x32_bf16 v[160:163], a[212:215], v[144:147], v[160:163]
ds_read_b64_tr_b16 v[244:245], v24 offset:40960
v_cvt_pk_bf16_f32 v230, v188, v189
v_mfma_f32_16x16x32_bf16 v[168:171], a[192:195], v[68:71], v[36:39]
ds_read_b64_tr_b16 v[246:247], v24 offset:47104
v_cvt_pk_bf16_f32 v231, v190, v191
v_mfma_f32_16x16x32_bf16 v[168:171], a[196:199], v[84:87], v[168:171]
ds_read_b64_tr_b16 v[248:249], v21 offset:41088
v_mfma_f32_16x16x32_bf16 v[168:171], a[200:203], v[100:103], v[168:171]
ds_read_b64_tr_b16 v[250:251], v21 offset:47232
v_mfma_f32_16x16x32_bf16 v[168:171], a[204:207], v[116:119], v[168:171]
v_exp_f32 v160, v160
v_mfma_f32_16x16x32_bf16 v[168:171], a[208:211], v[132:135], v[168:171]
buffer_load_dwordx4 v6, s[8:11], s22 offen offset:1024 nt lds
v_mfma_f32_16x16x32_bf16 v[168:171], a[212:215], v[148:151], v[168:171]
ds_read_b64_tr_b16 v[252:253], v22 offset:41088
v_add_f32 v26, v26, v160
v_mfma_f32_16x16x32_bf16 v[192:195], a[192:195], v[72:75], v[40:43]
v_exp_f32 v161, v161
v_mfma_f32_16x16x32_bf16 v[192:195], a[196:199], v[88:91], v[192:195]
ds_read_b64_tr_b16 v[254:255], v22 offset:47232
v_add_f32 v26, v26, v161
v_mfma_f32_16x16x32_bf16 v[192:195], a[200:203], v[104:107], v[192:195]
v_exp_f32 v162, v162
v_mfma_f32_16x16x32_bf16 v[192:195], a[204:207], v[120:123], v[192:195]
v_exp_f32 v163, v163
v_mfma_f32_16x16x32_bf16 v[192:195], a[208:211], v[136:139], v[192:195]
v_exp_f32 v168, v168
v_mfma_f32_16x16x32_bf16 v[192:195], a[212:215], v[152:155], v[192:195]
v_exp_f32 v169, v169
v_mfma_f32_16x16x32_bf16 v[200:203], a[192:195], v[76:79], v[44:47]
v_exp_f32 v170, v170
v_mfma_f32_16x16x32_bf16 v[200:203], a[196:199], v[92:95], v[200:203]
buffer_load_dwordx4 v7, s[8:11], s22 offen offset:2048 nt lds
v_mfma_f32_16x16x32_bf16 v[200:203], a[200:203], v[108:111], v[200:203]
s_add_u32 s22, s22, 12288
v_exp_f32 v171, v171
v_mfma_f32_16x16x32_bf16 v[200:203], a[204:207], v[124:127], v[200:203]
s_add_u32 m0, s25, 69632
v_exp_f32 v192, v192
v_mfma_f32_16x16x32_bf16 v[200:203], a[208:211], v[140:143], v[200:203]
v_exp_f32 v193, v193
v_mfma_f32_16x16x32_bf16 v[200:203], a[212:215], v[156:159], v[200:203]
s_waitcnt lgkmcnt(15)
v_exp_f32 v194, v194
v_mfma_f32_16x16x32_bf16 v[164:167], a[216:219], v[64:67], v[32:35]
s_waitcnt lgkmcnt(15)
v_exp_f32 v195, v195
v_mfma_f32_16x16x32_bf16 v[164:167], a[220:223], v[80:83], v[164:167]
s_waitcnt lgkmcnt(15)
v_add_f32 v26, v26, v162
v_add_f32 v26, v26, v163
v_mfma_f32_16x16x32_bf16 v[164:167], a[224:227], v[96:99], v[164:167]
s_waitcnt lgkmcnt(15)
v_cvt_pk_bf16_f32 v216, v160, v161
v_cvt_pk_bf16_f32 v217, v162, v163
v_mfma_f32_16x16x32_bf16 v[164:167], a[228:231], v[112:115], v[164:167]
s_waitcnt lgkmcnt(15)
v_exp_f32 v200, v200
v_mfma_f32_16x16x32_bf16 v[164:167], a[232:235], v[128:131], v[164:167]
s_waitcnt lgkmcnt(14)
buffer_load_dwordx4 v8, s[92:95], s23 offen offset:0 nt lds
v_mfma_f32_16x16x32_bf16 v[164:167], a[236:239], v[144:147], v[164:167]
v_exp_f32 v201, v201
v_mfma_f32_16x16x32_bf16 v[172:175], a[216:219], v[68:71], v[36:39]
v_exp_f32 v202, v202
v_mfma_f32_16x16x32_bf16 v[172:175], a[220:223], v[84:87], v[172:175]
v_exp_f32 v203, v203
v_mfma_f32_16x16x32_bf16 v[172:175], a[224:227], v[100:103], v[172:175]
v_add_f32 v27, v27, v168
v_add_f32 v27, v27, v169
v_mfma_f32_16x16x32_bf16 v[172:175], a[228:231], v[116:119], v[172:175]
v_exp_f32 v164, v164
v_mfma_f32_16x16x32_bf16 v[172:175], a[232:235], v[132:135], v[172:175]
v_exp_f32 v165, v165
v_mfma_f32_16x16x32_bf16 v[172:175], a[236:239], v[148:151], v[172:175]
v_exp_f32 v166, v166
v_mfma_f32_16x16x32_bf16 v[196:199], a[216:219], v[72:75], v[40:43]
v_exp_f32 v167, v167
v_mfma_f32_16x16x32_bf16 v[196:199], a[220:223], v[88:91], v[196:199]
buffer_load_dwordx4 v9, s[92:95], s23 offen offset:1024 nt lds
v_mfma_f32_16x16x32_bf16 v[196:199], a[224:227], v[104:107], v[196:199]
v_add_f32 v27, v27, v170
v_add_f32 v27, v27, v171
v_mfma_f32_16x16x32_bf16 v[196:199], a[228:231], v[120:123], v[196:199]
v_exp_f32 v172, v172
v_mfma_f32_16x16x32_bf16 v[196:199], a[232:235], v[136:139], v[196:199]
v_exp_f32 v173, v173
v_mfma_f32_16x16x32_bf16 v[196:199], a[236:239], v[152:155], v[196:199]
v_exp_f32 v174, v174
v_mfma_f32_16x16x32_bf16 v[204:207], a[216:219], v[76:79], v[44:47]
v_exp_f32 v175, v175
v_mfma_f32_16x16x32_bf16 v[204:207], a[220:223], v[92:95], v[204:207]
v_cvt_pk_bf16_f32 v220, v168, v169
v_cvt_pk_bf16_f32 v221, v170, v171
v_mfma_f32_16x16x32_bf16 v[204:207], a[224:227], v[108:111], v[204:207]
v_add_f32 v26, v26, v164
v_add_f32 v26, v26, v165
v_mfma_f32_16x16x32_bf16 v[204:207], a[228:231], v[124:127], v[204:207]
buffer_load_dwordx4 v10, s[92:95], s23 offen offset:2048 nt lds
v_mfma_f32_16x16x32_bf16 v[204:207], a[232:235], v[140:143], v[204:207]
s_add_u32 s23, s23, 12288
v_exp_f32 v196, v196
v_mfma_f32_16x16x32_bf16 v[204:207], a[236:239], v[156:159], v[204:207]
s_waitcnt lgkmcnt(10)
v_exp_f32 v197, v197
v_mfma_f32_16x16x32_bf16 a[0:3], v[232:235], v[208:211], a[0:3]
s_add_u32 m0, s26, 81920
v_exp_f32 v198, v198
v_mfma_f32_16x16x32_bf16 a[4:7], v[232:235], v[212:215], a[4:7]
v_exp_f32 v199, v199
v_mfma_f32_16x16x32_bf16 a[8:11], v[232:235], v[224:227], a[8:11]
v_add_f32 v26, v26, v166
v_add_f32 v26, v26, v167
v_mfma_f32_16x16x32_bf16 a[12:15], v[232:235], v[228:231], a[12:15]
s_waitcnt lgkmcnt(8)
ds_read_b64_tr_b16 v[232:233], v23 offset:41088
v_cvt_pk_bf16_f32 v218, v164, v165
v_mfma_f32_16x16x32_bf16 a[16:19], v[236:239], v[208:211], a[16:19]
ds_read_b64_tr_b16 v[234:235], v23 offset:47232
v_cvt_pk_bf16_f32 v219, v166, v167
v_mfma_f32_16x16x32_bf16 a[20:23], v[236:239], v[212:215], a[20:23]
v_exp_f32 v204, v204
v_mfma_f32_16x16x32_bf16 a[24:27], v[236:239], v[224:227], a[24:27]
buffer_load_dwordx4 v12, s[16:19], s41 offen nt lds
v_mfma_f32_16x16x32_bf16 a[28:31], v[236:239], v[228:231], a[28:31]
s_waitcnt lgkmcnt(8)
ds_read_b64_tr_b16 v[236:237], v24 offset:41088
v_add_f32 v27, v27, v172
v_mfma_f32_16x16x32_bf16 a[32:35], v[240:243], v[208:211], a[32:35]
s_add_u32 s41, s41, 40960
ds_read_b64_tr_b16 v[238:239], v24 offset:47232
v_add_f32 v27, v27, v173
v_mfma_f32_16x16x32_bf16 a[36:39], v[240:243], v[212:215], a[36:39]
v_exp_f32 v205, v205
v_mfma_f32_16x16x32_bf16 a[40:43], v[240:243], v[224:227], a[40:43]
v_exp_f32 v206, v206
v_mfma_f32_16x16x32_bf16 a[44:47], v[240:243], v[228:231], a[44:47]
s_waitcnt lgkmcnt(8)
ds_read_b64_tr_b16 v[240:241], v21 offset:41216
v_add_f32 v27, v27, v174
v_mfma_f32_16x16x32_bf16 a[48:51], v[244:247], v[208:211], a[48:51]
ds_read_b64_tr_b16 v[242:243], v21 offset:47360
v_add_f32 v27, v27, v175
v_mfma_f32_16x16x32_bf16 a[52:55], v[244:247], v[212:215], a[52:55]
v_exp_f32 v207, v207
v_mfma_f32_16x16x32_bf16 a[56:59], v[244:247], v[224:227], a[56:59]
v_cvt_pk_bf16_f32 v222, v172, v173
v_cvt_pk_bf16_f32 v223, v174, v175
v_mfma_f32_16x16x32_bf16 a[60:63], v[244:247], v[228:231], a[60:63]
s_waitcnt lgkmcnt(8)
buffer_load_dwordx4 v[48:51], v1, s[12:15], s31 offen sc1
v_mfma_f32_16x16x32_bf16 a[64:67], v[248:251], v[208:211], a[64:67]
ds_read_b64_tr_b16 v[244:245], v22 offset:41216
v_add_u32 v21, 0xffff2000, v21
v_mfma_f32_16x16x32_bf16 a[68:71], v[248:251], v[212:215], a[68:71]
ds_read_b64_tr_b16 v[246:247], v22 offset:47360
v_add_u32 v22, 0xffff2000, v22
v_mfma_f32_16x16x32_bf16 a[72:75], v[248:251], v[224:227], a[72:75]
v_add_f32 v28, v28, v192
v_add_f32 v29, v29, v200
v_mfma_f32_16x16x32_bf16 a[76:79], v[248:251], v[228:231], a[76:79]
s_waitcnt lgkmcnt(8)
ds_read_b64_tr_b16 v[248:249], v23 offset:41216
v_add_f32 v28, v28, v193
v_mfma_f32_16x16x32_bf16 a[80:83], v[252:255], v[208:211], a[80:83]
ds_read_b64_tr_b16 v[250:251], v23 offset:47360
v_add_u32 v23, 0xffff2000, v23
v_mfma_f32_16x16x32_bf16 a[84:87], v[252:255], v[212:215], a[84:87]
v_add_f32 v29, v29, v201
v_add_f32 v28, v28, v194
v_mfma_f32_16x16x32_bf16 a[88:91], v[252:255], v[224:227], a[88:91]
v_add_f32 v29, v29, v202
v_add_f32 v28, v28, v195
v_mfma_f32_16x16x32_bf16 a[92:95], v[252:255], v[228:231], a[92:95]
s_waitcnt lgkmcnt(8)
ds_read_b64_tr_b16 v[252:253], v24 offset:41216
v_add_f32 v29, v29, v203
v_mfma_f32_16x16x32_bf16 a[96:99], v[232:235], v[208:211], a[96:99]
ds_read_b64_tr_b16 v[254:255], v24 offset:47360
v_add_u32 v24, 0xffff2000, v24
v_mfma_f32_16x16x32_bf16 a[100:103], v[232:235], v[212:215], a[100:103]
v_add_f32 v28, v28, v196
v_add_f32 v29, v29, v204
v_mfma_f32_16x16x32_bf16 a[104:107], v[232:235], v[224:227], a[104:107]
v_add_f32 v28, v28, v197
v_add_f32 v29, v29, v205
v_mfma_f32_16x16x32_bf16 a[108:111], v[232:235], v[228:231], a[108:111]
s_waitcnt lgkmcnt(8)
v_add_f32 v28, v28, v198
v_add_f32 v29, v29, v206
v_mfma_f32_16x16x32_bf16 a[112:115], v[236:239], v[208:211], a[112:115]
v_add_f32 v28, v28, v199
v_add_f32 v29, v29, v207
v_mfma_f32_16x16x32_bf16 a[116:119], v[236:239], v[212:215], a[116:119]
v_mfma_f32_16x16x32_bf16 a[120:123], v[236:239], v[224:227], a[120:123]
s_waitcnt vmcnt(18) lgkmcnt(0)
s_barrier
v_mfma_f32_16x16x32_bf16 a[124:127], v[236:239], v[228:231], a[124:127]
ds_read_b128 a[192:195], v19 offset:0
v_mfma_f32_16x16x32_bf16 a[128:131], v[240:243], v[208:211], a[128:131]
ds_read_b128 a[196:199], v20 offset:0
v_mfma_f32_16x16x32_bf16 a[132:135], v[240:243], v[212:215], a[132:135]
ds_read_b128 a[200:203], v19 offset:128
v_mfma_f32_16x16x32_bf16 a[136:139], v[240:243], v[224:227], a[136:139]
ds_read_b128 a[204:207], v20 offset:128
v_mfma_f32_16x16x32_bf16 a[140:143], v[240:243], v[228:231], a[140:143]
ds_read_b128 a[208:211], v19 offset:256
v_mfma_f32_16x16x32_bf16 a[144:147], v[244:247], v[208:211], a[144:147]
buffer_store_dwordx4 a[240:243], v1, s[12:15], s42 offen sc1
v_mfma_f32_16x16x32_bf16 a[148:151], v[244:247], v[212:215], a[148:151]
s_add_u32 s42, s42, 10240
ds_read_b128 a[212:215], v20 offset:256
v_mfma_f32_16x16x32_bf16 a[152:155], v[244:247], v[224:227], a[152:155]
s_add_u32 m0, s25, 86016
ds_read_b128 a[216:219], v19 offset:6144
v_mfma_f32_16x16x32_bf16 a[156:159], v[244:247], v[228:231], a[156:159]
ds_read_b128 a[220:223], v20 offset:6144
v_mfma_f32_16x16x32_bf16 a[160:163], v[248:251], v[208:211], a[160:163]
ds_read_b128 a[224:227], v19 offset:6272
v_mfma_f32_16x16x32_bf16 a[164:167], v[248:251], v[212:215], a[164:167]
ds_read_b128 a[228:231], v20 offset:6272
v_mfma_f32_16x16x32_bf16 a[168:171], v[248:251], v[224:227], a[168:171]
ds_read_b128 a[232:235], v19 offset:6400
v_mfma_f32_16x16x32_bf16 a[172:175], v[248:251], v[228:231], a[172:175]
ds_read_b128 a[236:239], v20 offset:6400
v_mfma_f32_16x16x32_bf16 a[176:179], v[252:255], v[208:211], a[176:179]
ds_read_b64_tr_b16 a[240:241], v16 offset:24576
v_mfma_f32_16x16x32_bf16 a[180:183], v[252:255], v[212:215], a[180:183]
ds_read_b64_tr_b16 a[242:243], v16 offset:26624
v_mfma_f32_16x16x32_bf16 a[184:187], v[252:255], v[224:227], a[184:187]
ds_read_b64_tr_b16 v[232:233], v21 offset:12288
v_cvt_pk_bf16_f32 v224, v192, v193
v_mfma_f32_16x16x32_bf16 a[188:191], v[252:255], v[228:231], a[188:191]
s_waitcnt lgkmcnt(14)
ds_read_b64_tr_b16 v[234:235], v21 offset:18432
v_cvt_pk_bf16_f32 v225, v194, v195
v_mfma_f32_16x16x32_bf16 v[160:163], a[192:195], v[64:67], v[32:35]
s_waitcnt lgkmcnt(14)
ds_read_b64_tr_b16 v[236:237], v22 offset:12288
v_cvt_pk_bf16_f32 v226, v196, v197
v_mfma_f32_16x16x32_bf16 v[160:163], a[196:199], v[80:83], v[160:163]
s_waitcnt lgkmcnt(14)
ds_read_b64_tr_b16 v[238:239], v22 offset:18432
v_cvt_pk_bf16_f32 v227, v198, v199
v_mfma_f32_16x16x32_bf16 v[160:163], a[200:203], v[96:99], v[160:163]
s_waitcnt lgkmcnt(14)
buffer_load_dwordx4 v5, s[8:11], s22 offen offset:0 nt lds
v_mfma_f32_16x16x32_bf16 v[160:163], a[204:207], v[112:115], v[160:163]
s_waitcnt lgkmcnt(13)
ds_read_b64_tr_b16 v[240:241], v23 offset:12288
v_cvt_pk_bf16_f32 v228, v200, v201
v_mfma_f32_16x16x32_bf16 v[160:163], a[208:211], v[128:131], v[160:163]
s_waitcnt lgkmcnt(13)
ds_read_b64_tr_b16 v[242:243], v23 offset:18432
v_cvt_pk_bf16_f32 v229, v202, v203
v_mfma_f32_16x16x32_bf16 v[160:163], a[212:215], v[144:147], v[160:163]
ds_read_b64_tr_b16 v[244:245], v24 offset:12288
v_cvt_pk_bf16_f32 v230, v204, v205
v_mfma_f32_16x16x32_bf16 v[168:171], a[192:195], v[68:71], v[36:39]
ds_read_b64_tr_b16 v[246:247], v24 offset:18432
v_cvt_pk_bf16_f32 v231, v206, v207
v_mfma_f32_16x16x32_bf16 v[168:171], a[196:199], v[84:87], v[168:171]
ds_read_b64_tr_b16 v[248:249], v21 offset:12416
v_mfma_f32_16x16x32_bf16 v[168:171], a[200:203], v[100:103], v[168:171]
ds_read_b64_tr_b16 v[250:251], v21 offset:18560
v_mfma_f32_16x16x32_bf16 v[168:171], a[204:207], v[116:119], v[168:171]
v_exp_f32 v160, v160
v_mfma_f32_16x16x32_bf16 v[168:171], a[208:211], v[132:135], v[168:171]
ds_read_b64_tr_b16 v[252:253], v22 offset:12416
v_add_f32 v26, v26, v160
v_mfma_f32_16x16x32_bf16 v[168:171], a[212:215], v[148:151], v[168:171]
v_exp_f32 v161, v161
v_mfma_f32_16x16x32_bf16 v[176:179], a[192:195], v[72:75], v[40:43]
buffer_load_dwordx4 v6, s[8:11], s22 offen offset:1024 nt lds
v_mfma_f32_16x16x32_bf16 v[176:179], a[196:199], v[88:91], v[176:179]
ds_read_b64_tr_b16 v[254:255], v22 offset:18560
v_add_f32 v26, v26, v161
v_mfma_f32_16x16x32_bf16 v[176:179], a[200:203], v[104:107], v[176:179]
v_exp_f32 v162, v162
v_mfma_f32_16x16x32_bf16 v[176:179], a[204:207], v[120:123], v[176:179]
v_exp_f32 v168, v168
v_mfma_f32_16x16x32_bf16 v[176:179], a[208:211], v[136:139], v[176:179]
v_exp_f32 v169, v169
v_mfma_f32_16x16x32_bf16 v[176:179], a[212:215], v[152:155], v[176:179]
v_exp_f32 v170, v170
v_mfma_f32_16x16x32_bf16 v[184:187], a[192:195], v[76:79], v[44:47]
v_exp_f32 v163, v163
v_mfma_f32_16x16x32_bf16 v[184:187], a[196:199], v[92:95], v[184:187]
v_exp_f32 v171, v171
v_mfma_f32_16x16x32_bf16 v[184:187], a[200:203], v[108:111], v[184:187]
v_add_f32 v27, v27, v168
v_add_f32 v27, v27, v169
v_mfma_f32_16x16x32_bf16 v[184:187], a[204:207], v[124:127], v[184:187]
v_add_f32 v26, v26, v162
v_add_f32 v27, v27, v170
v_mfma_f32_16x16x32_bf16 v[184:187], a[208:211], v[140:143], v[184:187]
buffer_load_dwordx4 v7, s[8:11], s22 offen offset:2048 nt lds
v_mfma_f32_16x16x32_bf16 v[184:187], a[212:215], v[156:159], v[184:187]
s_waitcnt lgkmcnt(15)
v_add_f32 v26, v26, v163
v_add_f32 v27, v27, v171
v_mfma_f32_16x16x32_bf16 v[164:167], a[216:219], v[64:67], v[32:35]
s_waitcnt lgkmcnt(15)
v_cvt_pk_bf16_f32 v208, v160, v161
v_cvt_pk_bf16_f32 v209, v162, v163
v_mfma_f32_16x16x32_bf16 v[164:167], a[220:223], v[80:83], v[164:167]
s_waitcnt lgkmcnt(15)
v_cvt_pk_bf16_f32 v212, v168, v169
v_cvt_pk_bf16_f32 v213, v170, v171
v_mfma_f32_16x16x32_bf16 v[164:167], a[224:227], v[96:99], v[164:167]
s_waitcnt lgkmcnt(15)
v_mfma_f32_16x16x32_bf16 v[164:167], a[228:231], v[112:115], v[164:167]
s_waitcnt lgkmcnt(15)
v_mfma_f32_16x16x32_bf16 v[164:167], a[232:235], v[128:131], v[164:167]
s_waitcnt lgkmcnt(14)
v_mfma_f32_16x16x32_bf16 v[164:167], a[236:239], v[144:147], v[164:167]
s_add_u32 s22, s22, 12288
v_mfma_f32_16x16x32_bf16 v[172:175], a[216:219], v[68:71], v[36:39]
s_add_u32 m0, s25, 98304
v_mfma_f32_16x16x32_bf16 v[172:175], a[220:223], v[84:87], v[172:175]
v_mfma_f32_16x16x32_bf16 v[172:175], a[224:227], v[100:103], v[172:175]
buffer_load_dwordx4 v8, s[92:95], s23 offen offset:0 nt lds
v_mfma_f32_16x16x32_bf16 v[172:175], a[228:231], v[116:119], v[172:175]
s_nop 0
v_exp_f32 v164, v164
v_mfma_f32_16x16x32_bf16 v[172:175], a[232:235], v[132:135], v[172:175]
v_exp_f32 v165, v165
v_mfma_f32_16x16x32_bf16 v[172:175], a[236:239], v[148:151], v[172:175]
v_exp_f32 v166, v166
v_mfma_f32_16x16x32_bf16 v[180:183], a[216:219], v[72:75], v[40:43]
v_exp_f32 v167, v167
v_mfma_f32_16x16x32_bf16 v[180:183], a[220:223], v[88:91], v[180:183]
v_add_f32 v26, v26, v164
v_add_f32 v26, v26, v165
v_mfma_f32_16x16x32_bf16 v[180:183], a[224:227], v[104:107], v[180:183]
v_add_f32 v26, v26, v166
v_add_f32 v26, v26, v167
v_mfma_f32_16x16x32_bf16 v[180:183], a[228:231], v[120:123], v[180:183]
v_exp_f32 v172, v172
v_mfma_f32_16x16x32_bf16 v[180:183], a[232:235], v[136:139], v[180:183]
v_exp_f32 v173, v173
v_mfma_f32_16x16x32_bf16 v[180:183], a[236:239], v[152:155], v[180:183]
v_exp_f32 v174, v174
v_mfma_f32_16x16x32_bf16 v[188:191], a[216:219], v[76:79], v[44:47]
buffer_load_dwordx4 v9, s[92:95], s23 offen offset:1024 nt lds
v_mfma_f32_16x16x32_bf16 v[188:191], a[220:223], v[92:95], v[188:191]
v_exp_f32 v175, v175
v_mfma_f32_16x16x32_bf16 v[188:191], a[224:227], v[108:111], v[188:191]
v_add_f32 v27, v27, v172
v_add_f32 v27, v27, v173
v_mfma_f32_16x16x32_bf16 v[188:191], a[228:231], v[124:127], v[188:191]
v_add_f32 v27, v27, v174
v_cvt_pk_bf16_f32 v210, v164, v165
v_mfma_f32_16x16x32_bf16 v[188:191], a[232:235], v[140:143], v[188:191]
v_cvt_pk_bf16_f32 v211, v166, v167
v_add_f32 v27, v27, v175
v_mfma_f32_16x16x32_bf16 v[188:191], a[236:239], v[156:159], v[188:191]
s_waitcnt lgkmcnt(10)
v_cvt_pk_bf16_f32 v214, v172, v173
v_cvt_pk_bf16_f32 v215, v174, v175
v_mfma_f32_16x16x32_bf16 a[0:3], v[232:235], v[216:219], a[0:3]
v_mfma_f32_16x16x32_bf16 a[4:7], v[232:235], v[220:223], a[4:7]
v_mfma_f32_16x16x32_bf16 a[8:11], v[232:235], v[224:227], a[8:11]
v_mfma_f32_16x16x32_bf16 a[12:15], v[232:235], v[228:231], a[12:15]
s_waitcnt lgkmcnt(8)
ds_read_b64_tr_b16 v[232:233], v23 offset:12416
v_mfma_f32_16x16x32_bf16 a[16:19], v[236:239], v[216:219], a[16:19]
buffer_load_dwordx4 v10, s[92:95], s23 offen offset:2048 nt lds
v_mfma_f32_16x16x32_bf16 a[20:23], v[236:239], v[220:223], a[20:23]
s_add_u32 s23, s23, 12288
ds_read_b64_tr_b16 v[234:235], v23 offset:18560
v_mfma_f32_16x16x32_bf16 a[24:27], v[236:239], v[224:227], a[24:27]
s_add_u32 m0, s26, 110592
v_mfma_f32_16x16x32_bf16 a[28:31], v[236:239], v[228:231], a[28:31]
s_waitcnt lgkmcnt(8)
ds_read_b64_tr_b16 v[236:237], v24 offset:12416
v_mfma_f32_16x16x32_bf16 a[32:35], v[240:243], v[216:219], a[32:35]
ds_read_b64_tr_b16 v[238:239], v24 offset:18560
v_mfma_f32_16x16x32_bf16 a[36:39], v[240:243], v[220:223], a[36:39]
v_mfma_f32_16x16x32_bf16 a[40:43], v[240:243], v[224:227], a[40:43]
v_mfma_f32_16x16x32_bf16 a[44:47], v[240:243], v[228:231], a[44:47]
s_waitcnt lgkmcnt(8)
ds_read_b64_tr_b16 v[240:241], v21 offset:12544
v_mfma_f32_16x16x32_bf16 a[48:51], v[244:247], v[216:219], a[48:51]
ds_read_b64_tr_b16 v[242:243], v21 offset:18688
s_waitcnt vmcnt(7)
v_xor_b32 v48, s40, v48
v_mfma_f32_16x16x32_bf16 a[52:55], v[244:247], v[220:223], a[52:55]
v_xor_b32 v49, s40, v49
v_xor_b32 v50, s40, v50
v_mfma_f32_16x16x32_bf16 a[56:59], v[244:247], v[224:227], a[56:59]
buffer_load_dwordx4 v12, s[16:19], s41 offen nt lds
v_mfma_f32_16x16x32_bf16 a[60:63], v[244:247], v[228:231], a[60:63]
s_waitcnt lgkmcnt(8)
ds_read_b64_tr_b16 v[244:245], v22 offset:12544
v_xor_b32 v51, s40, v51
v_mfma_f32_16x16x32_bf16 a[64:67], v[248:251], v[216:219], a[64:67]
s_add_u32 s41, s41, 40960
ds_read_b64_tr_b16 v[246:247], v22 offset:18688
v_or3_b32 v48, v48, v49, v50
v_mfma_f32_16x16x32_bf16 a[68:71], v[248:251], v[220:223], a[68:71]
v_or_b32 v48, v48, v51
v_cmp_ne_u32 vcc, 0, v48
v_mfma_f32_16x16x32_bf16 a[72:75], v[248:251], v[224:227], a[72:75]
v_mfma_f32_16x16x32_bf16 a[76:79], v[248:251], v[228:231], a[76:79]
s_waitcnt lgkmcnt(8)
ds_read_b64_tr_b16 v[248:249], v23 offset:12544
v_mfma_f32_16x16x32_bf16 a[80:83], v[252:255], v[216:219], a[80:83]
ds_read_b64_tr_b16 v[250:251], v23 offset:18688
v_mfma_f32_16x16x32_bf16 a[84:87], v[252:255], v[220:223], a[84:87]
v_mfma_f32_16x16x32_bf16 a[88:91], v[252:255], v[224:227], a[88:91]
v_mfma_f32_16x16x32_bf16 a[92:95], v[252:255], v[228:231], a[92:95]
s_waitcnt lgkmcnt(8)
ds_read_b64_tr_b16 v[252:253], v24 offset:12544
v_mfma_f32_16x16x32_bf16 a[96:99], v[232:235], v[216:219], a[96:99]
ds_read_b64_tr_b16 v[254:255], v24 offset:18688
v_mfma_f32_16x16x32_bf16 a[100:103], v[232:235], v[220:223], a[100:103]
v_mfma_f32_16x16x32_bf16 a[104:107], v[232:235], v[224:227], a[104:107]
v_mfma_f32_16x16x32_bf16 a[108:111], v[232:235], v[228:231], a[108:111]
s_waitcnt lgkmcnt(8)
v_mfma_f32_16x16x32_bf16 a[112:115], v[236:239], v[216:219], a[112:115]
v_mfma_f32_16x16x32_bf16 a[116:119], v[236:239], v[220:223], a[116:119]
v_mfma_f32_16x16x32_bf16 a[120:123], v[236:239], v[224:227], a[120:123]
s_waitcnt lgkmcnt(0)
s_barrier
v_mfma_f32_16x16x32_bf16 a[124:127], v[236:239], v[228:231], a[124:127]
ds_read_b128 a[192:195], v19 offset:28672
v_mfma_f32_16x16x32_bf16 a[128:131], v[240:243], v[216:219], a[128:131]
ds_read_b128 a[196:199], v20 offset:28672
v_mfma_f32_16x16x32_bf16 a[132:135], v[240:243], v[220:223], a[132:135]
ds_read_b128 a[200:203], v19 offset:28800
v_mfma_f32_16x16x32_bf16 a[136:139], v[240:243], v[224:227], a[136:139]
ds_read_b128 a[204:207], v20 offset:28800
v_mfma_f32_16x16x32_bf16 a[140:143], v[240:243], v[228:231], a[140:143]
ds_read_b128 a[208:211], v19 offset:28928
v_mfma_f32_16x16x32_bf16 a[144:147], v[244:247], v[216:219], a[144:147]
buffer_store_dwordx4 a[240:243], v1, s[12:15], s42 offen sc1
v_mfma_f32_16x16x32_bf16 a[148:151], v[244:247], v[220:223], a[148:151]
s_add_u32 s42, s42, 10240
ds_read_b128 a[212:215], v20 offset:28928
v_mfma_f32_16x16x32_bf16 a[152:155], v[244:247], v[224:227], a[152:155]
v_mfma_f32_16x16x32_bf16 a[156:159], v[244:247], v[228:231], a[156:159]
v_mfma_f32_16x16x32_bf16 a[160:163], v[248:251], v[216:219], a[160:163]
v_mfma_f32_16x16x32_bf16 a[164:167], v[248:251], v[220:223], a[164:167]
v_mfma_f32_16x16x32_bf16 a[168:171], v[248:251], v[224:227], a[168:171]
v_mfma_f32_16x16x32_bf16 a[172:175], v[248:251], v[228:231], a[172:175]
v_mfma_f32_16x16x32_bf16 a[176:179], v[252:255], v[216:219], a[176:179]
v_mfma_f32_16x16x32_bf16 a[180:183], v[252:255], v[220:223], a[180:183]
v_mfma_f32_16x16x32_bf16 a[184:187], v[252:255], v[224:227], a[184:187]
v_mfma_f32_16x16x32_bf16 a[188:191], v[252:255], v[228:231], a[188:191]
s_cbranch_vccnz L_spin_g
L_back_g:
s_waitcnt lgkmcnt(5)
v_mfma_f32_16x16x32_bf16 v[160:163], a[192:195], v[64:67], v[32:35]
s_waitcnt lgkmcnt(4)
s_add_u32 m0, s25, 0
v_exp_f32 v176, v176
v_mfma_f32_16x16x32_bf16 v[160:163], a[196:199], v[80:83], v[160:163]
s_waitcnt lgkmcnt(3)
s_mov_b32 s16, s80
ds_read_b128 a[216:219], v19 offset:34816
v_add_f32 v28, v28, v176
v_mfma_f32_16x16x32_bf16 v[160:163], a[200:203], v[96:99], v[160:163]
s_waitcnt lgkmcnt(3)
s_mov_b32 s17, s81
buffer_load_dwordx4 v5, s[8:11], s22 offen offset:0 nt lds
v_mfma_f32_16x16x32_bf16 v[160:163], a[204:207], v[112:115], v[160:163]
s_waitcnt lgkmcnt(2)
s_mov_b32 s18, 0x1e0000
v_exp_f32 v177, v177
v_mfma_f32_16x16x32_bf16 v[160:163], a[208:211], v[128:131], v[160:163]
s_waitcnt lgkmcnt(1)
s_mov_b32 s41, s44
ds_read_b128 a[220:223], v20 offset:34816
v_cvt_pk_bf16_f32 v224, v176, v177
v_mfma_f32_16x16x32_bf16 v[160:163], a[212:215], v[144:147], v[160:163]
s_mul_i32 s27, s100, 81920
ds_read_b128 a[224:227], v19 offset:34944
v_add_f32 v28, v28, v177
v_mfma_f32_16x16x32_bf16 v[168:171], a[192:195], v[68:71], v[36:39]
v_exp_f32 v178, v178
v_mfma_f32_16x16x32_bf16 v[168:171], a[196:199], v[84:87], v[168:171]
buffer_load_dwordx4 v6, s[8:11], s22 offen offset:1024 nt lds
v_mfma_f32_16x16x32_bf16 v[168:171], a[200:203], v[100:103], v[168:171]
ds_read_b128 a[228:231], v20 offset:34944
v_add_f32 v28, v28, v178
v_mfma_f32_16x16x32_bf16 v[168:171], a[204:207], v[116:119], v[168:171]
v_exp_f32 v179, v179
v_mfma_f32_16x16x32_bf16 v[168:171], a[208:211], v[132:135], v[168:171]
ds_read_b128 a[232:235], v19 offset:35072
v_cvt_pk_bf16_f32 v225, v178, v179
v_mfma_f32_16x16x32_bf16 v[168:171], a[212:215], v[148:151], v[168:171]
ds_read_b128 a[236:239], v20 offset:35072
v_add_f32 v28, v28, v179
v_mfma_f32_16x16x32_bf16 v[192:195], a[192:195], v[72:75], v[40:43]
buffer_load_dwordx4 v7, s[8:11], s22 offen offset:2048 nt lds
v_mfma_f32_16x16x32_bf16 v[192:195], a[196:199], v[88:91], v[192:195]
s_add_u32 s22, s22, 12288
v_exp_f32 v180, v180
v_mfma_f32_16x16x32_bf16 v[192:195], a[200:203], v[104:107], v[192:195]
s_add_u32 m0, s25, 12288
ds_read_b64_tr_b16 a[240:241], v16 offset:53248
v_add_f32 v28, v28, v180
v_mfma_f32_16x16x32_bf16 v[192:195], a[204:207], v[120:123], v[192:195]
v_exp_f32 v181, v181
v_mfma_f32_16x16x32_bf16 v[192:195], a[208:211], v[136:139], v[192:195]
ds_read_b64_tr_b16 a[242:243], v16 offset:55296
v_cvt_pk_bf16_f32 v226, v180, v181
v_mfma_f32_16x16x32_bf16 v[192:195], a[212:215], v[152:155], v[192:195]
ds_read_b64_tr_b16 v[232:233], v21 offset:40960
v_add_f32 v28, v28, v181
v_mfma_f32_16x16x32_bf16 v[200:203], a[192:195], v[76:79], v[44:47]
buffer_load_dwordx4 v8, s[92:95], s23 offen offset:0 nt lds
v_mfma_f32_16x16x32_bf16 v[200:203], a[196:199], v[92:95], v[200:203]
ds_read_b64_tr_b16 v[234:235], v21 offset:47104
v_add_u32 v16, 0xe000, v16
v_mfma_f32_16x16x32_bf16 v[200:203], a[200:203], v[108:111], v[200:203]
ds_read_b64_tr_b16 v[236:237], v22 offset:40960
v_mfma_f32_16x16x32_bf16 v[200:203], a[204:207], v[124:127], v[200:203]
global_load_dword v30, v1, s[62:63]
v_mfma_f32_16x16x32_bf16 v[200:203], a[208:211], v[140:143], v[200:203]
s_add_u32 s62, s62, 0x2000
v_exp_f32 v182, v182
v_mfma_f32_16x16x32_bf16 v[200:203], a[212:215], v[156:159], v[200:203]
s_waitcnt lgkmcnt(10)
ds_read_b64_tr_b16 v[238:239], v22 offset:47104
v_add_f32 v28, v28, v182
v_mfma_f32_16x16x32_bf16 v[164:167], a[216:219], v[64:67], v[32:35]
s_waitcnt lgkmcnt(10)
buffer_load_dwordx4 v9, s[92:95], s23 offen offset:1024 nt lds
v_mfma_f32_16x16x32_bf16 v[164:167], a[220:223], v[80:83], v[164:167]
s_waitcnt lgkmcnt(9)
v_exp_f32 v183, v183
v_mfma_f32_16x16x32_bf16 v[164:167], a[224:227], v[96:99], v[164:167]
s_waitcnt lgkmcnt(8)
ds_read_b64_tr_b16 v[240:241], v23 offset:40960
v_cvt_pk_bf16_f32 v227, v182, v183
v_mfma_f32_16x16x32_bf16 v[164:167], a[228:231], v[112:115], v[164:167]
s_waitcnt lgkmcnt(8)
ds_read_b64_tr_b16 v[242:243], v23 offset:47104
v_add_f32 v28, v28, v183
v_mfma_f32_16x16x32_bf16 v[164:167], a[232:235], v[128:131], v[164:167]
s_waitcnt lgkmcnt(8)
buffer_load_dwordx4 v10, s[92:95], s23 offen offset:2048 nt lds
v_mfma_f32_16x16x32_bf16 v[164:167], a[236:239], v[144:147], v[164:167]
s_addc_u32 s63, s63, 0
v_exp_f32 v184, v184
v_mfma_f32_16x16x32_bf16 v[172:175], a[216:219], v[68:71], v[36:39]
s_add_u32 s23, s23, 12288
v_exp_f32 v185, v185
v_mfma_f32_16x16x32_bf16 v[172:175], a[220:223], v[84:87], v[172:175]
s_add_u32 m0, s26, 24576
v_exp_f32 v186, v186
v_mfma_f32_16x16x32_bf16 v[172:175], a[224:227], v[100:103], v[172:175]
v_exp_f32 v187, v187
v_mfma_f32_16x16x32_bf16 v[172:175], a[228:231], v[116:119], v[172:175]
v_exp_f32 v188, v188
v_mfma_f32_16x16x32_bf16 v[172:175], a[232:235], v[132:135], v[172:175]
buffer_load_dwordx4 v12, s[16:19], s41 offen nt lds
v_mfma_f32_16x16x32_bf16 v[172:175], a[236:239], v[148:151], v[172:175]
s_add_u32 s41, s41, 40960
v_exp_f32 v189, v189
v_mfma_f32_16x16x32_bf16 v[196:199], a[216:219], v[72:75], v[40:43]
s_add_u32 m0, s24, 114688
v_exp_f32 v190, v190
v_mfma_f32_16x16x32_bf16 v[196:199], a[220:223], v[88:91], v[196:199]
v_exp_f32 v191, v191
v_mfma_f32_16x16x32_bf16 v[196:199], a[224:227], v[104:107], v[196:199]
ds_read_b64_tr_b16 v[244:245], v24 offset:40960
v_cvt_pk_bf16_f32 v228, v184, v185
v_mfma_f32_16x16x32_bf16 v[196:199], a[228:231], v[120:123], v[196:199]
buffer_load_dwordx4 v1, s[12:15], s36 offen offset:0 sc1 lds
v_mfma_f32_16x16x32_bf16 v[196:199], a[232:235], v[136:139], v[196:199]
ds_read_b64_tr_b16 v[246:247], v24 offset:47104
v_cvt_pk_bf16_f32 v229, v186, v187
v_mfma_f32_16x16x32_bf16 v[196:199], a[236:239], v[152:155], v[196:199]
ds_read_b64_tr_b16 v[248:249], v21 offset:41088
v_cvt_pk_bf16_f32 v230, v188, v189
v_mfma_f32_16x16x32_bf16 v[204:207], a[216:219], v[76:79], v[44:47]
ds_read_b64_tr_b16 v[250:251], v21 offset:47232
v_cvt_pk_bf16_f32 v231, v190, v191
v_mfma_f32_16x16x32_bf16 v[204:207], a[220:223], v[92:95], v[204:207]
ds_read_b64_tr_b16 v[252:253], v22 offset:41088
v_add_f32 v29, v29, v184
v_mfma_f32_16x16x32_bf16 v[204:207], a[224:227], v[108:111], v[204:207]
ds_read_b64_tr_b16 v[254:255], v22 offset:47232
v_add_f32 v29, v29, v185
v_mfma_f32_16x16x32_bf16 v[204:207], a[228:231], v[124:127], v[204:207]
buffer_load_dwordx4 v1, s[12:15], s36 offen offset:1024 sc1 lds
v_mfma_f32_16x16x32_bf16 v[204:207], a[232:235], v[140:143], v[204:207]
v_exp_f32 v160, v160
v_mfma_f32_16x16x32_bf16 v[204:207], a[236:239], v[156:159], v[204:207]
s_waitcnt lgkmcnt(10)
v_exp_f32 v161, v161
v_mfma_f32_16x16x32_bf16 a[0:3], v[232:235], v[208:211], a[0:3]
v_exp_f32 v162, v162
v_mfma_f32_16x16x32_bf16 a[4:7], v[232:235], v[212:215], a[4:7]
v_exp_f32 v163, v163
v_mfma_f32_16x16x32_bf16 a[8:11], v[232:235], v[224:227], a[8:11]
buffer_load_dwordx4 v1, s[12:15], s36 offen offset:2048 sc1 lds
v_mfma_f32_16x16x32_bf16 a[12:15], v[232:235], v[228:231], a[12:15]
s_waitcnt lgkmcnt(8)
ds_read_b64_tr_b16 v[232:233], v23 offset:41088
v_add_f32 v26, v26, v160
v_mfma_f32_16x16x32_bf16 a[16:19], v[236:239], v[208:211], a[16:19]
s_add_u32 s36, s36, 3072
ds_read_b64_tr_b16 v[234:235], v23 offset:47232
v_add_f32 v26, v26, v161
v_mfma_f32_16x16x32_bf16 a[20:23], v[236:239], v[212:215], a[20:23]
s_add_u32 m0, s24, 117760
v_exp_f32 v168, v168
v_mfma_f32_16x16x32_bf16 a[24:27], v[236:239], v[224:227], a[24:27]
v_exp_f32 v169, v169
v_mfma_f32_16x16x32_bf16 a[28:31], v[236:239], v[228:231], a[28:31]
s_waitcnt lgkmcnt(8)
buffer_load_dwordx4 v1, s[12:15], s36 offen offset:0 sc1 lds
v_mfma_f32_16x16x32_bf16 a[32:35], v[240:243], v[208:211], a[32:35]
ds_read_b64_tr_b16 v[236:237], v24 offset:41088
v_add_f32 v26, v26, v162
v_mfma_f32_16x16x32_bf16 a[36:39], v[240:243], v[212:215], a[36:39]
ds_read_b64_tr_b16 v[238:239], v24 offset:47232
v_add_f32 v26, v26, v163
v_mfma_f32_16x16x32_bf16 a[40:43], v[240:243], v[224:227], a[40:43]
v_exp_f32 v170, v170
v_mfma_f32_16x16x32_bf16 a[44:47], v[240:243], v[228:231], a[44:47]
s_waitcnt lgkmcnt(8)
ds_read_b64_tr_b16 v[240:241], v21 offset:41216
v_cvt_pk_bf16_f32 v216, v160, v161
v_mfma_f32_16x16x32_bf16 a[48:51], v[244:247], v[208:211], a[48:51]
ds_read_b64_tr_b16 v[242:243], v21 offset:47360
v_cvt_pk_bf16_f32 v217, v162, v163
v_mfma_f32_16x16x32_bf16 a[52:55], v[244:247], v[212:215], a[52:55]
buffer_load_dwordx4 v1, s[12:15], s36 offen offset:1024 sc1 lds
v_mfma_f32_16x16x32_bf16 a[56:59], v[244:247], v[224:227], a[56:59]
v_exp_f32 v171, v171
v_mfma_f32_16x16x32_bf16 a[60:63], v[244:247], v[228:231], a[60:63]
s_waitcnt lgkmcnt(8)
ds_read_b64_tr_b16 v[244:245], v22 offset:41216
v_add_f32 v27, v27, v168
v_mfma_f32_16x16x32_bf16 a[64:67], v[248:251], v[208:211], a[64:67]
ds_read_b64_tr_b16 v[246:247], v22 offset:47360
v_add_f32 v27, v27, v169
v_mfma_f32_16x16x32_bf16 a[68:71], v[248:251], v[212:215], a[68:71]
v_exp_f32 v164, v164
v_mfma_f32_16x16x32_bf16 a[72:75], v[248:251], v[224:227], a[72:75]
buffer_load_dwordx4 v1, s[12:15], s36 offen offset:2048 sc1 lds
v_mfma_f32_16x16x32_bf16 a[76:79], v[248:251], v[228:231], a[76:79]
s_waitcnt lgkmcnt(8)
ds_read_b64_tr_b16 v[248:249], v23 offset:41216
v_add_f32 v27, v27, v170
v_mfma_f32_16x16x32_bf16 a[80:83], v[252:255], v[208:211], a[80:83]
ds_read_b64_tr_b16 v[250:251], v23 offset:47360
v_add_f32 v27, v27, v171
v_mfma_f32_16x16x32_bf16 a[84:87], v[252:255], v[212:215], a[84:87]
v_exp_f32 v165, v165
v_mfma_f32_16x16x32_bf16 a[88:91], v[252:255], v[224:227], a[88:91]
v_exp_f32 v166, v166
v_mfma_f32_16x16x32_bf16 a[92:95], v[252:255], v[228:231], a[92:95]
s_waitcnt lgkmcnt(8)
ds_read_b64_tr_b16 v[252:253], v24 offset:41216
v_cvt_pk_bf16_f32 v220, v168, v169
v_mfma_f32_16x16x32_bf16 a[96:99], v[232:235], v[208:211], a[96:99]
ds_read_b64_tr_b16 v[254:255], v24 offset:47360
v_cvt_pk_bf16_f32 v221, v170, v171
v_mfma_f32_16x16x32_bf16 a[100:103], v[232:235], v[212:215], a[100:103]
v_exp_f32 v167, v167
v_mfma_f32_16x16x32_bf16 a[104:107], v[232:235], v[224:227], a[104:107]
v_exp_f32 v172, v172
v_mfma_f32_16x16x32_bf16 a[108:111], v[232:235], v[228:231], a[108:111]
s_waitcnt lgkmcnt(8)
v_exp_f32 v173, v173
v_mfma_f32_16x16x32_bf16 a[112:115], v[236:239], v[208:211], a[112:115]
v_exp_f32 v174, v174
v_mfma_f32_16x16x32_bf16 a[116:119], v[236:239], v[212:215], a[116:119]
v_exp_f32 v175, v175
v_mfma_f32_16x16x32_bf16 a[120:123], v[236:239], v[224:227], a[120:123]
s_waitcnt lgkmcnt(0)
s_barrier
v_exp_f32 v192, v192
v_mfma_f32_16x16x32_bf16 a[124:127], v[236:239], v[228:231], a[124:127]
ds_read_b128 a[192:195], v19 offset:57344
v_add_f32 v29, v29, v186
v_mfma_f32_16x16x32_bf16 a[128:131], v[240:243], v[208:211], a[128:131]
ds_read_b128 a[196:199], v20 offset:57344
v_add_f32 v29, v29, v187
v_mfma_f32_16x16x32_bf16 a[132:135], v[240:243], v[212:215], a[132:135]
ds_read_b128 a[200:203], v19 offset:57472
v_add_f32 v26, v26, v164
v_mfma_f32_16x16x32_bf16 a[136:139], v[240:243], v[224:227], a[136:139]
ds_read_b128 a[204:207], v20 offset:57472
v_add_f32 v26, v26, v165
v_mfma_f32_16x16x32_bf16 a[140:143], v[240:243], v[228:231], a[140:143]
ds_read_b128 a[208:211], v19 offset:57600
v_add_f32 v26, v26, v166
v_mfma_f32_16x16x32_bf16 a[144:147], v[244:247], v[208:211], a[144:147]
buffer_store_dwordx4 a[240:243], v1, s[12:15], s42 offen sc1
v_mfma_f32_16x16x32_bf16 a[148:151], v[244:247], v[212:215], a[148:151]
s_add_u32 s42, s42, 10240
ds_read_b128 a[212:215], v20 offset:57600
v_add_f32 v26, v26, v167
v_mfma_f32_16x16x32_bf16 a[152:155], v[244:247], v[224:227], a[152:155]
s_add_u32 m0, s25, 28672
ds_read_b128 a[216:219], v19 offset:63488
v_cvt_pk_bf16_f32 v218, v164, v165
v_mfma_f32_16x16x32_bf16 a[156:159], v[244:247], v[228:231], a[156:159]
ds_read_b128 a[220:223], v20 offset:63488
v_cvt_pk_bf16_f32 v219, v166, v167
v_mfma_f32_16x16x32_bf16 a[160:163], v[248:251], v[208:211], a[160:163]
ds_read_b128 a[224:227], v19 offset:63616
v_add_f32 v27, v27, v172
v_mfma_f32_16x16x32_bf16 a[164:167], v[248:251], v[212:215], a[164:167]
ds_read_b128 a[228:231], v20 offset:63616
v_add_f32 v27, v27, v173
v_mfma_f32_16x16x32_bf16 a[168:171], v[248:251], v[224:227], a[168:171]
ds_read_b128 a[232:235], v19 offset:63744
v_add_f32 v27, v27, v174
v_mfma_f32_16x16x32_bf16 a[172:175], v[248:251], v[228:231], a[172:175]
ds_read_b128 a[236:239], v20 offset:63744
v_add_f32 v27, v27, v175
v_mfma_f32_16x16x32_bf16 a[176:179], v[252:255], v[208:211], a[176:179]
ds_read_b64_tr_b16 a[240:241], v16 offset:24576
v_cvt_pk_bf16_f32 v222, v172, v173
v_mfma_f32_16x16x32_bf16 a[180:183], v[252:255], v[212:215], a[180:183]
ds_read_b64_tr_b16 a[242:243], v16 offset:26624
v_cvt_pk_bf16_f32 v223, v174, v175
v_mfma_f32_16x16x32_bf16 a[184:187], v[252:255], v[224:227], a[184:187]
v_exp_f32 v193, v193
v_mfma_f32_16x16x32_bf16 a[188:191], v[252:255], v[228:231], a[188:191]
s_waitcnt lgkmcnt(13)
v_exp_f32 v194, v194
v_mfma_f32_16x16x32_bf16 v[160:163], a[192:195], v[64:67], v[32:35]
s_waitcnt lgkmcnt(12)
v_exp_f32 v195, v195
v_mfma_f32_16x16x32_bf16 v[160:163], a[196:199], v[80:83], v[160:163]
s_waitcnt lgkmcnt(11)
v_exp_f32 v196, v196
v_mfma_f32_16x16x32_bf16 v[160:163], a[200:203], v[96:99], v[160:163]
s_waitcnt lgkmcnt(10)
buffer_load_dwordx4 v5, s[8:11], s22 offen offset:0 nt lds
v_mfma_f32_16x16x32_bf16 v[160:163], a[204:207], v[112:115], v[160:163]
s_waitcnt lgkmcnt(9)
v_exp_f32 v197, v197
v_mfma_f32_16x16x32_bf16 v[160:163], a[208:211], v[128:131], v[160:163]
s_waitcnt lgkmcnt(8)
v_exp_f32 v198, v198
v_mfma_f32_16x16x32_bf16 v[160:163], a[212:215], v[144:147], v[160:163]
v_exp_f32 v199, v199
v_mfma_f32_16x16x32_bf16 v[168:171], a[192:195], v[68:71], v[36:39]
v_exp_f32 v200, v200
v_mfma_f32_16x16x32_bf16 v[168:171], a[196:199], v[84:87], v[168:171]
v_exp_f32 v201, v201
v_mfma_f32_16x16x32_bf16 v[168:171], a[200:203], v[100:103], v[168:171]
v_exp_f32 v202, v202
v_mfma_f32_16x16x32_bf16 v[168:171], a[204:207], v[116:119], v[168:171]
buffer_load_dwordx4 v6, s[8:11], s22 offen offset:1024 nt lds
v_mfma_f32_16x16x32_bf16 v[168:171], a[208:211], v[132:135], v[168:171]
v_exp_f32 v203, v203
v_mfma_f32_16x16x32_bf16 v[168:171], a[212:215], v[148:151], v[168:171]
v_exp_f32 v204, v204
v_mfma_f32_16x16x32_bf16 v[176:179], a[192:195], v[72:75], v[40:43]
v_exp_f32 v205, v205
v_mfma_f32_16x16x32_bf16 v[176:179], a[196:199], v[88:91], v[176:179]
v_exp_f32 v206, v206
v_mfma_f32_16x16x32_bf16 v[176:179], a[200:203], v[104:107], v[176:179]
v_exp_f32 v207, v207
v_mfma_f32_16x16x32_bf16 v[176:179], a[204:207], v[120:123], v[176:179]
v_exp_f32 v160, v160
v_mfma_f32_16x16x32_bf16 v[176:179], a[208:211], v[136:139], v[176:179]
buffer_load_dwordx4 v7, s[8:11], s22 offen offset:2048 nt lds
v_mfma_f32_16x16x32_bf16 v[176:179], a[212:215], v[152:155], v[176:179]
s_add_u32 s22, s22, 12288
v_exp_f32 v161, v161
v_mfma_f32_16x16x32_bf16 v[184:187], a[192:195], v[76:79], v[44:47]
s_add_u32 m0, s25, 40960
v_exp_f32 v162, v162
v_mfma_f32_16x16x32_bf16 v[184:187], a[196:199], v[92:95], v[184:187]
v_exp_f32 v163, v163
v_mfma_f32_16x16x32_bf16 v[184:187], a[200:203], v[108:111], v[184:187]
v_exp_f32 v168, v168
v_mfma_f32_16x16x32_bf16 v[184:187], a[204:207], v[124:127], v[184:187]
v_exp_f32 v169, v169
v_mfma_f32_16x16x32_bf16 v[184:187], a[208:211], v[140:143], v[184:187]
v_exp_f32 v170, v170
v_mfma_f32_16x16x32_bf16 v[184:187], a[212:215], v[156:159], v[184:187]
s_waitcnt lgkmcnt(7)
buffer_load_dwordx4 v8, s[92:95], s23 offen offset:0 nt lds
v_mfma_f32_16x16x32_bf16 v[164:167], a[216:219], v[64:67], v[32:35]
s_waitcnt lgkmcnt(6)
v_exp_f32 v171, v171
v_mfma_f32_16x16x32_bf16 v[164:167], a[220:223], v[80:83], v[164:167]
s_waitcnt lgkmcnt(5)
v_exp_f32 v176, v176
v_mfma_f32_16x16x32_bf16 v[164:167], a[224:227], v[96:99], v[164:167]
s_waitcnt lgkmcnt(4)
v_exp_f32 v177, v177
v_mfma_f32_16x16x32_bf16 v[164:167], a[228:231], v[112:115], v[164:167]
s_waitcnt lgkmcnt(3)
v_exp_f32 v178, v178
v_mfma_f32_16x16x32_bf16 v[164:167], a[232:235], v[128:131], v[164:167]
s_waitcnt lgkmcnt(2)
v_exp_f32 v179, v179
v_mfma_f32_16x16x32_bf16 v[164:167], a[236:239], v[144:147], v[164:167]
v_exp_f32 v184, v184
v_mfma_f32_16x16x32_bf16 v[172:175], a[216:219], v[68:71], v[36:39]
buffer_load_dwordx4 v9, s[92:95], s23 offen offset:1024 nt lds
v_mfma_f32_16x16x32_bf16 v[172:175], a[220:223], v[84:87], v[172:175]
v_exp_f32 v185, v185
v_mfma_f32_16x16x32_bf16 v[172:175], a[224:227], v[100:103], v[172:175]
v_exp_f32 v186, v186
v_mfma_f32_16x16x32_bf16 v[172:175], a[228:231], v[116:119], v[172:175]
v_exp_f32 v164, v164
v_mfma_f32_16x16x32_bf16 v[172:175], a[232:235], v[132:135], v[172:175]
v_add_u32 v21, 0xe000, v21
v_add_f32 v29, v29, v188
v_mfma_f32_16x16x32_bf16 v[172:175], a[236:239], v[148:151], v[172:175]
ds_read_b64_tr_b16 v[232:233], v21 offset:12288
v_add_f32 v29, v29, v189
v_mfma_f32_16x16x32_bf16 v[180:183], a[216:219], v[72:75], v[40:43]
ds_read_b64_tr_b16 v[234:235], v21 offset:18432
v_add_f32 v29, v29, v190
v_mfma_f32_16x16x32_bf16 v[180:183], a[220:223], v[88:91], v[180:183]
buffer_load_dwordx4 v10, s[92:95], s23 offen offset:2048 nt lds
v_mfma_f32_16x16x32_bf16 v[180:183], a[224:227], v[104:107], v[180:183]
s_add_u32 s23, s23, 12288
v_add_f32 v29, v29, v191
v_add_u32 v22, 0xe000, v22
v_mfma_f32_16x16x32_bf16 v[180:183], a[228:231], v[120:123], v[180:183]
s_add_u32 m0, s26, 53248
ds_read_b64_tr_b16 v[236:237], v22 offset:12288
v_add_u32 v23, 0xe000, v23
v_mfma_f32_16x16x32_bf16 v[180:183], a[232:235], v[136:139], v[180:183]
ds_read_b64_tr_b16 v[238:239], v22 offset:18432
v_cvt_pk_bf16_f32 v224, v192, v193
v_mfma_f32_16x16x32_bf16 v[180:183], a[236:239], v[152:155], v[180:183]
ds_read_b64_tr_b16 v[240:241], v23 offset:12288
v_cvt_pk_bf16_f32 v225, v194, v195
v_mfma_f32_16x16x32_bf16 v[188:191], a[216:219], v[76:79], v[44:47]
ds_read_b64_tr_b16 v[242:243], v23 offset:18432
v_cvt_pk_bf16_f32 v226, v196, v197
v_mfma_f32_16x16x32_bf16 v[188:191], a[220:223], v[92:95], v[188:191]
v_exp_f32 v165, v165
v_mfma_f32_16x16x32_bf16 v[188:191], a[224:227], v[108:111], v[188:191]
buffer_load_dwordx4 v12, s[16:19], s41 offen nt lds
v_mfma_f32_16x16x32_bf16 v[188:191], a[228:231], v[124:127], v[188:191]
s_add_u32 s41, s41, 40960
v_cvt_pk_bf16_f32 v227, v198, v199
v_cvt_pk_bf16_f32 v228, v200, v201
v_mfma_f32_16x16x32_bf16 v[188:191], a[232:235], v[140:143], v[188:191]
s_add_u32 s36, s36, 21504
v_cvt_pk_bf16_f32 v229, v202, v203
v_cvt_pk_bf16_f32 v230, v204, v205
v_mfma_f32_16x16x32_bf16 v[188:191], a[236:239], v[156:159], v[188:191]
s_waitcnt lgkmcnt(4)
v_cvt_pk_bf16_f32 v231, v206, v207
v_add_u32 v24, 0xe000, v24
v_mfma_f32_16x16x32_bf16 a[0:3], v[232:235], v[216:219], a[0:3]
s_add_u32 m0, s24, 139264
ds_read_b64_tr_b16 v[244:245], v24 offset:12288
v_add_u32 v19, 0x15000, v19
v_mfma_f32_16x16x32_bf16 a[4:7], v[232:235], v[220:223], a[4:7]
ds_read_b64_tr_b16 v[246:247], v24 offset:18432
v_add_u32 v20, 0x15000, v20
v_mfma_f32_16x16x32_bf16 a[8:11], v[232:235], v[224:227], a[8:11]
ds_read_b64_tr_b16 v[248:249], v21 offset:12416
v_add_f32 v26, v26, v160
v_mfma_f32_16x16x32_bf16 a[12:15], v[232:235], v[228:231], a[12:15]
s_waitcnt lgkmcnt(5)
buffer_load_dwordx4 v1, s[12:15], s36 offen offset:0 sc1 lds
v_mfma_f32_16x16x32_bf16 a[16:19], v[236:239], v[216:219], a[16:19]
ds_read_b64_tr_b16 v[250:251], v21 offset:18560
v_add_f32 v26, v26, v161
v_mfma_f32_16x16x32_bf16 a[20:23], v[236:239], v[220:223], a[20:23]
ds_read_b64_tr_b16 v[252:253], v22 offset:12416
v_add_f32 v26, v26, v162
v_mfma_f32_16x16x32_bf16 a[24:27], v[236:239], v[224:227], a[24:27]
ds_read_b64_tr_b16 v[254:255], v22 offset:18560
v_add_f32 v26, v26, v163
v_mfma_f32_16x16x32_bf16 a[28:31], v[236:239], v[228:231], a[28:31]
s_waitcnt lgkmcnt(6)
ds_read_b64_tr_b16 v[232:233], v23 offset:12416
v_cvt_pk_bf16_f32 v208, v160, v161
v_mfma_f32_16x16x32_bf16 a[32:35], v[240:243], v[216:219], a[32:35]
ds_read_b64_tr_b16 v[234:235], v23 offset:18560
v_cvt_pk_bf16_f32 v209, v162, v163
v_mfma_f32_16x16x32_bf16 a[36:39], v[240:243], v[220:223], a[36:39]
ds_read_b64_tr_b16 v[236:237], v24 offset:12416
v_add_f32 v27, v27, v168
v_mfma_f32_16x16x32_bf16 a[40:43], v[240:243], v[224:227], a[40:43]
buffer_load_dwordx4 v1, s[12:15], s36 offen offset:1024 sc1 lds
v_mfma_f32_16x16x32_bf16 a[44:47], v[240:243], v[228:231], a[44:47]
s_waitcnt lgkmcnt(7)
ds_read_b64_tr_b16 v[238:239], v24 offset:18560
v_add_f32 v27, v27, v169
v_mfma_f32_16x16x32_bf16 a[48:51], v[244:247], v[216:219], a[48:51]
ds_read_b64_tr_b16 v[240:241], v21 offset:12544
v_add_f32 v27, v27, v170
v_mfma_f32_16x16x32_bf16 a[52:55], v[244:247], v[220:223], a[52:55]
ds_read_b64_tr_b16 v[242:243], v21 offset:18688
v_add_f32 v27, v27, v171
v_mfma_f32_16x16x32_bf16 a[56:59], v[244:247], v[224:227], a[56:59]
v_exp_f32 v166, v166
v_mfma_f32_16x16x32_bf16 a[60:63], v[244:247], v[228:231], a[60:63]
s_waitcnt lgkmcnt(8)
ds_read_b64_tr_b16 v[244:245], v22 offset:12544
v_cvt_pk_bf16_f32 v212, v168, v169
v_mfma_f32_16x16x32_bf16 a[64:67], v[248:251], v[216:219], a[64:67]
ds_read_b64_tr_b16 v[246:247], v22 offset:18688
v_cvt_pk_bf16_f32 v213, v170, v171
v_mfma_f32_16x16x32_bf16 a[68:71], v[248:251], v[220:223], a[68:71]
buffer_load_dwordx4 v1, s[12:15], s36 offen offset:2048 sc1 lds
v_mfma_f32_16x16x32_bf16 a[72:75], v[248:251], v[224:227], a[72:75]
v_exp_f32 v167, v167
v_mfma_f32_16x16x32_bf16 a[76:79], v[248:251], v[228:231], a[76:79]
s_waitcnt lgkmcnt(8)
ds_read_b64_tr_b16 v[248:249], v23 offset:12544
v_add_f32 v28, v28, v192
v_mfma_f32_16x16x32_bf16 a[80:83], v[252:255], v[216:219], a[80:83]
ds_read_b64_tr_b16 v[250:251], v23 offset:18688
v_add_f32 v28, v28, v193
v_mfma_f32_16x16x32_bf16 a[84:87], v[252:255], v[220:223], a[84:87]
v_exp_f32 v172, v172
v_mfma_f32_16x16x32_bf16 a[88:91], v[252:255], v[224:227], a[88:91]
v_exp_f32 v173, v173
v_mfma_f32_16x16x32_bf16 a[92:95], v[252:255], v[228:231], a[92:95]
s_waitcnt lgkmcnt(8)
ds_read_b64_tr_b16 v[252:253], v24 offset:12544
v_add_f32 v28, v28, v194
v_mfma_f32_16x16x32_bf16 a[96:99], v[232:235], v[216:219], a[96:99]
ds_read_b64_tr_b16 v[254:255], v24 offset:18688
v_add_f32 v28, v28, v195
v_mfma_f32_16x16x32_bf16 a[100:103], v[232:235], v[220:223], a[100:103]
v_exp_f32 v174, v174
v_mfma_f32_16x16x32_bf16 a[104:107], v[232:235], v[224:227], a[104:107]
v_exp_f32 v175, v175
v_mfma_f32_16x16x32_bf16 a[108:111], v[232:235], v[228:231], a[108:111]
s_waitcnt lgkmcnt(8)
v_exp_f32 v180, v180
v_mfma_f32_16x16x32_bf16 a[112:115], v[236:239], v[216:219], a[112:115]
v_exp_f32 v181, v181
v_mfma_f32_16x16x32_bf16 a[116:119], v[236:239], v[220:223], a[116:119]
v_exp_f32 v182, v182
v_mfma_f32_16x16x32_bf16 a[120:123], v[236:239], v[224:227], a[120:123]
s_waitcnt vmcnt(26) lgkmcnt(0)
s_barrier
v_exp_f32 v183, v183
v_mfma_f32_16x16x32_bf16 a[124:127], v[236:239], v[228:231], a[124:127]
ds_read_b128 a[192:195], v19 offset:0
v_add_f32 v29, v29, v200
v_mfma_f32_16x16x32_bf16 a[128:131], v[240:243], v[216:219], a[128:131]
ds_read_b128 a[196:199], v20 offset:0
v_add_f32 v29, v29, v201
v_mfma_f32_16x16x32_bf16 a[132:135], v[240:243], v[220:223], a[132:135]
ds_read_b128 a[200:203], v19 offset:128
v_add_f32 v29, v29, v202
v_mfma_f32_16x16x32_bf16 a[136:139], v[240:243], v[224:227], a[136:139]
ds_read_b128 a[204:207], v20 offset:128
v_add_f32 v29, v29, v203
v_mfma_f32_16x16x32_bf16 a[140:143], v[240:243], v[228:231], a[140:143]
ds_read_b128 a[208:211], v19 offset:256
v_add_f32 v26, v26, v164
v_mfma_f32_16x16x32_bf16 a[144:147], v[244:247], v[216:219], a[144:147]
buffer_store_dwordx4 a[240:243], v1, s[12:15], s42 offen sc1
v_mfma_f32_16x16x32_bf16 a[148:151], v[244:247], v[220:223], a[148:151]
s_add_u32 s42, s42, 10240
ds_read_b128 a[212:215], v20 offset:256
v_add_f32 v26, v26, v165
v_mfma_f32_16x16x32_bf16 a[152:155], v[244:247], v[224:227], a[152:155]
s_add_u32 m0, s25, 69632
ds_read_b128 a[216:219], v19 offset:6144
v_add_f32 v26, v26, v166
v_mfma_f32_16x16x32_bf16 a[156:159], v[244:247], v[228:231], a[156:159]
ds_read_b128 a[220:223], v20 offset:6144
v_add_f32 v26, v26, v167
v_mfma_f32_16x16x32_bf16 a[160:163], v[248:251], v[216:219], a[160:163]
ds_read_b128 a[224:227], v19 offset:6272
v_cvt_pk_bf16_f32 v210, v164, v165
v_mfma_f32_16x16x32_bf16 a[164:167], v[248:251], v[220:223], a[164:167]
ds_read_b128 a[228:231], v20 offset:6272
v_cvt_pk_bf16_f32 v211, v166, v167
v_mfma_f32_16x16x32_bf16 a[168:171], v[248:251], v[224:227], a[168:171]
ds_read_b128 a[232:235], v19 offset:6400
v_add_f32 v27, v27, v172
v_mfma_f32_16x16x32_bf16 a[172:175], v[248:251], v[228:231], a[172:175]
ds_read_b128 a[236:239], v20 offset:6400
v_add_f32 v27, v27, v173
v_mfma_f32_16x16x32_bf16 a[176:179], v[252:255], v[216:219], a[176:179]
ds_read_b64_tr_b16 a[240:241], v16 offset:53248
v_add_f32 v27, v27, v174
v_mfma_f32_16x16x32_bf16 a[180:183], v[252:255], v[220:223], a[180:183]
ds_read_b64_tr_b16 a[242:243], v16 offset:55296
v_add_f32 v27, v27, v175
v_mfma_f32_16x16x32_bf16 a[184:187], v[252:255], v[224:227], a[184:187]
ds_read_b64_tr_b16 v[232:233], v21 offset:40960
v_cvt_pk_bf16_f32 v214, v172, v173
v_mfma_f32_16x16x32_bf16 a[188:191], v[252:255], v[228:231], a[188:191]
s_waitcnt lgkmcnt(14)
ds_read_b64_tr_b16 v[234:235], v21 offset:47104
v_cvt_pk_bf16_f32 v215, v174, v175
v_mfma_f32_16x16x32_bf16 v[160:163], a[192:195], v[64:67], v[32:35]
s_waitcnt lgkmcnt(14)
ds_read_b64_tr_b16 v[236:237], v22 offset:40960
v_add_f32 v28, v28, v196
v_mfma_f32_16x16x32_bf16 v[160:163], a[196:199], v[80:83], v[160:163]
s_waitcnt lgkmcnt(14)
ds_read_b64_tr_b16 v[238:239], v22 offset:47104
v_add_f32 v28, v28, v197
v_mfma_f32_16x16x32_bf16 v[160:163], a[200:203], v[96:99], v[160:163]
s_waitcnt lgkmcnt(14)
buffer_load_dwordx4 v8, s[92:95], s23 offen offset:0 nt lds
v_mfma_f32_16x16x32_bf16 v[160:163], a[204:207], v[112:115], v[160:163]
s_waitcnt lgkmcnt(13)
ds_read_b64_tr_b16 v[240:241], v23 offset:40960
v_add_f32 v28, v28, v198
v_mfma_f32_16x16x32_bf16 v[160:163], a[208:211], v[128:131], v[160:163]
s_waitcnt lgkmcnt(13)
ds_read_b64_tr_b16 v[242:243], v23 offset:47104
v_add_f32 v28, v28, v199
v_mfma_f32_16x16x32_bf16 v[160:163], a[212:215], v[144:147], v[160:163]
ds_read_b64_tr_b16 v[244:245], v24 offset:40960
v_add_f32 v29, v29, v204
v_mfma_f32_16x16x32_bf16 v[168:171], a[192:195], v[68:71], v[36:39]
ds_read_b64_tr_b16 v[246:247], v24 offset:47104
v_add_f32 v29, v29, v205
v_mfma_f32_16x16x32_bf16 v[168:171], a[196:199], v[84:87], v[168:171]
ds_read_b64_tr_b16 v[248:249], v21 offset:41088
v_add_f32 v29, v29, v206
v_mfma_f32_16x16x32_bf16 v[168:171], a[200:203], v[100:103], v[168:171]
ds_read_b64_tr_b16 v[250:251], v21 offset:47232
v_add_f32 v29, v29, v207
v_mfma_f32_16x16x32_bf16 v[168:171], a[204:207], v[116:119], v[168:171]
ds_read_b64_tr_b16 v[252:253], v22 offset:41088
v_cvt_pk_bf16_f32 v224, v176, v177
v_mfma_f32_16x16x32_bf16 v[168:171], a[208:211], v[132:135], v[168:171]
ds_read_b64_tr_b16 v[254:255], v22 offset:47232
v_cvt_pk_bf16_f32 v225, v178, v179
v_mfma_f32_16x16x32_bf16 v[168:171], a[212:215], v[148:151], v[168:171]
v_exp_f32 v187, v187
v_mfma_f32_16x16x32_bf16 v[192:195], a[192:195], v[72:75], v[40:43]
v_exp_f32 v188, v188
v_mfma_f32_16x16x32_bf16 v[192:195], a[196:199], v[88:91], v[192:195]
buffer_load_dwordx4 v9, s[92:95], s23 offen offset:1024 nt lds
v_mfma_f32_16x16x32_bf16 v[192:195], a[200:203], v[104:107], v[192:195]
v_exp_f32 v189, v189
v_mfma_f32_16x16x32_bf16 v[192:195], a[204:207], v[120:123], v[192:195]
v_exp_f32 v190, v190
v_mfma_f32_16x16x32_bf16 v[192:195], a[208:211], v[136:139], v[192:195]
v_exp_f32 v191, v191
v_mfma_f32_16x16x32_bf16 v[192:195], a[212:215], v[152:155], v[192:195]
v_exp_f32 v160, v160
v_mfma_f32_16x16x32_bf16 v[200:203], a[192:195], v[76:79], v[44:47]
v_exp_f32 v161, v161
v_mfma_f32_16x16x32_bf16 v[200:203], a[196:199], v[92:95], v[200:203]
v_exp_f32 v162, v162
v_mfma_f32_16x16x32_bf16 v[200:203], a[200:203], v[108:111], v[200:203]
v_exp_f32 v163, v163
v_mfma_f32_16x16x32_bf16 v[200:203], a[204:207], v[124:127], v[200:203]
v_exp_f32 v168, v168
v_mfma_f32_16x16x32_bf16 v[200:203], a[208:211], v[140:143], v[200:203]
v_exp_f32 v169, v169
v_mfma_f32_16x16x32_bf16 v[200:203], a[212:215], v[156:159], v[200:203]
s_waitcnt lgkmcnt(15)
v_exp_f32 v170, v170
v_mfma_f32_16x16x32_bf16 v[164:167], a[216:219], v[64:67], v[32:35]
s_waitcnt lgkmcnt(15)
v_exp_f32 v171, v171
v_mfma_f32_16x16x32_bf16 v[164:167], a[220:223], v[80:83], v[164:167]
s_waitcnt lgkmcnt(15)
buffer_load_dwordx4 v10, s[92:95], s23 offen offset:2048 nt lds
v_mfma_f32_16x16x32_bf16 v[164:167], a[224:227], v[96:99], v[164:167]
s_waitcnt lgkmcnt(15)
v_exp_f32 v192, v192
v_mfma_f32_16x16x32_bf16 v[164:167], a[228:231], v[112:115], v[164:167]
s_waitcnt lgkmcnt(15)
v_exp_f32 v193, v193
v_mfma_f32_16x16x32_bf16 v[164:167], a[232:235], v[128:131], v[164:167]
s_waitcnt lgkmcnt(14)
v_exp_f32 v194, v194
v_mfma_f32_16x16x32_bf16 v[164:167], a[236:239], v[144:147], v[164:167]
s_add_u32 s23, s23, 12288
v_exp_f32 v195, v195
v_mfma_f32_16x16x32_bf16 v[172:175], a[216:219], v[68:71], v[36:39]
s_add_u32 s36, s36, 3072
v_exp_f32 v200, v200
v_mfma_f32_16x16x32_bf16 v[172:175], a[220:223], v[84:87], v[172:175]
s_add_u32 m0, s24, 142336
v_exp_f32 v201, v201
v_mfma_f32_16x16x32_bf16 v[172:175], a[224:227], v[100:103], v[172:175]
v_exp_f32 v202, v202
v_mfma_f32_16x16x32_bf16 v[172:175], a[228:231], v[116:119], v[172:175]
v_exp_f32 v164, v164
v_mfma_f32_16x16x32_bf16 v[172:175], a[232:235], v[132:135], v[172:175]
v_exp_f32 v165, v165
v_mfma_f32_16x16x32_bf16 v[172:175], a[236:239], v[148:151], v[172:175]
v_exp_f32 v166, v166
v_mfma_f32_16x16x32_bf16 v[196:199], a[216:219], v[72:75], v[40:43]
v_exp_f32 v167, v167
v_mfma_f32_16x16x32_bf16 v[196:199], a[220:223], v[88:91], v[196:199]
buffer_load_dwordx4 v1, s[12:15], s36 offen offset:0 sc1 lds
v_mfma_f32_16x16x32_bf16 v[196:199], a[224:227], v[104:107], v[196:199]
v_exp_f32 v203, v203
v_mfma_f32_16x16x32_bf16 v[196:199], a[228:231], v[120:123], v[196:199]
v_exp_f32 v172, v172
v_mfma_f32_16x16x32_bf16 v[196:199], a[232:235], v[136:139], v[196:199]
v_exp_f32 v173, v173
v_mfma_f32_16x16x32_bf16 v[196:199], a[236:239], v[152:155], v[196:199]
v_exp_f32 v174, v174
v_mfma_f32_16x16x32_bf16 v[204:207], a[216:219], v[76:79], v[44:47]
v_exp_f32 v175, v175
v_mfma_f32_16x16x32_bf16 v[204:207], a[220:223], v[92:95], v[204:207]
v_cvt_pk_bf16_f32 v226, v180, v181
v_cvt_pk_bf16_f32 v227, v182, v183
v_mfma_f32_16x16x32_bf16 v[204:207], a[224:227], v[108:111], v[204:207]
v_cvt_pk_bf16_f32 v228, v184, v185
v_cvt_pk_bf16_f32 v229, v186, v187
v_mfma_f32_16x16x32_bf16 v[204:207], a[228:231], v[124:127], v[204:207]
v_exp_f32 v196, v196
v_mfma_f32_16x16x32_bf16 v[204:207], a[232:235], v[140:143], v[204:207]
v_cvt_pk_bf16_f32 v230, v188, v189
v_cvt_pk_bf16_f32 v231, v190, v191
v_mfma_f32_16x16x32_bf16 v[204:207], a[236:239], v[156:159], v[204:207]
s_waitcnt lgkmcnt(10)
v_exp_f32 v197, v197
v_mfma_f32_16x16x32_bf16 a[0:3], v[232:235], v[208:211], a[0:3]
buffer_load_dwordx4 v1, s[12:15], s36 offen offset:1024 sc1 lds
v_mfma_f32_16x16x32_bf16 a[4:7], v[232:235], v[212:215], a[4:7]
v_exp_f32 v198, v198
v_mfma_f32_16x16x32_bf16 a[8:11], v[232:235], v[224:227], a[8:11]
v_exp_f32 v199, v199
v_mfma_f32_16x16x32_bf16 a[12:15], v[232:235], v[228:231], a[12:15]
s_waitcnt lgkmcnt(8)
ds_read_b64_tr_b16 v[232:233], v23 offset:41088
v_add_u32 v19, 0xfffeb000, v19
v_mfma_f32_16x16x32_bf16 a[16:19], v[236:239], v[208:211], a[16:19]
ds_read_b64_tr_b16 v[234:235], v23 offset:47232
v_add_u32 v20, 0xfffeb000, v20
v_mfma_f32_16x16x32_bf16 a[20:23], v[236:239], v[212:215], a[20:23]
v_exp_f32 v204, v204
v_mfma_f32_16x16x32_bf16 a[24:27], v[236:239], v[224:227], a[24:27]
v_exp_f32 v205, v205
v_mfma_f32_16x16x32_bf16 a[28:31], v[236:239], v[228:231], a[28:31]
s_waitcnt lgkmcnt(8)
ds_read_b64_tr_b16 v[236:237], v24 offset:41088
v_add_f32 v26, v26, v160
v_mfma_f32_16x16x32_bf16 a[32:35], v[240:243], v[208:211], a[32:35]
ds_read_b64_tr_b16 v[238:239], v24 offset:47232
v_add_f32 v26, v26, v161
v_mfma_f32_16x16x32_bf16 a[36:39], v[240:243], v[212:215], a[36:39]
v_exp_f32 v206, v206
v_mfma_f32_16x16x32_bf16 a[40:43], v[240:243], v[224:227], a[40:43]
v_exp_f32 v207, v207
v_mfma_f32_16x16x32_bf16 a[44:47], v[240:243], v[228:231], a[44:47]
s_waitcnt lgkmcnt(8)
ds_read_b64_tr_b16 v[240:241], v21 offset:41216
v_add_f32 v26, v26, v162
v_mfma_f32_16x16x32_bf16 a[48:51], v[244:247], v[208:211], a[48:51]
buffer_load_dwordx4 v1, s[12:15], s36 offen offset:2048 sc1 lds
v_mfma_f32_16x16x32_bf16 a[52:55], v[244:247], v[212:215], a[52:55]
s_add_u32 s36, s36, 21504
ds_read_b64_tr_b16 v[242:243], v21 offset:47360
v_add_f32 v26, v26, v163
v_mfma_f32_16x16x32_bf16 a[56:59], v[244:247], v[224:227], a[56:59]
v_cvt_pk_bf16_f32 v216, v160, v161
v_cvt_pk_bf16_f32 v217, v162, v163
v_mfma_f32_16x16x32_bf16 a[60:63], v[244:247], v[228:231], a[60:63]
s_waitcnt lgkmcnt(8)
ds_read_b64_tr_b16 v[244:245], v22 offset:41216
v_add_f32 v27, v27, v168
v_mfma_f32_16x16x32_bf16 a[64:67], v[248:251], v[208:211], a[64:67]
ds_read_b64_tr_b16 v[246:247], v22 offset:47360
v_add_f32 v27, v27, v169
v_mfma_f32_16x16x32_bf16 a[68:71], v[248:251], v[212:215], a[68:71]
v_add_f32 v27, v27, v170
v_add_f32 v27, v27, v171
v_mfma_f32_16x16x32_bf16 a[72:75], v[248:251], v[224:227], a[72:75]
v_cvt_pk_bf16_f32 v220, v168, v169
v_cvt_pk_bf16_f32 v221, v170, v171
v_mfma_f32_16x16x32_bf16 a[76:79], v[248:251], v[228:231], a[76:79]
s_waitcnt lgkmcnt(8)
ds_read_b64_tr_b16 v[248:249], v23 offset:41216
v_add_f32 v28, v28, v176
v_mfma_f32_16x16x32_bf16 a[80:83], v[252:255], v[208:211], a[80:83]
ds_read_b64_tr_b16 v[250:251], v23 offset:47360
v_add_f32 v28, v28, v177
v_mfma_f32_16x16x32_bf16 a[84:87], v[252:255], v[212:215], a[84:87]
v_add_f32 v28, v28, v178
v_add_f32 v28, v28, v179
v_mfma_f32_16x16x32_bf16 a[88:91], v[252:255], v[224:227], a[88:91]
v_add_f32 v29, v29, v184
v_add_f32 v29, v29, v185
v_mfma_f32_16x16x32_bf16 a[92:95], v[252:255], v[228:231], a[92:95]
s_waitcnt lgkmcnt(8)
ds_read_b64_tr_b16 v[252:253], v24 offset:41216
v_add_f32 v29, v29, v186
v_mfma_f32_16x16x32_bf16 a[96:99], v[232:235], v[208:211], a[96:99]
ds_read_b64_tr_b16 v[254:255], v24 offset:47360
v_add_f32 v29, v29, v187
v_mfma_f32_16x16x32_bf16 a[100:103], v[232:235], v[212:215], a[100:103]
v_add_f32 v26, v26, v164
v_add_f32 v26, v26, v165
v_mfma_f32_16x16x32_bf16 a[104:107], v[232:235], v[224:227], a[104:107]
v_add_f32 v26, v26, v166
v_add_f32 v26, v26, v167
v_mfma_f32_16x16x32_bf16 a[108:111], v[232:235], v[228:231], a[108:111]
s_waitcnt lgkmcnt(8)
v_cvt_pk_bf16_f32 v218, v164, v165
v_cvt_pk_bf16_f32 v219, v166, v167
v_mfma_f32_16x16x32_bf16 a[112:115], v[236:239], v[208:211], a[112:115]
v_add_f32 v27, v27, v172
v_add_f32 v27, v27, v173
v_mfma_f32_16x16x32_bf16 a[116:119], v[236:239], v[212:215], a[116:119]
v_add_f32 v27, v27, v174
v_add_f32 v27, v27, v175
v_mfma_f32_16x16x32_bf16 a[120:123], v[236:239], v[224:227], a[120:123]
s_waitcnt vmcnt(24) lgkmcnt(0)
s_barrier
v_cvt_pk_bf16_f32 v222, v172, v173
v_cvt_pk_bf16_f32 v223, v174, v175
v_mfma_f32_16x16x32_bf16 a[124:127], v[236:239], v[228:231], a[124:127]
ds_read_b128 a[192:195], v19 offset:0
v_add_f32 v28, v28, v180
v_mfma_f32_16x16x32_bf16 a[128:131], v[240:243], v[208:211], a[128:131]
ds_read_b128 a[196:199], v20 offset:0
v_add_f32 v28, v28, v181
v_mfma_f32_16x16x32_bf16 a[132:135], v[240:243], v[212:215], a[132:135]
ds_read_b128 a[200:203], v19 offset:128
v_add_f32 v28, v28, v182
v_mfma_f32_16x16x32_bf16 a[136:139], v[240:243], v[224:227], a[136:139]
ds_read_b128 a[204:207], v20 offset:128
v_add_f32 v28, v28, v183
v_mfma_f32_16x16x32_bf16 a[140:143], v[240:243], v[228:231], a[140:143]
ds_read_b128 a[208:211], v19 offset:256
v_add_u32 v16, 0xffff2000, v16
v_mfma_f32_16x16x32_bf16 a[144:147], v[244:247], v[208:211], a[144:147]
buffer_store_dwordx4 a[240:243], v1, s[12:15], s42 offen sc1
v_mfma_f32_16x16x32_bf16 a[148:151], v[244:247], v[212:215], a[148:151]
s_add_u32 s42, s42, 10240
ds_read_b128 a[212:215], v20 offset:256
v_add_u32 v21, 0xffff2000, v21
v_mfma_f32_16x16x32_bf16 a[152:155], v[244:247], v[224:227], a[152:155]
s_add_u32 m0, s24, 86016
ds_read_b128 a[216:219], v19 offset:6144
v_add_f32 v29, v29, v188
v_mfma_f32_16x16x32_bf16 a[156:159], v[244:247], v[228:231], a[156:159]
ds_read_b128 a[220:223], v20 offset:6144
v_add_f32 v29, v29, v189
v_mfma_f32_16x16x32_bf16 a[160:163], v[248:251], v[208:211], a[160:163]
s_mov_b32 s42, s46
ds_read_b128 a[224:227], v19 offset:6272
v_add_f32 v29, v29, v190
v_mfma_f32_16x16x32_bf16 a[164:167], v[248:251], v[212:215], a[164:167]
ds_read_b128 a[228:231], v20 offset:6272
v_add_f32 v29, v29, v191
v_mfma_f32_16x16x32_bf16 a[168:171], v[248:251], v[224:227], a[168:171]
ds_read_b128 a[232:235], v19 offset:6400
v_add_u32 v22, 0xffff2000, v22
v_mfma_f32_16x16x32_bf16 a[172:175], v[248:251], v[228:231], a[172:175]
ds_read_b128 a[236:239], v20 offset:6400
v_add_u32 v23, 0xffff2000, v23
v_mfma_f32_16x16x32_bf16 a[176:179], v[252:255], v[208:211], a[176:179]
ds_read_b64_tr_b16 a[240:241], v16 offset:24576
v_add_u32 v24, 0xffff2000, v24
v_mfma_f32_16x16x32_bf16 a[180:183], v[252:255], v[212:215], a[180:183]
ds_read_b64_tr_b16 a[242:243], v16 offset:26624
v_add_f32 v28, v28, v192
v_mfma_f32_16x16x32_bf16 a[184:187], v[252:255], v[224:227], a[184:187]
ds_read_b64_tr_b16 v[232:233], v21 offset:12288
v_cvt_pk_bf16_f32 v224, v192, v193
v_mfma_f32_16x16x32_bf16 a[188:191], v[252:255], v[228:231], a[188:191]
s_waitcnt lgkmcnt(14)
ds_read_b64_tr_b16 v[234:235], v21 offset:18432
v_cvt_pk_bf16_f32 v225, v194, v195
v_mfma_f32_16x16x32_bf16 v[160:163], a[192:195], v[64:67], v[32:35]
s_waitcnt lgkmcnt(14)
ds_read_b64_tr_b16 v[236:237], v22 offset:12288
v_cvt_pk_bf16_f32 v226, v196, v197
v_mfma_f32_16x16x32_bf16 v[160:163], a[196:199], v[80:83], v[160:163]
s_waitcnt lgkmcnt(14)
ds_read_b64_tr_b16 v[238:239], v22 offset:18432
v_cvt_pk_bf16_f32 v227, v198, v199
v_mfma_f32_16x16x32_bf16 v[160:163], a[200:203], v[96:99], v[160:163]
s_waitcnt lgkmcnt(14)
buffer_load_dwordx4 v1, s[12:15], s36 offen offset:0 sc1 lds
v_mfma_f32_16x16x32_bf16 v[160:163], a[204:207], v[112:115], v[160:163]
s_waitcnt lgkmcnt(13)
ds_read_b64_tr_b16 v[240:241], v23 offset:12288
v_cvt_pk_bf16_f32 v228, v200, v201
v_mfma_f32_16x16x32_bf16 v[160:163], a[208:211], v[128:131], v[160:163]
s_waitcnt lgkmcnt(13)
ds_read_b64_tr_b16 v[242:243], v23 offset:18432
v_cvt_pk_bf16_f32 v229, v202, v203
v_mfma_f32_16x16x32_bf16 v[160:163], a[212:215], v[144:147], v[160:163]
ds_read_b64_tr_b16 v[244:245], v24 offset:12288
v_cvt_pk_bf16_f32 v230, v204, v205
v_mfma_f32_16x16x32_bf16 v[168:171], a[192:195], v[68:71], v[36:39]
ds_read_b64_tr_b16 v[246:247], v24 offset:18432
v_cvt_pk_bf16_f32 v231, v206, v207
v_mfma_f32_16x16x32_bf16 v[168:171], a[196:199], v[84:87], v[168:171]
ds_read_b64_tr_b16 v[248:249], v21 offset:12416
v_add_f32 v28, v28, v193
v_mfma_f32_16x16x32_bf16 v[168:171], a[200:203], v[100:103], v[168:171]
ds_read_b64_tr_b16 v[250:251], v21 offset:18560
v_add_f32 v28, v28, v194
v_mfma_f32_16x16x32_bf16 v[168:171], a[204:207], v[116:119], v[168:171]
ds_read_b64_tr_b16 v[252:253], v22 offset:12416
v_add_f32 v28, v28, v195
v_mfma_f32_16x16x32_bf16 v[168:171], a[208:211], v[132:135], v[168:171]
ds_read_b64_tr_b16 v[254:255], v22 offset:18560
v_add_f32 v29, v29, v200
v_mfma_f32_16x16x32_bf16 v[168:171], a[212:215], v[148:151], v[168:171]
v_exp_f32 v160, v160
v_mfma_f32_16x16x32_bf16 v[176:179], a[192:195], v[72:75], v[40:43]
v_exp_f32 v161, v161
v_mfma_f32_16x16x32_bf16 v[176:179], a[196:199], v[88:91], v[176:179]
buffer_load_dwordx4 v1, s[12:15], s36 offen offset:1024 sc1 lds
v_mfma_f32_16x16x32_bf16 v[176:179], a[200:203], v[104:107], v[176:179]
v_exp_f32 v162, v162
v_mfma_f32_16x16x32_bf16 v[176:179], a[204:207], v[120:123], v[176:179]
v_exp_f32 v163, v163
v_mfma_f32_16x16x32_bf16 v[176:179], a[208:211], v[136:139], v[176:179]
v_exp_f32 v168, v168
v_mfma_f32_16x16x32_bf16 v[176:179], a[212:215], v[152:155], v[176:179]
v_exp_f32 v169, v169
v_mfma_f32_16x16x32_bf16 v[184:187], a[192:195], v[76:79], v[44:47]
v_exp_f32 v170, v170
v_mfma_f32_16x16x32_bf16 v[184:187], a[196:199], v[92:95], v[184:187]
v_exp_f32 v171, v171
v_mfma_f32_16x16x32_bf16 v[184:187], a[200:203], v[108:111], v[184:187]
v_add_f32 v26, v26, v160
v_add_f32 v26, v26, v161
v_mfma_f32_16x16x32_bf16 v[184:187], a[204:207], v[124:127], v[184:187]
v_exp_f32 v176, v176
v_mfma_f32_16x16x32_bf16 v[184:187], a[208:211], v[140:143], v[184:187]
v_exp_f32 v177, v177
v_mfma_f32_16x16x32_bf16 v[184:187], a[212:215], v[156:159], v[184:187]
s_waitcnt lgkmcnt(15)
v_exp_f32 v178, v178
v_mfma_f32_16x16x32_bf16 v[164:167], a[216:219], v[64:67], v[32:35]
s_waitcnt lgkmcnt(15)
v_exp_f32 v179, v179
v_mfma_f32_16x16x32_bf16 v[164:167], a[220:223], v[80:83], v[164:167]
s_waitcnt lgkmcnt(15)
buffer_load_dwordx4 v1, s[12:15], s36 offen offset:2048 sc1 lds
v_mfma_f32_16x16x32_bf16 v[164:167], a[224:227], v[96:99], v[164:167]
s_waitcnt lgkmcnt(15)
v_add_f32 v26, v26, v162
v_add_f32 v26, v26, v163
v_mfma_f32_16x16x32_bf16 v[164:167], a[228:231], v[112:115], v[164:167]
s_waitcnt lgkmcnt(15)
v_exp_f32 v184, v184
v_mfma_f32_16x16x32_bf16 v[164:167], a[232:235], v[128:131], v[164:167]
s_waitcnt lgkmcnt(14)
v_exp_f32 v185, v185
v_mfma_f32_16x16x32_bf16 v[164:167], a[236:239], v[144:147], v[164:167]
s_add_u32 s36, s36, 3072
v_exp_f32 v186, v186
v_mfma_f32_16x16x32_bf16 v[172:175], a[216:219], v[68:71], v[36:39]
s_add_u32 m0, s24, 89088
v_exp_f32 v187, v187
v_mfma_f32_16x16x32_bf16 v[172:175], a[220:223], v[84:87], v[172:175]
v_cvt_pk_bf16_f32 v208, v160, v161
v_cvt_pk_bf16_f32 v209, v162, v163
v_mfma_f32_16x16x32_bf16 v[172:175], a[224:227], v[100:103], v[172:175]
v_add_f32 v27, v27, v168
v_add_f32 v27, v27, v169
v_mfma_f32_16x16x32_bf16 v[172:175], a[228:231], v[116:119], v[172:175]
v_exp_f32 v164, v164
v_mfma_f32_16x16x32_bf16 v[172:175], a[232:235], v[132:135], v[172:175]
v_exp_f32 v165, v165
v_mfma_f32_16x16x32_bf16 v[172:175], a[236:239], v[148:151], v[172:175]
v_exp_f32 v166, v166
v_mfma_f32_16x16x32_bf16 v[180:183], a[216:219], v[72:75], v[40:43]
v_exp_f32 v167, v167
v_mfma_f32_16x16x32_bf16 v[180:183], a[220:223], v[88:91], v[180:183]
buffer_load_dwordx4 v1, s[12:15], s36 offen offset:0 sc1 lds
v_mfma_f32_16x16x32_bf16 v[180:183], a[224:227], v[104:107], v[180:183]
v_add_f32 v27, v27, v170
v_add_f32 v27, v27, v171
v_mfma_f32_16x16x32_bf16 v[180:183], a[228:231], v[120:123], v[180:183]
v_exp_f32 v172, v172
v_mfma_f32_16x16x32_bf16 v[180:183], a[232:235], v[136:139], v[180:183]
v_exp_f32 v173, v173
v_mfma_f32_16x16x32_bf16 v[180:183], a[236:239], v[152:155], v[180:183]
v_exp_f32 v174, v174
v_mfma_f32_16x16x32_bf16 v[188:191], a[216:219], v[76:79], v[44:47]
v_exp_f32 v175, v175
v_mfma_f32_16x16x32_bf16 v[188:191], a[220:223], v[92:95], v[188:191]
v_cvt_pk_bf16_f32 v212, v168, v169
v_cvt_pk_bf16_f32 v213, v170, v171
v_mfma_f32_16x16x32_bf16 v[188:191], a[224:227], v[108:111], v[188:191]
v_add_f32 v29, v29, v201
v_add_f32 v29, v29, v202
v_mfma_f32_16x16x32_bf16 v[188:191], a[228:231], v[124:127], v[188:191]
v_exp_f32 v180, v180
v_mfma_f32_16x16x32_bf16 v[188:191], a[232:235], v[140:143], v[188:191]
v_exp_f32 v181, v181
v_mfma_f32_16x16x32_bf16 v[188:191], a[236:239], v[156:159], v[188:191]
s_waitcnt lgkmcnt(10)
v_exp_f32 v182, v182
v_mfma_f32_16x16x32_bf16 a[0:3], v[232:235], v[216:219], a[0:3]
buffer_load_dwordx4 v1, s[12:15], s36 offen offset:1024 sc1 lds
v_mfma_f32_16x16x32_bf16 a[4:7], v[232:235], v[220:223], a[4:7]
v_exp_f32 v183, v183
v_mfma_f32_16x16x32_bf16 a[8:11], v[232:235], v[224:227], a[8:11]
v_add_f32 v29, v29, v203
v_add_f32 v26, v26, v164
v_mfma_f32_16x16x32_bf16 a[12:15], v[232:235], v[228:231], a[12:15]
s_waitcnt lgkmcnt(8)
ds_read_b64_tr_b16 v[232:233], v23 offset:12416
v_add_f32 v26, v26, v165
v_mfma_f32_16x16x32_bf16 a[16:19], v[236:239], v[216:219], a[16:19]
ds_read_b64_tr_b16 v[234:235], v23 offset:18560
v_add_f32 v26, v26, v166
v_mfma_f32_16x16x32_bf16 a[20:23], v[236:239], v[220:223], a[20:23]
v_exp_f32 v188, v188
v_mfma_f32_16x16x32_bf16 a[24:27], v[236:239], v[224:227], a[24:27]
v_exp_f32 v189, v189
v_mfma_f32_16x16x32_bf16 a[28:31], v[236:239], v[228:231], a[28:31]
s_waitcnt lgkmcnt(8)
ds_read_b64_tr_b16 v[236:237], v24 offset:12416
v_add_f32 v26, v26, v167
v_mfma_f32_16x16x32_bf16 a[32:35], v[240:243], v[216:219], a[32:35]
ds_read_b64_tr_b16 v[238:239], v24 offset:18560
v_cvt_pk_bf16_f32 v210, v164, v165
v_mfma_f32_16x16x32_bf16 a[36:39], v[240:243], v[220:223], a[36:39]
v_exp_f32 v190, v190
v_mfma_f32_16x16x32_bf16 a[40:43], v[240:243], v[224:227], a[40:43]
v_exp_f32 v191, v191
v_mfma_f32_16x16x32_bf16 a[44:47], v[240:243], v[228:231], a[44:47]
s_waitcnt lgkmcnt(8)
ds_read_b64_tr_b16 v[240:241], v21 offset:12544
v_cvt_pk_bf16_f32 v211, v166, v167
v_mfma_f32_16x16x32_bf16 a[48:51], v[244:247], v[216:219], a[48:51]
buffer_load_dwordx4 v1, s[12:15], s36 offen offset:2048 sc1 lds
v_mfma_f32_16x16x32_bf16 a[52:55], v[244:247], v[220:223], a[52:55]
s_add_u32 s36, s36, 21504
ds_read_b64_tr_b16 v[242:243], v21 offset:18688
v_add_f32 v27, v27, v172
v_mfma_f32_16x16x32_bf16 a[56:59], v[244:247], v[224:227], a[56:59]
v_add_f32 v27, v27, v173
v_add_f32 v27, v27, v174
v_mfma_f32_16x16x32_bf16 a[60:63], v[244:247], v[228:231], a[60:63]
s_waitcnt lgkmcnt(8)
ds_read_b64_tr_b16 v[244:245], v22 offset:12544
v_add_f32 v27, v27, v175
v_mfma_f32_16x16x32_bf16 a[64:67], v[248:251], v[216:219], a[64:67]
ds_read_b64_tr_b16 v[246:247], v22 offset:18688
v_cvt_pk_bf16_f32 v214, v172, v173
v_mfma_f32_16x16x32_bf16 a[68:71], v[248:251], v[220:223], a[68:71]
v_cvt_pk_bf16_f32 v215, v174, v175
v_add_f32 v28, v28, v196
v_mfma_f32_16x16x32_bf16 a[72:75], v[248:251], v[224:227], a[72:75]
v_add_f32 v28, v28, v197
v_add_f32 v28, v28, v198
v_mfma_f32_16x16x32_bf16 a[76:79], v[248:251], v[228:231], a[76:79]
s_waitcnt lgkmcnt(8)
ds_read_b64_tr_b16 v[248:249], v23 offset:12544
v_add_f32 v28, v28, v199
v_mfma_f32_16x16x32_bf16 a[80:83], v[252:255], v[216:219], a[80:83]
ds_read_b64_tr_b16 v[250:251], v23 offset:18688
v_add_f32 v29, v29, v204
v_mfma_f32_16x16x32_bf16 a[84:87], v[252:255], v[220:223], a[84:87]
v_add_f32 v29, v29, v205
v_add_f32 v29, v29, v206
v_mfma_f32_16x16x32_bf16 a[88:91], v[252:255], v[224:227], a[88:91]
v_add_f32 v29, v29, v207
v_add_f32 v28, v28, v176
v_mfma_f32_16x16x32_bf16 a[92:95], v[252:255], v[228:231], a[92:95]
s_waitcnt lgkmcnt(8)
ds_read_b64_tr_b16 v[252:253], v24 offset:12544
v_add_f32 v29, v29, v184
v_mfma_f32_16x16x32_bf16 a[96:99], v[232:235], v[216:219], a[96:99]
ds_read_b64_tr_b16 v[254:255], v24 offset:18688
v_add_f32 v28, v28, v177
v_mfma_f32_16x16x32_bf16 a[100:103], v[232:235], v[220:223], a[100:103]
v_add_f32 v29, v29, v185
v_add_f32 v28, v28, v178
v_mfma_f32_16x16x32_bf16 a[104:107], v[232:235], v[224:227], a[104:107]
v_add_f32 v29, v29, v186
v_add_f32 v28, v28, v179
v_mfma_f32_16x16x32_bf16 a[108:111], v[232:235], v[228:231], a[108:111]
s_waitcnt lgkmcnt(8)
v_add_f32 v29, v29, v187
v_add_f32 v28, v28, v180
v_mfma_f32_16x16x32_bf16 a[112:115], v[236:239], v[216:219], a[112:115]
v_add_f32 v29, v29, v188
v_add_f32 v28, v28, v181
v_mfma_f32_16x16x32_bf16 a[116:119], v[236:239], v[220:223], a[116:119]
v_add_f32 v29, v29, v189
v_add_f32 v28, v28, v182
v_mfma_f32_16x16x32_bf16 a[120:123], v[236:239], v[224:227], a[120:123]
s_waitcnt vmcnt(17) lgkmcnt(0)
s_barrier
v_add_f32 v29, v29, v190
v_add_f32 v28, v28, v183
v_mfma_f32_16x16x32_bf16 a[124:127], v[236:239], v[228:231], a[124:127]
ds_read_b128 a[192:195], v19 offset:28672
v_add_f32 v29, v29, v191
v_mfma_f32_16x16x32_bf16 a[128:131], v[240:243], v[216:219], a[128:131]
ds_read_b128 a[196:199], v20 offset:28672
v_mfma_f32_16x16x32_bf16 a[132:135], v[240:243], v[220:223], a[132:135]
ds_read_b128 a[200:203], v19 offset:28800
v_mfma_f32_16x16x32_bf16 a[136:139], v[240:243], v[224:227], a[136:139]
ds_read_b128 a[204:207], v20 offset:28800
v_mfma_f32_16x16x32_bf16 a[140:143], v[240:243], v[228:231], a[140:143]
ds_read_b128 a[208:211], v19 offset:28928
v_mfma_f32_16x16x32_bf16 a[144:147], v[244:247], v[216:219], a[144:147]
buffer_store_dwordx4 a[240:243], v1, s[12:15], s42 offen sc1
v_mfma_f32_16x16x32_bf16 a[148:151], v[244:247], v[220:223], a[148:151]
s_add_u32 s42, s42, 5120
ds_read_b128 a[212:215], v20 offset:28928
v_mfma_f32_16x16x32_bf16 a[152:155], v[244:247], v[224:227], a[152:155]
s_add_u32 m0, s24, 0
ds_read_b128 a[216:219], v19 offset:34816
v_mfma_f32_16x16x32_bf16 a[156:159], v[244:247], v[228:231], a[156:159]
ds_read_b128 a[220:223], v20 offset:34816
v_mfma_f32_16x16x32_bf16 a[160:163], v[248:251], v[216:219], a[160:163]
ds_read_b128 a[224:227], v19 offset:34944
v_mfma_f32_16x16x32_bf16 a[164:167], v[248:251], v[220:223], a[164:167]
ds_read_b128 a[228:231], v20 offset:34944
v_mfma_f32_16x16x32_bf16 a[168:171], v[248:251], v[224:227], a[168:171]
ds_read_b128 a[232:235], v19 offset:35072
v_mfma_f32_16x16x32_bf16 a[172:175], v[248:251], v[228:231], a[172:175]
ds_read_b128 a[236:239], v20 offset:35072
v_mfma_f32_16x16x32_bf16 a[176:179], v[252:255], v[216:219], a[176:179]
ds_read_b64_tr_b16 a[240:241], v16 offset:53248
v_mfma_f32_16x16x32_bf16 a[180:183], v[252:255], v[220:223], a[180:183]
ds_read_b64_tr_b16 a[242:243], v16 offset:55296
v_mfma_f32_16x16x32_bf16 a[184:187], v[252:255], v[224:227], a[184:187]
ds_read_b64_tr_b16 v[232:233], v21 offset:40960
v_cvt_pk_bf16_f32 v224, v176, v177
v_mfma_f32_16x16x32_bf16 a[188:191], v[252:255], v[228:231], a[188:191]
s_waitcnt lgkmcnt(14)
ds_read_b64_tr_b16 v[234:235], v21 offset:47104
v_cvt_pk_bf16_f32 v225, v178, v179
v_mfma_f32_16x16x32_bf16 v[160:163], a[192:195], v[64:67], v[32:35]
s_waitcnt lgkmcnt(14)
ds_read_b64_tr_b16 v[236:237], v22 offset:40960
v_cvt_pk_bf16_f32 v226, v180, v181
v_mfma_f32_16x16x32_bf16 v[160:163], a[196:199], v[80:83], v[160:163]
s_waitcnt lgkmcnt(14)
ds_read_b64_tr_b16 v[238:239], v22 offset:47104
v_cvt_pk_bf16_f32 v227, v182, v183
v_mfma_f32_16x16x32_bf16 v[160:163], a[200:203], v[96:99], v[160:163]
s_waitcnt lgkmcnt(14)
buffer_load_dwordx4 v1, s[12:15], s36 offen offset:0 sc1 lds
v_mfma_f32_16x16x32_bf16 v[160:163], a[204:207], v[112:115], v[160:163]
s_waitcnt lgkmcnt(13)
ds_read_b64_tr_b16 v[240:241], v23 offset:40960
v_cvt_pk_bf16_f32 v228, v184, v185
v_mfma_f32_16x16x32_bf16 v[160:163], a[208:211], v[128:131], v[160:163]
s_waitcnt lgkmcnt(13)
ds_read_b64_tr_b16 v[242:243], v23 offset:47104
v_cvt_pk_bf16_f32 v229, v186, v187
v_mfma_f32_16x16x32_bf16 v[160:163], a[212:215], v[144:147], v[160:163]
ds_read_b64_tr_b16 v[244:245], v24 offset:40960
v_cvt_pk_bf16_f32 v230, v188, v189
v_mfma_f32_16x16x32_bf16 v[168:171], a[192:195], v[68:71], v[36:39]
ds_read_b64_tr_b16 v[246:247], v24 offset:47104
v_cvt_pk_bf16_f32 v231, v190, v191
v_mfma_f32_16x16x32_bf16 v[168:171], a[196:199], v[84:87], v[168:171]
ds_read_b64_tr_b16 v[248:249], v21 offset:41088
v_mfma_f32_16x16x32_bf16 v[168:171], a[200:203], v[100:103], v[168:171]
ds_read_b64_tr_b16 v[250:251], v21 offset:47232
v_mfma_f32_16x16x32_bf16 v[168:171], a[204:207], v[116:119], v[168:171]
v_exp_f32 v160, v160
v_mfma_f32_16x16x32_bf16 v[168:171], a[208:211], v[132:135], v[168:171]
ds_read_b64_tr_b16 v[252:253], v22 offset:41088
v_add_f32 v26, v26, v160
v_mfma_f32_16x16x32_bf16 v[168:171], a[212:215], v[148:151], v[168:171]
v_exp_f32 v161, v161
v_mfma_f32_16x16x32_bf16 v[192:195], a[192:195], v[72:75], v[40:43]
ds_read_b64_tr_b16 v[254:255], v22 offset:47232
v_cvt_pk_bf16_f32 v216, v160, v161
v_mfma_f32_16x16x32_bf16 v[192:195], a[196:199], v[88:91], v[192:195]
buffer_load_dwordx4 v1, s[12:15], s36 offen offset:1024 sc1 lds
v_mfma_f32_16x16x32_bf16 v[192:195], a[200:203], v[104:107], v[192:195]
v_exp_f32 v162, v162
v_mfma_f32_16x16x32_bf16 v[192:195], a[204:207], v[120:123], v[192:195]
v_exp_f32 v163, v163
v_mfma_f32_16x16x32_bf16 v[192:195], a[208:211], v[136:139], v[192:195]
v_exp_f32 v168, v168
v_mfma_f32_16x16x32_bf16 v[192:195], a[212:215], v[152:155], v[192:195]
v_exp_f32 v169, v169
v_mfma_f32_16x16x32_bf16 v[200:203], a[192:195], v[76:79], v[44:47]
v_exp_f32 v170, v170
v_mfma_f32_16x16x32_bf16 v[200:203], a[196:199], v[92:95], v[200:203]
v_exp_f32 v171, v171
v_mfma_f32_16x16x32_bf16 v[200:203], a[200:203], v[108:111], v[200:203]
v_cvt_pk_bf16_f32 v217, v162, v163
v_cvt_pk_bf16_f32 v220, v168, v169
v_mfma_f32_16x16x32_bf16 v[200:203], a[204:207], v[124:127], v[200:203]
v_exp_f32 v192, v192
v_mfma_f32_16x16x32_bf16 v[200:203], a[208:211], v[140:143], v[200:203]
v_exp_f32 v193, v193
v_mfma_f32_16x16x32_bf16 v[200:203], a[212:215], v[156:159], v[200:203]
s_waitcnt lgkmcnt(15)
v_exp_f32 v194, v194
v_mfma_f32_16x16x32_bf16 v[164:167], a[216:219], v[64:67], v[32:35]
s_waitcnt lgkmcnt(15)
v_exp_f32 v195, v195
v_mfma_f32_16x16x32_bf16 v[164:167], a[220:223], v[80:83], v[164:167]
s_waitcnt lgkmcnt(15)
buffer_load_dwordx4 v1, s[12:15], s36 offen offset:2048 sc1 lds
v_mfma_f32_16x16x32_bf16 v[164:167], a[224:227], v[96:99], v[164:167]
s_waitcnt lgkmcnt(15)
v_cvt_pk_bf16_f32 v221, v170, v171
v_cvt_pk_bf16_f32 v56, v192, v193
v_mfma_f32_16x16x32_bf16 v[164:167], a[228:231], v[112:115], v[164:167]
s_waitcnt lgkmcnt(15)
v_exp_f32 v200, v200
v_mfma_f32_16x16x32_bf16 v[164:167], a[232:235], v[128:131], v[164:167]
s_waitcnt lgkmcnt(14)
v_exp_f32 v201, v201
v_mfma_f32_16x16x32_bf16 v[164:167], a[236:239], v[144:147], v[164:167]
s_add_u32 s36, s36, 3072
v_exp_f32 v202, v202
v_mfma_f32_16x16x32_bf16 v[172:175], a[216:219], v[68:71], v[36:39]
s_add_u32 m0, s24, 3072
v_exp_f32 v203, v203
v_mfma_f32_16x16x32_bf16 v[172:175], a[220:223], v[84:87], v[172:175]
v_cvt_pk_bf16_f32 v57, v194, v195
v_cvt_pk_bf16_f32 v60, v200, v201
v_mfma_f32_16x16x32_bf16 v[172:175], a[224:227], v[100:103], v[172:175]
v_cvt_pk_bf16_f32 v61, v202, v203
v_add_f32 v27, v27, v168
v_mfma_f32_16x16x32_bf16 v[172:175], a[228:231], v[116:119], v[172:175]
v_exp_f32 v164, v164
v_mfma_f32_16x16x32_bf16 v[172:175], a[232:235], v[132:135], v[172:175]
v_exp_f32 v165, v165
v_mfma_f32_16x16x32_bf16 v[172:175], a[236:239], v[148:151], v[172:175]
v_exp_f32 v166, v166
v_mfma_f32_16x16x32_bf16 v[196:199], a[216:219], v[72:75], v[40:43]
v_exp_f32 v167, v167
v_mfma_f32_16x16x32_bf16 v[196:199], a[220:223], v[88:91], v[196:199]
buffer_load_dwordx4 v1, s[12:15], s36 offen offset:0 sc1 lds
v_mfma_f32_16x16x32_bf16 v[196:199], a[224:227], v[104:107], v[196:199]
v_cvt_pk_bf16_f32 v218, v164, v165
v_cvt_pk_bf16_f32 v219, v166, v167
v_mfma_f32_16x16x32_bf16 v[196:199], a[228:231], v[120:123], v[196:199]
v_exp_f32 v172, v172
v_mfma_f32_16x16x32_bf16 v[196:199], a[232:235], v[136:139], v[196:199]
v_exp_f32 v173, v173
v_mfma_f32_16x16x32_bf16 v[196:199], a[236:239], v[152:155], v[196:199]
v_exp_f32 v174, v174
v_mfma_f32_16x16x32_bf16 v[204:207], a[216:219], v[76:79], v[44:47]
v_exp_f32 v175, v175
v_mfma_f32_16x16x32_bf16 v[204:207], a[220:223], v[92:95], v[204:207]
v_cvt_pk_bf16_f32 v222, v172, v173
v_cvt_pk_bf16_f32 v223, v174, v175
v_mfma_f32_16x16x32_bf16 v[204:207], a[224:227], v[108:111], v[204:207]
v_add_f32 v28, v28, v192
v_add_f32 v29, v29, v200
v_mfma_f32_16x16x32_bf16 v[204:207], a[228:231], v[124:127], v[204:207]
v_exp_f32 v196, v196
v_mfma_f32_16x16x32_bf16 v[204:207], a[232:235], v[140:143], v[204:207]
v_exp_f32 v197, v197
v_mfma_f32_16x16x32_bf16 v[204:207], a[236:239], v[156:159], v[204:207]
s_waitcnt lgkmcnt(10)
v_exp_f32 v198, v198
v_mfma_f32_16x16x32_bf16 a[0:3], v[232:235], v[208:211], a[0:3]
buffer_load_dwordx4 v1, s[12:15], s36 offen offset:1024 sc1 lds
v_mfma_f32_16x16x32_bf16 a[4:7], v[232:235], v[212:215], a[4:7]
v_exp_f32 v199, v199
v_mfma_f32_16x16x32_bf16 a[8:11], v[232:235], v[224:227], a[8:11]
v_cvt_pk_bf16_f32 v58, v196, v197
v_cvt_pk_bf16_f32 v59, v198, v199
v_mfma_f32_16x16x32_bf16 a[12:15], v[232:235], v[228:231], a[12:15]
s_waitcnt lgkmcnt(8)
ds_read_b64_tr_b16 v[232:233], v23 offset:41088
v_add_f32 v26, v26, v161
v_mfma_f32_16x16x32_bf16 a[16:19], v[236:239], v[208:211], a[16:19]
ds_read_b64_tr_b16 v[234:235], v23 offset:47232
v_add_f32 v27, v27, v169
v_mfma_f32_16x16x32_bf16 a[20:23], v[236:239], v[212:215], a[20:23]
v_exp_f32 v204, v204
v_mfma_f32_16x16x32_bf16 a[24:27], v[236:239], v[224:227], a[24:27]
v_exp_f32 v205, v205
v_mfma_f32_16x16x32_bf16 a[28:31], v[236:239], v[228:231], a[28:31]
s_waitcnt lgkmcnt(8)
ds_read_b64_tr_b16 v[236:237], v24 offset:41088
v_cvt_pk_bf16_f32 v62, v204, v205
v_mfma_f32_16x16x32_bf16 a[32:35], v[240:243], v[208:211], a[32:35]
ds_read_b64_tr_b16 v[238:239], v24 offset:47232
v_add_f32 v28, v28, v193
v_mfma_f32_16x16x32_bf16 a[36:39], v[240:243], v[212:215], a[36:39]
v_exp_f32 v206, v206
v_mfma_f32_16x16x32_bf16 a[40:43], v[240:243], v[224:227], a[40:43]
v_exp_f32 v207, v207
v_mfma_f32_16x16x32_bf16 a[44:47], v[240:243], v[228:231], a[44:47]
s_waitcnt lgkmcnt(8)
ds_read_b64_tr_b16 v[240:241], v21 offset:41216
v_cvt_pk_bf16_f32 v63, v206, v207
v_mfma_f32_16x16x32_bf16 a[48:51], v[244:247], v[208:211], a[48:51]
buffer_load_dwordx4 v1, s[12:15], s36 offen offset:2048 sc1 lds
v_mfma_f32_16x16x32_bf16 a[52:55], v[244:247], v[212:215], a[52:55]
s_add_u32 s36, s36, 21504
ds_read_b64_tr_b16 v[242:243], v21 offset:47360
v_add_u32 v21, 0xe000, v21
v_mfma_f32_16x16x32_bf16 a[56:59], v[244:247], v[224:227], a[56:59]
v_add_f32 v29, v29, v201
v_add_f32 v26, v26, v162
v_mfma_f32_16x16x32_bf16 a[60:63], v[244:247], v[228:231], a[60:63]
s_waitcnt lgkmcnt(8)
ds_read_b64_tr_b16 v[244:245], v22 offset:41216
v_add_f32 v27, v27, v170
v_mfma_f32_16x16x32_bf16 a[64:67], v[248:251], v[208:211], a[64:67]
ds_read_b64_tr_b16 v[246:247], v22 offset:47360
v_add_u32 v22, 0xe000, v22
v_mfma_f32_16x16x32_bf16 a[68:71], v[248:251], v[212:215], a[68:71]
v_add_f32 v28, v28, v194
v_add_f32 v29, v29, v202
v_mfma_f32_16x16x32_bf16 a[72:75], v[248:251], v[224:227], a[72:75]
v_add_f32 v26, v26, v163
v_add_f32 v27, v27, v171
v_mfma_f32_16x16x32_bf16 a[76:79], v[248:251], v[228:231], a[76:79]
s_waitcnt lgkmcnt(8)
ds_read_b64_tr_b16 v[248:249], v23 offset:41216
v_add_f32 v28, v28, v195
v_mfma_f32_16x16x32_bf16 a[80:83], v[252:255], v[208:211], a[80:83]
ds_read_b64_tr_b16 v[250:251], v23 offset:47360
v_add_u32 v23, 0xe000, v23
v_mfma_f32_16x16x32_bf16 a[84:87], v[252:255], v[212:215], a[84:87]
v_add_f32 v29, v29, v203
v_add_f32 v26, v26, v164
v_mfma_f32_16x16x32_bf16 a[88:91], v[252:255], v[224:227], a[88:91]
v_add_f32 v27, v27, v172
v_add_f32 v28, v28, v196
v_mfma_f32_16x16x32_bf16 a[92:95], v[252:255], v[228:231], a[92:95]
s_waitcnt lgkmcnt(8)
ds_read_b64_tr_b16 v[252:253], v24 offset:41216
v_add_f32 v29, v29, v204
v_mfma_f32_16x16x32_bf16 a[96:99], v[232:235], v[208:211], a[96:99]
ds_read_b64_tr_b16 v[254:255], v24 offset:47360
v_add_u32 v24, 0xe000, v24
v_mfma_f32_16x16x32_bf16 a[100:103], v[232:235], v[212:215], a[100:103]
v_add_f32 v26, v26, v165
v_add_f32 v27, v27, v173
v_mfma_f32_16x16x32_bf16 a[104:107], v[232:235], v[224:227], a[104:107]
v_add_f32 v28, v28, v197
v_add_f32 v29, v29, v205
v_mfma_f32_16x16x32_bf16 a[108:111], v[232:235], v[228:231], a[108:111]
s_waitcnt lgkmcnt(8)
v_add_f32 v26, v26, v166
v_add_f32 v27, v27, v174
v_mfma_f32_16x16x32_bf16 a[112:115], v[236:239], v[208:211], a[112:115]
v_add_f32 v28, v28, v198
v_add_f32 v29, v29, v206
v_mfma_f32_16x16x32_bf16 a[116:119], v[236:239], v[212:215], a[116:119]
v_add_f32 v26, v26, v167
v_add_f32 v27, v27, v175
v_mfma_f32_16x16x32_bf16 a[120:123], v[236:239], v[224:227], a[120:123]
s_waitcnt vmcnt(13) lgkmcnt(0)
s_barrier
v_add_f32 v28, v28, v199
v_add_f32 v29, v29, v207
v_mfma_f32_16x16x32_bf16 a[124:127], v[236:239], v[228:231], a[124:127]
ds_read_b64_tr_b16 v[232:233], v21 offset:12288
v_mov_b32 v48, v26
v_mfma_f32_16x16x32_bf16 a[128:131], v[240:243], v[208:211], a[128:131]
ds_read_b64_tr_b16 v[234:235], v21 offset:18432
v_mov_b32 v49, v27
v_mfma_f32_16x16x32_bf16 a[132:135], v[240:243], v[212:215], a[132:135]
ds_read_b64_tr_b16 v[236:237], v22 offset:12288
v_mov_b32 v50, v28
v_mfma_f32_16x16x32_bf16 a[136:139], v[240:243], v[224:227], a[136:139]
ds_read_b64_tr_b16 v[238:239], v22 offset:18432
v_mov_b32 v51, v29
v_mfma_f32_16x16x32_bf16 a[140:143], v[240:243], v[228:231], a[140:143]
ds_read_b64_tr_b16 v[240:241], v23 offset:12288
v_permlane16_swap_b32 v26, v48
v_mfma_f32_16x16x32_bf16 a[144:147], v[244:247], v[208:211], a[144:147]
buffer_store_dwordx4 a[240:243], v1, s[12:15], s42 offen sc1
v_mfma_f32_16x16x32_bf16 a[148:151], v[244:247], v[212:215], a[148:151]
s_add_u32 s42, s42, 5120
ds_read_b64_tr_b16 v[242:243], v23 offset:18432
v_permlane16_swap_b32 v27, v49
v_mfma_f32_16x16x32_bf16 a[152:155], v[244:247], v[224:227], a[152:155]
v_permlane16_swap_b32 v28, v50
v_permlane16_swap_b32 v29, v51
v_mfma_f32_16x16x32_bf16 a[156:159], v[244:247], v[228:231], a[156:159]
buffer_store_dword v15, v14, s[12:15], s55 offen sc1
v_mfma_f32_16x16x32_bf16 a[160:163], v[248:251], v[208:211], a[160:163]
s_add_u32 s55, s55, 4096
ds_read_b64_tr_b16 v[244:245], v24 offset:12288
v_add_f32 v26, v26, v48
v_mfma_f32_16x16x32_bf16 a[164:167], v[248:251], v[212:215], a[164:167]
ds_read_b64_tr_b16 v[246:247], v24 offset:18432
v_add_f32 v27, v27, v49
v_mfma_f32_16x16x32_bf16 a[168:171], v[248:251], v[224:227], a[168:171]
buffer_load_dwordx4 a[192:195], v1, s[12:15], s27 offen offset:0 sc1
v_mfma_f32_16x16x32_bf16 a[172:175], v[248:251], v[228:231], a[172:175]
ds_read_b64_tr_b16 v[248:249], v21 offset:12416
v_add_f32 v28, v28, v50
v_mfma_f32_16x16x32_bf16 a[176:179], v[252:255], v[208:211], a[176:179]
ds_read_b64_tr_b16 v[250:251], v21 offset:18560
v_add_f32 v29, v29, v51
v_mfma_f32_16x16x32_bf16 a[180:183], v[252:255], v[212:215], a[180:183]
buffer_load_dwordx4 a[196:199], v1, s[12:15], s27 offen offset:1024 sc1
v_mfma_f32_16x16x32_bf16 a[184:187], v[252:255], v[224:227], a[184:187]
v_mov_b32 v48, v26
v_mov_b32 v49, v27
v_mfma_f32_16x16x32_bf16 a[188:191], v[252:255], v[228:231], a[188:191]
s_waitcnt lgkmcnt(8)
ds_read_b64_tr_b16 v[252:253], v22 offset:12416
v_mov_b32 v50, v28
v_mfma_f32_16x16x32_bf16 a[0:3], v[232:235], v[216:219], a[0:3]
global_load_dword v30, v1, s[62:63]
v_mfma_f32_16x16x32_bf16 a[4:7], v[232:235], v[220:223], a[4:7]
s_add_u32 s62, s62, 0x2000
ds_read_b64_tr_b16 v[254:255], v22 offset:18560
v_mov_b32 v51, v29
v_mfma_f32_16x16x32_bf16 a[8:11], v[232:235], v[56:59], a[8:11]
s_addc_u32 s63, s63, 0
v_permlane32_swap_b32 v26, v48
v_permlane32_swap_b32 v27, v49
v_mfma_f32_16x16x32_bf16 a[12:15], v[232:235], v[60:63], a[12:15]
s_waitcnt lgkmcnt(8)
buffer_load_dwordx4 a[200:203], v1, s[12:15], s27 offen offset:2048 sc1
v_mfma_f32_16x16x32_bf16 a[16:19], v[236:239], v[216:219], a[16:19]
ds_read_b64_tr_b16 v[232:233], v23 offset:12416
v_permlane32_swap_b32 v28, v50
v_mfma_f32_16x16x32_bf16 a[20:23], v[236:239], v[220:223], a[20:23]
ds_read_b64_tr_b16 v[234:235], v23 offset:18560
v_permlane32_swap_b32 v29, v51
v_mfma_f32_16x16x32_bf16 a[24:27], v[236:239], v[56:59], a[24:27]
buffer_load_dwordx4 a[204:207], v1, s[12:15], s27 offen offset:3072 sc1
v_mfma_f32_16x16x32_bf16 a[28:31], v[236:239], v[60:63], a[28:31]
s_waitcnt lgkmcnt(8)
ds_read_b64_tr_b16 v[236:237], v24 offset:12416
v_add_f32 v26, v26, v48
v_mfma_f32_16x16x32_bf16 a[32:35], v[240:243], v[216:219], a[32:35]
s_add_u32 s27, s27, 4096
ds_read_b64_tr_b16 v[238:239], v24 offset:18560
v_add_f32 v27, v27, v49
v_mfma_f32_16x16x32_bf16 a[36:39], v[240:243], v[220:223], a[36:39]
buffer_load_dwordx4 a[208:211], v1, s[12:15], s27 offen offset:0 sc1
v_mfma_f32_16x16x32_bf16 a[40:43], v[240:243], v[56:59], a[40:43]
v_add_f32 v28, v28, v50
v_add_f32 v29, v29, v51
v_mfma_f32_16x16x32_bf16 a[44:47], v[240:243], v[60:63], a[44:47]
s_waitcnt lgkmcnt(8)
ds_read_b64_tr_b16 v[240:241], v21 offset:12544
v_add_f32 v48, v26, v27
v_mfma_f32_16x16x32_bf16 a[48:51], v[244:247], v[216:219], a[48:51]
buffer_load_dwordx4 a[212:215], v1, s[12:15], s27 offen offset:1024 sc1
v_mfma_f32_16x16x32_bf16 a[52:55], v[244:247], v[220:223], a[52:55]
ds_read_b64_tr_b16 v[242:243], v21 offset:18688
v_add_f32 v49, v28, v29
v_mfma_f32_16x16x32_bf16 a[56:59], v[244:247], v[56:59], a[56:59]
v_add_f32 v48, v48, v49
v_cmp_ngt_f32 vcc, 0x67800000, v48
v_mfma_f32_16x16x32_bf16 a[60:63], v[244:247], v[60:63], a[60:63]
s_waitcnt lgkmcnt(8)
buffer_load_dwordx4 a[216:219], v1, s[12:15], s27 offen offset:2048 sc1
v_mfma_f32_16x16x32_bf16 a[64:67], v[248:251], v[216:219], a[64:67]
ds_read_b64_tr_b16 v[244:245], v22 offset:12544
v_mfma_f32_16x16x32_bf16 a[68:71], v[248:251], v[220:223], a[68:71]
ds_read_b64_tr_b16 v[246:247], v22 offset:18688
v_mfma_f32_16x16x32_bf16 a[72:75], v[248:251], v[56:59], a[72:75]
buffer_load_dwordx4 a[220:223], v1, s[12:15], s27 offen offset:3072 sc1
v_mfma_f32_16x16x32_bf16 a[76:79], v[248:251], v[60:63], a[76:79]
s_waitcnt lgkmcnt(8)
v_rcp_f32 v26, v26
v_mfma_f32_16x16x32_bf16 a[80:83], v[252:255], v[216:219], a[80:83]
s_add_u32 s27, s27, 4096
v_rcp_f32 v27, v27
v_mfma_f32_16x16x32_bf16 a[84:87], v[252:255], v[220:223], a[84:87]
buffer_load_dwordx4 a[224:227], v1, s[12:15], s27 offen offset:0 sc1
v_mfma_f32_16x16x32_bf16 a[88:91], v[252:255], v[56:59], a[88:91]
ds_read_b64_tr_b16 v[248:249], v23 offset:12544
v_mfma_f32_16x16x32_bf16 a[92:95], v[252:255], v[60:63], a[92:95]
s_waitcnt lgkmcnt(7)
ds_read_b64_tr_b16 v[250:251], v23 offset:18688
v_mfma_f32_16x16x32_bf16 a[96:99], v[232:235], v[216:219], a[96:99]
buffer_load_dwordx4 a[228:231], v1, s[12:15], s27 offen offset:1024 sc1
v_mfma_f32_16x16x32_bf16 a[100:103], v[232:235], v[220:223], a[100:103]
ds_read_b64_tr_b16 v[252:253], v24 offset:12544
v_mfma_f32_16x16x32_bf16 a[104:107], v[232:235], v[56:59], a[104:107]
ds_read_b64_tr_b16 v[254:255], v24 offset:18688
v_mfma_f32_16x16x32_bf16 a[108:111], v[232:235], v[60:63], a[108:111]
s_waitcnt lgkmcnt(8)
buffer_load_dwordx4 a[232:235], v1, s[12:15], s27 offen offset:2048 sc1
v_mfma_f32_16x16x32_bf16 a[112:115], v[236:239], v[216:219], a[112:115]
ds_read_b128 v[160:163], v25 offset:0
v_mfma_f32_16x16x32_bf16 a[116:119], v[236:239], v[220:223], a[116:119]
ds_read_b128 v[164:167], v25 offset:6144
v_mfma_f32_16x16x32_bf16 a[120:123], v[236:239], v[56:59], a[120:123]
buffer_load_dwordx4 a[236:239], v1, s[12:15], s27 offen offset:3072 sc1
v_mfma_f32_16x16x32_bf16 a[124:127], v[236:239], v[60:63], a[124:127]
s_waitcnt lgkmcnt(8)
v_rcp_f32 v28, v28
v_mfma_f32_16x16x32_bf16 a[128:131], v[240:243], v[216:219], a[128:131]
s_add_u32 s27, s27, 4096
v_rcp_f32 v29, v29
v_mfma_f32_16x16x32_bf16 a[132:135], v[240:243], v[220:223], a[132:135]
buffer_load_dwordx4 a[240:243], v1, s[12:15], s27 offen offset:0 sc1
v_mfma_f32_16x16x32_bf16 a[136:139], v[240:243], v[56:59], a[136:139]
ds_read_b128 v[168:171], v25 offset:1024
v_mfma_f32_16x16x32_bf16 a[140:143], v[240:243], v[60:63], a[140:143]
s_waitcnt lgkmcnt(7)
ds_read_b128 v[172:175], v25 offset:7168
v_mfma_f32_16x16x32_bf16 a[144:147], v[244:247], v[216:219], a[144:147]
buffer_load_dwordx4 a[244:247], v1, s[12:15], s27 offen offset:1024 sc1
v_mfma_f32_16x16x32_bf16 a[148:151], v[244:247], v[220:223], a[148:151]
v_mfma_f32_16x16x32_bf16 a[152:155], v[244:247], v[56:59], a[152:155]
v_mfma_f32_16x16x32_bf16 a[156:159], v[244:247], v[60:63], a[156:159]
s_waitcnt lgkmcnt(6)
v_mfma_f32_16x16x32_bf16 a[160:163], v[248:251], v[216:219], a[160:163]
buffer_load_dwordx4 a[248:251], v1, s[12:15], s27 offen offset:2048 sc1
v_mfma_f32_16x16x32_bf16 a[164:167], v[248:251], v[220:223], a[164:167]
v_mfma_f32_16x16x32_bf16 a[168:171], v[248:251], v[56:59], a[168:171]
v_mfma_f32_16x16x32_bf16 a[172:175], v[248:251], v[60:63], a[172:175]
s_waitcnt lgkmcnt(4)
v_mfma_f32_16x16x32_bf16 a[176:179], v[252:255], v[216:219], a[176:179]
buffer_load_dwordx4 a[252:255], v1, s[12:15], s27 offen offset:3072 sc1
v_mfma_f32_16x16x32_bf16 a[180:183], v[252:255], v[220:223], a[180:183]
s_add_u32 s27, s27, 4096
v_mfma_f32_16x16x32_bf16 a[184:187], v[252:255], v[56:59], a[184:187]
v_mfma_f32_16x16x32_bf16 a[188:191], v[252:255], v[60:63], a[188:191]
s_cbranch_vccnz L_fb
L_fb_back:
s_waitcnt vmcnt(16) lgkmcnt(3)
v_mfma_f32_16x16x32_bf16 v[64:67], v[160:163], a[192:195], 0
s_waitcnt vmcnt(11) lgkmcnt(2)
s_add_u32 m0, s24, 36864
buffer_load_dwordx4 v[208:211], v1, s[12:15], s27 offen offset:0 sc1
v_mfma_f32_16x16x32_bf16 v[64:67], v[164:167], a[208:211], v[64:67]
v_accvgpr_read_b32 v48, a0
v_accvgpr_read_b32 v49, a1
v_mfma_f32_16x16x32_bf16 v[68:71], v[160:163], a[196:199], 0
s_waitcnt vmcnt(11)
v_accvgpr_read_b32 v50, a2
v_accvgpr_read_b32 v51, a3
v_mfma_f32_16x16x32_bf16 v[68:71], v[164:167], a[212:215], v[68:71]
buffer_load_dwordx4 v1, s[12:15], s36 offen offset:0 sc1 lds
v_mfma_f32_16x16x32_bf16 v[72:75], v[160:163], a[200:203], 0
s_waitcnt vmcnt(11)
v_accvgpr_read_b32 v52, a16
v_accvgpr_read_b32 v53, a17
v_mfma_f32_16x16x32_bf16 v[72:75], v[164:167], a[216:219], v[72:75]
v_accvgpr_read_b32 v54, a18
v_accvgpr_read_b32 v55, a19
v_mfma_f32_16x16x32_bf16 v[76:79], v[160:163], a[204:207], 0
s_waitcnt vmcnt(10)
v_mul_f32 v48, v48, v26
v_mul_f32 v49, v49, v26
v_mfma_f32_16x16x32_bf16 v[76:79], v[164:167], a[220:223], v[76:79]
s_waitcnt lgkmcnt(1)
ds_read_b128 v[176:179], v25 offset:2048
v_mul_f32 v50, v50, v26
v_mfma_f32_16x16x32_bf16 v[80:83], v[168:171], a[192:195], 0
s_waitcnt lgkmcnt(1)
ds_read_b128 v[180:183], v25 offset:8192
v_mul_f32 v51, v51, v26
v_mfma_f32_16x16x32_bf16 v[80:83], v[172:175], a[208:211], v[80:83]
v_mul_f32 v52, v52, v26
v_mul_f32 v53, v53, v26
v_mfma_f32_16x16x32_bf16 v[84:87], v[168:171], a[196:199], 0
v_mul_f32 v54, v54, v26
v_mul_f32 v55, v55, v26
v_mfma_f32_16x16x32_bf16 v[84:87], v[172:175], a[212:215], v[84:87]
buffer_load_dwordx4 v[212:215], v1, s[12:15], s27 offen offset:1024 sc1
v_mfma_f32_16x16x32_bf16 v[88:91], v[168:171], a[200:203], 0
v_cvt_pk_bf16_f32 v184, v48, v49
v_cvt_pk_bf16_f32 v185, v50, v51
v_mfma_f32_16x16x32_bf16 v[88:91], v[172:175], a[216:219], v[88:91]
v_cvt_pk_bf16_f32 v186, v52, v53
v_cvt_pk_bf16_f32 v187, v54, v55
v_mfma_f32_16x16x32_bf16 v[92:95], v[168:171], a[204:207], 0
v_accvgpr_write_b32 a0, v184
v_accvgpr_write_b32 a1, v185
v_mfma_f32_16x16x32_bf16 v[92:95], v[172:175], a[220:223], v[92:95]
s_waitcnt lgkmcnt(1)
ds_read_b128 v[160:163], v25 offset:3072
v_accvgpr_write_b32 a2, v186
v_mfma_f32_16x16x32_bf16 v[96:99], v[176:179], a[192:195], 0
s_waitcnt lgkmcnt(1)
ds_read_b128 v[164:167], v25 offset:9216
v_accvgpr_write_b32 a3, v187
v_mfma_f32_16x16x32_bf16 v[96:99], v[180:183], a[208:211], v[96:99]
buffer_store_dwordx4 a[0:3], v1, s[12:15], s34 offen offset:0 sc1
v_mfma_f32_16x16x32_bf16 v[100:103], v[176:179], a[196:199], 0
v_accvgpr_read_b32 v56, a4
v_accvgpr_read_b32 v57, a5
v_mfma_f32_16x16x32_bf16 v[100:103], v[180:183], a[212:215], v[100:103]
buffer_load_dwordx4 v[216:219], v1, s[12:15], s27 offen offset:2048 sc1
v_mfma_f32_16x16x32_bf16 v[104:107], v[176:179], a[200:203], 0
v_accvgpr_read_b32 v58, a6
v_accvgpr_read_b32 v59, a7
v_mfma_f32_16x16x32_bf16 v[104:107], v[180:183], a[216:219], v[104:107]
buffer_load_dwordx4 v[220:223], v1, s[12:15], s27 offen offset:3072 sc1
v_mfma_f32_16x16x32_bf16 v[108:111], v[176:179], a[204:207], 0
s_add_u32 s27, s27, 4096
v_accvgpr_read_b32 v60, a20
v_accvgpr_read_b32 v61, a21
v_mfma_f32_16x16x32_bf16 v[108:111], v[180:183], a[220:223], v[108:111]
s_waitcnt lgkmcnt(1)
ds_read_b128 v[168:171], v25 offset:4096
v_accvgpr_read_b32 v62, a22
v_mfma_f32_16x16x32_bf16 v[112:115], v[160:163], a[192:195], 0
s_waitcnt lgkmcnt(1)
ds_read_b128 v[172:175], v25 offset:10240
v_accvgpr_read_b32 v63, a23
v_mfma_f32_16x16x32_bf16 v[112:115], v[164:167], a[208:211], v[112:115]
buffer_load_dwordx4 v1, s[12:15], s36 offen offset:1024 sc1 lds
v_mfma_f32_16x16x32_bf16 v[116:119], v[160:163], a[196:199], 0
v_mul_f32 v56, v56, v27
v_mul_f32 v57, v57, v27
v_mfma_f32_16x16x32_bf16 v[116:119], v[164:167], a[212:215], v[116:119]
buffer_load_dwordx4 v[224:227], v1, s[12:15], s27 offen offset:0 sc1
v_mfma_f32_16x16x32_bf16 v[120:123], v[160:163], a[200:203], 0
v_mul_f32 v58, v58, v27
v_mul_f32 v59, v59, v27
v_mfma_f32_16x16x32_bf16 v[120:123], v[164:167], a[216:219], v[120:123]
buffer_load_dwordx4 v[228:231], v1, s[12:15], s27 offen offset:1024 sc1
v_mfma_f32_16x16x32_bf16 v[124:127], v[160:163], a[204:207], 0
v_mul_f32 v60, v60, v27
v_mul_f32 v61, v61, v27
v_mfma_f32_16x16x32_bf16 v[124:127], v[164:167], a[220:223], v[124:127]
s_waitcnt lgkmcnt(1)
ds_read_b128 v[176:179], v25 offset:5120
v_mul_f32 v62, v62, v27
v_mfma_f32_16x16x32_bf16 v[128:131], v[168:171], a[192:195], 0
s_waitcnt lgkmcnt(1)
ds_read_b128 v[180:183], v25 offset:11264
v_mul_f32 v63, v63, v27
v_mfma_f32_16x16x32_bf16 v[128:131], v[172:175], a[208:211], v[128:131]
v_cvt_pk_bf16_f32 v188, v56, v57
v_cvt_pk_bf16_f32 v189, v58, v59
v_mfma_f32_16x16x32_bf16 v[132:135], v[168:171], a[196:199], 0
v_cvt_pk_bf16_f32 v190, v60, v61
v_cvt_pk_bf16_f32 v191, v62, v63
v_mfma_f32_16x16x32_bf16 v[132:135], v[172:175], a[212:215], v[132:135]
v_accvgpr_write_b32 a4, v188
v_accvgpr_write_b32 a5, v189
v_mfma_f32_16x16x32_bf16 v[136:139], v[168:171], a[200:203], 0
v_accvgpr_write_b32 a6, v190
v_accvgpr_write_b32 a7, v191
v_mfma_f32_16x16x32_bf16 v[136:139], v[172:175], a[216:219], v[136:139]
buffer_store_dwordx4 a[4:7], v1, s[12:15], s34 offen offset:1024 sc1
v_mfma_f32_16x16x32_bf16 v[140:143], v[168:171], a[204:207], 0
v_accvgpr_read_b32 v48, a8
v_accvgpr_read_b32 v49, a9
v_mfma_f32_16x16x32_bf16 v[140:143], v[172:175], a[220:223], v[140:143]
s_waitcnt lgkmcnt(1)
buffer_load_dwordx4 v[232:235], v1, s[12:15], s27 offen offset:2048 sc1
v_mfma_f32_16x16x32_bf16 v[144:147], v[176:179], a[192:195], 0
s_waitcnt lgkmcnt(0)
v_accvgpr_read_b32 v50, a10
v_accvgpr_read_b32 v51, a11
v_mfma_f32_16x16x32_bf16 v[144:147], v[180:183], a[208:211], v[144:147]
buffer_load_dwordx4 v1, s[12:15], s36 offen offset:2048 sc1 lds
v_mfma_f32_16x16x32_bf16 v[148:151], v[176:179], a[196:199], 0
v_accvgpr_read_b32 v52, a24
v_accvgpr_read_b32 v53, a25
v_mfma_f32_16x16x32_bf16 v[148:151], v[180:183], a[212:215], v[148:151]
buffer_load_dwordx4 v[236:239], v1, s[12:15], s27 offen offset:3072 sc1
v_mfma_f32_16x16x32_bf16 v[152:155], v[176:179], a[200:203], 0
s_add_u32 s27, s27, 4096
ds_read_b128 v[160:163], v25 offset:12288
v_accvgpr_read_b32 v54, a26
v_mfma_f32_16x16x32_bf16 v[152:155], v[180:183], a[216:219], v[152:155]
ds_read_b128 v[164:167], v25 offset:18432
v_accvgpr_read_b32 v55, a27
v_mfma_f32_16x16x32_bf16 v[156:159], v[176:179], a[204:207], 0
ds_read_b128 v[168:171], v25 offset:13312
v_accvgpr_read_b32 v56, a12
v_mfma_f32_16x16x32_bf16 v[156:159], v[180:183], a[220:223], v[156:159]
ds_read_b128 v[172:175], v25 offset:19456
v_accvgpr_read_b32 v57, a13
v_accvgpr_read_b32 v58, a14
v_accvgpr_read_b32 v59, a15
v_accvgpr_read_b32 v60, a28
v_accvgpr_read_b32 v61, a29
v_accvgpr_read_b32 v62, a30
v_accvgpr_read_b32 v63, a31
v_mul_f32 v48, v48, v28
v_mul_f32 v49, v49, v28
v_mul_f32 v50, v50, v28
v_mul_f32 v51, v51, v28
v_mul_f32 v52, v52, v28
v_mul_f32 v53, v53, v28
v_mul_f32 v54, v54, v28
v_mul_f32 v55, v55, v28
v_mul_f32 v56, v56, v29
v_mul_f32 v57, v57, v29
v_mul_f32 v58, v58, v29
v_mul_f32 v59, v59, v29
v_mul_f32 v60, v60, v29
v_mul_f32 v61, v61, v29
v_mul_f32 v62, v62, v29
v_mul_f32 v63, v63, v29
v_cvt_pk_bf16_f32 v192, v48, v49
v_cvt_pk_bf16_f32 v193, v50, v51
v_cvt_pk_bf16_f32 v194, v52, v53
v_cvt_pk_bf16_f32 v195, v54, v55
v_cvt_pk_bf16_f32 v196, v56, v57
v_cvt_pk_bf16_f32 v197, v58, v59
v_cvt_pk_bf16_f32 v198, v60, v61
v_cvt_pk_bf16_f32 v199, v62, v63
v_accvgpr_write_b32 a8, v192
v_accvgpr_write_b32 a9, v193
v_accvgpr_write_b32 a10, v194
v_accvgpr_write_b32 a11, v195
v_accvgpr_write_b32 a12, v196
v_accvgpr_write_b32 a13, v197
v_accvgpr_write_b32 a14, v198
v_accvgpr_write_b32 a15, v199
s_waitcnt vmcnt(20) lgkmcnt(3)
v_mfma_f32_16x16x32_bf16 v[64:67], v[160:163], a[224:227], v[64:67]
s_waitcnt vmcnt(16) lgkmcnt(2)
s_add_u32 s36, s36, 3072
buffer_load_dwordx4 a[192:195], v1, s[12:15], s27 offen offset:0 sc1
v_mfma_f32_16x16x32_bf16 v[64:67], v[164:167], a[240:243], v[64:67]
s_add_u32 m0, s24, 39936
ds_read_b128 v[176:179], v25 offset:14336
v_accvgpr_read_b32 v48, a32
v_mfma_f32_16x16x32_bf16 v[68:71], v[160:163], a[228:231], v[68:71]
s_waitcnt vmcnt(16)
ds_read_b128 v[180:183], v25 offset:20480
v_accvgpr_read_b32 v49, a33
v_mfma_f32_16x16x32_bf16 v[68:71], v[164:167], a[244:247], v[68:71]
buffer_load_dwordx4 v1, s[12:15], s36 offen offset:0 sc1 lds
v_mfma_f32_16x16x32_bf16 v[72:75], v[160:163], a[232:235], v[72:75]
s_waitcnt vmcnt(16)
v_accvgpr_read_b32 v50, a34
v_accvgpr_read_b32 v51, a35
v_mfma_f32_16x16x32_bf16 v[72:75], v[164:167], a[248:251], v[72:75]
v_accvgpr_read_b32 v52, a48
v_accvgpr_read_b32 v53, a49
v_mfma_f32_16x16x32_bf16 v[76:79], v[160:163], a[236:239], v[76:79]
s_waitcnt vmcnt(15)
buffer_load_dwordx4 a[196:199], v1, s[12:15], s27 offen offset:1024 sc1
v_mfma_f32_16x16x32_bf16 v[76:79], v[164:167], a[252:255], v[76:79]
s_waitcnt lgkmcnt(3)
ds_read_b128 v[160:163], v25 offset:15360
v_accvgpr_read_b32 v54, a50
v_mfma_f32_16x16x32_bf16 v[80:83], v[168:171], a[224:227], v[80:83]
s_waitcnt lgkmcnt(3)
ds_read_b128 v[164:167], v25 offset:21504
v_accvgpr_read_b32 v55, a51
v_mfma_f32_16x16x32_bf16 v[80:83], v[172:175], a[240:243], v[80:83]
v_mul_f32 v48, v48, v26
v_mul_f32 v49, v49, v26
v_mfma_f32_16x16x32_bf16 v[84:87], v[168:171], a[228:231], v[84:87]
buffer_store_dwordx4 a[8:11], v1, s[12:15], s34 offen offset:2048 sc1
v_mfma_f32_16x16x32_bf16 v[84:87], v[172:175], a[244:247], v[84:87]
v_mul_f32 v50, v50, v26
v_mul_f32 v51, v51, v26
v_mfma_f32_16x16x32_bf16 v[88:91], v[168:171], a[232:235], v[88:91]
v_mul_f32 v52, v52, v26
v_mul_f32 v53, v53, v26
v_mfma_f32_16x16x32_bf16 v[88:91], v[172:175], a[248:251], v[88:91]
buffer_load_dwordx4 a[200:203], v1, s[12:15], s27 offen offset:2048 sc1
v_mfma_f32_16x16x32_bf16 v[92:95], v[168:171], a[236:239], v[92:95]
ds_read_b128 v[168:171], v25 offset:16384
v_mul_f32 v54, v54, v26
v_mfma_f32_16x16x32_bf16 v[92:95], v[172:175], a[252:255], v[92:95]
s_waitcnt lgkmcnt(4)
ds_read_b128 v[172:175], v25 offset:22528
v_mul_f32 v55, v55, v26
v_mfma_f32_16x16x32_bf16 v[96:99], v[176:179], a[224:227], v[96:99]
s_waitcnt lgkmcnt(4)
buffer_load_dwordx4 a[204:207], v1, s[12:15], s27 offen offset:3072 sc1
v_mfma_f32_16x16x32_bf16 v[96:99], v[180:183], a[240:243], v[96:99]
v_cvt_pk_bf16_f32 v200, v48, v49
v_cvt_pk_bf16_f32 v201, v50, v51
v_mfma_f32_16x16x32_bf16 v[100:103], v[176:179], a[228:231], v[100:103]
v_cvt_pk_bf16_f32 v202, v52, v53
v_cvt_pk_bf16_f32 v203, v54, v55
v_mfma_f32_16x16x32_bf16 v[100:103], v[180:183], a[244:247], v[100:103]
v_accvgpr_write_b32 a32, v200
v_accvgpr_write_b32 a33, v201
v_mfma_f32_16x16x32_bf16 v[104:107], v[176:179], a[232:235], v[104:107]
buffer_load_dwordx4 v1, s[12:15], s36 offen offset:1024 sc1 lds
v_mfma_f32_16x16x32_bf16 v[104:107], v[180:183], a[248:251], v[104:107]
v_accvgpr_write_b32 a34, v202
v_accvgpr_write_b32 a35, v203
v_mfma_f32_16x16x32_bf16 v[108:111], v[176:179], a[236:239], v[108:111]
ds_read_b128 v[176:179], v25 offset:17408
v_accvgpr_read_b32 v56, a36
v_mfma_f32_16x16x32_bf16 v[108:111], v[180:183], a[252:255], v[108:111]
s_waitcnt lgkmcnt(4)
buffer_store_dwordx4 a[12:15], v1, s[12:15], s34 offen offset:3072 sc1
v_mfma_f32_16x16x32_bf16 v[112:115], v[160:163], a[224:227], v[112:115]
s_waitcnt lgkmcnt(3)
ds_read_b128 v[180:183], v25 offset:23552
v_accvgpr_read_b32 v57, a37
v_mfma_f32_16x16x32_bf16 v[112:115], v[164:167], a[240:243], v[112:115]
s_barrier
v_accvgpr_read_b32 v58, a38
v_accvgpr_read_b32 v59, a39
v_mfma_f32_16x16x32_bf16 v[116:119], v[160:163], a[228:231], v[116:119]
s_add_u32 s34, s34, 4096
v_accvgpr_read_b32 v60, a52
v_accvgpr_read_b32 v61, a53
v_mfma_f32_16x16x32_bf16 v[116:119], v[164:167], a[244:247], v[116:119]
s_add_u32 s27, s27, 4096
v_accvgpr_read_b32 v62, a54
v_accvgpr_read_b32 v63, a55
v_mfma_f32_16x16x32_bf16 v[120:123], v[160:163], a[232:235], v[120:123]
buffer_load_dwordx4 a[208:211], v1, s[12:15], s27 offen offset:0 sc1
v_mfma_f32_16x16x32_bf16 v[120:123], v[164:167], a[248:251], v[120:123]
v_accvgpr_read_b32 v48, a40
v_accvgpr_read_b32 v49, a41
v_mfma_f32_16x16x32_bf16 v[124:127], v[160:163], a[236:239], v[124:127]
buffer_load_dwordx4 a[212:215], v1, s[12:15], s27 offen offset:1024 sc1
v_mfma_f32_16x16x32_bf16 v[124:127], v[164:167], a[252:255], v[124:127]
s_waitcnt lgkmcnt(3)
ds_read_b128 v[160:163], v25 offset:24576
v_accvgpr_read_b32 v50, a42
v_mfma_f32_16x16x32_bf16 v[128:131], v[168:171], a[224:227], v[128:131]
s_waitcnt lgkmcnt(3)
ds_read_b128 v[164:167], v25 offset:30720
v_accvgpr_read_b32 v51, a43
v_mfma_f32_16x16x32_bf16 v[128:131], v[172:175], a[240:243], v[128:131]
buffer_load_dwordx4 v1, s[12:15], s36 offen offset:2048 sc1 lds
v_mfma_f32_16x16x32_bf16 v[132:135], v[168:171], a[228:231], v[132:135]
s_add_u32 s36, s36, 21504
v_accvgpr_read_b32 v52, a56
v_accvgpr_read_b32 v53, a57
v_mfma_f32_16x16x32_bf16 v[132:135], v[172:175], a[244:247], v[132:135]
v_accvgpr_read_b32 v54, a58
v_accvgpr_read_b32 v55, a59
v_mfma_f32_16x16x32_bf16 v[136:139], v[168:171], a[232:235], v[136:139]
buffer_load_dwordx4 a[216:219], v1, s[12:15], s27 offen offset:2048 sc1
v_mfma_f32_16x16x32_bf16 v[136:139], v[172:175], a[248:251], v[136:139]
v_mul_f32 v56, v56, v27
v_mul_f32 v57, v57, v27
v_mfma_f32_16x16x32_bf16 v[140:143], v[168:171], a[236:239], v[140:143]
ds_read_b128 v[168:171], v25 offset:25600
v_mul_f32 v58, v58, v27
v_mfma_f32_16x16x32_bf16 v[140:143], v[172:175], a[252:255], v[140:143]
s_waitcnt lgkmcnt(4)
ds_read_b128 v[172:175], v25 offset:31744
v_mul_f32 v59, v59, v27
v_mfma_f32_16x16x32_bf16 v[144:147], v[176:179], a[224:227], v[144:147]
s_waitcnt lgkmcnt(4)
buffer_store_dwordx4 a[32:35], v1, s[12:15], s34 offen offset:0 sc1
v_mfma_f32_16x16x32_bf16 v[144:147], v[180:183], a[240:243], v[144:147]
v_mul_f32 v60, v60, v27
v_mul_f32 v61, v61, v27
v_mfma_f32_16x16x32_bf16 v[148:151], v[176:179], a[228:231], v[148:151]
v_mul_f32 v62, v62, v27
v_mul_f32 v63, v63, v27
v_mfma_f32_16x16x32_bf16 v[148:151], v[180:183], a[244:247], v[148:151]
buffer_load_dwordx4 a[220:223], v1, s[12:15], s27 offen offset:3072 sc1
v_mfma_f32_16x16x32_bf16 v[152:155], v[176:179], a[232:235], v[152:155]
s_add_u32 s27, s27, 4096
v_mul_f32 v48, v48, v28
v_mul_f32 v49, v49, v28
v_mfma_f32_16x16x32_bf16 v[152:155], v[180:183], a[248:251], v[152:155]
v_mul_f32 v50, v50, v28
v_mul_f32 v51, v51, v28
v_mfma_f32_16x16x32_bf16 v[156:159], v[176:179], a[236:239], v[156:159]
v_mul_f32 v52, v52, v28
v_mul_f32 v53, v53, v28
v_mfma_f32_16x16x32_bf16 v[156:159], v[180:183], a[252:255], v[156:159]
v_mul_f32 v54, v54, v28
v_mul_f32 v55, v55, v28
v_cvt_pk_bf16_f32 v204, v56, v57
v_cvt_pk_bf16_f32 v205, v58, v59
v_cvt_pk_bf16_f32 v206, v60, v61
v_cvt_pk_bf16_f32 v207, v62, v63
v_cvt_pk_bf16_f32 v184, v48, v49
v_cvt_pk_bf16_f32 v185, v50, v51
v_cvt_pk_bf16_f32 v186, v52, v53
v_cvt_pk_bf16_f32 v187, v54, v55
v_accvgpr_write_b32 a36, v204
v_accvgpr_write_b32 a37, v205
v_accvgpr_write_b32 a38, v206
v_accvgpr_write_b32 a39, v207
v_accvgpr_write_b32 a40, v184
v_accvgpr_write_b32 a41, v185
v_accvgpr_write_b32 a42, v186
v_accvgpr_write_b32 a43, v187
s_waitcnt vmcnt(26) lgkmcnt(3)
v_mfma_f32_16x16x32_bf16 v[64:67], v[160:163], v[208:211], v[64:67]
s_waitcnt vmcnt(19) lgkmcnt(2)
buffer_store_dword v15, v14, s[12:15], s55 offen sc1
v_mfma_f32_16x16x32_bf16 v[64:67], v[164:167], v[224:227], v[64:67]
ds_read_b128 v[176:179], v25 offset:26624
v_accvgpr_read_b32 v56, a44
v_mfma_f32_16x16x32_bf16 v[68:71], v[160:163], v[212:215], v[68:71]
s_waitcnt vmcnt(19)
ds_read_b128 v[180:183], v25 offset:32768
v_accvgpr_read_b32 v57, a45
v_mfma_f32_16x16x32_bf16 v[68:71], v[164:167], v[228:231], v[68:71]
buffer_load_dwordx4 a[224:227], v1, s[12:15], s27 offen offset:0 sc1
v_mfma_f32_16x16x32_bf16 v[72:75], v[160:163], v[216:219], v[72:75]
s_waitcnt vmcnt(18)
v_accvgpr_read_b32 v58, a46
v_accvgpr_read_b32 v59, a47
v_mfma_f32_16x16x32_bf16 v[72:75], v[164:167], v[232:235], v[72:75]
v_accvgpr_read_b32 v60, a60
v_accvgpr_read_b32 v61, a61
v_mfma_f32_16x16x32_bf16 v[76:79], v[160:163], v[220:223], v[76:79]
s_waitcnt vmcnt(16)
ds_read_b128 v[160:163], v25 offset:27648
v_accvgpr_read_b32 v62, a62
v_mfma_f32_16x16x32_bf16 v[76:79], v[164:167], v[236:239], v[76:79]
s_waitcnt lgkmcnt(4)
buffer_store_dwordx4 a[36:39], v1, s[12:15], s34 offen offset:1024 sc1
v_mfma_f32_16x16x32_bf16 v[80:83], v[168:171], v[208:211], v[80:83]
s_waitcnt lgkmcnt(3)
ds_read_b128 v[164:167], v25 offset:33792
v_accvgpr_read_b32 v63, a63
v_mfma_f32_16x16x32_bf16 v[80:83], v[172:175], v[224:227], v[80:83]
v_mul_f32 v56, v56, v29
v_mul_f32 v57, v57, v29
v_mfma_f32_16x16x32_bf16 v[84:87], v[168:171], v[212:215], v[84:87]
v_mul_f32 v58, v58, v29
v_mul_f32 v59, v59, v29
v_mfma_f32_16x16x32_bf16 v[84:87], v[172:175], v[228:231], v[84:87]
buffer_load_dwordx4 a[228:231], v1, s[12:15], s27 offen offset:1024 sc1
v_mfma_f32_16x16x32_bf16 v[88:91], v[168:171], v[216:219], v[88:91]
v_mul_f32 v60, v60, v29
v_mul_f32 v61, v61, v29
v_mfma_f32_16x16x32_bf16 v[88:91], v[172:175], v[232:235], v[88:91]
v_mul_f32 v62, v62, v29
v_mul_f32 v63, v63, v29
v_mfma_f32_16x16x32_bf16 v[92:95], v[168:171], v[220:223], v[92:95]
ds_read_b128 v[168:171], v25 offset:28672
v_cvt_pk_bf16_f32 v188, v56, v57
v_mfma_f32_16x16x32_bf16 v[92:95], v[172:175], v[236:239], v[92:95]
s_waitcnt lgkmcnt(4)
buffer_load_dwordx4 a[232:235], v1, s[12:15], s27 offen offset:2048 sc1
v_mfma_f32_16x16x32_bf16 v[96:99], v[176:179], v[208:211], v[96:99]
s_waitcnt lgkmcnt(3)
ds_read_b128 v[172:175], v25 offset:34816
v_cvt_pk_bf16_f32 v189, v58, v59
v_mfma_f32_16x16x32_bf16 v[96:99], v[180:183], v[224:227], v[96:99]
v_cvt_pk_bf16_f32 v190, v60, v61
v_cvt_pk_bf16_f32 v191, v62, v63
v_mfma_f32_16x16x32_bf16 v[100:103], v[176:179], v[212:215], v[100:103]
v_accvgpr_write_b32 a44, v188
v_accvgpr_write_b32 a45, v189
v_mfma_f32_16x16x32_bf16 v[100:103], v[180:183], v[228:231], v[100:103]
buffer_load_dwordx4 a[236:239], v1, s[12:15], s27 offen offset:3072 sc1
v_mfma_f32_16x16x32_bf16 v[104:107], v[176:179], v[216:219], v[104:107]
s_add_u32 s27, s27, 4096
v_accvgpr_write_b32 a46, v190
v_accvgpr_write_b32 a47, v191
v_mfma_f32_16x16x32_bf16 v[104:107], v[180:183], v[232:235], v[104:107]
v_accvgpr_read_b32 v48, a64
v_accvgpr_read_b32 v49, a65
v_mfma_f32_16x16x32_bf16 v[108:111], v[176:179], v[220:223], v[108:111]
ds_read_b128 v[176:179], v25 offset:29696
v_accvgpr_read_b32 v50, a66
v_mfma_f32_16x16x32_bf16 v[108:111], v[180:183], v[236:239], v[108:111]
s_waitcnt lgkmcnt(4)
buffer_store_dwordx4 a[40:43], v1, s[12:15], s34 offen offset:2048 sc1
v_mfma_f32_16x16x32_bf16 v[112:115], v[160:163], v[208:211], v[112:115]
s_waitcnt lgkmcnt(3)
ds_read_b128 v[180:183], v25 offset:35840
v_accvgpr_read_b32 v51, a67
v_mfma_f32_16x16x32_bf16 v[112:115], v[164:167], v[224:227], v[112:115]
v_accvgpr_read_b32 v52, a80
v_accvgpr_read_b32 v53, a81
v_mfma_f32_16x16x32_bf16 v[116:119], v[160:163], v[212:215], v[116:119]
v_accvgpr_read_b32 v54, a82
v_accvgpr_read_b32 v55, a83
v_mfma_f32_16x16x32_bf16 v[116:119], v[164:167], v[228:231], v[116:119]
buffer_load_dwordx4 a[240:243], v1, s[12:15], s27 offen offset:0 sc1
v_mfma_f32_16x16x32_bf16 v[120:123], v[160:163], v[216:219], v[120:123]
v_accvgpr_read_b32 v56, a68
v_accvgpr_read_b32 v57, a69
v_mfma_f32_16x16x32_bf16 v[120:123], v[164:167], v[232:235], v[120:123]
v_accvgpr_read_b32 v58, a70
v_accvgpr_read_b32 v59, a71
v_mfma_f32_16x16x32_bf16 v[124:127], v[160:163], v[220:223], v[124:127]
ds_read_b128 v[160:163], v25 offset:36864
v_accvgpr_read_b32 v60, a84
v_mfma_f32_16x16x32_bf16 v[124:127], v[164:167], v[236:239], v[124:127]
s_waitcnt lgkmcnt(4)
buffer_load_dwordx4 a[244:247], v1, s[12:15], s27 offen offset:1024 sc1
v_mfma_f32_16x16x32_bf16 v[128:131], v[168:171], v[208:211], v[128:131]
s_waitcnt lgkmcnt(3)
ds_read_b128 v[164:167], v25 offset:43008
v_accvgpr_read_b32 v61, a85
v_mfma_f32_16x16x32_bf16 v[128:131], v[172:175], v[224:227], v[128:131]
v_accvgpr_read_b32 v62, a86
v_accvgpr_read_b32 v63, a87
v_mfma_f32_16x16x32_bf16 v[132:135], v[168:171], v[212:215], v[132:135]
v_mul_f32 v48, v48, v26
v_mul_f32 v49, v49, v26
v_mfma_f32_16x16x32_bf16 v[132:135], v[172:175], v[228:231], v[132:135]
buffer_load_dwordx4 a[248:251], v1, s[12:15], s27 offen offset:2048 sc1
v_mfma_f32_16x16x32_bf16 v[136:139], v[168:171], v[216:219], v[136:139]
v_mul_f32 v50, v50, v26
v_mul_f32 v51, v51, v26
v_mfma_f32_16x16x32_bf16 v[136:139], v[172:175], v[232:235], v[136:139]
v_mul_f32 v52, v52, v26
v_mul_f32 v53, v53, v26
v_mfma_f32_16x16x32_bf16 v[140:143], v[168:171], v[220:223], v[140:143]
ds_read_b128 v[168:171], v25 offset:37888
v_mul_f32 v54, v54, v26
v_mfma_f32_16x16x32_bf16 v[140:143], v[172:175], v[236:239], v[140:143]
s_waitcnt lgkmcnt(4)
buffer_store_dwordx4 a[44:47], v1, s[12:15], s34 offen offset:3072 sc1
v_mfma_f32_16x16x32_bf16 v[144:147], v[176:179], v[208:211], v[144:147]
s_waitcnt lgkmcnt(3)
ds_read_b128 v[172:175], v25 offset:44032
v_mul_f32 v55, v55, v26
v_mfma_f32_16x16x32_bf16 v[144:147], v[180:183], v[224:227], v[144:147]
s_add_u32 s34, s34, 4096
v_mul_f32 v56, v56, v27
v_mul_f32 v57, v57, v27
v_mfma_f32_16x16x32_bf16 v[148:151], v[176:179], v[212:215], v[148:151]
v_mul_f32 v58, v58, v27
v_mul_f32 v59, v59, v27
v_mfma_f32_16x16x32_bf16 v[148:151], v[180:183], v[228:231], v[148:151]
buffer_load_dwordx4 a[252:255], v1, s[12:15], s27 offen offset:3072 sc1
v_mfma_f32_16x16x32_bf16 v[152:155], v[176:179], v[216:219], v[152:155]
s_add_u32 s27, s27, 4096
v_mul_f32 v60, v60, v27
v_mul_f32 v61, v61, v27
v_mfma_f32_16x16x32_bf16 v[152:155], v[180:183], v[232:235], v[152:155]
v_mul_f32 v62, v62, v27
v_mul_f32 v63, v63, v27
v_mfma_f32_16x16x32_bf16 v[156:159], v[176:179], v[220:223], v[156:159]
v_cvt_pk_bf16_f32 v192, v48, v49
v_cvt_pk_bf16_f32 v193, v50, v51
v_mfma_f32_16x16x32_bf16 v[156:159], v[180:183], v[236:239], v[156:159]
v_cvt_pk_bf16_f32 v194, v52, v53
v_cvt_pk_bf16_f32 v195, v54, v55
v_cvt_pk_bf16_f32 v196, v56, v57
v_cvt_pk_bf16_f32 v197, v58, v59
v_cvt_pk_bf16_f32 v198, v60, v61
v_cvt_pk_bf16_f32 v199, v62, v63
v_accvgpr_write_b32 a64, v192
v_accvgpr_write_b32 a65, v193
v_accvgpr_write_b32 a66, v194
v_accvgpr_write_b32 a67, v195
v_accvgpr_write_b32 a68, v196
v_accvgpr_write_b32 a69, v197
v_accvgpr_write_b32 a70, v198
v_accvgpr_write_b32 a71, v199
s_waitcnt vmcnt(25) lgkmcnt(3)
v_mfma_f32_16x16x32_bf16 v[64:67], v[160:163], a[192:195], v[64:67]
s_waitcnt vmcnt(17) lgkmcnt(2)
s_and_b32 s52, s30, 1
buffer_load_dwordx4 v[208:211], v1, s[12:15], s27 offen offset:0 sc1
v_mfma_f32_16x16x32_bf16 v[64:67], v[164:167], a[208:211], v[64:67]
s_lshl1_add_u32 s32, s48, s52
ds_read_b128 v[176:179], v25 offset:38912
v_accvgpr_read_b32 v48, a72
v_mfma_f32_16x16x32_bf16 v[68:71], v[160:163], a[196:199], v[68:71]
s_waitcnt vmcnt(17)
s_lshl2_add_u32 s32, s32, s47
ds_read_b128 v[180:183], v25 offset:45056
v_accvgpr_read_b32 v49, a73
v_mfma_f32_16x16x32_bf16 v[68:71], v[164:167], a[212:215], v[68:71]
s_lshl_b32 s32, s32, 7
v_accvgpr_read_b32 v50, a74
v_accvgpr_read_b32 v51, a75
v_mfma_f32_16x16x32_bf16 v[72:75], v[160:163], a[200:203], v[72:75]
s_waitcnt vmcnt(15)
s_mul_i32 s52, s52, 5120
buffer_store_dwordx4 a[64:67], v1, s[12:15], s34 offen offset:0 sc1
v_mfma_f32_16x16x32_bf16 v[72:75], v[164:167], a[216:219], v[72:75]
s_add_u32 s32, s32, 0x3a08000
v_accvgpr_read_b32 v52, a88
v_accvgpr_read_b32 v53, a89
v_mfma_f32_16x16x32_bf16 v[76:79], v[160:163], a[204:207], v[76:79]
s_waitcnt vmcnt(14)
s_add_u32 s52, s52, 110592
ds_read_b128 v[160:163], v25 offset:39936
v_accvgpr_read_b32 v54, a90
v_mfma_f32_16x16x32_bf16 v[76:79], v[164:167], a[220:223], v[76:79]
s_waitcnt lgkmcnt(4)
s_lshr_b32 s33, s30, 1
ds_read_b128 v[164:167], v25 offset:46080
v_add_u32 v32, s52, v1
v_mfma_f32_16x16x32_bf16 v[80:83], v[168:171], a[192:195], v[80:83]
s_waitcnt lgkmcnt(4)
s_lshl_b32 s33, s33, 12
buffer_load_dwordx4 v[212:215], v1, s[12:15], s27 offen offset:1024 sc1
v_mfma_f32_16x16x32_bf16 v[80:83], v[172:175], a[208:211], v[80:83]
s_add_u32 s33, s33, 131072
v_accvgpr_read_b32 v55, a91
v_mul_f32 v48, v48, v28
v_mfma_f32_16x16x32_bf16 v[84:87], v[168:171], a[196:199], v[84:87]
s_mov_b32 s41, s56
v_add_u32 v33, s33, v1
v_mul_f32 v49, v49, v28
v_mfma_f32_16x16x32_bf16 v[84:87], v[172:175], a[212:215], v[84:87]
s_and_b32 s33, s30, 1
v_mul_f32 v50, v50, v28
v_mul_f32 v51, v51, v28
v_mfma_f32_16x16x32_bf16 v[88:91], v[168:171], a[200:203], v[88:91]
s_lshl_b32 s33, s33, 12
buffer_load_dwordx4 v[216:219], v1, s[12:15], s27 offen offset:2048 sc1
v_mfma_f32_16x16x32_bf16 v[88:91], v[172:175], a[216:219], v[88:91]
v_add_u32 v35, s33, v1
v_mul_f32 v52, v52, v28
v_mfma_f32_16x16x32_bf16 v[92:95], v[168:171], a[204:207], v[92:95]
s_and_b32 s33, s28, 7
ds_read_b128 v[168:171], v25 offset:40960
v_mul_f32 v53, v53, v28
v_mfma_f32_16x16x32_bf16 v[92:95], v[172:175], a[220:223], v[92:95]
s_waitcnt lgkmcnt(4)
ds_read_b128 v[172:175], v25 offset:47104
v_mul_f32 v54, v54, v28
v_mfma_f32_16x16x32_bf16 v[96:99], v[176:179], a[192:195], v[96:99]
s_waitcnt lgkmcnt(4)
v_mul_f32 v55, v55, v28
v_cvt_pk_bf16_f32 v200, v48, v49
v_mfma_f32_16x16x32_bf16 v[96:99], v[180:183], a[208:211], v[96:99]
s_mul_i32 s52, s33, 61440
buffer_load_dwordx4 v[220:223], v1, s[12:15], s27 offen offset:3072 sc1
v_mfma_f32_16x16x32_bf16 v[100:103], v[176:179], a[196:199], v[100:103]
s_add_u32 s56, s56, s52
v_cvt_pk_bf16_f32 v201, v50, v51
v_cvt_pk_bf16_f32 v202, v52, v53
v_mfma_f32_16x16x32_bf16 v[100:103], v[180:183], a[212:215], v[100:103]
s_mul_i32 s52, s33, 24576
v_cvt_pk_bf16_f32 v203, v54, v55
v_accvgpr_write_b32 a72, v200
v_mfma_f32_16x16x32_bf16 v[104:107], v[176:179], a[200:203], v[104:107]
s_add_u32 s35, s56, 61440
v_accvgpr_write_b32 a73, v201
v_accvgpr_write_b32 a74, v202
v_mfma_f32_16x16x32_bf16 v[104:107], v[180:183], a[216:219], v[104:107]
s_add_u32 s60, s57, s52
buffer_store_dwordx4 a[68:71], v1, s[12:15], s34 offen offset:1024 sc1
v_mfma_f32_16x16x32_bf16 v[108:111], v[176:179], a[204:207], v[108:111]
s_add_u32 s21, s60, 24576
ds_read_b128 v[176:179], v25 offset:41984
v_accvgpr_write_b32 a75, v203
v_mfma_f32_16x16x32_bf16 v[108:111], v[180:183], a[220:223], v[108:111]
s_waitcnt lgkmcnt(4)
ds_read_b128 v[180:183], v25 offset:48128
v_add_u32 v25, 0xffff9000, v25
v_mfma_f32_16x16x32_bf16 v[112:115], v[160:163], a[192:195], v[112:115]
s_waitcnt lgkmcnt(4)
s_barrier
v_accvgpr_read_b32 v56, a76
v_accvgpr_read_b32 v57, a77
v_mfma_f32_16x16x32_bf16 v[112:115], v[164:167], a[208:211], v[112:115]
s_add_u32 s27, s27, 4096
v_accvgpr_read_b32 v58, a78
v_accvgpr_read_b32 v59, a79
v_mfma_f32_16x16x32_bf16 v[116:119], v[160:163], a[196:199], v[116:119]
s_mov_b32 s20, s56
buffer_load_dwordx4 v[224:227], v1, s[12:15], s27 offen offset:0 sc1
v_mfma_f32_16x16x32_bf16 v[116:119], v[164:167], a[212:215], v[116:119]
v_accvgpr_read_b32 v60, a92
v_accvgpr_read_b32 v61, a93
v_mfma_f32_16x16x32_bf16 v[120:123], v[160:163], a[200:203], v[120:123]
v_accvgpr_read_b32 v62, a94
v_accvgpr_read_b32 v63, a95
v_mfma_f32_16x16x32_bf16 v[120:123], v[164:167], a[216:219], v[120:123]
buffer_load_dwordx4 v[228:231], v1, s[12:15], s27 offen offset:1024 sc1
v_mfma_f32_16x16x32_bf16 v[124:127], v[160:163], a[204:207], v[124:127]
ds_read_b128 v[160:163], v25 offset:0
v_accvgpr_read_b32 v48, a96
v_mfma_f32_16x16x32_bf16 v[124:127], v[164:167], a[220:223], v[124:127]
s_waitcnt lgkmcnt(4)
ds_read_b128 v[164:167], v25 offset:6144
v_accvgpr_read_b32 v49, a97
v_mfma_f32_16x16x32_bf16 v[128:131], v[168:171], a[192:195], v[128:131]
s_waitcnt lgkmcnt(4)
v_accvgpr_read_b32 v50, a98
v_accvgpr_read_b32 v51, a99
v_mfma_f32_16x16x32_bf16 v[128:131], v[172:175], a[208:211], v[128:131]
v_accvgpr_read_b32 v52, a112
v_accvgpr_read_b32 v53, a113
v_mfma_f32_16x16x32_bf16 v[132:135], v[168:171], a[196:199], v[132:135]
buffer_load_dwordx4 v[232:235], v1, s[12:15], s27 offen offset:2048 sc1
v_mfma_f32_16x16x32_bf16 v[132:135], v[172:175], a[212:215], v[132:135]
v_accvgpr_read_b32 v54, a114
v_accvgpr_read_b32 v55, a115
v_mfma_f32_16x16x32_bf16 v[136:139], v[168:171], a[200:203], v[136:139]
v_mul_f32 v56, v56, v29
v_mul_f32 v57, v57, v29
v_mfma_f32_16x16x32_bf16 v[136:139], v[172:175], a[216:219], v[136:139]
v_mul_f32 v58, v58, v29
v_mul_f32 v59, v59, v29
v_mfma_f32_16x16x32_bf16 v[140:143], v[168:171], a[204:207], v[140:143]
buffer_store_dwordx4 a[72:75], v1, s[12:15], s34 offen offset:2048 sc1
v_mfma_f32_16x16x32_bf16 v[140:143], v[172:175], a[220:223], v[140:143]
s_waitcnt lgkmcnt(3)
ds_read_b128 v[168:171], v25 offset:1024
v_mul_f32 v60, v60, v29
v_mfma_f32_16x16x32_bf16 v[144:147], v[176:179], a[192:195], v[144:147]
s_waitcnt lgkmcnt(3)
ds_read_b128 v[172:175], v25 offset:7168
v_mul_f32 v61, v61, v29
v_mfma_f32_16x16x32_bf16 v[144:147], v[180:183], a[208:211], v[144:147]
v_mul_f32 v62, v62, v29
v_mul_f32 v63, v63, v29
v_mfma_f32_16x16x32_bf16 v[148:151], v[176:179], a[196:199], v[148:151]
buffer_load_dwordx4 v[236:239], v1, s[12:15], s27 offen offset:3072 sc1
v_mfma_f32_16x16x32_bf16 v[148:151], v[180:183], a[212:215], v[148:151]
s_add_u32 s27, s27, 4096
v_mul_f32 v48, v48, v26
v_mul_f32 v49, v49, v26
v_mfma_f32_16x16x32_bf16 v[152:155], v[176:179], a[200:203], v[152:155]
v_mul_f32 v50, v50, v26
v_mul_f32 v51, v51, v26
v_mfma_f32_16x16x32_bf16 v[152:155], v[180:183], a[216:219], v[152:155]
v_mul_f32 v52, v52, v26
v_mul_f32 v53, v53, v26
v_mfma_f32_16x16x32_bf16 v[156:159], v[176:179], a[204:207], v[156:159]
v_mul_f32 v54, v54, v26
v_mul_f32 v55, v55, v26
v_mfma_f32_16x16x32_bf16 v[156:159], v[180:183], a[220:223], v[156:159]
v_and_b32 v36, 32, v0
v_cvt_pk_bf16_f32 v204, v56, v57
v_cvt_pk_bf16_f32 v205, v58, v59
v_cvt_pk_bf16_f32 v206, v60, v61
v_cvt_pk_bf16_f32 v207, v62, v63
v_cvt_pk_bf16_f32 v184, v48, v49
v_cvt_pk_bf16_f32 v185, v50, v51
v_cvt_pk_bf16_f32 v186, v52, v53
v_cvt_pk_bf16_f32 v187, v54, v55
v_lshlrev_b32 v36, 4, v36
v_and_b32 v42, 7, v0
v_accvgpr_write_b32 a76, v204
v_accvgpr_write_b32 a77, v205
v_accvgpr_write_b32 a78, v206
v_accvgpr_write_b32 a79, v207
v_accvgpr_write_b32 a96, v184
v_accvgpr_write_b32 a97, v185
v_accvgpr_write_b32 a98, v186
v_accvgpr_write_b32 a99, v187
v_add_u32 v36, v36, v1
v_lshlrev_b32 v42, 2, v42
v_add_u32 v34, 110592, v1
s_waitcnt vmcnt(21) lgkmcnt(3)
v_mfma_f32_16x16x32_bf16 v[64:67], v[160:163], a[224:227], v[64:67]
s_waitcnt vmcnt(15) lgkmcnt(2)
s_mov_b32 s31, 0x3a21000
ds_read_b128 v[176:179], v25 offset:2048
v_accvgpr_read_b32 v56, a100
v_mfma_f32_16x16x32_bf16 v[64:67], v[164:167], a[240:243], v[64:67]
buffer_load_dwordx4 v[44:47], v1, s[12:15], s31 offen sc1
v_mfma_f32_16x16x32_bf16 v[68:71], v[160:163], a[228:231], v[68:71]
s_waitcnt vmcnt(15)
ds_read_b128 v[180:183], v25 offset:8192
v_accvgpr_read_b32 v57, a101
v_mfma_f32_16x16x32_bf16 v[68:71], v[164:167], a[244:247], v[68:71]
buffer_load_dwordx4 a[192:195], v1, s[12:15], s27 offen offset:0 sc1
v_mfma_f32_16x16x32_bf16 v[72:75], v[160:163], a[232:235], v[72:75]
s_waitcnt vmcnt(15)
v_accvgpr_read_b32 v58, a102
v_accvgpr_read_b32 v59, a103
v_mfma_f32_16x16x32_bf16 v[72:75], v[164:167], a[248:251], v[72:75]
v_accvgpr_read_b32 v60, a116
v_accvgpr_read_b32 v61, a117
v_mfma_f32_16x16x32_bf16 v[76:79], v[160:163], a[236:239], v[76:79]
s_waitcnt vmcnt(13)
ds_read_b128 v[160:163], v25 offset:3072
v_accvgpr_read_b32 v62, a118
v_mfma_f32_16x16x32_bf16 v[76:79], v[164:167], a[252:255], v[76:79]
s_waitcnt lgkmcnt(4)
buffer_store_dwordx4 a[76:79], v1, s[12:15], s34 offen offset:3072 sc1
v_mfma_f32_16x16x32_bf16 v[80:83], v[168:171], a[224:227], v[80:83]
s_waitcnt lgkmcnt(3)
s_add_u32 s34, s34, 4096
ds_read_b128 v[164:167], v25 offset:9216
v_accvgpr_read_b32 v63, a119
v_mfma_f32_16x16x32_bf16 v[80:83], v[172:175], a[240:243], v[80:83]
v_mul_f32 v56, v56, v27
v_mul_f32 v57, v57, v27
v_mfma_f32_16x16x32_bf16 v[84:87], v[168:171], a[228:231], v[84:87]
v_mul_f32 v58, v58, v27
v_mul_f32 v59, v59, v27
v_mfma_f32_16x16x32_bf16 v[84:87], v[172:175], a[244:247], v[84:87]
buffer_load_dwordx4 a[196:199], v1, s[12:15], s27 offen offset:1024 sc1
v_mfma_f32_16x16x32_bf16 v[88:91], v[168:171], a[232:235], v[88:91]
v_mul_f32 v60, v60, v27
v_mul_f32 v61, v61, v27
v_mfma_f32_16x16x32_bf16 v[88:91], v[172:175], a[248:251], v[88:91]
v_mul_f32 v62, v62, v27
v_mul_f32 v63, v63, v27
v_mfma_f32_16x16x32_bf16 v[92:95], v[168:171], a[236:239], v[92:95]
ds_read_b128 v[168:171], v25 offset:4096
v_cvt_pk_bf16_f32 v188, v56, v57
v_mfma_f32_16x16x32_bf16 v[92:95], v[172:175], a[252:255], v[92:95]
s_waitcnt lgkmcnt(4)
buffer_load_dwordx4 a[200:203], v1, s[12:15], s27 offen offset:2048 sc1
v_mfma_f32_16x16x32_bf16 v[96:99], v[176:179], a[224:227], v[96:99]
s_waitcnt lgkmcnt(3)
ds_read_b128 v[172:175], v25 offset:10240
v_cvt_pk_bf16_f32 v189, v58, v59
v_mfma_f32_16x16x32_bf16 v[96:99], v[180:183], a[240:243], v[96:99]
v_cvt_pk_bf16_f32 v190, v60, v61
v_cvt_pk_bf16_f32 v191, v62, v63
v_mfma_f32_16x16x32_bf16 v[100:103], v[176:179], a[228:231], v[100:103]
v_accvgpr_write_b32 a100, v188
v_accvgpr_write_b32 a101, v189
v_mfma_f32_16x16x32_bf16 v[100:103], v[180:183], a[244:247], v[100:103]
buffer_load_dwordx4 a[204:207], v1, s[12:15], s27 offen offset:3072 sc1
v_mfma_f32_16x16x32_bf16 v[104:107], v[176:179], a[232:235], v[104:107]
s_add_u32 s27, s27, 4096
v_accvgpr_write_b32 a102, v190
v_accvgpr_write_b32 a103, v191
v_mfma_f32_16x16x32_bf16 v[104:107], v[180:183], a[248:251], v[104:107]
v_accvgpr_read_b32 v48, a104
v_accvgpr_read_b32 v49, a105
v_mfma_f32_16x16x32_bf16 v[108:111], v[176:179], a[236:239], v[108:111]
ds_read_b128 v[176:179], v25 offset:5120
v_accvgpr_read_b32 v50, a106
v_mfma_f32_16x16x32_bf16 v[108:111], v[180:183], a[252:255], v[108:111]
s_waitcnt lgkmcnt(4)
buffer_store_dwordx4 a[96:99], v1, s[12:15], s34 offen offset:0 sc1
v_mfma_f32_16x16x32_bf16 v[112:115], v[160:163], a[224:227], v[112:115]
s_waitcnt lgkmcnt(3)
ds_read_b128 v[180:183], v25 offset:11264
v_accvgpr_read_b32 v51, a107
v_mfma_f32_16x16x32_bf16 v[112:115], v[164:167], a[240:243], v[112:115]
v_accvgpr_read_b32 v52, a120
v_accvgpr_read_b32 v53, a121
v_mfma_f32_16x16x32_bf16 v[116:119], v[160:163], a[228:231], v[116:119]
v_accvgpr_read_b32 v54, a122
v_accvgpr_read_b32 v55, a123
v_mfma_f32_16x16x32_bf16 v[116:119], v[164:167], a[244:247], v[116:119]
buffer_load_dwordx4 a[208:211], v1, s[12:15], s27 offen offset:0 sc1
v_mfma_f32_16x16x32_bf16 v[120:123], v[160:163], a[232:235], v[120:123]
v_accvgpr_read_b32 v56, a108
v_accvgpr_read_b32 v57, a109
v_mfma_f32_16x16x32_bf16 v[120:123], v[164:167], a[248:251], v[120:123]
v_accvgpr_read_b32 v58, a110
v_accvgpr_read_b32 v59, a111
v_mfma_f32_16x16x32_bf16 v[124:127], v[160:163], a[236:239], v[124:127]
ds_read_b128 v[160:163], v25 offset:12288
v_accvgpr_read_b32 v60, a124
v_mfma_f32_16x16x32_bf16 v[124:127], v[164:167], a[252:255], v[124:127]
s_waitcnt lgkmcnt(4)
buffer_load_dwordx4 a[212:215], v1, s[12:15], s27 offen offset:1024 sc1
v_mfma_f32_16x16x32_bf16 v[128:131], v[168:171], a[224:227], v[128:131]
s_waitcnt lgkmcnt(3)
ds_read_b128 v[164:167], v25 offset:18432
v_accvgpr_read_b32 v61, a125
v_mfma_f32_16x16x32_bf16 v[128:131], v[172:175], a[240:243], v[128:131]
v_accvgpr_read_b32 v62, a126
v_accvgpr_read_b32 v63, a127
v_mfma_f32_16x16x32_bf16 v[132:135], v[168:171], a[228:231], v[132:135]
v_mul_f32 v48, v48, v28
v_mul_f32 v49, v49, v28
v_mfma_f32_16x16x32_bf16 v[132:135], v[172:175], a[244:247], v[132:135]
buffer_load_dwordx4 a[216:219], v1, s[12:15], s27 offen offset:2048 sc1
v_mfma_f32_16x16x32_bf16 v[136:139], v[168:171], a[232:235], v[136:139]
v_mul_f32 v50, v50, v28
v_mul_f32 v51, v51, v28
v_mfma_f32_16x16x32_bf16 v[136:139], v[172:175], a[248:251], v[136:139]
v_mul_f32 v52, v52, v28
v_mul_f32 v53, v53, v28
v_mfma_f32_16x16x32_bf16 v[140:143], v[168:171], a[236:239], v[140:143]
ds_read_b128 v[168:171], v25 offset:13312
v_mul_f32 v54, v54, v28
v_mfma_f32_16x16x32_bf16 v[140:143], v[172:175], a[252:255], v[140:143]
s_waitcnt lgkmcnt(4)
buffer_store_dwordx4 a[100:103], v1, s[12:15], s34 offen offset:1024 sc1
v_mfma_f32_16x16x32_bf16 v[144:147], v[176:179], a[224:227], v[144:147]
s_waitcnt lgkmcnt(3)
ds_read_b128 v[172:175], v25 offset:19456
v_mul_f32 v55, v55, v28
v_mfma_f32_16x16x32_bf16 v[144:147], v[180:183], a[240:243], v[144:147]
v_mul_f32 v56, v56, v29
v_mul_f32 v57, v57, v29
v_mfma_f32_16x16x32_bf16 v[148:151], v[176:179], a[228:231], v[148:151]
v_mul_f32 v58, v58, v29
v_mul_f32 v59, v59, v29
v_mfma_f32_16x16x32_bf16 v[148:151], v[180:183], a[244:247], v[148:151]
buffer_load_dwordx4 a[220:223], v1, s[12:15], s27 offen offset:3072 sc1
v_mfma_f32_16x16x32_bf16 v[152:155], v[176:179], a[232:235], v[152:155]
s_add_u32 s27, s27, 4096
v_mul_f32 v60, v60, v29
v_mul_f32 v61, v61, v29
v_mfma_f32_16x16x32_bf16 v[152:155], v[180:183], a[248:251], v[152:155]
v_mul_f32 v62, v62, v29
v_mul_f32 v63, v63, v29
v_mfma_f32_16x16x32_bf16 v[156:159], v[176:179], a[236:239], v[156:159]
v_cvt_pk_bf16_f32 v192, v48, v49
v_cvt_pk_bf16_f32 v193, v50, v51
v_mfma_f32_16x16x32_bf16 v[156:159], v[180:183], a[252:255], v[156:159]
v_cvt_pk_bf16_f32 v194, v52, v53
v_cvt_pk_bf16_f32 v195, v54, v55
v_cvt_pk_bf16_f32 v196, v56, v57
v_cvt_pk_bf16_f32 v197, v58, v59
v_cvt_pk_bf16_f32 v198, v60, v61
v_cvt_pk_bf16_f32 v199, v62, v63
v_accvgpr_write_b32 a104, v192
v_accvgpr_write_b32 a105, v193
v_accvgpr_write_b32 a106, v194
v_accvgpr_write_b32 a107, v195
v_accvgpr_write_b32 a108, v196
v_accvgpr_write_b32 a109, v197
v_accvgpr_write_b32 a110, v198
v_accvgpr_write_b32 a111, v199
s_waitcnt vmcnt(22) lgkmcnt(3)
v_mfma_f32_16x16x32_bf16 v[64:67], v[160:163], v[208:211], v[64:67]
s_waitcnt vmcnt(16) lgkmcnt(2)
buffer_load_dwordx4 a[224:227], v1, s[12:15], s27 offen offset:0 sc1
v_mfma_f32_16x16x32_bf16 v[64:67], v[164:167], v[224:227], v[64:67]
ds_read_b128 v[176:179], v25 offset:14336
v_accvgpr_read_b32 v48, a128
v_mfma_f32_16x16x32_bf16 v[68:71], v[160:163], v[212:215], v[68:71]
s_waitcnt vmcnt(16)
ds_read_b128 v[180:183], v25 offset:20480
v_accvgpr_read_b32 v49, a129
v_mfma_f32_16x16x32_bf16 v[68:71], v[164:167], v[228:231], v[68:71]
v_accvgpr_read_b32 v50, a130
v_accvgpr_read_b32 v51, a131
v_mfma_f32_16x16x32_bf16 v[72:75], v[160:163], v[216:219], v[72:75]
s_waitcnt vmcnt(15)
buffer_store_dwordx4 a[104:107], v1, s[12:15], s34 offen offset:2048 sc1
v_mfma_f32_16x16x32_bf16 v[72:75], v[164:167], v[232:235], v[72:75]
v_accvgpr_read_b32 v52, a144
v_accvgpr_read_b32 v53, a145
v_mfma_f32_16x16x32_bf16 v[76:79], v[160:163], v[220:223], v[76:79]
s_waitcnt vmcnt(14)
ds_read_b128 v[160:163], v25 offset:15360
v_accvgpr_read_b32 v54, a146
v_mfma_f32_16x16x32_bf16 v[76:79], v[164:167], v[236:239], v[76:79]
s_waitcnt lgkmcnt(4)
ds_read_b128 v[164:167], v25 offset:21504
v_accvgpr_read_b32 v55, a147
v_mfma_f32_16x16x32_bf16 v[80:83], v[168:171], v[208:211], v[80:83]
s_waitcnt lgkmcnt(4)
buffer_load_dwordx4 a[228:231], v1, s[12:15], s27 offen offset:1024 sc1
v_mfma_f32_16x16x32_bf16 v[80:83], v[172:175], v[224:227], v[80:83]
v_mul_f32 v48, v48, v26
v_mul_f32 v49, v49, v26
v_mfma_f32_16x16x32_bf16 v[84:87], v[168:171], v[212:215], v[84:87]
v_mul_f32 v50, v50, v26
v_mul_f32 v51, v51, v26
v_mfma_f32_16x16x32_bf16 v[84:87], v[172:175], v[228:231], v[84:87]
v_mul_f32 v52, v52, v26
v_mul_f32 v53, v53, v26
v_mfma_f32_16x16x32_bf16 v[88:91], v[168:171], v[216:219], v[88:91]
buffer_load_dwordx4 a[232:235], v1, s[12:15], s27 offen offset:2048 sc1
v_mfma_f32_16x16x32_bf16 v[88:91], v[172:175], v[232:235], v[88:91]
v_mul_f32 v54, v54, v26
v_mul_f32 v55, v55, v26
v_mfma_f32_16x16x32_bf16 v[92:95], v[168:171], v[220:223], v[92:95]
ds_read_b128 v[168:171], v25 offset:16384
v_cvt_pk_bf16_f32 v200, v48, v49
v_mfma_f32_16x16x32_bf16 v[92:95], v[172:175], v[236:239], v[92:95]
s_waitcnt lgkmcnt(4)
ds_read_b128 v[172:175], v25 offset:22528
v_cvt_pk_bf16_f32 v201, v50, v51
v_mfma_f32_16x16x32_bf16 v[96:99], v[176:179], v[208:211], v[96:99]
s_waitcnt lgkmcnt(4)
v_cvt_pk_bf16_f32 v202, v52, v53
v_cvt_pk_bf16_f32 v203, v54, v55
v_mfma_f32_16x16x32_bf16 v[96:99], v[180:183], v[224:227], v[96:99]
buffer_load_dwordx4 a[236:239], v1, s[12:15], s27 offen offset:3072 sc1
v_mfma_f32_16x16x32_bf16 v[100:103], v[176:179], v[212:215], v[100:103]
v_accvgpr_write_b32 a128, v200
v_accvgpr_write_b32 a129, v201
v_mfma_f32_16x16x32_bf16 v[100:103], v[180:183], v[228:231], v[100:103]
v_accvgpr_write_b32 a130, v202
v_accvgpr_write_b32 a131, v203
v_mfma_f32_16x16x32_bf16 v[104:107], v[176:179], v[216:219], v[104:107]
v_accvgpr_read_b32 v56, a132
v_accvgpr_read_b32 v57, a133
v_mfma_f32_16x16x32_bf16 v[104:107], v[180:183], v[232:235], v[104:107]
buffer_store_dwordx4 a[108:111], v1, s[12:15], s34 offen offset:3072 sc1
v_mfma_f32_16x16x32_bf16 v[108:111], v[176:179], v[220:223], v[108:111]
s_add_u32 s34, s34, 4096
ds_read_b128 v[176:179], v25 offset:17408
v_accvgpr_read_b32 v58, a134
v_mfma_f32_16x16x32_bf16 v[108:111], v[180:183], v[236:239], v[108:111]
s_waitcnt lgkmcnt(4)
ds_read_b128 v[180:183], v25 offset:23552
v_add_u32 v25, 0xfffeb000, v25
v_mfma_f32_16x16x32_bf16 v[112:115], v[160:163], v[208:211], v[112:115]
s_waitcnt lgkmcnt(4)
v_accvgpr_read_b32 v59, a135
v_accvgpr_read_b32 v60, a148
v_mfma_f32_16x16x32_bf16 v[112:115], v[164:167], v[224:227], v[112:115]
s_add_u32 s27, s27, 4096
v_accvgpr_read_b32 v61, a149
v_accvgpr_read_b32 v62, a150
v_mfma_f32_16x16x32_bf16 v[116:119], v[160:163], v[212:215], v[116:119]
buffer_load_dwordx4 a[240:243], v1, s[12:15], s27 offen offset:0 sc1
v_mfma_f32_16x16x32_bf16 v[116:119], v[164:167], v[228:231], v[116:119]
v_accvgpr_read_b32 v63, a151
v_accvgpr_read_b32 v48, a136
v_mfma_f32_16x16x32_bf16 v[120:123], v[160:163], v[216:219], v[120:123]
v_accvgpr_read_b32 v49, a137
v_accvgpr_read_b32 v50, a138
v_mfma_f32_16x16x32_bf16 v[120:123], v[164:167], v[232:235], v[120:123]
buffer_load_dwordx4 a[244:247], v1, s[12:15], s27 offen offset:1024 sc1
v_mfma_f32_16x16x32_bf16 v[124:127], v[160:163], v[220:223], v[124:127]
s_waitcnt lgkmcnt(0)
s_barrier
v_accvgpr_read_b32 v51, a139
v_accvgpr_read_b32 v52, a152
v_mfma_f32_16x16x32_bf16 v[124:127], v[164:167], v[236:239], v[124:127]
ds_read_b128 v[160:163], v25 offset:0
v_accvgpr_read_b32 v53, a153
v_mfma_f32_16x16x32_bf16 v[128:131], v[168:171], v[208:211], v[128:131]
ds_read_b128 v[164:167], v25 offset:6144
v_accvgpr_read_b32 v54, a154
v_mfma_f32_16x16x32_bf16 v[128:131], v[172:175], v[224:227], v[128:131]
v_accvgpr_read_b32 v55, a155
v_mul_f32 v56, v56, v27
v_mfma_f32_16x16x32_bf16 v[132:135], v[168:171], v[212:215], v[132:135]
buffer_load_dwordx4 a[248:251], v1, s[12:15], s27 offen offset:2048 sc1
v_mfma_f32_16x16x32_bf16 v[132:135], v[172:175], v[228:231], v[132:135]
v_mul_f32 v57, v57, v27
v_mul_f32 v58, v58, v27
v_mfma_f32_16x16x32_bf16 v[136:139], v[168:171], v[216:219], v[136:139]
v_mul_f32 v59, v59, v27
v_mul_f32 v60, v60, v27
v_mfma_f32_16x16x32_bf16 v[136:139], v[172:175], v[232:235], v[136:139]
v_mul_f32 v61, v61, v27
v_mul_f32 v62, v62, v27
v_mfma_f32_16x16x32_bf16 v[140:143], v[168:171], v[220:223], v[140:143]
buffer_store_dwordx4 a[128:131], v1, s[12:15], s34 offen offset:0 sc1
v_mfma_f32_16x16x32_bf16 v[140:143], v[172:175], v[236:239], v[140:143]
ds_read_b128 v[168:171], v25 offset:1024
v_mul_f32 v63, v63, v27
v_mfma_f32_16x16x32_bf16 v[144:147], v[176:179], v[208:211], v[144:147]
ds_read_b128 v[172:175], v25 offset:7168
v_mul_f32 v48, v48, v28
v_mfma_f32_16x16x32_bf16 v[144:147], v[180:183], v[224:227], v[144:147]
v_mul_f32 v49, v49, v28
v_mul_f32 v50, v50, v28
v_mfma_f32_16x16x32_bf16 v[148:151], v[176:179], v[212:215], v[148:151]
buffer_load_dwordx4 a[252:255], v1, s[12:15], s27 offen offset:3072 sc1
v_mfma_f32_16x16x32_bf16 v[148:151], v[180:183], v[228:231], v[148:151]
s_add_u32 s27, s27, 4096
v_mul_f32 v51, v51, v28
v_mul_f32 v52, v52, v28
v_mfma_f32_16x16x32_bf16 v[152:155], v[176:179], v[216:219], v[152:155]
v_mul_f32 v53, v53, v28
v_mul_f32 v54, v54, v28
v_mfma_f32_16x16x32_bf16 v[152:155], v[180:183], v[232:235], v[152:155]
v_mul_f32 v55, v55, v28
v_cvt_pk_bf16_f32 v204, v56, v57
v_mfma_f32_16x16x32_bf16 v[156:159], v[176:179], v[220:223], v[156:159]
v_cvt_pk_bf16_f32 v205, v58, v59
v_cvt_pk_bf16_f32 v206, v60, v61
v_mfma_f32_16x16x32_bf16 v[156:159], v[180:183], v[236:239], v[156:159]
v_cvt_pk_bf16_f32 v207, v62, v63
v_cvt_pk_bf16_f32 v184, v48, v49
v_cvt_pk_bf16_f32 v185, v50, v51
v_cvt_pk_bf16_f32 v186, v52, v53
v_cvt_pk_bf16_f32 v187, v54, v55
v_accvgpr_write_b32 a132, v204
v_accvgpr_write_b32 a133, v205
v_accvgpr_write_b32 a134, v206
v_accvgpr_write_b32 a135, v207
v_accvgpr_write_b32 a136, v184
v_accvgpr_write_b32 a137, v185
v_accvgpr_write_b32 a138, v186
v_accvgpr_write_b32 a139, v187
s_waitcnt vmcnt(22)
v_xor_b32 v44, s40, v44
v_xor_b32 v45, s40, v45
v_xor_b32 v46, s40, v46
v_xor_b32 v47, s40, v47
v_or3_b32 v44, v44, v45, v46
v_or_b32 v44, v44, v47
v_cmp_ne_u32 vcc, 0, v44
s_nop 1
s_cbranch_vccnz L_spin_w
L_back_w:
s_lshr_b32 s33, s30, 1
s_xor_b32 s33, s33, s48
s_bitcmp1_b32 s33, 0
s_cbranch_scc1 L_ow0
v_add_u32 v38, 131072, v35
ds_write_b128 v38, a[0:3] offset:0
ds_write_b128 v38, a[4:7] offset:1024
ds_write_b128 v38, a[8:11] offset:2048
ds_write_b128 v38, a[12:15] offset:3072
ds_write_b128 v38, a[32:35] offset:8192
ds_write_b128 v38, a[36:39] offset:9216
ds_write_b128 v38, a[40:43] offset:10240
ds_write_b128 v38, a[44:47] offset:11264
s_waitcnt lgkmcnt(0)
L_ow0:
s_waitcnt vmcnt(21) lgkmcnt(3)
v_mfma_f32_16x16x32_bf16 v[64:67], v[160:163], a[192:195], v[64:67]
s_waitcnt vmcnt(15) lgkmcnt(2)
s_add_u32 m0, s58, 110592
buffer_load_dwordx4 v[208:211], v1, s[12:15], s27 offen offset:0 sc1
v_mfma_f32_16x16x32_bf16 v[64:67], v[164:167], a[208:211], v[64:67]
ds_read_b128 v[176:179], v25 offset:2048
v_accvgpr_read_b32 v56, a140
v_mfma_f32_16x16x32_bf16 v[68:71], v[160:163], a[196:199], v[68:71]
s_waitcnt vmcnt(15)
buffer_load_dwordx4 v1, s[12:15], s56 offen offset:0 sc1 lds
v_mfma_f32_16x16x32_bf16 v[68:71], v[164:167], a[212:215], v[68:71]
ds_read_b128 v[180:183], v25 offset:8192
v_accvgpr_read_b32 v57, a141
v_mfma_f32_16x16x32_bf16 v[72:75], v[160:163], a[200:203], v[72:75]
s_waitcnt vmcnt(15)
global_load_dword v30, v1, s[62:63]
v_mfma_f32_16x16x32_bf16 v[72:75], v[164:167], a[216:219], v[72:75]
s_add_u32 s62, s62, 0x2000
v_accvgpr_read_b32 v58, a142
v_accvgpr_read_b32 v59, a143
v_mfma_f32_16x16x32_bf16 v[76:79], v[160:163], a[204:207], v[76:79]
s_waitcnt vmcnt(14)
s_addc_u32 s63, s63, 0
buffer_store_dwordx4 a[132:135], v1, s[12:15], s34 offen offset:1024 sc1
v_mfma_f32_16x16x32_bf16 v[76:79], v[164:167], a[220:223], v[76:79]
s_waitcnt lgkmcnt(3)
ds_read_b128 v[160:163], v25 offset:3072
v_accvgpr_read_b32 v60, a156
v_mfma_f32_16x16x32_bf16 v[80:83], v[168:171], a[192:195], v[80:83]
s_waitcnt lgkmcnt(3)
buffer_load_dwordx4 v[212:215], v1, s[12:15], s27 offen offset:1024 sc1
v_mfma_f32_16x16x32_bf16 v[80:83], v[172:175], a[208:211], v[80:83]
ds_read_b128 v[164:167], v25 offset:9216
v_accvgpr_read_b32 v61, a157
v_mfma_f32_16x16x32_bf16 v[84:87], v[168:171], a[196:199], v[84:87]
v_accvgpr_read_b32 v62, a158
v_accvgpr_read_b32 v63, a159
v_mfma_f32_16x16x32_bf16 v[84:87], v[172:175], a[212:215], v[84:87]
buffer_load_dwordx4 v1, s[12:15], s56 offen offset:1024 sc1 lds
v_mfma_f32_16x16x32_bf16 v[88:91], v[168:171], a[200:203], v[88:91]
v_mul_f32 v56, v56, v29
v_mul_f32 v57, v57, v29
v_mfma_f32_16x16x32_bf16 v[88:91], v[172:175], a[216:219], v[88:91]
v_mul_f32 v58, v58, v29
v_mul_f32 v59, v59, v29
v_mfma_f32_16x16x32_bf16 v[92:95], v[168:171], a[204:207], v[92:95]
buffer_load_dwordx4 v[216:219], v1, s[12:15], s27 offen offset:2048 sc1
v_mfma_f32_16x16x32_bf16 v[92:95], v[172:175], a[220:223], v[92:95]
s_waitcnt lgkmcnt(3)
ds_read_b128 v[168:171], v25 offset:4096
v_mul_f32 v60, v60, v29
v_mfma_f32_16x16x32_bf16 v[96:99], v[176:179], a[192:195], v[96:99]
s_waitcnt lgkmcnt(3)
ds_read_b128 v[172:175], v25 offset:10240
v_mul_f32 v61, v61, v29
v_mfma_f32_16x16x32_bf16 v[96:99], v[180:183], a[208:211], v[96:99]
buffer_load_dwordx4 v[220:223], v1, s[12:15], s27 offen offset:3072 sc1
v_mfma_f32_16x16x32_bf16 v[100:103], v[176:179], a[196:199], v[100:103]
s_add_u32 s27, s27, 4096
v_mul_f32 v62, v62, v29
v_mul_f32 v63, v63, v29
v_mfma_f32_16x16x32_bf16 v[100:103], v[180:183], a[212:215], v[100:103]
v_cvt_pk_bf16_f32 v188, v56, v57
v_cvt_pk_bf16_f32 v189, v58, v59
v_mfma_f32_16x16x32_bf16 v[104:107], v[176:179], a[200:203], v[104:107]
buffer_load_dwordx4 v1, s[12:15], s56 offen offset:2048 sc1 lds
v_mfma_f32_16x16x32_bf16 v[104:107], v[180:183], a[216:219], v[104:107]
v_cvt_pk_bf16_f32 v190, v60, v61
v_cvt_pk_bf16_f32 v191, v62, v63
v_mfma_f32_16x16x32_bf16 v[108:111], v[176:179], a[204:207], v[108:111]
ds_read_b128 v[176:179], v25 offset:5120
v_accvgpr_write_b32 a140, v188
v_mfma_f32_16x16x32_bf16 v[108:111], v[180:183], a[220:223], v[108:111]
s_waitcnt lgkmcnt(4)
buffer_store_dwordx4 a[136:139], v1, s[12:15], s34 offen offset:2048 sc1
v_mfma_f32_16x16x32_bf16 v[112:115], v[160:163], a[192:195], v[112:115]
s_waitcnt lgkmcnt(3)
ds_read_b128 v[180:183], v25 offset:11264
v_accvgpr_write_b32 a141, v189
v_mfma_f32_16x16x32_bf16 v[112:115], v[164:167], a[208:211], v[112:115]
v_accvgpr_write_b32 a142, v190
v_accvgpr_write_b32 a143, v191
v_mfma_f32_16x16x32_bf16 v[116:119], v[160:163], a[196:199], v[116:119]
buffer_load_dwordx4 v[224:227], v1, s[12:15], s27 offen offset:0 sc1
v_mfma_f32_16x16x32_bf16 v[116:119], v[164:167], a[212:215], v[116:119]
v_accvgpr_read_b32 v48, a160
v_accvgpr_read_b32 v49, a161
v_mfma_f32_16x16x32_bf16 v[120:123], v[160:163], a[200:203], v[120:123]
v_accvgpr_read_b32 v50, a162
v_accvgpr_read_b32 v51, a163
v_mfma_f32_16x16x32_bf16 v[120:123], v[164:167], a[216:219], v[120:123]
buffer_load_dwordx4 v[228:231], v1, s[12:15], s27 offen offset:1024 sc1
v_mfma_f32_16x16x32_bf16 v[124:127], v[160:163], a[204:207], v[124:127]
ds_read_b128 v[160:163], v25 offset:12288
v_accvgpr_read_b32 v52, a176
v_mfma_f32_16x16x32_bf16 v[124:127], v[164:167], a[220:223], v[124:127]
s_waitcnt lgkmcnt(4)
ds_read_b128 v[164:167], v25 offset:18432
v_accvgpr_read_b32 v53, a177
v_mfma_f32_16x16x32_bf16 v[128:131], v[168:171], a[192:195], v[128:131]
s_waitcnt lgkmcnt(4)
buffer_load_dwordx4 v1, s[12:15], s56 offen offset:3072 sc1 lds
v_mfma_f32_16x16x32_bf16 v[128:131], v[172:175], a[208:211], v[128:131]
v_accvgpr_read_b32 v54, a178
v_accvgpr_read_b32 v55, a179
v_mfma_f32_16x16x32_bf16 v[132:135], v[168:171], a[196:199], v[132:135]
v_accvgpr_read_b32 v56, a164
v_accvgpr_read_b32 v57, a165
v_mfma_f32_16x16x32_bf16 v[132:135], v[172:175], a[212:215], v[132:135]
buffer_load_dwordx4 v[232:235], v1, s[12:15], s27 offen offset:2048 sc1
v_mfma_f32_16x16x32_bf16 v[136:139], v[168:171], a[200:203], v[136:139]
v_accvgpr_read_b32 v58, a166
v_accvgpr_read_b32 v59, a167
v_mfma_f32_16x16x32_bf16 v[136:139], v[172:175], a[216:219], v[136:139]
v_accvgpr_read_b32 v60, a180
v_accvgpr_read_b32 v61, a181
v_mfma_f32_16x16x32_bf16 v[140:143], v[168:171], a[204:207], v[140:143]
buffer_store_dwordx4 a[140:143], v1, s[12:15], s34 offen offset:3072 sc1
v_mfma_f32_16x16x32_bf16 v[140:143], v[172:175], a[220:223], v[140:143]
s_waitcnt lgkmcnt(3)
ds_read_b128 v[168:171], v25 offset:13312
v_accvgpr_read_b32 v62, a182
v_mfma_f32_16x16x32_bf16 v[144:147], v[176:179], a[192:195], v[144:147]
s_waitcnt lgkmcnt(3)
ds_read_b128 v[172:175], v25 offset:19456
v_accvgpr_read_b32 v63, a183
v_mfma_f32_16x16x32_bf16 v[144:147], v[180:183], a[208:211], v[144:147]
s_add_u32 s34, s34, 4096
v_mul_f32 v48, v48, v26
v_mul_f32 v49, v49, v26
v_mfma_f32_16x16x32_bf16 v[148:151], v[176:179], a[196:199], v[148:151]
s_add_u32 m0, s58, 114688
v_mul_f32 v50, v50, v26
v_mul_f32 v51, v51, v26
v_mfma_f32_16x16x32_bf16 v[148:151], v[180:183], a[212:215], v[148:151]
s_add_u32 s56, s56, 4096
v_mul_f32 v52, v52, v26
v_mul_f32 v53, v53, v26
v_mfma_f32_16x16x32_bf16 v[152:155], v[176:179], a[200:203], v[152:155]
buffer_load_dwordx4 v1, s[12:15], s56 offen offset:0 sc1 lds
v_mfma_f32_16x16x32_bf16 v[152:155], v[180:183], a[216:219], v[152:155]
s_add_u32 s56, s56, 16384
v_mul_f32 v54, v54, v26
v_mul_f32 v55, v55, v26
v_mfma_f32_16x16x32_bf16 v[156:159], v[176:179], a[204:207], v[156:159]
buffer_load_dwordx4 v[236:239], v1, s[12:15], s27 offen offset:3072 sc1
v_mfma_f32_16x16x32_bf16 v[156:159], v[180:183], a[220:223], v[156:159]
v_mul_f32 v56, v56, v27
v_mul_f32 v57, v57, v27
v_mul_f32 v58, v58, v27
v_mul_f32 v59, v59, v27
v_mul_f32 v60, v60, v27
v_mul_f32 v61, v61, v27
v_mul_f32 v62, v62, v27
v_mul_f32 v63, v63, v27
v_cvt_pk_bf16_f32 v192, v48, v49
v_cvt_pk_bf16_f32 v193, v50, v51
v_cvt_pk_bf16_f32 v194, v52, v53
v_cvt_pk_bf16_f32 v195, v54, v55
v_cvt_pk_bf16_f32 v196, v56, v57
v_cvt_pk_bf16_f32 v197, v58, v59
v_cvt_pk_bf16_f32 v198, v60, v61
v_cvt_pk_bf16_f32 v199, v62, v63
v_accvgpr_write_b32 a160, v192
v_accvgpr_write_b32 a161, v193
v_accvgpr_write_b32 a162, v194
v_accvgpr_write_b32 a163, v195
v_accvgpr_write_b32 a164, v196
v_accvgpr_write_b32 a165, v197
v_accvgpr_write_b32 a166, v198
v_accvgpr_write_b32 a167, v199
s_add_u32 s27, s27, 4096
s_lshr_b32 s33, s30, 1
s_xor_b32 s33, s33, s48
s_bitcmp1_b32 s33, 0
s_cbranch_scc1 L_ow1
v_add_u32 v38, 94208, v35
ds_write_b128 v38, a[64:67] offset:0
ds_write_b128 v38, a[68:71] offset:1024
ds_write_b128 v38, a[72:75] offset:2048
ds_write_b128 v38, a[76:79] offset:3072
ds_write_b128 v38, a[96:99] offset:8192
ds_write_b128 v38, a[100:103] offset:9216
ds_write_b128 v38, a[104:107] offset:10240
ds_write_b128 v38, a[108:111] offset:11264
s_waitcnt lgkmcnt(0)
L_ow1:
s_waitcnt vmcnt(27) lgkmcnt(3)
v_mfma_f32_16x16x32_bf16 v[64:67], v[160:163], a[224:227], v[64:67]
s_waitcnt vmcnt(21) lgkmcnt(2)
buffer_load_dwordx4 a[192:195], v1, s[12:15], s27 offen offset:0 sc1
v_mfma_f32_16x16x32_bf16 v[64:67], v[164:167], a[240:243], v[64:67]
ds_read_b128 v[176:179], v25 offset:14336
v_accvgpr_read_b32 v48, a168
v_mfma_f32_16x16x32_bf16 v[68:71], v[160:163], a[228:231], v[68:71]
s_waitcnt vmcnt(21)
ds_read_b128 v[180:183], v25 offset:20480
v_accvgpr_read_b32 v49, a169
v_mfma_f32_16x16x32_bf16 v[68:71], v[164:167], a[244:247], v[68:71]
buffer_load_dwordx4 a[196:199], v1, s[12:15], s27 offen offset:1024 sc1
v_mfma_f32_16x16x32_bf16 v[72:75], v[160:163], a[232:235], v[72:75]
s_waitcnt vmcnt(21)
v_accvgpr_read_b32 v50, a170
v_accvgpr_read_b32 v51, a171
v_mfma_f32_16x16x32_bf16 v[72:75], v[164:167], a[248:251], v[72:75]
v_accvgpr_read_b32 v52, a184
v_accvgpr_read_b32 v53, a185
v_mfma_f32_16x16x32_bf16 v[76:79], v[160:163], a[236:239], v[76:79]
s_waitcnt vmcnt(19)
ds_read_b128 v[160:163], v25 offset:15360
v_accvgpr_read_b32 v54, a186
v_mfma_f32_16x16x32_bf16 v[76:79], v[164:167], a[252:255], v[76:79]
s_waitcnt lgkmcnt(4)
buffer_load_dwordx4 a[200:203], v1, s[12:15], s27 offen offset:2048 sc1
v_mfma_f32_16x16x32_bf16 v[80:83], v[168:171], a[224:227], v[80:83]
s_waitcnt lgkmcnt(3)
ds_read_b128 v[164:167], v25 offset:21504
v_accvgpr_read_b32 v55, a187
v_mfma_f32_16x16x32_bf16 v[80:83], v[172:175], a[240:243], v[80:83]
v_mul_f32 v48, v48, v28
v_mul_f32 v49, v49, v28
v_mfma_f32_16x16x32_bf16 v[84:87], v[168:171], a[228:231], v[84:87]
v_mul_f32 v50, v50, v28
v_mul_f32 v51, v51, v28
v_mfma_f32_16x16x32_bf16 v[84:87], v[172:175], a[244:247], v[84:87]
buffer_load_dwordx4 a[204:207], v1, s[12:15], s27 offen offset:3072 sc1
v_mfma_f32_16x16x32_bf16 v[88:91], v[168:171], a[232:235], v[88:91]
s_add_u32 s27, s27, 4096
v_mul_f32 v52, v52, v28
v_mul_f32 v53, v53, v28
v_mfma_f32_16x16x32_bf16 v[88:91], v[172:175], a[248:251], v[88:91]
v_mul_f32 v54, v54, v28
v_mul_f32 v55, v55, v28
v_mfma_f32_16x16x32_bf16 v[92:95], v[168:171], a[236:239], v[92:95]
ds_read_b128 v[168:171], v25 offset:16384
v_cvt_pk_bf16_f32 v200, v48, v49
v_mfma_f32_16x16x32_bf16 v[92:95], v[172:175], a[252:255], v[92:95]
s_waitcnt lgkmcnt(4)
buffer_load_dwordx4 a[208:211], v1, s[12:15], s27 offen offset:0 sc1
v_mfma_f32_16x16x32_bf16 v[96:99], v[176:179], a[224:227], v[96:99]
s_waitcnt lgkmcnt(3)
ds_read_b128 v[172:175], v25 offset:22528
v_cvt_pk_bf16_f32 v201, v50, v51
v_mfma_f32_16x16x32_bf16 v[96:99], v[180:183], a[240:243], v[96:99]
v_cvt_pk_bf16_f32 v202, v52, v53
v_cvt_pk_bf16_f32 v203, v54, v55
v_mfma_f32_16x16x32_bf16 v[100:103], v[176:179], a[228:231], v[100:103]
v_accvgpr_write_b32 a168, v200
v_accvgpr_write_b32 a169, v201
v_mfma_f32_16x16x32_bf16 v[100:103], v[180:183], a[244:247], v[100:103]
buffer_load_dwordx4 a[212:215], v1, s[12:15], s27 offen offset:1024 sc1
v_mfma_f32_16x16x32_bf16 v[104:107], v[176:179], a[232:235], v[104:107]
v_accvgpr_write_b32 a170, v202
v_accvgpr_write_b32 a171, v203
v_mfma_f32_16x16x32_bf16 v[104:107], v[180:183], a[248:251], v[104:107]
v_accvgpr_read_b32 v56, a172
v_accvgpr_read_b32 v57, a173
v_mfma_f32_16x16x32_bf16 v[108:111], v[176:179], a[236:239], v[108:111]
ds_read_b128 v[176:179], v25 offset:17408
v_accvgpr_read_b32 v58, a174
v_mfma_f32_16x16x32_bf16 v[108:111], v[180:183], a[252:255], v[108:111]
s_waitcnt lgkmcnt(4)
buffer_load_dwordx4 a[216:219], v1, s[12:15], s27 offen offset:2048 sc1
v_mfma_f32_16x16x32_bf16 v[112:115], v[160:163], a[224:227], v[112:115]
s_waitcnt lgkmcnt(3)
ds_read_b128 v[180:183], v25 offset:23552
v_accvgpr_read_b32 v59, a175
v_mfma_f32_16x16x32_bf16 v[112:115], v[164:167], a[240:243], v[112:115]
v_accvgpr_read_b32 v60, a188
v_accvgpr_read_b32 v61, a189
v_mfma_f32_16x16x32_bf16 v[116:119], v[160:163], a[228:231], v[116:119]
v_accvgpr_read_b32 v62, a190
v_accvgpr_read_b32 v63, a191
v_mfma_f32_16x16x32_bf16 v[116:119], v[164:167], a[244:247], v[116:119]
buffer_load_dwordx4 a[220:223], v1, s[12:15], s27 offen offset:3072 sc1
v_mfma_f32_16x16x32_bf16 v[120:123], v[160:163], a[232:235], v[120:123]
s_add_u32 s27, s27, 4096
v_mul_f32 v56, v56, v29
v_mul_f32 v57, v57, v29
v_mfma_f32_16x16x32_bf16 v[120:123], v[164:167], a[248:251], v[120:123]
v_mul_f32 v58, v58, v29
v_mul_f32 v59, v59, v29
v_mfma_f32_16x16x32_bf16 v[124:127], v[160:163], a[236:239], v[124:127]
s_waitcnt lgkmcnt(0)
s_barrier
v_mul_f32 v60, v60, v29
v_mul_f32 v61, v61, v29
v_mfma_f32_16x16x32_bf16 v[124:127], v[164:167], a[252:255], v[124:127]
buffer_store_dwordx4 a[160:163], v1, s[12:15], s34 offen offset:0 sc1
v_mfma_f32_16x16x32_bf16 v[128:131], v[168:171], a[224:227], v[128:131]
v_mul_f32 v62, v62, v29
v_mul_f32 v63, v63, v29
v_mfma_f32_16x16x32_bf16 v[128:131], v[172:175], a[240:243], v[128:131]
v_cvt_pk_bf16_f32 v204, v56, v57
v_cvt_pk_bf16_f32 v205, v58, v59
v_mfma_f32_16x16x32_bf16 v[132:135], v[168:171], a[228:231], v[132:135]
v_cvt_pk_bf16_f32 v206, v60, v61
v_cvt_pk_bf16_f32 v207, v62, v63
v_mfma_f32_16x16x32_bf16 v[132:135], v[172:175], a[244:247], v[132:135]
buffer_store_dwordx4 a[164:167], v1, s[12:15], s34 offen offset:1024 sc1
v_mfma_f32_16x16x32_bf16 v[136:139], v[168:171], a[232:235], v[136:139]
v_accvgpr_write_b32 a172, v204
v_accvgpr_write_b32 a173, v205
v_mfma_f32_16x16x32_bf16 v[136:139], v[172:175], a[248:251], v[136:139]
v_accvgpr_write_b32 a174, v206
v_accvgpr_write_b32 a175, v207
v_mfma_f32_16x16x32_bf16 v[140:143], v[168:171], a[236:239], v[140:143]
ds_read_b128 v[160:163], v25 offset:36864
v_mfma_f32_16x16x32_bf16 v[140:143], v[172:175], a[252:255], v[140:143]
buffer_store_dwordx4 a[168:171], v1, s[12:15], s34 offen offset:2048 sc1
v_mfma_f32_16x16x32_bf16 v[144:147], v[176:179], a[224:227], v[144:147]
ds_read_b128 v[164:167], v25 offset:43008
v_mfma_f32_16x16x32_bf16 v[144:147], v[180:183], a[240:243], v[144:147]
ds_read_b128 v[168:171], v25 offset:49152
v_mfma_f32_16x16x32_bf16 v[148:151], v[176:179], a[228:231], v[148:151]
ds_read_b128 v[172:175], v25 offset:55296
v_mfma_f32_16x16x32_bf16 v[148:151], v[180:183], a[244:247], v[148:151]
buffer_store_dwordx4 a[172:175], v1, s[12:15], s34 offen offset:3072 sc1
v_mfma_f32_16x16x32_bf16 v[152:155], v[176:179], a[232:235], v[152:155]
s_add_u32 s34, s34, 4096
v_mfma_f32_16x16x32_bf16 v[152:155], v[180:183], a[248:251], v[152:155]
v_mfma_f32_16x16x32_bf16 v[156:159], v[176:179], a[236:239], v[156:159]
v_mfma_f32_16x16x32_bf16 v[156:159], v[180:183], a[252:255], v[156:159]
s_lshr_b32 s33, s30, 1
s_xor_b32 s33, s33, s48
s_bitcmp1_b32 s33, 0
s_cbranch_scc1 L_ow2
v_add_u32 v38, 20480, v35
ds_write_b128 v38, a[128:131] offset:0
ds_write_b128 v38, a[132:135] offset:1024
ds_write_b128 v38, a[136:139] offset:2048
ds_write_b128 v38, a[140:143] offset:3072
ds_write_b128 v38, a[160:163] offset:8192
ds_write_b128 v38, a[164:167] offset:9216
ds_write_b128 v38, a[168:171] offset:10240
ds_write_b128 v38, a[172:175] offset:11264
s_waitcnt lgkmcnt(0)
L_ow2:
s_waitcnt vmcnt(28) lgkmcnt(3)
v_mfma_f32_16x16x32_bf16 v[64:67], v[160:163], v[208:211], v[64:67]
s_waitcnt vmcnt(18) lgkmcnt(2)
s_add_u32 m0, s58, 73728
ds_read_b128 v[176:179], v25 offset:37888
v_mfma_f32_16x16x32_bf16 v[64:67], v[164:167], v[224:227], v[64:67]
buffer_load_dwordx4 v1, s[12:15], s56 offen offset:0 sc1 lds
v_mfma_f32_16x16x32_bf16 v[68:71], v[160:163], v[212:215], v[68:71]
s_waitcnt vmcnt(18)
ds_read_b128 v[180:183], v25 offset:44032
v_mfma_f32_16x16x32_bf16 v[68:71], v[164:167], v[228:231], v[68:71]
v_mfma_f32_16x16x32_bf16 v[72:75], v[160:163], v[216:219], v[72:75]
s_waitcnt vmcnt(16)
v_mfma_f32_16x16x32_bf16 v[72:75], v[164:167], v[232:235], v[72:75]
v_mfma_f32_16x16x32_bf16 v[76:79], v[160:163], v[220:223], v[76:79]
s_waitcnt vmcnt(13)
ds_read_b128 v[160:163], v25 offset:50176
v_mfma_f32_16x16x32_bf16 v[76:79], v[164:167], v[236:239], v[76:79]
s_waitcnt vmcnt(12) lgkmcnt(4)
buffer_load_dwordx4 v1, s[12:15], s56 offen offset:1024 sc1 lds
v_mfma_f32_16x16x32_bf16 v[64:67], v[168:171], a[192:195], v[64:67]
s_waitcnt vmcnt(9) lgkmcnt(3)
ds_read_b128 v[164:167], v25 offset:56320
v_mfma_f32_16x16x32_bf16 v[64:67], v[172:175], a[208:211], v[64:67]
v_mfma_f32_16x16x32_bf16 v[68:71], v[168:171], a[196:199], v[68:71]
s_waitcnt vmcnt(8)
v_mfma_f32_16x16x32_bf16 v[68:71], v[172:175], a[212:215], v[68:71]
v_mfma_f32_16x16x32_bf16 v[72:75], v[168:171], a[200:203], v[72:75]
s_waitcnt vmcnt(7)
v_mfma_f32_16x16x32_bf16 v[72:75], v[172:175], a[216:219], v[72:75]
v_mfma_f32_16x16x32_bf16 v[76:79], v[168:171], a[204:207], v[76:79]
s_waitcnt vmcnt(6)
ds_read_b128 v[168:171], v25 offset:38912
v_mfma_f32_16x16x32_bf16 v[76:79], v[172:175], a[220:223], v[76:79]
s_waitcnt lgkmcnt(4)
buffer_load_dwordx4 v1, s[12:15], s56 offen offset:2048 sc1 lds
v_mfma_f32_16x16x32_bf16 v[80:83], v[176:179], v[208:211], v[80:83]
s_waitcnt lgkmcnt(3)
ds_read_b128 v[172:175], v25 offset:45056
v_mfma_f32_16x16x32_bf16 v[80:83], v[180:183], v[224:227], v[80:83]
v_mfma_f32_16x16x32_bf16 v[84:87], v[176:179], v[212:215], v[84:87]
v_mfma_f32_16x16x32_bf16 v[84:87], v[180:183], v[228:231], v[84:87]
v_mfma_f32_16x16x32_bf16 v[88:91], v[176:179], v[216:219], v[88:91]
v_mfma_f32_16x16x32_bf16 v[88:91], v[180:183], v[232:235], v[88:91]
v_mfma_f32_16x16x32_bf16 v[92:95], v[176:179], v[220:223], v[92:95]
ds_read_b128 v[176:179], v25 offset:51200
v_mfma_f32_16x16x32_bf16 v[92:95], v[180:183], v[236:239], v[92:95]
s_waitcnt vmcnt(3) lgkmcnt(4)
buffer_store_dword v15, v14, s[12:15], s50 offen sc1
v_mfma_f32_16x16x32_bf16 v[80:83], v[160:163], a[192:195], v[80:83]
s_waitcnt lgkmcnt(3)
ds_read_b128 v[180:183], v25 offset:57344
v_mfma_f32_16x16x32_bf16 v[80:83], v[164:167], a[208:211], v[80:83]
v_mfma_f32_16x16x32_bf16 v[84:87], v[160:163], a[196:199], v[84:87]
v_mfma_f32_16x16x32_bf16 v[84:87], v[164:167], a[212:215], v[84:87]
v_mfma_f32_16x16x32_bf16 v[88:91], v[160:163], a[200:203], v[88:91]
v_mfma_f32_16x16x32_bf16 v[88:91], v[164:167], a[216:219], v[88:91]
s_nop 3
v_mul_f32 v64, v64, v80
v_mul_f32 v65, v65, v81
v_mfma_f32_16x16x32_bf16 v[92:95], v[160:163], a[204:207], v[92:95]
ds_read_b128 v[160:163], v25 offset:39936
v_mul_f32 v66, v66, v82
v_mfma_f32_16x16x32_bf16 v[92:95], v[164:167], a[220:223], v[92:95]
s_waitcnt lgkmcnt(4)
buffer_load_dwordx4 v1, s[12:15], s56 offen offset:3072 sc1 lds
v_mfma_f32_16x16x32_bf16 v[96:99], v[168:171], v[208:211], v[96:99]
s_waitcnt lgkmcnt(3)
ds_read_b128 v[164:167], v25 offset:46080
v_mul_f32 v67, v67, v83
v_mfma_f32_16x16x32_bf16 v[96:99], v[172:175], v[224:227], v[96:99]
s_add_u32 m0, s58, 77824
v_mul_f32 v68, v68, v84
v_mul_f32 v69, v69, v85
v_mfma_f32_16x16x32_bf16 v[100:103], v[168:171], v[212:215], v[100:103]
s_add_u32 s56, s56, 4096
v_mul_f32 v70, v70, v86
v_mul_f32 v71, v71, v87
v_mfma_f32_16x16x32_bf16 v[100:103], v[172:175], v[228:231], v[100:103]
v_cvt_pk_bf16_f32 v184, v64, v65
v_cvt_pk_bf16_f32 v185, v66, v67
v_mfma_f32_16x16x32_bf16 v[104:107], v[168:171], v[216:219], v[104:107]
v_cvt_pk_bf16_f32 v186, v68, v69
v_cvt_pk_bf16_f32 v187, v70, v71
v_mfma_f32_16x16x32_bf16 v[104:107], v[172:175], v[232:235], v[104:107]
v_mul_f32 v72, v72, v88
v_mul_f32 v73, v73, v89
v_mfma_f32_16x16x32_bf16 v[108:111], v[168:171], v[220:223], v[108:111]
v_mul_f32 v74, v74, v90
v_mul_f32 v75, v75, v91
v_mfma_f32_16x16x32_bf16 v[108:111], v[172:175], v[236:239], v[108:111]
s_waitcnt lgkmcnt(3)
buffer_load_dwordx4 v1, s[12:15], s56 offen offset:0 sc1 lds
v_mfma_f32_16x16x32_bf16 v[96:99], v[176:179], a[192:195], v[96:99]
s_waitcnt lgkmcnt(2)
v_mul_f32 v76, v76, v92
v_mul_f32 v77, v77, v93
v_mfma_f32_16x16x32_bf16 v[96:99], v[180:183], a[208:211], v[96:99]
s_add_u32 s56, s56, 16384
v_mul_f32 v78, v78, v94
v_mul_f32 v79, v79, v95
v_mfma_f32_16x16x32_bf16 v[100:103], v[176:179], a[196:199], v[100:103]
s_add_u32 m0, s58, 0
v_permlane32_swap_b32 v184, v186
v_permlane32_swap_b32 v185, v187
v_mfma_f32_16x16x32_bf16 v[100:103], v[180:183], a[212:215], v[100:103]
v_cvt_pk_bf16_f32 v188, v72, v73
v_cvt_pk_bf16_f32 v189, v74, v75
v_mfma_f32_16x16x32_bf16 v[104:107], v[176:179], a[200:203], v[104:107]
v_cvt_pk_bf16_f32 v190, v76, v77
v_cvt_pk_bf16_f32 v191, v78, v79
v_mfma_f32_16x16x32_bf16 v[104:107], v[180:183], a[216:219], v[104:107]
buffer_store_dwordx4 v[184:187], v36, s[12:15], s37 offen offset:0 sc1
v_mfma_f32_16x16x32_bf16 v[108:111], v[176:179], a[204:207], v[108:111]
v_permlane32_swap_b32 v188, v190
v_permlane32_swap_b32 v189, v191
v_mfma_f32_16x16x32_bf16 v[108:111], v[180:183], a[220:223], v[108:111]
s_waitcnt lgkmcnt(1)
ds_read_b128 v[168:171], v25 offset:52224
v_mfma_f32_16x16x32_bf16 v[112:115], v[160:163], v[208:211], v[112:115]
s_waitcnt lgkmcnt(1)
ds_read_b128 v[172:175], v25 offset:58368
v_mfma_f32_16x16x32_bf16 v[112:115], v[164:167], v[224:227], v[112:115]
buffer_store_dwordx4 v[188:191], v36, s[12:15], s37 offen offset:2048 sc1
v_mfma_f32_16x16x32_bf16 v[116:119], v[160:163], v[212:215], v[116:119]
ds_read_b128 v[176:179], v25 offset:40960
v_mfma_f32_16x16x32_bf16 v[116:119], v[164:167], v[228:231], v[116:119]
buffer_load_dwordx4 v1, s[12:15], s56 offen offset:0 sc1 lds
v_mfma_f32_16x16x32_bf16 v[120:123], v[160:163], v[216:219], v[120:123]
ds_read_b128 v[180:183], v25 offset:47104
v_mfma_f32_16x16x32_bf16 v[120:123], v[164:167], v[232:235], v[120:123]
v_mfma_f32_16x16x32_bf16 v[124:127], v[160:163], v[220:223], v[124:127]
ds_read_b128 v[160:163], v25 offset:53248
v_mfma_f32_16x16x32_bf16 v[124:127], v[164:167], v[236:239], v[124:127]
s_waitcnt lgkmcnt(4)
ds_read_b128 v[164:167], v25 offset:59392
v_mfma_f32_16x16x32_bf16 v[112:115], v[168:171], a[192:195], v[112:115]
s_waitcnt lgkmcnt(4)
v_mfma_f32_16x16x32_bf16 v[112:115], v[172:175], a[208:211], v[112:115]
buffer_load_dwordx4 v1, s[12:15], s56 offen offset:1024 sc1 lds
v_mfma_f32_16x16x32_bf16 v[116:119], v[168:171], a[196:199], v[116:119]
v_mfma_f32_16x16x32_bf16 v[116:119], v[172:175], a[212:215], v[116:119]
v_mfma_f32_16x16x32_bf16 v[120:123], v[168:171], a[200:203], v[120:123]
v_mfma_f32_16x16x32_bf16 v[120:123], v[172:175], a[216:219], v[120:123]
s_nop 2
v_mul_f32 v96, v96, v112
v_mul_f32 v97, v97, v113
v_mfma_f32_16x16x32_bf16 v[124:127], v[168:171], a[204:207], v[124:127]
ds_read_b128 v[168:171], v25 offset:41984
v_mul_f32 v98, v98, v114
v_mfma_f32_16x16x32_bf16 v[124:127], v[172:175], a[220:223], v[124:127]
s_waitcnt lgkmcnt(4)
ds_read_b128 v[172:175], v25 offset:48128
v_mul_f32 v99, v99, v115
v_mfma_f32_16x16x32_bf16 v[128:131], v[176:179], v[208:211], v[128:131]
s_waitcnt lgkmcnt(4)
v_mul_f32 v100, v100, v116
v_mul_f32 v101, v101, v117
v_mfma_f32_16x16x32_bf16 v[128:131], v[180:183], v[224:227], v[128:131]
v_mul_f32 v102, v102, v118
v_mul_f32 v103, v103, v119
v_mfma_f32_16x16x32_bf16 v[132:135], v[176:179], v[212:215], v[132:135]
buffer_load_dwordx4 v1, s[12:15], s56 offen offset:2048 sc1 lds
v_mfma_f32_16x16x32_bf16 v[132:135], v[180:183], v[228:231], v[132:135]
v_cvt_pk_bf16_f32 v192, v96, v97
v_cvt_pk_bf16_f32 v193, v98, v99
v_mfma_f32_16x16x32_bf16 v[136:139], v[176:179], v[216:219], v[136:139]
v_cvt_pk_bf16_f32 v194, v100, v101
v_cvt_pk_bf16_f32 v195, v102, v103
v_mfma_f32_16x16x32_bf16 v[136:139], v[180:183], v[232:235], v[136:139]
v_mul_f32 v104, v104, v120
v_mul_f32 v105, v105, v121
v_mfma_f32_16x16x32_bf16 v[140:143], v[176:179], v[220:223], v[140:143]
ds_read_b128 v[176:179], v25 offset:54272
v_mul_f32 v106, v106, v122
v_mfma_f32_16x16x32_bf16 v[140:143], v[180:183], v[236:239], v[140:143]
s_waitcnt lgkmcnt(4)
ds_read_b128 v[180:183], v25 offset:60416
v_mul_f32 v107, v107, v123
v_mfma_f32_16x16x32_bf16 v[128:131], v[160:163], a[192:195], v[128:131]
s_waitcnt lgkmcnt(4)
v_mul_f32 v108, v108, v124
v_mul_f32 v109, v109, v125
v_mfma_f32_16x16x32_bf16 v[128:131], v[164:167], a[208:211], v[128:131]
v_mul_f32 v110, v110, v126
v_mul_f32 v111, v111, v127
v_mfma_f32_16x16x32_bf16 v[132:135], v[160:163], a[196:199], v[132:135]
s_barrier
v_permlane32_swap_b32 v192, v194
v_permlane32_swap_b32 v193, v195
v_mfma_f32_16x16x32_bf16 v[132:135], v[164:167], a[212:215], v[132:135]
ds_read_b128 a[0:3], v32 offset:0
v_cvt_pk_bf16_f32 v196, v104, v105
v_mfma_f32_16x16x32_bf16 v[136:139], v[160:163], a[200:203], v[136:139]
buffer_load_dwordx4 v1, s[12:15], s56 offen offset:3072 sc1 lds
v_mfma_f32_16x16x32_bf16 v[136:139], v[164:167], a[216:219], v[136:139]
s_add_u32 m0, s58, 4096
ds_read_b128 a[4:7], v32 offset:10240
v_cvt_pk_bf16_f32 v197, v106, v107
v_mfma_f32_16x16x32_bf16 v[140:143], v[160:163], a[204:207], v[140:143]
s_add_u32 s56, s56, 4096
ds_read_b128 a[40:43], v33 offset:0
v_cvt_pk_bf16_f32 v198, v108, v109
v_mfma_f32_16x16x32_bf16 v[140:143], v[164:167], a[220:223], v[140:143]
s_waitcnt lgkmcnt(6)
ds_read_b128 a[56:59], v33 offset:8192
v_cvt_pk_bf16_f32 v199, v110, v111
v_mfma_f32_16x16x32_bf16 v[144:147], v[168:171], v[208:211], v[144:147]
s_waitcnt lgkmcnt(6)
ds_read_b128 a[44:47], v33 offset:1024
v_permlane32_swap_b32 v196, v198
v_mfma_f32_16x16x32_bf16 v[144:147], v[172:175], v[224:227], v[144:147]
ds_read_b128 a[60:63], v33 offset:9216
v_permlane32_swap_b32 v197, v199
v_mfma_f32_16x16x32_bf16 v[148:151], v[168:171], v[212:215], v[148:151]
ds_read_b128 a[48:51], v33 offset:2048
v_mfma_f32_16x16x32_bf16 v[148:151], v[172:175], v[228:231], v[148:151]
ds_read_b128 a[64:67], v33 offset:10240
v_mfma_f32_16x16x32_bf16 v[152:155], v[168:171], v[216:219], v[152:155]
ds_read_b128 a[52:55], v33 offset:3072
v_mfma_f32_16x16x32_bf16 v[152:155], v[172:175], v[232:235], v[152:155]
buffer_load_dwordx4 v1, s[12:15], s56 offen offset:0 sc1 lds
v_mfma_f32_16x16x32_bf16 v[156:159], v[168:171], v[220:223], v[156:159]
s_add_u32 s56, s56, 16384
ds_read_b128 a[68:71], v33 offset:11264
v_mfma_f32_16x16x32_bf16 v[156:159], v[172:175], v[236:239], v[156:159]
s_waitcnt lgkmcnt(11)
ds_read_b128 a[8:11], v32 offset:1024
v_mfma_f32_16x16x32_bf16 v[144:147], v[176:179], a[192:195], v[144:147]
s_waitcnt lgkmcnt(11)
ds_read_b128 a[12:15], v32 offset:11264
v_mfma_f32_16x16x32_bf16 v[144:147], v[180:183], a[208:211], v[144:147]
s_mov_b32 s56, s41
ds_read_b128 a[16:19], v32 offset:2048
v_mfma_f32_16x16x32_bf16 v[148:151], v[176:179], a[196:199], v[148:151]
s_cmp_eq_u32 s56, s20
ds_read_b128 a[20:23], v32 offset:12288
v_mfma_f32_16x16x32_bf16 v[148:151], v[180:183], a[212:215], v[148:151]
s_cmov_b32 s56, s35
buffer_store_dwordx4 v[192:195], v36, s[12:15], s38 offen offset:0 sc1
v_mfma_f32_16x16x32_bf16 v[152:155], v[176:179], a[200:203], v[152:155]
ds_read_b128 a[24:27], v32 offset:3072
v_mfma_f32_16x16x32_bf16 v[152:155], v[180:183], a[216:219], v[152:155]
ds_read_b128 a[28:31], v32 offset:13312
v_mul_f32 v128, v128, v144
v_mfma_f32_16x16x32_bf16 v[156:159], v[176:179], a[204:207], v[156:159]
ds_read_b128 a[32:35], v32 offset:4096
v_mul_f32 v129, v129, v145
v_mfma_f32_16x16x32_bf16 v[156:159], v[180:183], a[220:223], v[156:159]
ds_read_b128 a[36:39], v32 offset:14336
v_mul_f32 v130, v130, v146
v_mul_f32 v131, v131, v147
v_mul_f32 v132, v132, v148
v_mul_f32 v133, v133, v149
v_mul_f32 v134, v134, v150
v_mul_f32 v135, v135, v151
v_cvt_pk_bf16_f32 v200, v128, v129
v_cvt_pk_bf16_f32 v201, v130, v131
v_cvt_pk_bf16_f32 v202, v132, v133
v_cvt_pk_bf16_f32 v203, v134, v135
v_mul_f32 v136, v136, v152
v_mul_f32 v137, v137, v153
v_mul_f32 v138, v138, v154
v_mul_f32 v139, v139, v155
v_mul_f32 v140, v140, v156
v_mul_f32 v141, v141, v157
v_mul_f32 v142, v142, v158
v_mul_f32 v143, v143, v159
buffer_store_dwordx4 v[196:199], v36, s[12:15], s38 offen offset:2048 sc1
v_permlane32_swap_b32 v200, v202
v_permlane32_swap_b32 v201, v203
v_cvt_pk_bf16_f32 v204, v136, v137
v_cvt_pk_bf16_f32 v205, v138, v139
v_cvt_pk_bf16_f32 v206, v140, v141
v_cvt_pk_bf16_f32 v207, v142, v143
buffer_store_dwordx4 v[200:203], v36, s[12:15], s39 offen offset:0 sc1
v_permlane32_swap_b32 v204, v206
v_permlane32_swap_b32 v205, v207
buffer_store_dwordx4 v[204:207], v36, s[12:15], s39 offen offset:2048 sc1
s_waitcnt lgkmcnt(15)
v_mfma_f32_16x16x32_bf16 v[64:67], a[0:3], a[40:43], 0
s_waitcnt lgkmcnt(14)
s_mov_b32 s27, s32
v_mov_b32 v39, v42
v_add_u32 v32, 0xffff7000, v32
v_mfma_f32_16x16x32_bf16 v[64:67], a[4:7], a[56:59], v[64:67]
s_waitcnt lgkmcnt(13)
s_lshl_b32 s54, s100, 7
buffer_load_dword v37, v39, s[12:15], s27 offen sc1
v_mfma_f32_16x16x32_bf16 v[68:71], a[0:3], a[44:47], 0
s_waitcnt vmcnt(12) lgkmcnt(0)
s_barrier
v_add_u32 v33, 0xffff7000, v33
v_lshlrev_b32 v42, 2, v0
v_mfma_f32_16x16x32_bf16 v[68:71], a[4:7], a[60:63], v[68:71]
s_lshl2_add_u32 s54, s101, s54
ds_read_b128 a[72:75], v32 offset:0
v_mfma_f32_16x16x32_bf16 v[72:75], a[0:3], a[48:51], 0
s_add_u32 m0, s58, 36864
ds_read_b128 a[76:79], v32 offset:10240
v_mfma_f32_16x16x32_bf16 v[72:75], a[4:7], a[64:67], v[72:75]
s_lshl_b32 s32, s48, 8
buffer_load_dwordx4 v1, s[12:15], s56 offen offset:0 sc1 lds
v_mfma_f32_16x16x32_bf16 v[76:79], a[0:3], a[52:55], 0
s_add_u32 s32, s32, 0x3a10000
ds_read_b128 a[112:115], v33 offset:0
v_mfma_f32_16x16x32_bf16 v[76:79], a[4:7], a[68:71], v[76:79]
s_and_b32 s33, s47, 1
buffer_load_dwordx4 v1, s[12:15], s56 offen offset:1024 sc1 lds
v_mfma_f32_16x16x32_bf16 v[80:83], a[8:11], a[40:43], 0
s_lshl1_add_u32 s33, s49, s33
ds_read_b128 a[128:131], v33 offset:8192
v_mfma_f32_16x16x32_bf16 v[80:83], a[12:15], a[56:59], v[80:83]
s_lshr_b32 s52, s47, 1
ds_read_b128 a[116:119], v33 offset:1024
v_mfma_f32_16x16x32_bf16 v[84:87], a[8:11], a[44:47], 0
s_lshl1_add_u32 s43, s33, s52
buffer_load_dwordx4 v1, s[12:15], s56 offen offset:2048 sc1 lds
v_mfma_f32_16x16x32_bf16 v[84:87], a[12:15], a[60:63], v[84:87]
s_mul_i32 s43, s43, 122880
ds_read_b128 a[132:135], v33 offset:9216
v_mfma_f32_16x16x32_bf16 v[88:91], a[8:11], a[48:51], 0
s_lshl_b32 s25, s30, 13
ds_read_b128 a[120:123], v33 offset:2048
v_mfma_f32_16x16x32_bf16 v[88:91], a[12:15], a[64:67], v[88:91]
s_add_u32 s43, s43, s25
ds_read_b128 a[136:139], v33 offset:10240
v_mfma_f32_16x16x32_bf16 v[92:95], a[8:11], a[52:55], 0
s_add_u32 s43, s43, 0x2e00000
buffer_load_dwordx4 v1, s[12:15], s56 offen offset:3072 sc1 lds
v_mfma_f32_16x16x32_bf16 v[92:95], a[12:15], a[68:71], v[92:95]
s_lshl2_add_u32 s34, s61, s30
ds_read_b128 a[124:127], v33 offset:3072
v_mfma_f32_16x16x32_bf16 v[96:99], a[16:19], a[40:43], 0
s_mul_i32 s33, s33, 160
ds_read_b128 a[140:143], v33 offset:11264
v_mfma_f32_16x16x32_bf16 v[96:99], a[20:23], a[56:59], v[96:99]
s_mul_i32 s34, s34, 20480
ds_read_b128 a[80:83], v32 offset:1024
v_mfma_f32_16x16x32_bf16 v[100:103], a[16:19], a[44:47], 0
s_add_u32 s34, s34, s33
ds_read_b128 a[84:87], v32 offset:11264
v_mfma_f32_16x16x32_bf16 v[100:103], a[20:23], a[60:63], v[100:103]
s_add_u32 m0, s58, 40960
ds_read_b128 a[88:91], v32 offset:2048
v_mfma_f32_16x16x32_bf16 v[104:107], a[16:19], a[48:51], 0
s_add_u32 s56, s56, 4096
ds_read_b128 a[92:95], v32 offset:12288
v_mfma_f32_16x16x32_bf16 v[104:107], a[20:23], a[64:67], v[104:107]
buffer_load_dwordx4 v1, s[12:15], s56 offen offset:0 sc1 lds
v_mfma_f32_16x16x32_bf16 v[108:111], a[16:19], a[52:55], 0
s_add_u32 s56, s56, 16384
ds_read_b128 a[96:99], v32 offset:3072
v_mfma_f32_16x16x32_bf16 v[108:111], a[20:23], a[68:71], v[108:111]
s_cmp_eq_u32 s56, s20
ds_read_b128 a[100:103], v32 offset:13312
v_mfma_f32_16x16x32_bf16 v[112:115], a[24:27], a[40:43], 0
s_cmov_b32 s56, s35
ds_read_b128 a[104:107], v32 offset:4096
v_mfma_f32_16x16x32_bf16 v[112:115], a[28:31], a[56:59], v[112:115]
s_add_u32 m0, s58, 110592
ds_read_b128 a[108:111], v32 offset:14336
v_mfma_f32_16x16x32_bf16 v[116:119], a[24:27], a[44:47], 0
buffer_load_dwordx4 v1, s[12:15], s56 offen offset:0 sc1 lds
v_mfma_f32_16x16x32_bf16 v[116:119], a[28:31], a[60:63], v[116:119]
v_mfma_f32_16x16x32_bf16 v[120:123], a[24:27], a[48:51], 0
buffer_load_dwordx4 v1, s[12:15], s56 offen offset:1024 sc1 lds
v_mfma_f32_16x16x32_bf16 v[120:123], a[28:31], a[64:67], v[120:123]
v_mfma_f32_16x16x32_bf16 v[124:127], a[24:27], a[52:55], 0
buffer_load_dwordx4 v1, s[12:15], s56 offen offset:2048 sc1 lds
v_mfma_f32_16x16x32_bf16 v[124:127], a[28:31], a[68:71], v[124:127]
v_mfma_f32_16x16x32_bf16 v[128:131], a[32:35], a[40:43], 0
buffer_load_dwordx4 v1, s[12:15], s56 offen offset:3072 sc1 lds
v_mfma_f32_16x16x32_bf16 v[128:131], a[36:39], a[56:59], v[128:131]
s_add_u32 m0, s58, 114688
v_mfma_f32_16x16x32_bf16 v[132:135], a[32:35], a[44:47], 0
s_add_u32 s56, s56, 4096
v_mfma_f32_16x16x32_bf16 v[132:135], a[36:39], a[60:63], v[132:135]
v_mfma_f32_16x16x32_bf16 v[136:139], a[32:35], a[48:51], 0
buffer_load_dwordx4 v1, s[12:15], s56 offen offset:0 sc1 lds
v_mfma_f32_16x16x32_bf16 v[136:139], a[36:39], a[64:67], v[136:139]
s_add_u32 s56, s56, 16384
v_mfma_f32_16x16x32_bf16 v[140:143], a[32:35], a[52:55], 0
s_cmp_eq_u32 s56, s20
v_mfma_f32_16x16x32_bf16 v[140:143], a[36:39], a[68:71], v[140:143]
s_cmov_b32 s56, s35
s_waitcnt vmcnt(10)
v_cmp_ne_u32 vcc, s40, v37
s_nop 1
s_cbranch_vccnz L_spin_o
L_back_o:
s_waitcnt lgkmcnt(15)
v_mfma_f32_16x16x32_bf16 v[64:67], a[72:75], a[112:115], v[64:67]
s_waitcnt lgkmcnt(14)
s_cmp_eq_u32 s57, s60
v_add_u32 v32, 0xfffee000, v32
v_add_u32 v33, 0xfffee000, v33
v_mfma_f32_16x16x32_bf16 v[64:67], a[76:79], a[128:131], v[64:67]
s_waitcnt lgkmcnt(13)
s_cmov_b32 s57, s21
v_mfma_f32_16x16x32_bf16 v[68:71], a[72:75], a[116:119], v[68:71]
s_waitcnt lgkmcnt(0)
s_barrier
v_mfma_f32_16x16x32_bf16 v[68:71], a[76:79], a[132:135], v[68:71]
s_add_u32 m0, s59, 57344
ds_read_b128 a[0:3], v32 offset:0
v_mfma_f32_16x16x32_bf16 v[72:75], a[72:75], a[120:123], v[72:75]
buffer_load_dwordx4 v1, s[12:15], s57 offen offset:0 sc1 lds
v_mfma_f32_16x16x32_bf16 v[72:75], a[76:79], a[136:139], v[72:75]
ds_read_b128 a[4:7], v32 offset:10240
v_mfma_f32_16x16x32_bf16 v[76:79], a[72:75], a[124:127], v[76:79]
buffer_load_dwordx4 v1, s[12:15], s57 offen offset:1024 sc1 lds
v_mfma_f32_16x16x32_bf16 v[76:79], a[76:79], a[140:143], v[76:79]
ds_read_b128 a[40:43], v33 offset:0
v_mfma_f32_16x16x32_bf16 v[80:83], a[80:83], a[112:115], v[80:83]
buffer_load_dwordx4 v1, s[12:15], s57 offen offset:2048 sc1 lds
v_mfma_f32_16x16x32_bf16 v[80:83], a[84:87], a[128:131], v[80:83]
ds_read_b128 a[56:59], v33 offset:8192
v_mfma_f32_16x16x32_bf16 v[84:87], a[80:83], a[116:119], v[84:87]
buffer_load_dwordx4 v1, s[12:15], s57 offen offset:3072 sc1 lds
v_mfma_f32_16x16x32_bf16 v[84:87], a[84:87], a[132:135], v[84:87]
s_add_u32 s57, s57, 8192
ds_read_b128 a[44:47], v33 offset:1024
v_mfma_f32_16x16x32_bf16 v[88:91], a[80:83], a[120:123], v[88:91]
s_cmp_eq_u32 s57, s60
ds_read_b128 a[60:63], v33 offset:9216
v_mfma_f32_16x16x32_bf16 v[88:91], a[84:87], a[136:139], v[88:91]
s_cmov_b32 s57, s21
ds_read_b128 a[48:51], v33 offset:2048
v_mfma_f32_16x16x32_bf16 v[92:95], a[80:83], a[124:127], v[92:95]
s_add_u32 m0, s59, 131072
ds_read_b128 a[64:67], v33 offset:10240
v_mfma_f32_16x16x32_bf16 v[92:95], a[84:87], a[140:143], v[92:95]
buffer_load_dwordx4 v1, s[12:15], s57 offen offset:0 sc1 lds
v_mfma_f32_16x16x32_bf16 v[96:99], a[88:91], a[112:115], v[96:99]
ds_read_b128 a[52:55], v33 offset:3072
v_mfma_f32_16x16x32_bf16 v[96:99], a[92:95], a[128:131], v[96:99]
buffer_load_dwordx4 v1, s[12:15], s57 offen offset:1024 sc1 lds
v_mfma_f32_16x16x32_bf16 v[100:103], a[88:91], a[116:119], v[100:103]
ds_read_b128 a[68:71], v33 offset:11264
v_mfma_f32_16x16x32_bf16 v[100:103], a[92:95], a[132:135], v[100:103]
buffer_load_dwordx4 v1, s[12:15], s57 offen offset:2048 sc1 lds
v_mfma_f32_16x16x32_bf16 v[104:107], a[88:91], a[120:123], v[104:107]
ds_read_b128 a[8:11], v32 offset:1024
v_mfma_f32_16x16x32_bf16 v[104:107], a[92:95], a[136:139], v[104:107]
buffer_load_dwordx4 v1, s[12:15], s57 offen offset:3072 sc1 lds
v_mfma_f32_16x16x32_bf16 v[108:111], a[88:91], a[124:127], v[108:111]
s_add_u32 s57, s57, 8192
ds_read_b128 a[12:15], v32 offset:11264
v_mfma_f32_16x16x32_bf16 v[108:111], a[92:95], a[140:143], v[108:111]
s_cmp_eq_u32 s57, s60
ds_read_b128 a[16:19], v32 offset:2048
v_mfma_f32_16x16x32_bf16 v[112:115], a[96:99], a[112:115], v[112:115]
s_cmov_b32 s57, s21
ds_read_b128 a[20:23], v32 offset:12288
v_mfma_f32_16x16x32_bf16 v[112:115], a[100:103], a[128:131], v[112:115]
s_add_u32 m0, s59, 94208
ds_read_b128 a[24:27], v32 offset:3072
v_mfma_f32_16x16x32_bf16 v[116:119], a[96:99], a[116:119], v[116:119]
buffer_load_dwordx4 v1, s[12:15], s57 offen offset:0 sc1 lds
v_mfma_f32_16x16x32_bf16 v[116:119], a[100:103], a[132:135], v[116:119]
ds_read_b128 a[28:31], v32 offset:13312
v_mfma_f32_16x16x32_bf16 v[120:123], a[96:99], a[120:123], v[120:123]
buffer_load_dwordx4 v1, s[12:15], s57 offen offset:1024 sc1 lds
v_mfma_f32_16x16x32_bf16 v[120:123], a[100:103], a[136:139], v[120:123]
ds_read_b128 a[32:35], v32 offset:4096
v_mfma_f32_16x16x32_bf16 v[124:127], a[96:99], a[124:127], v[124:127]
buffer_load_dwordx4 v1, s[12:15], s57 offen offset:2048 sc1 lds
v_mfma_f32_16x16x32_bf16 v[124:127], a[100:103], a[140:143], v[124:127]
ds_read_b128 a[36:39], v32 offset:14336
v_mfma_f32_16x16x32_bf16 v[128:131], a[104:107], a[112:115], v[128:131]
buffer_load_dwordx4 v1, s[12:15], s57 offen offset:3072 sc1 lds
v_mfma_f32_16x16x32_bf16 v[128:131], a[108:111], a[128:131], v[128:131]
s_add_u32 s57, s57, 8192
v_mfma_f32_16x16x32_bf16 v[132:135], a[104:107], a[116:119], v[132:135]
s_add_u32 m0, s58, 73728
v_mfma_f32_16x16x32_bf16 v[132:135], a[108:111], a[132:135], v[132:135]
buffer_load_dwordx4 v1, s[12:15], s56 offen offset:0 sc1 lds
v_mfma_f32_16x16x32_bf16 v[136:139], a[104:107], a[120:123], v[136:139]
v_mfma_f32_16x16x32_bf16 v[136:139], a[108:111], a[136:139], v[136:139]
buffer_load_dwordx4 v1, s[12:15], s56 offen offset:1024 sc1 lds
v_mfma_f32_16x16x32_bf16 v[140:143], a[104:107], a[124:127], v[140:143]
v_mfma_f32_16x16x32_bf16 v[140:143], a[108:111], a[140:143], v[140:143]
buffer_load_dwordx4 v1, s[12:15], s56 offen offset:2048 sc1 lds
buffer_load_dwordx4 v1, s[12:15], s56 offen offset:3072 sc1 lds
s_add_u32 m0, s58, 77824
s_add_u32 s56, s56, 4096
buffer_load_dwordx4 v1, s[12:15], s56 offen offset:0 sc1 lds
s_add_u32 s56, s56, 16384
s_cmp_eq_u32 s56, s20
s_cmov_b32 s56, s35
s_waitcnt lgkmcnt(15)
v_mfma_f32_16x16x32_bf16 v[64:67], a[0:3], a[40:43], v[64:67]
s_waitcnt lgkmcnt(14)
s_cmp_eq_u32 s57, s60
v_and_b32 v40, 15, v0
v_mul_u32_u24 v40, 1280, v40
v_mfma_f32_16x16x32_bf16 v[64:67], a[4:7], a[56:59], v[64:67]
s_waitcnt lgkmcnt(13)
s_cmov_b32 s57, s21
v_lshrrev_b32 v41, 4, v0
v_mfma_f32_16x16x32_bf16 v[68:71], a[0:3], a[44:47], v[68:71]
s_waitcnt vmcnt(13) lgkmcnt(0)
s_barrier
v_mfma_f32_16x16x32_bf16 v[68:71], a[4:7], a[60:63], v[68:71]
s_add_u32 m0, s59, 20480
ds_read_b128 a[72:75], v32 offset:36864
v_mfma_f32_16x16x32_bf16 v[72:75], a[0:3], a[48:51], v[72:75]
s_mul_i32 s52, s52, 24
buffer_load_dwordx4 v1, s[12:15], s57 offen offset:0 sc1 lds
v_mfma_f32_16x16x32_bf16 v[72:75], a[4:7], a[64:67], v[72:75]
s_add_u32 s52, s52, 192
ds_read_b128 a[76:79], v32 offset:47104
v_mfma_f32_16x16x32_bf16 v[76:79], a[0:3], a[52:55], v[76:79]
s_lshl_b32 s52, s52, 12
buffer_load_dwordx4 v1, s[12:15], s57 offen offset:1024 sc1 lds
v_mfma_f32_16x16x32_bf16 v[76:79], a[4:7], a[68:71], v[76:79]
s_add_u32 s52, s52, s26
ds_read_b128 a[112:115], v33 offset:36864
v_mfma_f32_16x16x32_bf16 v[80:83], a[8:11], a[40:43], v[80:83]
s_add_u32 s52, s52, 0x400000
ds_read_b128 a[128:131], v33 offset:45056
v_mfma_f32_16x16x32_bf16 v[80:83], a[12:15], a[56:59], v[80:83]
s_xor_b32 s44, s61, 1
ds_read_b128 a[116:119], v33 offset:37888
v_mfma_f32_16x16x32_bf16 v[84:87], a[8:11], a[44:47], v[84:87]
s_mul_i32 s44, s44, 983040
buffer_load_dwordx4 v1, s[12:15], s57 offen offset:2048 sc1 lds
v_mfma_f32_16x16x32_bf16 v[84:87], a[12:15], a[60:63], v[84:87]
s_mul_i32 s36, s61, 983040
ds_read_b128 a[132:135], v33 offset:46080
v_mfma_f32_16x16x32_bf16 v[88:91], a[8:11], a[48:51], v[88:91]
s_add_u32 s44, s44, s52
ds_read_b128 a[120:123], v33 offset:38912
v_mfma_f32_16x16x32_bf16 v[88:91], a[12:15], a[64:67], v[88:91]
s_add_u32 s36, s36, s52
ds_read_b128 a[136:139], v33 offset:47104
v_mfma_f32_16x16x32_bf16 v[92:95], a[8:11], a[52:55], v[92:95]
s_lshl2_add_u32 s31, s48, s49
buffer_load_dwordx4 v1, s[12:15], s57 offen offset:3072 sc1 lds
v_mfma_f32_16x16x32_bf16 v[92:95], a[12:15], a[68:71], v[92:95]
s_lshl2_add_u32 s52, s31, s47
ds_read_b128 a[124:127], v33 offset:39936
v_mfma_f32_16x16x32_bf16 v[96:99], a[16:19], a[40:43], v[96:99]
s_lshl2_add_u32 s33, s52, s30
ds_read_b128 a[140:143], v33 offset:48128
v_mfma_f32_16x16x32_bf16 v[96:99], a[20:23], a[56:59], v[96:99]
s_mul_i32 s53, s33, 10240
ds_read_b128 a[80:83], v32 offset:37888
v_mfma_f32_16x16x32_bf16 v[100:103], a[16:19], a[44:47], v[100:103]
s_add_u32 s53, s53, 0x3000000
ds_read_b128 a[84:87], v32 offset:48128
v_mfma_f32_16x16x32_bf16 v[100:103], a[20:23], a[60:63], v[100:103]
s_lshl2_add_u32 s50, s31, s30
ds_read_b128 a[88:91], v32 offset:38912
v_mfma_f32_16x16x32_bf16 v[104:107], a[16:19], a[48:51], v[104:107]
s_lshl_b32 s50, s50, 7
ds_read_b128 a[92:95], v32 offset:49152
v_mfma_f32_16x16x32_bf16 v[104:107], a[20:23], a[64:67], v[104:107]
s_lshl2_add_u32 s50, s47, s50
ds_read_b128 a[96:99], v32 offset:39936
v_mfma_f32_16x16x32_bf16 v[108:111], a[16:19], a[52:55], v[108:111]
s_add_u32 s50, s50, 0x3a18000
ds_read_b128 a[100:103], v32 offset:50176
v_mfma_f32_16x16x32_bf16 v[108:111], a[20:23], a[68:71], v[108:111]
s_add_u32 s57, s57, 8192
ds_read_b128 a[104:107], v32 offset:40960
v_mfma_f32_16x16x32_bf16 v[112:115], a[24:27], a[40:43], v[112:115]
s_add_u32 m0, s58, 0
ds_read_b128 a[108:111], v32 offset:51200
v_mfma_f32_16x16x32_bf16 v[112:115], a[28:31], a[56:59], v[112:115]
s_mov_b32 s23, 0x3a22000
buffer_load_dwordx4 v1, s[12:15], s56 offen offset:0 sc1 lds
v_mfma_f32_16x16x32_bf16 v[116:119], a[24:27], a[44:47], v[116:119]
v_mfma_f32_16x16x32_bf16 v[116:119], a[28:31], a[60:63], v[116:119]
buffer_load_dwordx4 v[48:51], v1, s[12:15], s23 offen sc1
v_mfma_f32_16x16x32_bf16 v[120:123], a[24:27], a[48:51], v[120:123]
v_mfma_f32_16x16x32_bf16 v[120:123], a[28:31], a[64:67], v[120:123]
buffer_load_dwordx4 v1, s[12:15], s56 offen offset:1024 sc1 lds
v_mfma_f32_16x16x32_bf16 v[124:127], a[24:27], a[52:55], v[124:127]
v_mfma_f32_16x16x32_bf16 v[124:127], a[28:31], a[68:71], v[124:127]
buffer_load_dwordx4 v1, s[12:15], s56 offen offset:2048 sc1 lds
v_mfma_f32_16x16x32_bf16 v[128:131], a[32:35], a[40:43], v[128:131]
v_mfma_f32_16x16x32_bf16 v[128:131], a[36:39], a[56:59], v[128:131]
buffer_load_dwordx4 v1, s[12:15], s56 offen offset:3072 sc1 lds
v_mfma_f32_16x16x32_bf16 v[132:135], a[32:35], a[44:47], v[132:135]
s_add_u32 m0, s58, 4096
v_mfma_f32_16x16x32_bf16 v[132:135], a[36:39], a[60:63], v[132:135]
s_add_u32 s56, s56, 4096
v_mfma_f32_16x16x32_bf16 v[136:139], a[32:35], a[48:51], v[136:139]
buffer_load_dwordx4 v1, s[12:15], s56 offen offset:0 sc1 lds
v_mfma_f32_16x16x32_bf16 v[136:139], a[36:39], a[64:67], v[136:139]
s_add_u32 s56, s56, 16384
v_mfma_f32_16x16x32_bf16 v[140:143], a[32:35], a[52:55], v[140:143]
s_cmp_eq_u32 s56, s20
v_mfma_f32_16x16x32_bf16 v[140:143], a[36:39], a[68:71], v[140:143]
s_cmov_b32 s56, s35
s_waitcnt lgkmcnt(15)
v_mfma_f32_16x16x32_bf16 v[64:67], a[72:75], a[112:115], v[64:67]
s_waitcnt lgkmcnt(14)
s_cmp_eq_u32 s57, s60
v_add_u32 v32, 0x1b000, v32
v_add_u32 v33, 0x1b000, v33
v_mfma_f32_16x16x32_bf16 v[64:67], a[76:79], a[128:131], v[64:67]
s_waitcnt lgkmcnt(13)
s_cmov_b32 s57, s21
v_and_b32 v43, 7, v0
v_lshl_add_u32 v40, v41, 3, v40
v_mfma_f32_16x16x32_bf16 v[68:71], a[72:75], a[116:119], v[68:71]
s_waitcnt vmcnt(19) lgkmcnt(0)
s_barrier
v_lshlrev_b32 v43, 2, v43
v_mfma_f32_16x16x32_bf16 v[68:71], a[76:79], a[132:135], v[68:71]
s_add_u32 m0, s59, 57344
ds_read_b128 a[0:3], v32 offset:0
v_mfma_f32_16x16x32_bf16 v[72:75], a[72:75], a[120:123], v[72:75]
s_lshl_b32 s55, s52, 7
buffer_load_dwordx4 v1, s[12:15], s57 offen offset:0 sc1 lds
v_mfma_f32_16x16x32_bf16 v[72:75], a[76:79], a[136:139], v[72:75]
s_add_u32 s55, s55, 0x3a18000
ds_read_b128 a[4:7], v32 offset:10240
v_mfma_f32_16x16x32_bf16 v[76:79], a[72:75], a[124:127], v[76:79]
s_lshl4_add_u32 s33, s31, s47
ds_read_b128 a[40:43], v33 offset:0
v_mfma_f32_16x16x32_bf16 v[76:79], a[76:79], a[140:143], v[76:79]
s_mul_i32 s22, s33, 10240
buffer_load_dwordx4 v1, s[12:15], s57 offen offset:1024 sc1 lds
v_mfma_f32_16x16x32_bf16 v[80:83], a[80:83], a[112:115], v[80:83]
s_add_u32 s22, s22, 0x3000000
ds_read_b128 a[56:59], v33 offset:8192
v_mfma_f32_16x16x32_bf16 v[80:83], a[84:87], a[128:131], v[80:83]
s_lshl2_add_u32 s33, s52, s30
ds_read_b128 a[44:47], v33 offset:1024
v_mfma_f32_16x16x32_bf16 v[84:87], a[80:83], a[116:119], v[84:87]
s_mul_i32 s42, s33, 2560
ds_read_b128 a[60:63], v33 offset:9216
v_mfma_f32_16x16x32_bf16 v[84:87], a[84:87], a[132:135], v[84:87]
s_add_u32 s42, s42, 0x3e00000
buffer_load_dwordx4 v1, s[12:15], s57 offen offset:2048 sc1 lds
v_mfma_f32_16x16x32_bf16 v[88:91], a[80:83], a[120:123], v[88:91]
s_xor_b32 s33, s33, 8
ds_read_b128 a[48:51], v33 offset:2048
v_mfma_f32_16x16x32_bf16 v[88:91], a[84:87], a[136:139], v[88:91]
s_mul_i32 s45, s33, 2560
ds_read_b128 a[64:67], v33 offset:10240
v_mfma_f32_16x16x32_bf16 v[92:95], a[80:83], a[124:127], v[92:95]
s_add_u32 s45, s45, 0x3e00000
ds_read_b128 a[52:55], v33 offset:3072
v_mfma_f32_16x16x32_bf16 v[92:95], a[84:87], a[140:143], v[92:95]
s_xor_b32 s46, s55, 0x100
buffer_load_dwordx4 v1, s[12:15], s57 offen offset:3072 sc1 lds
v_mfma_f32_16x16x32_bf16 v[96:99], a[88:91], a[112:115], v[96:99]
s_lshl2_add_u32 s46, s30, s46
ds_read_b128 a[68:71], v33 offset:11264
v_mfma_f32_16x16x32_bf16 v[96:99], a[92:95], a[128:131], v[96:99]
s_add_u32 s46, s46, 16
ds_read_b128 a[8:11], v32 offset:1024
v_mfma_f32_16x16x32_bf16 v[100:103], a[88:91], a[116:119], v[100:103]
s_add_u32 s57, s57, 8192
ds_read_b128 a[12:15], v32 offset:11264
v_mfma_f32_16x16x32_bf16 v[100:103], a[92:95], a[132:135], v[100:103]
s_add_u32 m0, s58, 36864
ds_read_b128 a[16:19], v32 offset:2048
v_mfma_f32_16x16x32_bf16 v[104:107], a[88:91], a[120:123], v[104:107]
s_mov_b32 s4, s82
buffer_load_dwordx4 v1, s[12:15], s56 offen offset:0 sc1 lds
v_mfma_f32_16x16x32_bf16 v[104:107], a[92:95], a[136:139], v[104:107]
s_mov_b32 s5, s83
ds_read_b128 a[20:23], v32 offset:12288
v_mfma_f32_16x16x32_bf16 v[108:111], a[88:91], a[124:127], v[108:111]
s_mov_b32 s6, 0x280000
ds_read_b128 a[24:27], v32 offset:3072
v_mfma_f32_16x16x32_bf16 v[108:111], a[92:95], a[140:143], v[108:111]
s_mov_b32 s7, 0x20000
buffer_load_dwordx4 v1, s[12:15], s56 offen offset:1024 sc1 lds
v_mfma_f32_16x16x32_bf16 v[112:115], a[96:99], a[112:115], v[112:115]
ds_read_b128 a[28:31], v32 offset:13312
v_mfma_f32_16x16x32_bf16 v[112:115], a[100:103], a[128:131], v[112:115]
ds_read_b128 a[32:35], v32 offset:4096
v_mfma_f32_16x16x32_bf16 v[116:119], a[96:99], a[116:119], v[116:119]
ds_read_b128 a[36:39], v32 offset:14336
v_mfma_f32_16x16x32_bf16 v[116:119], a[100:103], a[132:135], v[116:119]
buffer_load_dwordx4 v1, s[12:15], s56 offen offset:2048 sc1 lds
v_mfma_f32_16x16x32_bf16 v[120:123], a[96:99], a[120:123], v[120:123]
v_mfma_f32_16x16x32_bf16 v[120:123], a[100:103], a[136:139], v[120:123]
v_mfma_f32_16x16x32_bf16 v[124:127], a[96:99], a[124:127], v[124:127]
v_mfma_f32_16x16x32_bf16 v[124:127], a[100:103], a[140:143], v[124:127]
buffer_load_dwordx4 v1, s[12:15], s56 offen offset:3072 sc1 lds
v_mfma_f32_16x16x32_bf16 v[128:131], a[104:107], a[112:115], v[128:131]
s_add_u32 m0, s58, 40960
v_mfma_f32_16x16x32_bf16 v[128:131], a[108:111], a[128:131], v[128:131]
s_add_u32 s56, s56, 4096
v_mfma_f32_16x16x32_bf16 v[132:135], a[104:107], a[116:119], v[132:135]
v_mfma_f32_16x16x32_bf16 v[132:135], a[108:111], a[132:135], v[132:135]
buffer_load_dwordx4 v1, s[12:15], s56 offen offset:0 sc1 lds
v_mfma_f32_16x16x32_bf16 v[136:139], a[104:107], a[120:123], v[136:139]
s_add_u32 s56, s56, 16384
v_mfma_f32_16x16x32_bf16 v[136:139], a[108:111], a[136:139], v[136:139]
s_cmp_eq_u32 s56, s20
v_mfma_f32_16x16x32_bf16 v[140:143], a[104:107], a[124:127], v[140:143]
s_cmov_b32 s56, s35
v_mfma_f32_16x16x32_bf16 v[140:143], a[108:111], a[140:143], v[140:143]
s_add_u32 s54, s54, 0x3a10000
s_mov_b32 s28, 0
.p2align 6
L_o:
s_waitcnt lgkmcnt(15)
v_mfma_f32_16x16x32_bf16 v[64:67], a[0:3], a[40:43], v[64:67]
s_waitcnt lgkmcnt(14)
s_cmp_eq_u32 s57, s60
v_add_u32 v32, 0xffff7000, v32
v_add_u32 v33, 0xffff7000, v33
v_mfma_f32_16x16x32_bf16 v[64:67], a[4:7], a[56:59], v[64:67]
s_waitcnt lgkmcnt(13)
s_cmov_b32 s57, s21
v_mfma_f32_16x16x32_bf16 v[68:71], a[0:3], a[44:47], v[68:71]
s_waitcnt vmcnt(19) lgkmcnt(0)
s_barrier
v_mfma_f32_16x16x32_bf16 v[68:71], a[4:7], a[60:63], v[68:71]
s_add_u32 m0, s59, 131072
ds_read_b128 a[72:75], v32 offset:0
v_mfma_f32_16x16x32_bf16 v[72:75], a[0:3], a[48:51], v[72:75]
buffer_load_dwordx4 v1, s[12:15], s57 offen offset:0 sc1 lds
v_mfma_f32_16x16x32_bf16 v[72:75], a[4:7], a[64:67], v[72:75]
ds_read_b128 a[76:79], v32 offset:10240
v_mfma_f32_16x16x32_bf16 v[76:79], a[0:3], a[52:55], v[76:79]
ds_read_b128 a[112:115], v33 offset:0
v_mfma_f32_16x16x32_bf16 v[76:79], a[4:7], a[68:71], v[76:79]
buffer_load_dwordx4 v1, s[12:15], s57 offen offset:1024 sc1 lds
v_mfma_f32_16x16x32_bf16 v[80:83], a[8:11], a[40:43], v[80:83]
ds_read_b128 a[128:131], v33 offset:8192
v_mfma_f32_16x16x32_bf16 v[80:83], a[12:15], a[56:59], v[80:83]
ds_read_b128 a[116:119], v33 offset:1024
v_mfma_f32_16x16x32_bf16 v[84:87], a[8:11], a[44:47], v[84:87]
buffer_load_dwordx4 v1, s[12:15], s57 offen offset:2048 sc1 lds
v_mfma_f32_16x16x32_bf16 v[84:87], a[12:15], a[60:63], v[84:87]
ds_read_b128 a[132:135], v33 offset:9216
v_mfma_f32_16x16x32_bf16 v[88:91], a[8:11], a[48:51], v[88:91]
ds_read_b128 a[120:123], v33 offset:2048
v_mfma_f32_16x16x32_bf16 v[88:91], a[12:15], a[64:67], v[88:91]
ds_read_b128 a[136:139], v33 offset:10240
v_mfma_f32_16x16x32_bf16 v[92:95], a[8:11], a[52:55], v[92:95]
buffer_load_dwordx4 v1, s[12:15], s57 offen offset:3072 sc1 lds
v_mfma_f32_16x16x32_bf16 v[92:95], a[12:15], a[68:71], v[92:95]
s_add_u32 s57, s57, 8192
ds_read_b128 a[124:127], v33 offset:3072
v_mfma_f32_16x16x32_bf16 v[96:99], a[16:19], a[40:43], v[96:99]
s_add_u32 m0, s58, 110592
ds_read_b128 a[140:143], v33 offset:11264
v_mfma_f32_16x16x32_bf16 v[96:99], a[20:23], a[56:59], v[96:99]
s_cmp_eq_u32 s28, 3
buffer_load_dwordx4 v1, s[12:15], s56 offen offset:0 sc1 lds
v_mfma_f32_16x16x32_bf16 v[100:103], a[16:19], a[44:47], v[100:103]
s_cselect_b32 s33, s32, 0x40000000
ds_read_b128 a[80:83], v32 offset:1024
v_mfma_f32_16x16x32_bf16 v[100:103], a[20:23], a[60:63], v[100:103]
ds_read_b128 a[84:87], v32 offset:11264
v_mfma_f32_16x16x32_bf16 v[104:107], a[16:19], a[48:51], v[104:107]
ds_read_b128 a[88:91], v32 offset:2048
v_mfma_f32_16x16x32_bf16 v[104:107], a[20:23], a[64:67], v[104:107]
buffer_load_dword v44, v42, s[12:15], s33 offen sc1
v_mfma_f32_16x16x32_bf16 v[108:111], a[16:19], a[52:55], v[108:111]
ds_read_b128 a[92:95], v32 offset:12288
v_mfma_f32_16x16x32_bf16 v[108:111], a[20:23], a[68:71], v[108:111]
ds_read_b128 a[96:99], v32 offset:3072
v_mfma_f32_16x16x32_bf16 v[112:115], a[24:27], a[40:43], v[112:115]
ds_read_b128 a[100:103], v32 offset:13312
v_mfma_f32_16x16x32_bf16 v[112:115], a[28:31], a[56:59], v[112:115]
buffer_load_dwordx4 v1, s[12:15], s56 offen offset:1024 sc1 lds
v_mfma_f32_16x16x32_bf16 v[116:119], a[24:27], a[44:47], v[116:119]
ds_read_b128 a[104:107], v32 offset:4096
v_mfma_f32_16x16x32_bf16 v[116:119], a[28:31], a[60:63], v[116:119]
ds_read_b128 a[108:111], v32 offset:14336
v_mfma_f32_16x16x32_bf16 v[120:123], a[24:27], a[48:51], v[120:123]
buffer_load_dwordx4 v1, s[12:15], s56 offen offset:2048 sc1 lds
v_mfma_f32_16x16x32_bf16 v[120:123], a[28:31], a[64:67], v[120:123]
v_mfma_f32_16x16x32_bf16 v[124:127], a[24:27], a[52:55], v[124:127]
v_mfma_f32_16x16x32_bf16 v[124:127], a[28:31], a[68:71], v[124:127]
v_mfma_f32_16x16x32_bf16 v[128:131], a[32:35], a[40:43], v[128:131]
buffer_load_dwordx4 v1, s[12:15], s56 offen offset:3072 sc1 lds
v_mfma_f32_16x16x32_bf16 v[128:131], a[36:39], a[56:59], v[128:131]
s_add_u32 m0, s58, 114688
v_mfma_f32_16x16x32_bf16 v[132:135], a[32:35], a[44:47], v[132:135]
s_add_u32 s56, s56, 4096
v_mfma_f32_16x16x32_bf16 v[132:135], a[36:39], a[60:63], v[132:135]
v_mfma_f32_16x16x32_bf16 v[136:139], a[32:35], a[48:51], v[136:139]
buffer_load_dwordx4 v1, s[12:15], s56 offen offset:0 sc1 lds
v_mfma_f32_16x16x32_bf16 v[136:139], a[36:39], a[64:67], v[136:139]
s_add_u32 s56, s56, 16384
v_mfma_f32_16x16x32_bf16 v[140:143], a[32:35], a[52:55], v[140:143]
s_cmp_eq_u32 s56, s20
v_mfma_f32_16x16x32_bf16 v[140:143], a[36:39], a[68:71], v[140:143]
s_cmov_b32 s56, s35
s_waitcnt lgkmcnt(15)
v_mfma_f32_16x16x32_bf16 v[64:67], a[72:75], a[112:115], v[64:67]
s_waitcnt lgkmcnt(14)
s_cmp_eq_u32 s57, s60
v_add_u32 v32, 0xfffee000, v32
v_add_u32 v33, 0xfffee000, v33
v_mfma_f32_16x16x32_bf16 v[64:67], a[76:79], a[128:131], v[64:67]
s_waitcnt lgkmcnt(13)
s_cmov_b32 s57, s21
v_mfma_f32_16x16x32_bf16 v[68:71], a[72:75], a[116:119], v[68:71]
s_waitcnt vmcnt(19) lgkmcnt(0)
s_barrier
v_mfma_f32_16x16x32_bf16 v[68:71], a[76:79], a[132:135], v[68:71]
s_add_u32 m0, s59, 94208
ds_read_b128 a[0:3], v32 offset:0
v_mfma_f32_16x16x32_bf16 v[72:75], a[72:75], a[120:123], v[72:75]
buffer_load_dwordx4 v1, s[12:15], s57 offen offset:0 sc1 lds
v_mfma_f32_16x16x32_bf16 v[72:75], a[76:79], a[136:139], v[72:75]
ds_read_b128 a[4:7], v32 offset:10240
v_mfma_f32_16x16x32_bf16 v[76:79], a[72:75], a[124:127], v[76:79]
ds_read_b128 a[40:43], v33 offset:0
v_mfma_f32_16x16x32_bf16 v[76:79], a[76:79], a[140:143], v[76:79]
buffer_load_dwordx4 v1, s[12:15], s57 offen offset:1024 sc1 lds
v_mfma_f32_16x16x32_bf16 v[80:83], a[80:83], a[112:115], v[80:83]
ds_read_b128 a[56:59], v33 offset:8192
v_mfma_f32_16x16x32_bf16 v[80:83], a[84:87], a[128:131], v[80:83]
ds_read_b128 a[44:47], v33 offset:1024
v_mfma_f32_16x16x32_bf16 v[84:87], a[80:83], a[116:119], v[84:87]
ds_read_b128 a[60:63], v33 offset:9216
v_mfma_f32_16x16x32_bf16 v[84:87], a[84:87], a[132:135], v[84:87]
buffer_load_dwordx4 v1, s[12:15], s57 offen offset:2048 sc1 lds
v_mfma_f32_16x16x32_bf16 v[88:91], a[80:83], a[120:123], v[88:91]
ds_read_b128 a[48:51], v33 offset:2048
v_mfma_f32_16x16x32_bf16 v[88:91], a[84:87], a[136:139], v[88:91]
ds_read_b128 a[64:67], v33 offset:10240
v_mfma_f32_16x16x32_bf16 v[92:95], a[80:83], a[124:127], v[92:95]
ds_read_b128 a[52:55], v33 offset:3072
v_mfma_f32_16x16x32_bf16 v[92:95], a[84:87], a[140:143], v[92:95]
buffer_load_dwordx4 v1, s[12:15], s57 offen offset:3072 sc1 lds
v_mfma_f32_16x16x32_bf16 v[96:99], a[88:91], a[112:115], v[96:99]
s_add_u32 s57, s57, 8192
ds_read_b128 a[68:71], v33 offset:11264
v_mfma_f32_16x16x32_bf16 v[96:99], a[92:95], a[128:131], v[96:99]
s_add_u32 m0, s58, 73728
ds_read_b128 a[8:11], v32 offset:1024
v_mfma_f32_16x16x32_bf16 v[100:103], a[88:91], a[116:119], v[100:103]
ds_read_b128 a[12:15], v32 offset:11264
v_mfma_f32_16x16x32_bf16 v[100:103], a[92:95], a[132:135], v[100:103]
buffer_load_dwordx4 v1, s[12:15], s56 offen offset:0 sc1 lds
v_mfma_f32_16x16x32_bf16 v[104:107], a[88:91], a[120:123], v[104:107]
ds_read_b128 a[16:19], v32 offset:2048
v_mfma_f32_16x16x32_bf16 v[104:107], a[92:95], a[136:139], v[104:107]
ds_read_b128 a[20:23], v32 offset:12288
v_mfma_f32_16x16x32_bf16 v[108:111], a[88:91], a[124:127], v[108:111]
ds_read_b128 a[24:27], v32 offset:3072
v_mfma_f32_16x16x32_bf16 v[108:111], a[92:95], a[140:143], v[108:111]
buffer_load_dwordx4 v1, s[12:15], s56 offen offset:1024 sc1 lds
v_mfma_f32_16x16x32_bf16 v[112:115], a[96:99], a[112:115], v[112:115]
ds_read_b128 a[28:31], v32 offset:13312
v_mfma_f32_16x16x32_bf16 v[112:115], a[100:103], a[128:131], v[112:115]
ds_read_b128 a[32:35], v32 offset:4096
v_mfma_f32_16x16x32_bf16 v[116:119], a[96:99], a[116:119], v[116:119]
ds_read_b128 a[36:39], v32 offset:14336
v_mfma_f32_16x16x32_bf16 v[116:119], a[100:103], a[132:135], v[116:119]
buffer_load_dwordx4 v1, s[12:15], s56 offen offset:2048 sc1 lds
v_mfma_f32_16x16x32_bf16 v[120:123], a[96:99], a[120:123], v[120:123]
v_mfma_f32_16x16x32_bf16 v[120:123], a[100:103], a[136:139], v[120:123]
v_mfma_f32_16x16x32_bf16 v[124:127], a[96:99], a[124:127], v[124:127]
v_mfma_f32_16x16x32_bf16 v[124:127], a[100:103], a[140:143], v[124:127]
buffer_load_dwordx4 v1, s[12:15], s56 offen offset:3072 sc1 lds
v_mfma_f32_16x16x32_bf16 v[128:131], a[104:107], a[112:115], v[128:131]
s_add_u32 m0, s58, 77824
v_mfma_f32_16x16x32_bf16 v[128:131], a[108:111], a[128:131], v[128:131]
s_add_u32 s56, s56, 4096
v_mfma_f32_16x16x32_bf16 v[132:135], a[104:107], a[116:119], v[132:135]
v_mfma_f32_16x16x32_bf16 v[132:135], a[108:111], a[132:135], v[132:135]
buffer_load_dwordx4 v1, s[12:15], s56 offen offset:0 sc1 lds
v_mfma_f32_16x16x32_bf16 v[136:139], a[104:107], a[120:123], v[136:139]
s_add_u32 s56, s56, 16384
v_mfma_f32_16x16x32_bf16 v[136:139], a[108:111], a[136:139], v[136:139]
s_cmp_eq_u32 s56, s20
v_mfma_f32_16x16x32_bf16 v[140:143], a[104:107], a[124:127], v[140:143]
s_cmov_b32 s56, s35
v_mfma_f32_16x16x32_bf16 v[140:143], a[108:111], a[140:143], v[140:143]
s_waitcnt lgkmcnt(15)
v_mfma_f32_16x16x32_bf16 v[64:67], a[0:3], a[40:43], v[64:67]
s_waitcnt lgkmcnt(14)
s_cmp_eq_u32 s57, s60
v_mfma_f32_16x16x32_bf16 v[64:67], a[4:7], a[56:59], v[64:67]
s_waitcnt lgkmcnt(13)
s_cmov_b32 s57, s21
v_mfma_f32_16x16x32_bf16 v[68:71], a[0:3], a[44:47], v[68:71]
s_waitcnt vmcnt(19) lgkmcnt(0)
s_barrier
v_mfma_f32_16x16x32_bf16 v[68:71], a[4:7], a[60:63], v[68:71]
s_add_u32 m0, s59, 20480
ds_read_b128 a[72:75], v32 offset:36864
v_mfma_f32_16x16x32_bf16 v[72:75], a[0:3], a[48:51], v[72:75]
buffer_load_dwordx4 v1, s[12:15], s57 offen offset:0 sc1 lds
v_mfma_f32_16x16x32_bf16 v[72:75], a[4:7], a[64:67], v[72:75]
ds_read_b128 a[76:79], v32 offset:47104
v_mfma_f32_16x16x32_bf16 v[76:79], a[0:3], a[52:55], v[76:79]
ds_read_b128 a[112:115], v33 offset:36864
v_mfma_f32_16x16x32_bf16 v[76:79], a[4:7], a[68:71], v[76:79]
buffer_load_dwordx4 v1, s[12:15], s57 offen offset:1024 sc1 lds
v_mfma_f32_16x16x32_bf16 v[80:83], a[8:11], a[40:43], v[80:83]
ds_read_b128 a[128:131], v33 offset:45056
v_mfma_f32_16x16x32_bf16 v[80:83], a[12:15], a[56:59], v[80:83]
ds_read_b128 a[116:119], v33 offset:37888
v_mfma_f32_16x16x32_bf16 v[84:87], a[8:11], a[44:47], v[84:87]
ds_read_b128 a[132:135], v33 offset:46080
v_mfma_f32_16x16x32_bf16 v[84:87], a[12:15], a[60:63], v[84:87]
buffer_load_dwordx4 v1, s[12:15], s57 offen offset:2048 sc1 lds
v_mfma_f32_16x16x32_bf16 v[88:91], a[8:11], a[48:51], v[88:91]
ds_read_b128 a[120:123], v33 offset:38912
v_mfma_f32_16x16x32_bf16 v[88:91], a[12:15], a[64:67], v[88:91]
ds_read_b128 a[136:139], v33 offset:47104
v_mfma_f32_16x16x32_bf16 v[92:95], a[8:11], a[52:55], v[92:95]
ds_read_b128 a[124:127], v33 offset:39936
v_mfma_f32_16x16x32_bf16 v[92:95], a[12:15], a[68:71], v[92:95]
buffer_load_dwordx4 v1, s[12:15], s57 offen offset:3072 sc1 lds
v_mfma_f32_16x16x32_bf16 v[96:99], a[16:19], a[40:43], v[96:99]
s_add_u32 s57, s57, 8192
ds_read_b128 a[140:143], v33 offset:48128
v_mfma_f32_16x16x32_bf16 v[96:99], a[20:23], a[56:59], v[96:99]
s_add_u32 m0, s58, 0
ds_read_b128 a[80:83], v32 offset:37888
v_mfma_f32_16x16x32_bf16 v[100:103], a[16:19], a[44:47], v[100:103]
ds_read_b128 a[84:87], v32 offset:48128
v_mfma_f32_16x16x32_bf16 v[100:103], a[20:23], a[60:63], v[100:103]
buffer_load_dwordx4 v1, s[12:15], s56 offen offset:0 sc1 lds
v_mfma_f32_16x16x32_bf16 v[104:107], a[16:19], a[48:51], v[104:107]
ds_read_b128 a[88:91], v32 offset:38912
v_mfma_f32_16x16x32_bf16 v[104:107], a[20:23], a[64:67], v[104:107]
ds_read_b128 a[92:95], v32 offset:49152
v_mfma_f32_16x16x32_bf16 v[108:111], a[16:19], a[52:55], v[108:111]
ds_read_b128 a[96:99], v32 offset:39936
v_mfma_f32_16x16x32_bf16 v[108:111], a[20:23], a[68:71], v[108:111]
buffer_load_dwordx4 v1, s[12:15], s56 offen offset:1024 sc1 lds
v_mfma_f32_16x16x32_bf16 v[112:115], a[24:27], a[40:43], v[112:115]
ds_read_b128 a[100:103], v32 offset:50176
v_mfma_f32_16x16x32_bf16 v[112:115], a[28:31], a[56:59], v[112:115]
ds_read_b128 a[104:107], v32 offset:40960
v_mfma_f32_16x16x32_bf16 v[116:119], a[24:27], a[44:47], v[116:119]
ds_read_b128 a[108:111], v32 offset:51200
v_mfma_f32_16x16x32_bf16 v[116:119], a[28:31], a[60:63], v[116:119]
buffer_load_dwordx4 v1, s[12:15], s56 offen offset:2048 sc1 lds
v_mfma_f32_16x16x32_bf16 v[120:123], a[24:27], a[48:51], v[120:123]
v_mfma_f32_16x16x32_bf16 v[120:123], a[28:31], a[64:67], v[120:123]
v_mfma_f32_16x16x32_bf16 v[124:127], a[24:27], a[52:55], v[124:127]
v_mfma_f32_16x16x32_bf16 v[124:127], a[28:31], a[68:71], v[124:127]
buffer_load_dwordx4 v1, s[12:15], s56 offen offset:3072 sc1 lds
v_mfma_f32_16x16x32_bf16 v[128:131], a[32:35], a[40:43], v[128:131]
s_add_u32 m0, s58, 4096
v_mfma_f32_16x16x32_bf16 v[128:131], a[36:39], a[56:59], v[128:131]
s_add_u32 s56, s56, 4096
v_mfma_f32_16x16x32_bf16 v[132:135], a[32:35], a[44:47], v[132:135]
v_mfma_f32_16x16x32_bf16 v[132:135], a[36:39], a[60:63], v[132:135]
buffer_load_dwordx4 v1, s[12:15], s56 offen offset:0 sc1 lds
v_mfma_f32_16x16x32_bf16 v[136:139], a[32:35], a[48:51], v[136:139]
s_add_u32 s56, s56, 16384
v_mfma_f32_16x16x32_bf16 v[136:139], a[36:39], a[64:67], v[136:139]
s_cmp_eq_u32 s56, s20
v_mfma_f32_16x16x32_bf16 v[140:143], a[32:35], a[52:55], v[140:143]
s_cmov_b32 s56, s35
v_mfma_f32_16x16x32_bf16 v[140:143], a[36:39], a[68:71], v[140:143]
s_waitcnt lgkmcnt(15)
v_mfma_f32_16x16x32_bf16 v[64:67], a[72:75], a[112:115], v[64:67]
s_waitcnt lgkmcnt(14)
s_cmp_eq_u32 s57, s60
v_add_u32 v32, 0x1b000, v32
v_add_u32 v33, 0x1b000, v33
v_mfma_f32_16x16x32_bf16 v[64:67], a[76:79], a[128:131], v[64:67]
s_waitcnt lgkmcnt(13)
s_cmov_b32 s57, s21
v_mfma_f32_16x16x32_bf16 v[68:71], a[72:75], a[116:119], v[68:71]
s_waitcnt vmcnt(18) lgkmcnt(0)
s_barrier
v_mfma_f32_16x16x32_bf16 v[68:71], a[76:79], a[132:135], v[68:71]
s_add_u32 m0, s59, 57344
ds_read_b128 a[0:3], v32 offset:0
v_mfma_f32_16x16x32_bf16 v[72:75], a[72:75], a[120:123], v[72:75]
buffer_load_dwordx4 v1, s[12:15], s57 offen offset:0 sc1 lds
v_mfma_f32_16x16x32_bf16 v[72:75], a[76:79], a[136:139], v[72:75]
ds_read_b128 a[4:7], v32 offset:10240
v_mfma_f32_16x16x32_bf16 v[76:79], a[72:75], a[124:127], v[76:79]
ds_read_b128 a[40:43], v33 offset:0
v_mfma_f32_16x16x32_bf16 v[76:79], a[76:79], a[140:143], v[76:79]
buffer_load_dwordx4 v1, s[12:15], s57 offen offset:1024 sc1 lds
v_mfma_f32_16x16x32_bf16 v[80:83], a[80:83], a[112:115], v[80:83]
ds_read_b128 a[56:59], v33 offset:8192
v_mfma_f32_16x16x32_bf16 v[80:83], a[84:87], a[128:131], v[80:83]
ds_read_b128 a[44:47], v33 offset:1024
v_mfma_f32_16x16x32_bf16 v[84:87], a[80:83], a[116:119], v[84:87]
buffer_load_dwordx4 v1, s[12:15], s57 offen offset:2048 sc1 lds
v_mfma_f32_16x16x32_bf16 v[84:87], a[84:87], a[132:135], v[84:87]
ds_read_b128 a[60:63], v33 offset:9216
v_mfma_f32_16x16x32_bf16 v[88:91], a[80:83], a[120:123], v[88:91]
ds_read_b128 a[48:51], v33 offset:2048
v_mfma_f32_16x16x32_bf16 v[88:91], a[84:87], a[136:139], v[88:91]
ds_read_b128 a[64:67], v33 offset:10240
v_mfma_f32_16x16x32_bf16 v[92:95], a[80:83], a[124:127], v[92:95]
buffer_load_dwordx4 v1, s[12:15], s57 offen offset:3072 sc1 lds
v_mfma_f32_16x16x32_bf16 v[92:95], a[84:87], a[140:143], v[92:95]
s_add_u32 s57, s57, 8192
ds_read_b128 a[52:55], v33 offset:3072
v_mfma_f32_16x16x32_bf16 v[96:99], a[88:91], a[112:115], v[96:99]
s_add_u32 m0, s58, 36864
ds_read_b128 a[68:71], v33 offset:11264
v_mfma_f32_16x16x32_bf16 v[96:99], a[92:95], a[128:131], v[96:99]
s_cmp_eq_u32 s28, 0
buffer_load_dwordx4 v1, s[12:15], s56 offen offset:0 sc1 lds
v_mfma_f32_16x16x32_bf16 v[100:103], a[88:91], a[116:119], v[100:103]
s_cselect_b32 s33, s54, 0x40000000
ds_read_b128 a[8:11], v32 offset:1024
v_mfma_f32_16x16x32_bf16 v[100:103], a[92:95], a[132:135], v[100:103]
ds_read_b128 a[12:15], v32 offset:11264
v_mfma_f32_16x16x32_bf16 v[104:107], a[88:91], a[120:123], v[104:107]
ds_read_b128 a[16:19], v32 offset:2048
v_mfma_f32_16x16x32_bf16 v[104:107], a[92:95], a[136:139], v[104:107]
buffer_store_dword v15, v14, s[12:15], s33 offen sc1
v_mfma_f32_16x16x32_bf16 v[108:111], a[88:91], a[124:127], v[108:111]
ds_read_b128 a[20:23], v32 offset:12288
v_mfma_f32_16x16x32_bf16 v[108:111], a[92:95], a[140:143], v[108:111]
ds_read_b128 a[24:27], v32 offset:3072
v_mfma_f32_16x16x32_bf16 v[112:115], a[96:99], a[112:115], v[112:115]
ds_read_b128 a[28:31], v32 offset:13312
v_mfma_f32_16x16x32_bf16 v[112:115], a[100:103], a[128:131], v[112:115]
buffer_load_dwordx4 v1, s[12:15], s56 offen offset:1024 sc1 lds
v_mfma_f32_16x16x32_bf16 v[116:119], a[96:99], a[116:119], v[116:119]
ds_read_b128 a[32:35], v32 offset:4096
v_mfma_f32_16x16x32_bf16 v[116:119], a[100:103], a[132:135], v[116:119]
ds_read_b128 a[36:39], v32 offset:14336
v_mfma_f32_16x16x32_bf16 v[120:123], a[96:99], a[120:123], v[120:123]
buffer_load_dwordx4 v1, s[12:15], s56 offen offset:2048 sc1 lds
v_mfma_f32_16x16x32_bf16 v[120:123], a[100:103], a[136:139], v[120:123]
v_mfma_f32_16x16x32_bf16 v[124:127], a[96:99], a[124:127], v[124:127]
v_mfma_f32_16x16x32_bf16 v[124:127], a[100:103], a[140:143], v[124:127]
v_mfma_f32_16x16x32_bf16 v[128:131], a[104:107], a[112:115], v[128:131]
buffer_load_dwordx4 v1, s[12:15], s56 offen offset:3072 sc1 lds
v_mfma_f32_16x16x32_bf16 v[128:131], a[108:111], a[128:131], v[128:131]
s_add_u32 m0, s58, 40960
v_mfma_f32_16x16x32_bf16 v[132:135], a[104:107], a[116:119], v[132:135]
s_add_u32 s56, s56, 4096
v_mfma_f32_16x16x32_bf16 v[132:135], a[108:111], a[132:135], v[132:135]
v_mfma_f32_16x16x32_bf16 v[136:139], a[104:107], a[120:123], v[136:139]
buffer_load_dwordx4 v1, s[12:15], s56 offen offset:0 sc1 lds
v_mfma_f32_16x16x32_bf16 v[136:139], a[108:111], a[136:139], v[136:139]
s_add_u32 s56, s56, 16384
v_mfma_f32_16x16x32_bf16 v[140:143], a[104:107], a[124:127], v[140:143]
s_cmp_eq_u32 s56, s20
v_mfma_f32_16x16x32_bf16 v[140:143], a[108:111], a[140:143], v[140:143]
s_cmov_b32 s56, s35
s_add_u32 s28, s28, 1
s_cmp_lt_u32 s28, 4
s_cbranch_scc1 L_o
v_xor_b32 v48, s40, v48
v_xor_b32 v49, s40, v49
v_xor_b32 v50, s40, v50
v_xor_b32 v51, s40, v51
v_or3_b32 v48, v48, v49, v50
v_or_b32 v48, v48, v51
v_cmp_ne_u32 vcc, 0, v48
s_nop 1
s_cbranch_vccnz L_spin_w2
L_back_w2:
v_cmp_ne_u32 vcc, s40, v44
s_nop 1
s_cbranch_vccnz L_spin_h
L_back_h:
s_waitcnt lgkmcnt(15)
v_mfma_f32_16x16x32_bf16 v[64:67], a[0:3], a[40:43], v[64:67]
s_waitcnt lgkmcnt(14)
s_add_u32 m0, s25, 110592
global_load_dword v30, v1, s[62:63]
v_mfma_f32_16x16x32_bf16 v[64:67], a[4:7], a[56:59], v[64:67]
s_waitcnt lgkmcnt(13)
s_add_u32 s62, s62, 0x2000
v_add_u32 v32, 0xffff7000, v32
v_add_u32 v33, 0xffff7000, v33
v_mfma_f32_16x16x32_bf16 v[68:71], a[0:3], a[44:47], v[68:71]
s_waitcnt vmcnt(20) lgkmcnt(0)
s_barrier
v_mfma_f32_16x16x32_bf16 v[68:71], a[4:7], a[60:63], v[68:71]
s_addc_u32 s63, s63, 0
buffer_load_dwordx4 v1, s[12:15], s43 offen offset:0 sc1 lds
v_mfma_f32_16x16x32_bf16 v[72:75], a[0:3], a[48:51], v[72:75]
ds_read_b128 a[72:75], v32 offset:0
v_mfma_f32_16x16x32_bf16 v[72:75], a[4:7], a[64:67], v[72:75]
ds_read_b128 a[76:79], v32 offset:10240
v_mfma_f32_16x16x32_bf16 v[76:79], a[0:3], a[52:55], v[76:79]
buffer_load_dwordx4 a[144:147], v1, s[12:15], s44 offen sc1
v_mfma_f32_16x16x32_bf16 v[76:79], a[4:7], a[68:71], v[76:79]
s_add_u32 s44, s44, 4096
ds_read_b128 a[112:115], v33 offset:0
v_mfma_f32_16x16x32_bf16 v[80:83], a[8:11], a[40:43], v[80:83]
ds_read_b128 a[128:131], v33 offset:8192
v_mfma_f32_16x16x32_bf16 v[80:83], a[12:15], a[56:59], v[80:83]
buffer_load_dwordx4 v1, s[12:15], s43 offen offset:1024 sc1 lds
v_mfma_f32_16x16x32_bf16 v[84:87], a[8:11], a[44:47], v[84:87]
ds_read_b128 a[116:119], v33 offset:1024
v_mfma_f32_16x16x32_bf16 v[84:87], a[12:15], a[60:63], v[84:87]
ds_read_b128 a[132:135], v33 offset:9216
v_mfma_f32_16x16x32_bf16 v[88:91], a[8:11], a[48:51], v[88:91]
buffer_load_dwordx4 v1, s[12:15], s43 offen offset:2048 sc1 lds
v_mfma_f32_16x16x32_bf16 v[88:91], a[12:15], a[64:67], v[88:91]
ds_read_b128 a[120:123], v33 offset:2048
v_mfma_f32_16x16x32_bf16 v[92:95], a[8:11], a[52:55], v[92:95]
ds_read_b128 a[136:139], v33 offset:10240
v_mfma_f32_16x16x32_bf16 v[92:95], a[12:15], a[68:71], v[92:95]
buffer_load_dwordx4 a[148:151], v1, s[12:15], s44 offen sc1
v_mfma_f32_16x16x32_bf16 v[96:99], a[16:19], a[40:43], v[96:99]
ds_read_b128 a[124:127], v33 offset:3072
v_mfma_f32_16x16x32_bf16 v[96:99], a[20:23], a[56:59], v[96:99]
ds_read_b128 a[140:143], v33 offset:11264
v_mfma_f32_16x16x32_bf16 v[100:103], a[16:19], a[44:47], v[100:103]
buffer_load_dwordx4 v1, s[12:15], s43 offen offset:3072 sc1 lds
v_mfma_f32_16x16x32_bf16 v[100:103], a[20:23], a[60:63], v[100:103]
s_add_u32 s43, s43, 4096
ds_read_b128 a[80:83], v32 offset:1024
v_mfma_f32_16x16x32_bf16 v[104:107], a[16:19], a[48:51], v[104:107]
s_add_u32 m0, s25, 114688
ds_read_b128 a[84:87], v32 offset:11264
v_mfma_f32_16x16x32_bf16 v[104:107], a[20:23], a[64:67], v[104:107]
s_add_u32 s44, s44, 4096
buffer_load_dwordx4 v1, s[12:15], s43 offen offset:0 sc1 lds
v_mfma_f32_16x16x32_bf16 v[108:111], a[16:19], a[52:55], v[108:111]
s_cmp_eq_u32 s30, 3
ds_read_b128 a[88:91], v32 offset:2048
v_mfma_f32_16x16x32_bf16 v[108:111], a[20:23], a[68:71], v[108:111]
s_cselect_b32 s56, 0x40000000, s43
ds_read_b128 a[92:95], v32 offset:12288
v_mfma_f32_16x16x32_bf16 v[112:115], a[24:27], a[40:43], v[112:115]
buffer_load_dwordx4 a[152:155], v1, s[12:15], s44 offen sc1
v_mfma_f32_16x16x32_bf16 v[112:115], a[28:31], a[56:59], v[112:115]
s_add_u32 s44, s44, 4096
ds_read_b128 a[96:99], v32 offset:3072
v_mfma_f32_16x16x32_bf16 v[116:119], a[24:27], a[44:47], v[116:119]
ds_read_b128 a[100:103], v32 offset:13312
v_mfma_f32_16x16x32_bf16 v[116:119], a[28:31], a[60:63], v[116:119]
buffer_load_dwordx4 v1, s[12:15], s43 offen offset:1024 sc1 lds
v_mfma_f32_16x16x32_bf16 v[120:123], a[24:27], a[48:51], v[120:123]
ds_read_b128 a[104:107], v32 offset:4096
v_mfma_f32_16x16x32_bf16 v[120:123], a[28:31], a[64:67], v[120:123]
ds_read_b128 a[108:111], v32 offset:14336
v_mfma_f32_16x16x32_bf16 v[124:127], a[24:27], a[52:55], v[124:127]
buffer_load_dwordx4 v1, s[12:15], s56 offen offset:2048 sc1 lds
v_mfma_f32_16x16x32_bf16 v[124:127], a[28:31], a[68:71], v[124:127]
v_mfma_f32_16x16x32_bf16 v[128:131], a[32:35], a[40:43], v[128:131]
v_mfma_f32_16x16x32_bf16 v[128:131], a[36:39], a[56:59], v[128:131]
buffer_load_dwordx4 a[156:159], v1, s[12:15], s44 offen sc1
v_mfma_f32_16x16x32_bf16 v[132:135], a[32:35], a[44:47], v[132:135]
s_add_u32 s44, s44, 4096
v_mfma_f32_16x16x32_bf16 v[132:135], a[36:39], a[60:63], v[132:135]
s_add_u32 s43, s43, 26624
v_mfma_f32_16x16x32_bf16 v[136:139], a[32:35], a[48:51], v[136:139]
buffer_load_dwordx4 v1, s[12:15], s56 offen offset:3072 sc1 lds
v_mfma_f32_16x16x32_bf16 v[136:139], a[36:39], a[64:67], v[136:139]
v_mfma_f32_16x16x32_bf16 v[140:143], a[32:35], a[52:55], v[140:143]
v_mfma_f32_16x16x32_bf16 v[140:143], a[36:39], a[68:71], v[140:143]
s_waitcnt lgkmcnt(15)
v_mfma_f32_16x16x32_bf16 v[64:67], a[72:75], a[112:115], v[64:67]
s_waitcnt lgkmcnt(14)
s_add_u32 m0, s25, 73728
v_add_u32 v32, 0xfffee000, v32
v_add_u32 v33, 0xfffee000, v33
v_mfma_f32_16x16x32_bf16 v[64:67], a[76:79], a[128:131], v[64:67]
s_waitcnt lgkmcnt(13)
v_mfma_f32_16x16x32_bf16 v[68:71], a[72:75], a[116:119], v[68:71]
s_waitcnt vmcnt(23) lgkmcnt(0)
s_barrier
v_mfma_f32_16x16x32_bf16 v[68:71], a[76:79], a[132:135], v[68:71]
buffer_load_dwordx4 v1, s[12:15], s43 offen offset:0 sc1 lds
v_mfma_f32_16x16x32_bf16 v[72:75], a[72:75], a[120:123], v[72:75]
ds_read_b128 a[0:3], v32 offset:0
v_mfma_f32_16x16x32_bf16 v[72:75], a[76:79], a[136:139], v[72:75]
ds_read_b128 a[4:7], v32 offset:10240
v_mfma_f32_16x16x32_bf16 v[76:79], a[72:75], a[124:127], v[76:79]
buffer_load_dwordx4 a[160:163], v1, s[12:15], s44 offen sc1
v_mfma_f32_16x16x32_bf16 v[76:79], a[76:79], a[140:143], v[76:79]
s_add_u32 s44, s44, 4096
ds_read_b128 a[40:43], v33 offset:0
v_mfma_f32_16x16x32_bf16 v[80:83], a[80:83], a[112:115], v[80:83]
ds_read_b128 a[56:59], v33 offset:8192
v_mfma_f32_16x16x32_bf16 v[80:83], a[84:87], a[128:131], v[80:83]
buffer_load_dwordx4 v1, s[12:15], s43 offen offset:1024 sc1 lds
v_mfma_f32_16x16x32_bf16 v[84:87], a[80:83], a[116:119], v[84:87]
ds_read_b128 a[44:47], v33 offset:1024
v_mfma_f32_16x16x32_bf16 v[84:87], a[84:87], a[132:135], v[84:87]
ds_read_b128 a[60:63], v33 offset:9216
v_mfma_f32_16x16x32_bf16 v[88:91], a[80:83], a[120:123], v[88:91]
buffer_load_dwordx4 v1, s[12:15], s43 offen offset:2048 sc1 lds
v_mfma_f32_16x16x32_bf16 v[88:91], a[84:87], a[136:139], v[88:91]
ds_read_b128 a[48:51], v33 offset:2048
v_mfma_f32_16x16x32_bf16 v[92:95], a[80:83], a[124:127], v[92:95]
ds_read_b128 a[64:67], v33 offset:10240
v_mfma_f32_16x16x32_bf16 v[92:95], a[84:87], a[140:143], v[92:95]
buffer_load_dwordx4 a[164:167], v1, s[12:15], s44 offen sc1
v_mfma_f32_16x16x32_bf16 v[96:99], a[88:91], a[112:115], v[96:99]
ds_read_b128 a[52:55], v33 offset:3072
v_mfma_f32_16x16x32_bf16 v[96:99], a[92:95], a[128:131], v[96:99]
ds_read_b128 a[68:71], v33 offset:11264
v_mfma_f32_16x16x32_bf16 v[100:103], a[88:91], a[116:119], v[100:103]
buffer_load_dwordx4 v1, s[12:15], s43 offen offset:3072 sc1 lds
v_mfma_f32_16x16x32_bf16 v[100:103], a[92:95], a[132:135], v[100:103]
s_add_u32 s43, s43, 4096
ds_read_b128 a[8:11], v32 offset:1024
v_mfma_f32_16x16x32_bf16 v[104:107], a[88:91], a[120:123], v[104:107]
s_add_u32 m0, s25, 77824
ds_read_b128 a[12:15], v32 offset:11264
v_mfma_f32_16x16x32_bf16 v[104:107], a[92:95], a[136:139], v[104:107]
s_add_u32 s44, s44, 4096
buffer_load_dwordx4 v1, s[12:15], s43 offen offset:0 sc1 lds
v_mfma_f32_16x16x32_bf16 v[108:111], a[88:91], a[124:127], v[108:111]
s_cmp_eq_u32 s30, 3
ds_read_b128 a[16:19], v32 offset:2048
v_mfma_f32_16x16x32_bf16 v[108:111], a[92:95], a[140:143], v[108:111]
s_cselect_b32 s56, 0x40000000, s43
ds_read_b128 a[20:23], v32 offset:12288
v_mfma_f32_16x16x32_bf16 v[112:115], a[96:99], a[112:115], v[112:115]
buffer_load_dwordx4 a[168:171], v1, s[12:15], s44 offen sc1
v_mfma_f32_16x16x32_bf16 v[112:115], a[100:103], a[128:131], v[112:115]
s_add_u32 s44, s44, 4096
ds_read_b128 a[24:27], v32 offset:3072
v_mfma_f32_16x16x32_bf16 v[116:119], a[96:99], a[116:119], v[116:119]
ds_read_b128 a[28:31], v32 offset:13312
v_mfma_f32_16x16x32_bf16 v[116:119], a[100:103], a[132:135], v[116:119]
buffer_load_dwordx4 v1, s[12:15], s43 offen offset:1024 sc1 lds
v_mfma_f32_16x16x32_bf16 v[120:123], a[96:99], a[120:123], v[120:123]
ds_read_b128 a[32:35], v32 offset:4096
v_mfma_f32_16x16x32_bf16 v[120:123], a[100:103], a[136:139], v[120:123]
ds_read_b128 a[36:39], v32 offset:14336
v_mfma_f32_16x16x32_bf16 v[124:127], a[96:99], a[124:127], v[124:127]
buffer_load_dwordx4 v1, s[12:15], s56 offen offset:2048 sc1 lds
v_mfma_f32_16x16x32_bf16 v[124:127], a[100:103], a[140:143], v[124:127]
v_mfma_f32_16x16x32_bf16 v[128:131], a[104:107], a[112:115], v[128:131]
v_mfma_f32_16x16x32_bf16 v[128:131], a[108:111], a[128:131], v[128:131]
buffer_load_dwordx4 a[172:175], v1, s[12:15], s44 offen sc1
v_mfma_f32_16x16x32_bf16 v[132:135], a[104:107], a[116:119], v[132:135]
s_add_u32 s44, s44, 4096
v_mfma_f32_16x16x32_bf16 v[132:135], a[108:111], a[132:135], v[132:135]
s_add_u32 s43, s43, 26624
v_mfma_f32_16x16x32_bf16 v[136:139], a[104:107], a[120:123], v[136:139]
buffer_load_dwordx4 v1, s[12:15], s56 offen offset:3072 sc1 lds
v_mfma_f32_16x16x32_bf16 v[136:139], a[108:111], a[136:139], v[136:139]
v_mfma_f32_16x16x32_bf16 v[140:143], a[104:107], a[124:127], v[140:143]
v_mfma_f32_16x16x32_bf16 v[140:143], a[108:111], a[140:143], v[140:143]
s_waitcnt lgkmcnt(15)
v_mfma_f32_16x16x32_bf16 v[64:67], a[0:3], a[40:43], v[64:67]
s_waitcnt lgkmcnt(14)
s_add_u32 m0, s25, 0
v_mfma_f32_16x16x32_bf16 v[64:67], a[4:7], a[56:59], v[64:67]
s_waitcnt lgkmcnt(13)
v_mfma_f32_16x16x32_bf16 v[68:71], a[0:3], a[44:47], v[68:71]
s_waitcnt vmcnt(25) lgkmcnt(0)
s_barrier
v_mfma_f32_16x16x32_bf16 v[68:71], a[4:7], a[60:63], v[68:71]
buffer_load_dwordx4 v1, s[12:15], s43 offen offset:0 sc1 lds
v_mfma_f32_16x16x32_bf16 v[72:75], a[0:3], a[48:51], v[72:75]
ds_read_b128 a[72:75], v32 offset:36864
v_mfma_f32_16x16x32_bf16 v[72:75], a[4:7], a[64:67], v[72:75]
buffer_load_dwordx4 a[176:179], v1, s[12:15], s44 offen sc1
v_mfma_f32_16x16x32_bf16 v[76:79], a[0:3], a[52:55], v[76:79]
s_add_u32 s44, s44, 4096
ds_read_b128 a[76:79], v32 offset:47104
v_mfma_f32_16x16x32_bf16 v[76:79], a[4:7], a[68:71], v[76:79]
ds_read_b128 a[112:115], v33 offset:36864
v_mfma_f32_16x16x32_bf16 v[80:83], a[8:11], a[40:43], v[80:83]
buffer_load_dwordx4 v1, s[12:15], s43 offen offset:1024 sc1 lds
v_mfma_f32_16x16x32_bf16 v[80:83], a[12:15], a[56:59], v[80:83]
ds_read_b128 a[128:131], v33 offset:45056
v_mfma_f32_16x16x32_bf16 v[84:87], a[8:11], a[44:47], v[84:87]
ds_read_b128 a[116:119], v33 offset:37888
v_mfma_f32_16x16x32_bf16 v[84:87], a[12:15], a[60:63], v[84:87]
buffer_load_dwordx4 a[180:183], v1, s[12:15], s44 offen sc1
v_mfma_f32_16x16x32_bf16 v[88:91], a[8:11], a[48:51], v[88:91]
s_add_u32 s44, s44, 4096
ds_read_b128 a[132:135], v33 offset:46080
v_mfma_f32_16x16x32_bf16 v[88:91], a[12:15], a[64:67], v[88:91]
ds_read_b128 a[120:123], v33 offset:38912
v_mfma_f32_16x16x32_bf16 v[92:95], a[8:11], a[52:55], v[92:95]
buffer_load_dwordx4 v1, s[12:15], s43 offen offset:2048 sc1 lds
v_mfma_f32_16x16x32_bf16 v[92:95], a[12:15], a[68:71], v[92:95]
ds_read_b128 a[136:139], v33 offset:47104
v_mfma_f32_16x16x32_bf16 v[96:99], a[16:19], a[40:43], v[96:99]
ds_read_b128 a[124:127], v33 offset:39936
v_mfma_f32_16x16x32_bf16 v[96:99], a[20:23], a[56:59], v[96:99]
buffer_load_dwordx4 v1, s[12:15], s43 offen offset:3072 sc1 lds
v_mfma_f32_16x16x32_bf16 v[100:103], a[16:19], a[44:47], v[100:103]
s_add_u32 s43, s43, 4096
ds_read_b128 a[140:143], v33 offset:48128
v_mfma_f32_16x16x32_bf16 v[100:103], a[20:23], a[60:63], v[100:103]
s_add_u32 m0, s25, 4096
ds_read_b128 a[80:83], v32 offset:37888
v_mfma_f32_16x16x32_bf16 v[104:107], a[16:19], a[48:51], v[104:107]
buffer_load_dwordx4 a[184:187], v1, s[12:15], s44 offen sc1
v_mfma_f32_16x16x32_bf16 v[104:107], a[20:23], a[64:67], v[104:107]
s_add_u32 s44, s44, 4096
ds_read_b128 a[84:87], v32 offset:48128
v_mfma_f32_16x16x32_bf16 v[108:111], a[16:19], a[52:55], v[108:111]
s_cmp_eq_u32 s30, 3
buffer_load_dwordx4 v1, s[12:15], s43 offen offset:0 sc1 lds
v_mfma_f32_16x16x32_bf16 v[108:111], a[20:23], a[68:71], v[108:111]
s_cselect_b32 s56, 0x40000000, s43
ds_read_b128 a[88:91], v32 offset:38912
v_mfma_f32_16x16x32_bf16 v[112:115], a[24:27], a[40:43], v[112:115]
ds_read_b128 a[92:95], v32 offset:49152
v_mfma_f32_16x16x32_bf16 v[112:115], a[28:31], a[56:59], v[112:115]
buffer_load_dwordx4 v1, s[12:15], s43 offen offset:1024 sc1 lds
v_mfma_f32_16x16x32_bf16 v[116:119], a[24:27], a[44:47], v[116:119]
ds_read_b128 a[96:99], v32 offset:39936
v_mfma_f32_16x16x32_bf16 v[116:119], a[28:31], a[60:63], v[116:119]
ds_read_b128 a[100:103], v32 offset:50176
v_mfma_f32_16x16x32_bf16 v[120:123], a[24:27], a[48:51], v[120:123]
buffer_load_dwordx4 a[188:191], v1, s[12:15], s44 offen sc1
v_mfma_f32_16x16x32_bf16 v[120:123], a[28:31], a[64:67], v[120:123]
s_add_u32 s44, s44, 4096
ds_read_b128 a[104:107], v32 offset:40960
v_mfma_f32_16x16x32_bf16 v[124:127], a[24:27], a[52:55], v[124:127]
ds_read_b128 a[108:111], v32 offset:51200
v_mfma_f32_16x16x32_bf16 v[124:127], a[28:31], a[68:71], v[124:127]
buffer_load_dwordx4 v1, s[12:15], s56 offen offset:2048 sc1 lds
v_mfma_f32_16x16x32_bf16 v[128:131], a[32:35], a[40:43], v[128:131]
v_mfma_f32_16x16x32_bf16 v[128:131], a[36:39], a[56:59], v[128:131]
v_mfma_f32_16x16x32_bf16 v[132:135], a[32:35], a[44:47], v[132:135]
buffer_load_dwordx4 a[192:195], v1, s[12:15], s44 offen sc1
v_mfma_f32_16x16x32_bf16 v[132:135], a[36:39], a[60:63], v[132:135]
s_add_u32 s44, s44, 4096
v_mfma_f32_16x16x32_bf16 v[136:139], a[32:35], a[48:51], v[136:139]
s_add_u32 s43, s43, 26624
v_mfma_f32_16x16x32_bf16 v[136:139], a[36:39], a[64:67], v[136:139]
buffer_load_dwordx4 v1, s[12:15], s56 offen offset:3072 sc1 lds
v_mfma_f32_16x16x32_bf16 v[140:143], a[32:35], a[52:55], v[140:143]
v_mfma_f32_16x16x32_bf16 v[140:143], a[36:39], a[68:71], v[140:143]
s_waitcnt lgkmcnt(15)
v_mfma_f32_16x16x32_bf16 v[64:67], a[72:75], a[112:115], v[64:67]
s_waitcnt lgkmcnt(14)
s_add_u32 m0, s25, 36864
v_and_b32 v46, 31, v0
v_lshlrev_b32 v46, 4, v46
v_mfma_f32_16x16x32_bf16 v[64:67], a[76:79], a[128:131], v[64:67]
s_waitcnt lgkmcnt(13)
s_lshl_b32 s33, s30, 11
v_lshrrev_b32 v39, 5, v0
v_and_b32 v38, 15, v0
v_mfma_f32_16x16x32_bf16 v[68:71], a[72:75], a[116:119], v[68:71]
s_waitcnt vmcnt(25) lgkmcnt(0)
s_barrier
v_add_u32 v45, s33, v1
v_lshl_add_u32 v46, v39, 3, v46
v_mfma_f32_16x16x32_bf16 v[68:71], a[76:79], a[132:135], v[68:71]
s_lshl_b32 s33, s30, 9
buffer_load_dwordx4 v1, s[12:15], s43 offen offset:0 sc1 lds
v_mfma_f32_16x16x32_bf16 v[72:75], a[72:75], a[120:123], v[72:75]
s_add_u32 s33, s33, 8192
ds_read_b128 a[240:243], v34 offset:0
v_mul_u32_u24 v38, 1280, v38
v_mfma_f32_16x16x32_bf16 v[72:75], a[76:79], a[136:139], v[72:75]
s_cmp_eq_u32 s30, s47
buffer_load_dwordx4 a[196:199], v1, s[12:15], s44 offen sc1
v_mfma_f32_16x16x32_bf16 v[76:79], a[72:75], a[124:127], v[76:79]
s_cmov_b32 s53, 0x40000000
ds_read_b128 a[244:247], v34 offset:5120
v_bfe_u32 v39, v0, 4, 1
v_mfma_f32_16x16x32_bf16 v[76:79], a[76:79], a[140:143], v[76:79]
s_add_u32 s44, s44, 4096
ds_read_b128 a[248:251], v34 offset:10240
v_lshl_add_u32 v38, v39, 5, v38
v_mfma_f32_16x16x32_bf16 v[80:83], a[80:83], a[112:115], v[80:83]
s_mov_b32 s57, s36
buffer_load_dwordx4 v1, s[12:15], s43 offen offset:1024 sc1 lds
v_mfma_f32_16x16x32_bf16 v[80:83], a[84:87], a[128:131], v[80:83]
ds_read_b128 a[252:255], v34 offset:15360
v_lshrrev_b32 v39, 5, v0
v_mfma_f32_16x16x32_bf16 v[84:87], a[80:83], a[116:119], v[84:87]
ds_read_b128 a[0:3], v34 offset:20480
v_add_u32 v46, s33, v46
v_mfma_f32_16x16x32_bf16 v[84:87], a[84:87], a[132:135], v[84:87]
buffer_load_dwordx4 a[200:203], v1, s[12:15], s44 offen sc1
v_mfma_f32_16x16x32_bf16 v[88:91], a[80:83], a[120:123], v[88:91]
s_add_u32 s44, s44, 4096
ds_read_b128 a[4:7], v34 offset:25600
v_add_u32 v47, 147456, v1
v_mfma_f32_16x16x32_bf16 v[88:91], a[84:87], a[136:139], v[88:91]
ds_read_b128 a[8:11], v34 offset:1024
v_lshl_add_u32 v38, v39, 4, v38
v_mfma_f32_16x16x32_bf16 v[92:95], a[80:83], a[124:127], v[92:95]
buffer_load_dwordx4 v1, s[12:15], s43 offen offset:2048 sc1 lds
v_mfma_f32_16x16x32_bf16 v[92:95], a[84:87], a[140:143], v[92:95]
ds_read_b128 a[12:15], v34 offset:6144
v_lshlrev_b32 v37, 3, v0
v_mfma_f32_16x16x32_bf16 v[96:99], a[88:91], a[112:115], v[96:99]
ds_read_b128 a[16:19], v34 offset:11264
v_mfma_f32_16x16x32_bf16 v[96:99], a[92:95], a[128:131], v[96:99]
buffer_load_dwordx4 v1, s[12:15], s43 offen offset:3072 sc1 lds
v_mfma_f32_16x16x32_bf16 v[100:103], a[88:91], a[116:119], v[100:103]
s_add_u32 s43, s43, 4096
ds_read_b128 a[20:23], v34 offset:16384
v_mfma_f32_16x16x32_bf16 v[100:103], a[92:95], a[132:135], v[100:103]
s_add_u32 m0, s25, 40960
ds_read_b128 a[24:27], v34 offset:21504
v_mfma_f32_16x16x32_bf16 v[104:107], a[88:91], a[120:123], v[104:107]
buffer_load_dwordx4 a[204:207], v1, s[12:15], s44 offen sc1
v_mfma_f32_16x16x32_bf16 v[104:107], a[92:95], a[136:139], v[104:107]
s_add_u32 s44, s44, 4096
ds_read_b128 a[28:31], v34 offset:26624
v_mfma_f32_16x16x32_bf16 v[108:111], a[88:91], a[124:127], v[108:111]
s_cmp_eq_u32 s30, 3
buffer_load_dwordx4 v1, s[12:15], s43 offen offset:0 sc1 lds
v_mfma_f32_16x16x32_bf16 v[108:111], a[92:95], a[140:143], v[108:111]
s_cselect_b32 s56, 0x40000000, s43
ds_read_b128 a[32:35], v34 offset:2048
v_mfma_f32_16x16x32_bf16 v[112:115], a[96:99], a[112:115], v[112:115]
v_mfma_f32_16x16x32_bf16 v[112:115], a[100:103], a[128:131], v[112:115]
buffer_load_dwordx4 v1, s[12:15], s43 offen offset:1024 sc1 lds
v_mfma_f32_16x16x32_bf16 v[116:119], a[96:99], a[116:119], v[116:119]
v_mfma_f32_16x16x32_bf16 v[116:119], a[100:103], a[132:135], v[116:119]
v_mfma_f32_16x16x32_bf16 v[120:123], a[96:99], a[120:123], v[120:123]
buffer_load_dwordx4 a[208:211], v1, s[12:15], s44 offen sc1
v_mfma_f32_16x16x32_bf16 v[120:123], a[100:103], a[136:139], v[120:123]
s_add_u32 s44, s44, 4096
v_mfma_f32_16x16x32_bf16 v[124:127], a[96:99], a[124:127], v[124:127]
v_mfma_f32_16x16x32_bf16 v[124:127], a[100:103], a[140:143], v[124:127]
buffer_load_dwordx4 v1, s[12:15], s56 offen offset:2048 sc1 lds
v_mfma_f32_16x16x32_bf16 v[128:131], a[104:107], a[112:115], v[128:131]
v_mfma_f32_16x16x32_bf16 v[128:131], a[108:111], a[128:131], v[128:131]
v_mfma_f32_16x16x32_bf16 v[132:135], a[104:107], a[116:119], v[132:135]
buffer_load_dwordx4 a[212:215], v1, s[12:15], s44 offen sc1
v_mfma_f32_16x16x32_bf16 v[132:135], a[108:111], a[132:135], v[132:135]
s_add_u32 s44, s44, 4096
v_mfma_f32_16x16x32_bf16 v[136:139], a[104:107], a[120:123], v[136:139]
s_add_u32 s43, s43, 26624
v_mfma_f32_16x16x32_bf16 v[136:139], a[108:111], a[136:139], v[136:139]
buffer_load_dwordx4 v1, s[12:15], s56 offen offset:3072 sc1 lds
v_mfma_f32_16x16x32_bf16 v[140:143], a[104:107], a[124:127], v[140:143]
v_mfma_f32_16x16x32_bf16 v[140:143], a[108:111], a[140:143], v[140:143]
s_waitcnt lgkmcnt(12)
v_mfma_f32_16x16x32_bf16 v[216:219], a[240:243], a[144:147], 0
s_waitcnt lgkmcnt(11)
ds_read_b128 a[36:39], v34 offset:7168
v_cvt_pk_bf16_f32 v164, v64, v65
v_cvt_pk_bf16_f32 v165, v66, v67
v_mfma_f32_16x16x32_bf16 v[216:219], a[244:247], a[148:151], v[216:219]
s_waitcnt lgkmcnt(11)
ds_read_b128 a[40:43], v34 offset:12288
v_cvt_pk_bf16_f32 v166, v80, v81
v_mfma_f32_16x16x32_bf16 v[216:219], a[248:251], a[152:155], v[216:219]
s_waitcnt lgkmcnt(11)
ds_read_b128 a[44:47], v34 offset:17408
v_cvt_pk_bf16_f32 v167, v82, v83
buffer_store_dwordx4 v[164:167], v1, s[12:15], s53 offen offset:0 sc1
v_mfma_f32_16x16x32_bf16 v[216:219], a[252:255], a[156:159], v[216:219]
s_waitcnt vmcnt(37) lgkmcnt(11)
ds_read_b128 a[240:243], v34 offset:22528
v_mfma_f32_16x16x32_bf16 v[216:219], a[0:3], a[160:163], v[216:219]
s_waitcnt vmcnt(34) lgkmcnt(11)
ds_read_b128 a[244:247], v34 offset:27648
buffer_load_dwordx4 a[216:219], v1, s[12:15], s44 offen sc1
v_mfma_f32_16x16x32_bf16 v[216:219], a[4:7], a[164:167], v[216:219]
s_waitcnt lgkmcnt(11)
ds_read_b128 a[248:251], v34 offset:3072
v_mfma_f32_16x16x32_bf16 v[220:223], a[8:11], a[144:147], 0
s_waitcnt lgkmcnt(11)
ds_read_b128 a[252:255], v34 offset:8192
s_add_u32 s44, s44, 4096
v_cvt_pk_bf16_f32 v168, v96, v97
v_mfma_f32_16x16x32_bf16 v[220:223], a[12:15], a[148:151], v[220:223]
s_waitcnt lgkmcnt(11)
ds_read_b128 a[0:3], v34 offset:13312
v_cvt_pk_bf16_f32 v169, v98, v99
v_mfma_f32_16x16x32_bf16 v[220:223], a[16:19], a[152:155], v[220:223]
s_waitcnt lgkmcnt(11)
ds_read_b128 a[4:7], v34 offset:18432
v_cvt_pk_bf16_f32 v170, v112, v113
v_cvt_pk_bf16_f32 v171, v114, v115
v_mfma_f32_16x16x32_bf16 v[220:223], a[20:23], a[156:159], v[220:223]
s_waitcnt lgkmcnt(11)
ds_read_b128 a[8:11], v34 offset:23552
buffer_store_dwordx4 v[168:171], v1, s[12:15], s53 offen offset:1024 sc1
v_mfma_f32_16x16x32_bf16 v[220:223], a[24:27], a[160:163], v[220:223]
s_waitcnt lgkmcnt(11)
ds_read_b128 a[12:15], v34 offset:28672
v_mfma_f32_16x16x32_bf16 v[220:223], a[28:31], a[164:167], v[220:223]
s_waitcnt lgkmcnt(11)
ds_read_b128 a[16:19], v34 offset:4096
buffer_load_dwordx4 a[220:223], v1, s[12:15], s44 offen sc1
v_mfma_f32_16x16x32_bf16 v[224:227], a[32:35], a[144:147], 0
s_waitcnt lgkmcnt(11)
ds_read_b128 a[20:23], v34 offset:9216
v_mfma_f32_16x16x32_bf16 v[224:227], a[36:39], a[148:151], v[224:227]
s_waitcnt lgkmcnt(11)
ds_read_b128 a[24:27], v34 offset:14336
s_add_u32 s44, s44, 4096
v_cvt_pk_bf16_f32 v172, v68, v69
v_mfma_f32_16x16x32_bf16 v[224:227], a[40:43], a[152:155], v[224:227]
s_waitcnt lgkmcnt(11)
ds_read_b128 a[28:31], v34 offset:19456
v_cvt_pk_bf16_f32 v173, v70, v71
v_mfma_f32_16x16x32_bf16 v[224:227], a[44:47], a[156:159], v[224:227]
s_waitcnt lgkmcnt(11)
ds_read_b128 a[32:35], v34 offset:24576
v_cvt_pk_bf16_f32 v174, v84, v85
v_cvt_pk_bf16_f32 v175, v86, v87
v_mfma_f32_16x16x32_bf16 v[224:227], a[240:243], a[160:163], v[224:227]
s_waitcnt lgkmcnt(11)
ds_read_b128 a[36:39], v34 offset:29696
buffer_store_dwordx4 v[172:175], v1, s[12:15], s53 offen offset:2048 sc1
v_mfma_f32_16x16x32_bf16 v[224:227], a[244:247], a[164:167], v[224:227]
s_waitcnt vmcnt(31) lgkmcnt(11)
s_barrier
v_add_u32 v34, 0xffff7000, v34
ds_read_b128 a[40:43], v34 offset:0
v_mfma_f32_16x16x32_bf16 v[228:231], a[248:251], a[144:147], 0
s_waitcnt lgkmcnt(11)
ds_read_b128 a[44:47], v34 offset:5120
v_cvt_pk_bf16_f32 v176, v100, v101
v_mfma_f32_16x16x32_bf16 v[228:231], a[252:255], a[148:151], v[228:231]
s_waitcnt lgkmcnt(11)
ds_read_b128 a[240:243], v34 offset:10240
v_cvt_pk_bf16_f32 v177, v102, v103
v_cvt_pk_bf16_f32 v178, v116, v117
v_mfma_f32_16x16x32_bf16 v[228:231], a[0:3], a[152:155], v[228:231]
s_waitcnt lgkmcnt(11)
ds_read_b128 a[244:247], v34 offset:15360
v_cvt_pk_bf16_f32 v179, v118, v119
v_mfma_f32_16x16x32_bf16 v[228:231], a[4:7], a[156:159], v[228:231]
s_waitcnt lgkmcnt(11)
ds_read_b128 a[248:251], v34 offset:20480
buffer_store_dwordx4 v[176:179], v1, s[12:15], s53 offen offset:3072 sc1
v_mfma_f32_16x16x32_bf16 v[228:231], a[8:11], a[160:163], v[228:231]
s_waitcnt lgkmcnt(11)
ds_read_b128 a[252:255], v34 offset:25600
v_mfma_f32_16x16x32_bf16 v[228:231], a[12:15], a[164:167], v[228:231]
s_waitcnt lgkmcnt(11)
ds_read_b128 a[0:3], v34 offset:1024
s_add_u32 s53, s53, 4096
buffer_load_dwordx4 a[224:227], v1, s[12:15], s44 offen sc1
v_mfma_f32_16x16x32_bf16 v[232:235], a[16:19], a[144:147], 0
s_waitcnt lgkmcnt(11)
ds_read_b128 a[4:7], v34 offset:6144
v_mfma_f32_16x16x32_bf16 v[232:235], a[20:23], a[148:151], v[232:235]
s_waitcnt lgkmcnt(11)
ds_read_b128 a[8:11], v34 offset:11264
s_add_u32 s44, s44, 4096
v_cvt_pk_bf16_f32 v180, v72, v73
v_cvt_pk_bf16_f32 v181, v74, v75
v_mfma_f32_16x16x32_bf16 v[232:235], a[24:27], a[152:155], v[232:235]
s_waitcnt lgkmcnt(11)
ds_read_b128 a[12:15], v34 offset:16384
v_cvt_pk_bf16_f32 v182, v88, v89
v_mfma_f32_16x16x32_bf16 v[232:235], a[28:31], a[156:159], v[232:235]
s_waitcnt lgkmcnt(11)
ds_read_b128 a[16:19], v34 offset:21504
v_cvt_pk_bf16_f32 v183, v90, v91
buffer_store_dwordx4 v[180:183], v1, s[12:15], s53 offen offset:0 sc1
v_mfma_f32_16x16x32_bf16 v[232:235], a[32:35], a[160:163], v[232:235]
s_waitcnt lgkmcnt(11)
ds_read_b128 a[20:23], v34 offset:26624
v_mfma_f32_16x16x32_bf16 v[232:235], a[36:39], a[164:167], v[232:235]
ds_read_b128 a[24:27], v34 offset:2048
s_waitcnt lgkmcnt(12)
v_mfma_f32_16x16x32_bf16 v[216:219], a[40:43], a[168:171], v[216:219]
s_waitcnt lgkmcnt(11)
ds_read_b128 a[28:31], v34 offset:7168
v_cvt_pk_bf16_f32 v184, v104, v105
v_cvt_pk_bf16_f32 v185, v106, v107
v_mfma_f32_16x16x32_bf16 v[216:219], a[44:47], a[172:175], v[216:219]
s_waitcnt vmcnt(32) lgkmcnt(11)
ds_read_b128 a[32:35], v34 offset:12288
v_cvt_pk_bf16_f32 v186, v120, v121
v_cvt_pk_bf16_f32 v187, v122, v123
v_mfma_f32_16x16x32_bf16 v[216:219], a[240:243], a[176:179], v[216:219]
s_waitcnt vmcnt(30) lgkmcnt(11)
ds_read_b128 a[36:39], v34 offset:17408
buffer_store_dwordx4 v[184:187], v1, s[12:15], s53 offen offset:1024 sc1
v_mfma_f32_16x16x32_bf16 v[216:219], a[244:247], a[180:183], v[216:219]
s_waitcnt vmcnt(28) lgkmcnt(11)
ds_read_b128 a[40:43], v34 offset:22528
v_mfma_f32_16x16x32_bf16 v[216:219], a[248:251], a[184:187], v[216:219]
s_waitcnt vmcnt(25) lgkmcnt(11)
ds_read_b128 a[44:47], v34 offset:27648
buffer_load_dwordx4 a[228:231], v1, s[12:15], s44 offen sc1
v_mfma_f32_16x16x32_bf16 v[216:219], a[252:255], a[188:191], v[216:219]
s_waitcnt lgkmcnt(11)
ds_read_b128 a[240:243], v34 offset:3072
v_mfma_f32_16x16x32_bf16 v[220:223], a[0:3], a[168:171], v[220:223]
s_waitcnt lgkmcnt(11)
ds_read_b128 a[244:247], v34 offset:8192
s_add_u32 s44, s44, 4096
v_cvt_pk_bf16_f32 v188, v76, v77
v_cvt_pk_bf16_f32 v189, v78, v79
v_mfma_f32_16x16x32_bf16 v[220:223], a[4:7], a[172:175], v[220:223]
s_waitcnt lgkmcnt(11)
ds_read_b128 a[248:251], v34 offset:13312
v_cvt_pk_bf16_f32 v190, v92, v93
v_mfma_f32_16x16x32_bf16 v[220:223], a[8:11], a[176:179], v[220:223]
s_waitcnt lgkmcnt(11)
ds_read_b128 a[252:255], v34 offset:18432
v_cvt_pk_bf16_f32 v191, v94, v95
buffer_store_dwordx4 v[188:191], v1, s[12:15], s53 offen offset:2048 sc1
v_mfma_f32_16x16x32_bf16 v[220:223], a[12:15], a[180:183], v[220:223]
s_waitcnt lgkmcnt(11)
ds_read_b128 a[0:3], v34 offset:23552
v_mfma_f32_16x16x32_bf16 v[220:223], a[16:19], a[184:187], v[220:223]
s_waitcnt lgkmcnt(11)
ds_read_b128 a[4:7], v34 offset:28672
buffer_load_dwordx4 a[232:235], v1, s[12:15], s44 offen sc1
v_mfma_f32_16x16x32_bf16 v[220:223], a[20:23], a[188:191], v[220:223]
s_waitcnt lgkmcnt(11)
ds_read_b128 a[8:11], v34 offset:4096
v_mfma_f32_16x16x32_bf16 v[224:227], a[24:27], a[168:171], v[224:227]
s_waitcnt lgkmcnt(11)
ds_read_b128 a[12:15], v34 offset:9216
s_add_u32 s44, s44, 4096
v_cvt_pk_bf16_f32 v192, v108, v109
v_mfma_f32_16x16x32_bf16 v[224:227], a[28:31], a[172:175], v[224:227]
s_waitcnt lgkmcnt(11)
ds_read_b128 a[16:19], v34 offset:14336
v_cvt_pk_bf16_f32 v193, v110, v111
v_cvt_pk_bf16_f32 v194, v124, v125
v_mfma_f32_16x16x32_bf16 v[224:227], a[32:35], a[176:179], v[224:227]
s_waitcnt lgkmcnt(11)
ds_read_b128 a[20:23], v34 offset:19456
v_cvt_pk_bf16_f32 v195, v126, v127
v_mfma_f32_16x16x32_bf16 v[224:227], a[36:39], a[180:183], v[224:227]
s_waitcnt lgkmcnt(11)
ds_read_b128 a[24:27], v34 offset:24576
buffer_store_dwordx4 v[192:195], v1, s[12:15], s53 offen offset:3072 sc1
v_mfma_f32_16x16x32_bf16 v[224:227], a[40:43], a[184:187], v[224:227]
s_waitcnt lgkmcnt(11)
ds_read_b128 a[28:31], v34 offset:29696
s_add_u32 s53, s53, 4096
v_cvt_pk_bf16_f32 v196, v128, v129
v_mfma_f32_16x16x32_bf16 v[224:227], a[44:47], a[188:191], v[224:227]
s_waitcnt vmcnt(26) lgkmcnt(11)
s_barrier
v_add_u32 v34, 0xfffee000, v34
ds_read_b128 a[32:35], v34 offset:0
v_cvt_pk_bf16_f32 v197, v130, v131
v_mfma_f32_16x16x32_bf16 v[228:231], a[240:243], a[168:171], v[228:231]
s_waitcnt lgkmcnt(11)
ds_read_b128 a[36:39], v34 offset:5120
v_cvt_pk_bf16_f32 v198, v132, v133
v_cvt_pk_bf16_f32 v199, v134, v135
v_mfma_f32_16x16x32_bf16 v[228:231], a[244:247], a[172:175], v[228:231]
s_waitcnt lgkmcnt(11)
ds_read_b128 a[40:43], v34 offset:10240
v_permlane32_swap_b32 v196, v198
v_mfma_f32_16x16x32_bf16 v[228:231], a[248:251], a[176:179], v[228:231]
s_waitcnt lgkmcnt(11)
ds_read_b128 a[44:47], v34 offset:15360
v_permlane32_swap_b32 v197, v199
buffer_store_dwordx4 v[196:199], v1, s[12:15], s53 offen offset:0 sc1
v_mfma_f32_16x16x32_bf16 v[228:231], a[252:255], a[180:183], v[228:231]
s_waitcnt lgkmcnt(11)
ds_read_b128 a[240:243], v34 offset:20480
v_mfma_f32_16x16x32_bf16 v[228:231], a[0:3], a[184:187], v[228:231]
s_waitcnt lgkmcnt(11)
ds_read_b128 a[244:247], v34 offset:25600
buffer_load_dwordx4 a[236:239], v1, s[12:15], s44 offen sc1
v_mfma_f32_16x16x32_bf16 v[228:231], a[4:7], a[188:191], v[228:231]
s_waitcnt lgkmcnt(11)
ds_read_b128 a[248:251], v34 offset:1024
v_mfma_f32_16x16x32_bf16 v[232:235], a[8:11], a[168:171], v[232:235]
s_waitcnt lgkmcnt(11)
ds_read_b128 a[252:255], v34 offset:6144
s_add_u32 s44, s44, 4096
v_cvt_pk_bf16_f32 v200, v136, v137
v_mfma_f32_16x16x32_bf16 v[232:235], a[12:15], a[172:175], v[232:235]
s_waitcnt lgkmcnt(11)
ds_read_b128 a[0:3], v34 offset:11264
v_cvt_pk_bf16_f32 v201, v138, v139
v_cvt_pk_bf16_f32 v202, v140, v141
v_mfma_f32_16x16x32_bf16 v[232:235], a[16:19], a[176:179], v[232:235]
s_waitcnt lgkmcnt(11)
ds_read_b128 a[4:7], v34 offset:16384
v_cvt_pk_bf16_f32 v203, v142, v143
v_permlane32_swap_b32 v200, v202
v_mfma_f32_16x16x32_bf16 v[232:235], a[20:23], a[180:183], v[232:235]
s_waitcnt lgkmcnt(11)
ds_read_b128 a[8:11], v34 offset:21504
v_permlane32_swap_b32 v201, v203
v_mfma_f32_16x16x32_bf16 v[232:235], a[24:27], a[184:187], v[232:235]
s_waitcnt lgkmcnt(11)
ds_read_b128 a[12:15], v34 offset:26624
buffer_store_dwordx4 v[200:203], v1, s[12:15], s53 offen offset:1024 sc1
v_mfma_f32_16x16x32_bf16 v[232:235], a[28:31], a[188:191], v[232:235]
ds_read_b128 a[16:19], v34 offset:2048
s_cmp_lg_u32 s30, s47
s_cbranch_scc1 L_own
ds_write_b128 v47, v[164:167] offset:0
ds_write_b128 v47, v[168:171] offset:1024
ds_write_b128 v47, v[172:175] offset:2048
ds_write_b128 v47, v[176:179] offset:3072
ds_write_b128 v47, v[180:183] offset:4096
ds_write_b128 v47, v[184:187] offset:5120
ds_write_b128 v47, v[188:191] offset:6144
ds_write_b128 v47, v[192:195] offset:7168
ds_write_b128 v47, v[196:199] offset:8192
ds_write_b128 v47, v[200:203] offset:9216
s_waitcnt lgkmcnt(0)
L_own:
s_waitcnt lgkmcnt(12)
v_mfma_f32_16x16x32_bf16 v[216:219], a[32:35], a[192:195], v[216:219]
s_waitcnt vmcnt(27) lgkmcnt(11)
ds_read_b128 a[20:23], v34 offset:7168
buffer_load_dwordx4 a[48:51], v1, s[12:15], s57 offen sc1
v_mfma_f32_16x16x32_bf16 v[216:219], a[36:39], a[196:199], v[216:219]
s_waitcnt vmcnt(26) lgkmcnt(11)
ds_read_b128 a[24:27], v34 offset:12288
v_mfma_f32_16x16x32_bf16 v[216:219], a[40:43], a[200:203], v[216:219]
s_waitcnt vmcnt(23) lgkmcnt(11)
ds_read_b128 a[28:31], v34 offset:17408
v_mfma_f32_16x16x32_bf16 v[216:219], a[44:47], a[204:207], v[216:219]
s_waitcnt vmcnt(20) lgkmcnt(11)
ds_read_b128 a[32:35], v34 offset:22528
s_add_u32 s57, s57, 4096
buffer_load_dwordx4 a[52:55], v1, s[12:15], s57 offen sc1
v_mfma_f32_16x16x32_bf16 v[216:219], a[240:243], a[208:211], v[216:219]
s_waitcnt vmcnt(19) lgkmcnt(11)
ds_read_b128 a[36:39], v34 offset:27648
v_mfma_f32_16x16x32_bf16 v[216:219], a[244:247], a[212:215], v[216:219]
s_waitcnt lgkmcnt(11)
ds_read_b128 a[40:43], v34 offset:3072
v_mfma_f32_16x16x32_bf16 v[220:223], a[248:251], a[192:195], v[220:223]
s_waitcnt lgkmcnt(11)
ds_read_b128 a[44:47], v34 offset:8192
s_add_u32 s57, s57, 4096
buffer_load_dwordx4 a[56:59], v1, s[12:15], s57 offen sc1
v_mfma_f32_16x16x32_bf16 v[220:223], a[252:255], a[196:199], v[220:223]
s_waitcnt lgkmcnt(11)
ds_read_b128 a[240:243], v34 offset:13312
v_mfma_f32_16x16x32_bf16 v[220:223], a[0:3], a[200:203], v[220:223]
s_waitcnt lgkmcnt(11)
ds_read_b128 a[244:247], v34 offset:18432
v_mfma_f32_16x16x32_bf16 v[220:223], a[4:7], a[204:207], v[220:223]
s_waitcnt lgkmcnt(11)
ds_read_b128 a[248:251], v34 offset:23552
v_mfma_f32_16x16x32_bf16 v[220:223], a[8:11], a[208:211], v[220:223]
s_waitcnt lgkmcnt(11)
ds_read_b128 a[252:255], v34 offset:28672
s_add_u32 s57, s57, 4096
buffer_load_dwordx4 a[60:63], v1, s[12:15], s57 offen sc1
v_mfma_f32_16x16x32_bf16 v[220:223], a[12:15], a[212:215], v[220:223]
s_waitcnt lgkmcnt(11)
ds_read_b128 a[0:3], v34 offset:4096
v_mfma_f32_16x16x32_bf16 v[224:227], a[16:19], a[192:195], v[224:227]
s_waitcnt lgkmcnt(11)
ds_read_b128 a[4:7], v34 offset:9216
v_mfma_f32_16x16x32_bf16 v[224:227], a[20:23], a[196:199], v[224:227]
s_waitcnt lgkmcnt(11)
ds_read_b128 a[8:11], v34 offset:14336
s_add_u32 s57, s57, 4096
buffer_load_dwordx4 a[64:67], v1, s[12:15], s57 offen sc1
v_mfma_f32_16x16x32_bf16 v[224:227], a[24:27], a[200:203], v[224:227]
s_waitcnt lgkmcnt(11)
ds_read_b128 a[12:15], v34 offset:19456
v_mfma_f32_16x16x32_bf16 v[224:227], a[28:31], a[204:207], v[224:227]
s_waitcnt lgkmcnt(11)
ds_read_b128 a[16:19], v34 offset:24576
v_mfma_f32_16x16x32_bf16 v[224:227], a[32:35], a[208:211], v[224:227]
s_waitcnt lgkmcnt(11)
ds_read_b128 a[20:23], v34 offset:29696
s_add_u32 s57, s57, 4096
buffer_load_dwordx4 a[68:71], v1, s[12:15], s57 offen sc1
v_mfma_f32_16x16x32_bf16 v[224:227], a[36:39], a[212:215], v[224:227]
s_waitcnt vmcnt(22) lgkmcnt(11)
s_barrier
ds_read_b128 a[24:27], v34 offset:36864
v_mfma_f32_16x16x32_bf16 v[228:231], a[40:43], a[192:195], v[228:231]
s_waitcnt lgkmcnt(11)
ds_read_b128 a[28:31], v34 offset:41984
v_mfma_f32_16x16x32_bf16 v[228:231], a[44:47], a[196:199], v[228:231]
s_waitcnt lgkmcnt(11)
ds_read_b128 a[32:35], v34 offset:47104
v_mfma_f32_16x16x32_bf16 v[228:231], a[240:243], a[200:203], v[228:231]
s_waitcnt lgkmcnt(11)
ds_read_b128 a[36:39], v34 offset:52224
s_add_u32 s57, s57, 4096
buffer_load_dwordx4 a[72:75], v1, s[12:15], s57 offen sc1
v_mfma_f32_16x16x32_bf16 v[228:231], a[244:247], a[204:207], v[228:231]
s_waitcnt lgkmcnt(11)
ds_read_b128 a[40:43], v34 offset:57344
v_mfma_f32_16x16x32_bf16 v[228:231], a[248:251], a[208:211], v[228:231]
s_waitcnt lgkmcnt(11)
ds_read_b128 a[44:47], v34 offset:62464
v_mfma_f32_16x16x32_bf16 v[228:231], a[252:255], a[212:215], v[228:231]
s_waitcnt lgkmcnt(11)
ds_read_b128 a[240:243], v34 offset:37888
s_add_u32 s57, s57, 4096
buffer_load_dwordx4 a[76:79], v1, s[12:15], s57 offen sc1
v_mfma_f32_16x16x32_bf16 v[232:235], a[0:3], a[192:195], v[232:235]
s_waitcnt lgkmcnt(11)
ds_read_b128 a[244:247], v34 offset:43008
v_mfma_f32_16x16x32_bf16 v[232:235], a[4:7], a[196:199], v[232:235]
s_waitcnt lgkmcnt(11)
ds_read_b128 a[248:251], v34 offset:48128
v_mfma_f32_16x16x32_bf16 v[232:235], a[8:11], a[200:203], v[232:235]
s_waitcnt lgkmcnt(11)
ds_read_b128 a[252:255], v34 offset:53248
s_add_u32 s57, s57, 4096
buffer_load_dwordx4 a[80:83], v1, s[12:15], s57 offen sc1
v_mfma_f32_16x16x32_bf16 v[232:235], a[12:15], a[204:207], v[232:235]
s_waitcnt lgkmcnt(11)
ds_read_b128 a[0:3], v34 offset:58368
v_mfma_f32_16x16x32_bf16 v[232:235], a[16:19], a[208:211], v[232:235]
s_waitcnt lgkmcnt(11)
ds_read_b128 a[4:7], v34 offset:63488
v_mfma_f32_16x16x32_bf16 v[232:235], a[20:23], a[212:215], v[232:235]
ds_read_b128 a[8:11], v34 offset:38912
s_add_u32 s57, s57, 4096
s_waitcnt vmcnt(23) lgkmcnt(12)
v_mfma_f32_16x16x32_bf16 v[216:219], a[24:27], a[216:219], v[216:219]
s_waitcnt vmcnt(21) lgkmcnt(11)
ds_read_b128 a[12:15], v34 offset:44032
buffer_load_dwordx4 a[84:87], v1, s[12:15], s57 offen sc1
v_mfma_f32_16x16x32_bf16 v[216:219], a[28:31], a[220:223], v[216:219]
s_waitcnt vmcnt(19) lgkmcnt(11)
ds_read_b128 a[16:19], v34 offset:49152
s_add_u32 s57, s57, 4096
buffer_load_dwordx4 a[88:91], v1, s[12:15], s57 offen sc1
v_mfma_f32_16x16x32_bf16 v[216:219], a[32:35], a[224:227], v[216:219]
s_waitcnt vmcnt(17) lgkmcnt(11)
ds_read_b128 a[20:23], v34 offset:54272
v_mfma_f32_16x16x32_bf16 v[216:219], a[36:39], a[228:231], v[216:219]
s_waitcnt vmcnt(15) lgkmcnt(11)
ds_read_b128 a[24:27], v34 offset:59392
s_add_u32 s57, s57, 4096
buffer_load_dwordx4 a[92:95], v1, s[12:15], s57 offen sc1
v_mfma_f32_16x16x32_bf16 v[216:219], a[40:43], a[232:235], v[216:219]
s_waitcnt vmcnt(13) lgkmcnt(11)
ds_read_b128 a[28:31], v34 offset:64512
v_mfma_f32_16x16x32_bf16 v[216:219], a[44:47], a[236:239], v[216:219]
s_waitcnt lgkmcnt(11)
ds_read_b128 a[32:35], v34 offset:39936
s_add_u32 s57, s57, 4096
buffer_load_dwordx4 a[96:99], v1, s[12:15], s57 offen sc1
v_mfma_f32_16x16x32_bf16 v[220:223], a[240:243], a[216:219], v[220:223]
s_waitcnt lgkmcnt(11)
ds_read_b128 a[36:39], v34 offset:45056
s_add_u32 s57, s57, 4096
buffer_load_dwordx4 a[100:103], v1, s[12:15], s57 offen sc1
v_mfma_f32_16x16x32_bf16 v[220:223], a[244:247], a[220:223], v[220:223]
s_waitcnt lgkmcnt(11)
ds_read_b128 a[40:43], v34 offset:50176
v_mfma_f32_16x16x32_bf16 v[220:223], a[248:251], a[224:227], v[220:223]
s_waitcnt lgkmcnt(11)
ds_read_b128 a[44:47], v34 offset:55296
s_add_u32 s57, s57, 4096
buffer_load_dwordx4 a[104:107], v1, s[12:15], s57 offen sc1
v_mfma_f32_16x16x32_bf16 v[220:223], a[252:255], a[228:231], v[220:223]
s_waitcnt lgkmcnt(11)
ds_read_b128 a[240:243], v34 offset:60416
v_mfma_f32_16x16x32_bf16 v[220:223], a[0:3], a[232:235], v[220:223]
s_waitcnt lgkmcnt(11)
v_add_u32 v34, 0x9000, v34
ds_read_b128 a[244:247], v34 offset:28672
s_add_u32 s57, s57, 4096
s_and_b32 s33, s47, 1
s_lshl1_add_u32 s33, s49, s33
s_mul_i32 s33, s33, 10
s_mul_i32 s52, s61, 81920
s_add_u32 s52, s52, s26
s_add_u32 s52, s52, 0x3b00000
v_bfe_u32 v2, v0, 4, 1
v_lshrrev_b32 v3, 5, v0
v_mfma_f32_16x16x32_bf16 v[220:223], a[4:7], a[236:239], v[220:223]
s_waitcnt lgkmcnt(11)
ds_read_b128 a[248:251], v34 offset:4096
v_lshl_add_u32 v4, v2, 1, v3
v_mfma_f32_16x16x32_bf16 v[224:227], a[8:11], a[216:219], v[224:227]
s_waitcnt lgkmcnt(11)
ds_read_b128 a[252:255], v34 offset:9216
v_add_u32 v4, s33, v4
v_and_b32 v5, 15, v0
v_mfma_f32_16x16x32_bf16 v[224:227], a[12:15], a[220:223], v[224:227]
s_waitcnt lgkmcnt(11)
ds_read_b128 a[0:3], v34 offset:14336
v_lshlrev_b32 v5, 4, v5
v_lshrrev_b32 v6, 2, v4
v_mfma_f32_16x16x32_bf16 v[224:227], a[16:19], a[224:227], v[224:227]
s_waitcnt lgkmcnt(11)
ds_read_b128 a[4:7], v34 offset:19456
v_lshl_add_u32 v6, v6, 12, v5
v_mfma_f32_16x16x32_bf16 v[224:227], a[20:23], a[228:231], v[224:227]
s_waitcnt lgkmcnt(11)
ds_read_b128 a[8:11], v34 offset:24576
v_and_b32 v4, 3, v4
v_lshl_add_u32 v6, v4, 8, v6
v_mfma_f32_16x16x32_bf16 v[224:227], a[24:27], a[232:235], v[224:227]
s_waitcnt lgkmcnt(11)
ds_read_b128 a[12:15], v34 offset:29696
v_add_u32 v7, 4096, v6
v_add_u32 v4, s33, v3
v_mfma_f32_16x16x32_bf16 v[224:227], a[28:31], a[236:239], v[224:227]
s_waitcnt lgkmcnt(11)
v_add_u32 v34, 0x12000, v34
ds_read_b128 a[16:19], v34 offset:0
v_add_u32 v4, 8, v4
v_lshrrev_b32 v8, 2, v4
v_mfma_f32_16x16x32_bf16 v[228:231], a[32:35], a[216:219], v[228:231]
s_waitcnt lgkmcnt(11)
ds_read_b128 a[20:23], v34 offset:5120
v_lshl_add_u32 v8, v8, 12, v5
v_mfma_f32_16x16x32_bf16 v[228:231], a[36:39], a[220:223], v[228:231]
s_waitcnt lgkmcnt(11)
ds_read_b128 a[24:27], v34 offset:10240
v_and_b32 v4, 3, v4
v_lshl_add_u32 v8, v4, 8, v8
v_mfma_f32_16x16x32_bf16 v[228:231], a[40:43], a[224:227], v[228:231]
s_waitcnt lgkmcnt(11)
ds_read_b128 a[28:31], v34 offset:15360
v_lshl_add_u32 v8, v2, 3, v8
buffer_load_dwordx4 v[204:207], v6, s[12:15], s52 offen sc1
v_mfma_f32_16x16x32_bf16 v[228:231], a[44:47], a[228:231], v[228:231]
s_waitcnt lgkmcnt(11)
ds_read_b128 a[32:35], v34 offset:20480
v_mfma_f32_16x16x32_bf16 v[228:231], a[240:243], a[232:235], v[228:231]
s_waitcnt lgkmcnt(11)
ds_read_b128 a[36:39], v34 offset:25600
buffer_load_dwordx4 v[208:211], v7, s[12:15], s52 offen sc1
v_mfma_f32_16x16x32_bf16 v[228:231], a[244:247], a[236:239], v[228:231]
s_waitcnt lgkmcnt(11)
ds_read_b128 a[40:43], v34 offset:1024
v_mfma_f32_16x16x32_bf16 v[232:235], a[248:251], a[216:219], v[232:235]
s_waitcnt lgkmcnt(11)
ds_read_b128 a[44:47], v34 offset:6144
buffer_load_dwordx2 v[212:213], v8, s[12:15], s52 offen sc1
v_mfma_f32_16x16x32_bf16 v[232:235], a[252:255], a[220:223], v[232:235]
s_waitcnt lgkmcnt(11)
ds_read_b128 a[240:243], v34 offset:11264
s_lshl2_add_u32 s33, s61, s30
s_lshl_b32 s33, s33, 7
s_add_u32 s33, s33, 0x3a30000
v_lshrrev_b32 v9, 1, v5
v_mfma_f32_16x16x32_bf16 v[232:235], a[0:3], a[224:227], v[232:235]
s_waitcnt lgkmcnt(11)
ds_read_b128 a[244:247], v34 offset:16384
buffer_load_dword v10, v9, s[12:15], s33 offen offset:4 sc1
v_mfma_f32_16x16x32_bf16 v[232:235], a[4:7], a[228:231], v[232:235]
s_waitcnt lgkmcnt(11)
ds_read_b128 a[248:251], v34 offset:21504
v_mfma_f32_16x16x32_bf16 v[232:235], a[8:11], a[232:235], v[232:235]
s_waitcnt lgkmcnt(11)
ds_read_b128 a[252:255], v34 offset:26624
s_waitcnt vmcnt(19)
buffer_store_dword v15, v14, s[12:15], s50 offen sc1
v_mfma_f32_16x16x32_bf16 v[232:235], a[12:15], a[236:239], v[232:235]
ds_read_b128 a[0:3], v34 offset:2048
v_cvt_pk_bf16_f32 v236, v216, v217
v_cvt_pk_bf16_f32 v237, v218, v219
v_cvt_pk_bf16_f32 v238, v220, v221
v_cvt_pk_bf16_f32 v239, v222, v223
buffer_store_dwordx4 v[236:239], v1, s[12:15], s42 offen offset:0 sc1
v_cvt_pk_bf16_f32 v240, v224, v225
v_cvt_pk_bf16_f32 v241, v226, v227
v_cvt_pk_bf16_f32 v242, v228, v229
v_cvt_pk_bf16_f32 v243, v230, v231
buffer_store_dwordx4 v[240:243], v1, s[12:15], s42 offen offset:1024 sc1
v_cvt_pk_bf16_f32 v244, v232, v233
v_cvt_pk_bf16_f32 v245, v234, v235
buffer_store_dwordx2 v[244:245], v37, s[12:15], s42 offen offset:2048 sc1
s_waitcnt vmcnt(22) lgkmcnt(12)
v_mfma_f32_16x16x32_bf16 v[144:147], a[16:19], a[48:51], 0
s_waitcnt vmcnt(21) lgkmcnt(11)
ds_read_b128 a[4:7], v34 offset:7168
v_and_b32 v12, 12, v43
buffer_load_dword v44, v12, s[12:15], s55 offen sc1
v_mfma_f32_16x16x32_bf16 v[144:147], a[20:23], a[52:55], v[144:147]
s_waitcnt vmcnt(21) lgkmcnt(11)
ds_read_b128 a[8:11], v34 offset:12288
v_mfma_f32_16x16x32_bf16 v[144:147], a[24:27], a[56:59], v[144:147]
s_waitcnt vmcnt(20) lgkmcnt(11)
ds_read_b128 a[12:15], v34 offset:17408
v_mfma_f32_16x16x32_bf16 v[144:147], a[28:31], a[60:63], v[144:147]
s_waitcnt vmcnt(19) lgkmcnt(11)
ds_read_b128 a[16:19], v34 offset:22528
buffer_load_dwordx4 a[108:111], v1, s[12:15], s57 offen sc1
v_mfma_f32_16x16x32_bf16 v[144:147], a[32:35], a[64:67], v[144:147]
s_waitcnt vmcnt(19) lgkmcnt(11)
ds_read_b128 a[20:23], v34 offset:27648
v_mfma_f32_16x16x32_bf16 v[144:147], a[36:39], a[68:71], v[144:147]
s_waitcnt lgkmcnt(11)
ds_read_b128 a[24:27], v34 offset:3072
s_add_u32 s57, s57, 4096
buffer_load_dwordx4 a[112:115], v1, s[12:15], s57 offen sc1
v_mfma_f32_16x16x32_bf16 v[148:151], a[40:43], a[48:51], 0
s_waitcnt lgkmcnt(11)
ds_read_b128 a[28:31], v34 offset:8192
v_mfma_f32_16x16x32_bf16 v[148:151], a[44:47], a[52:55], v[148:151]
s_waitcnt lgkmcnt(11)
ds_read_b128 a[32:35], v34 offset:13312
v_mfma_f32_16x16x32_bf16 v[148:151], a[240:243], a[56:59], v[148:151]
s_waitcnt lgkmcnt(11)
ds_read_b128 a[36:39], v34 offset:18432
s_add_u32 s57, s57, 4096
buffer_load_dwordx4 a[116:119], v1, s[12:15], s57 offen sc1
v_mfma_f32_16x16x32_bf16 v[148:151], a[244:247], a[60:63], v[148:151]
s_waitcnt lgkmcnt(11)
ds_read_b128 a[40:43], v34 offset:23552
v_mfma_f32_16x16x32_bf16 v[148:151], a[248:251], a[64:67], v[148:151]
s_waitcnt lgkmcnt(11)
ds_read_b128 a[44:47], v34 offset:28672
s_add_u32 s57, s57, 4096
buffer_load_dwordx4 a[120:123], v1, s[12:15], s57 offen sc1
v_mfma_f32_16x16x32_bf16 v[148:151], a[252:255], a[68:71], v[148:151]
s_waitcnt lgkmcnt(11)
ds_read_b128 a[240:243], v34 offset:4096
v_mfma_f32_16x16x32_bf16 v[152:155], a[0:3], a[48:51], 0
s_waitcnt lgkmcnt(11)
ds_read_b128 a[244:247], v34 offset:9216
s_add_u32 s57, s57, 4096
buffer_load_dwordx4 a[124:127], v1, s[12:15], s57 offen sc1
v_mfma_f32_16x16x32_bf16 v[152:155], a[4:7], a[52:55], v[152:155]
s_waitcnt lgkmcnt(11)
ds_read_b128 a[248:251], v34 offset:14336
v_mfma_f32_16x16x32_bf16 v[152:155], a[8:11], a[56:59], v[152:155]
s_waitcnt lgkmcnt(11)
ds_read_b128 a[252:255], v34 offset:19456
v_mfma_f32_16x16x32_bf16 v[152:155], a[12:15], a[60:63], v[152:155]
s_waitcnt lgkmcnt(11)
ds_read_b128 a[0:3], v34 offset:24576
s_add_u32 s57, s57, 4096
buffer_load_dwordx4 a[128:131], v1, s[12:15], s57 offen sc1
v_mfma_f32_16x16x32_bf16 v[152:155], a[16:19], a[64:67], v[152:155]
s_waitcnt lgkmcnt(11)
ds_read_b128 a[4:7], v34 offset:29696
v_mfma_f32_16x16x32_bf16 v[152:155], a[20:23], a[68:71], v[152:155]
s_waitcnt lgkmcnt(11)
v_add_u32 v34, 0xffff7000, v34
ds_read_b128 a[8:11], v34 offset:0
s_add_u32 s57, s57, 4096
buffer_load_dwordx4 a[132:135], v1, s[12:15], s57 offen sc1
v_mfma_f32_16x16x32_bf16 v[156:159], a[24:27], a[48:51], 0
s_waitcnt lgkmcnt(11)
ds_read_b128 a[12:15], v34 offset:5120
v_mfma_f32_16x16x32_bf16 v[156:159], a[28:31], a[52:55], v[156:159]
s_waitcnt lgkmcnt(11)
ds_read_b128 a[16:19], v34 offset:10240
v_mfma_f32_16x16x32_bf16 v[156:159], a[32:35], a[56:59], v[156:159]
s_waitcnt lgkmcnt(11)
ds_read_b128 a[20:23], v34 offset:15360
s_add_u32 s57, s57, 4096
buffer_load_dwordx4 a[136:139], v1, s[12:15], s57 offen sc1
v_mfma_f32_16x16x32_bf16 v[156:159], a[36:39], a[60:63], v[156:159]
s_waitcnt lgkmcnt(11)
ds_read_b128 a[24:27], v34 offset:20480
v_mfma_f32_16x16x32_bf16 v[156:159], a[40:43], a[64:67], v[156:159]
s_waitcnt lgkmcnt(11)
ds_read_b128 a[28:31], v34 offset:25600
s_add_u32 s57, s57, 4096
buffer_load_dwordx4 a[140:143], v1, s[12:15], s57 offen sc1
v_mfma_f32_16x16x32_bf16 v[156:159], a[44:47], a[68:71], v[156:159]
s_waitcnt lgkmcnt(11)
ds_read_b128 a[32:35], v34 offset:1024
v_mfma_f32_16x16x32_bf16 v[160:163], a[240:243], a[48:51], 0
s_waitcnt lgkmcnt(11)
ds_read_b128 a[36:39], v34 offset:6144
v_mfma_f32_16x16x32_bf16 v[160:163], a[244:247], a[52:55], v[160:163]
s_waitcnt lgkmcnt(11)
ds_read_b128 a[40:43], v34 offset:11264
s_add_u32 s57, s57, 4096
v_add_u32 v47, 147456, v45
ds_read_b128 v[64:67], v47
v_mfma_f32_16x16x32_bf16 v[160:163], a[248:251], a[56:59], v[160:163]
s_waitcnt lgkmcnt(12)
ds_read_b128 a[44:47], v34 offset:16384
ds_read_b128 v[68:71], v47 offset:1024
v_mfma_f32_16x16x32_bf16 v[160:163], a[252:255], a[60:63], v[160:163]
s_waitcnt lgkmcnt(13)
ds_read_b128 a[240:243], v34 offset:21504
v_add_u32 v47, 147456, v46
v_mfma_f32_16x16x32_bf16 v[160:163], a[0:3], a[64:67], v[160:163]
s_waitcnt lgkmcnt(13)
ds_read_b128 a[244:247], v34 offset:26624
ds_read_b64 v[72:73], v47
v_mfma_f32_16x16x32_bf16 v[160:163], a[4:7], a[68:71], v[160:163]
ds_read_b128 a[248:251], v34 offset:2048
s_lshl2_add_u32 s32, s30, s55
s_add_u32 s32, s32, 16
v_mov_b32 v13, 0
s_waitcnt vmcnt(26) lgkmcnt(15)
v_mfma_f32_16x16x32_bf16 v[144:147], a[8:11], a[72:75], v[144:147]
s_waitcnt lgkmcnt(14)
ds_read_b128 a[252:255], v34 offset:7168
s_waitcnt vmcnt(10)
buffer_store_dword v15, v14, s[12:15], s46 offen sc1
v_mfma_f32_16x16x32_bf16 v[144:147], a[12:15], a[76:79], v[144:147]
s_waitcnt lgkmcnt(14)
ds_read_b128 a[0:3], v34 offset:12288
v_mfma_f32_16x16x32_bf16 v[144:147], a[16:19], a[80:83], v[144:147]
s_waitcnt lgkmcnt(14)
ds_read_b128 a[4:7], v34 offset:17408
v_mfma_f32_16x16x32_bf16 v[144:147], a[20:23], a[84:87], v[144:147]
s_waitcnt lgkmcnt(14)
ds_read_b128 a[8:11], v34 offset:22528
v_mfma_f32_16x16x32_bf16 v[144:147], a[24:27], a[88:91], v[144:147]
s_waitcnt lgkmcnt(14)
ds_read_b128 a[12:15], v34 offset:27648
v_mfma_f32_16x16x32_bf16 v[144:147], a[28:31], a[92:95], v[144:147]
s_waitcnt lgkmcnt(14)
ds_read_b128 a[16:19], v34 offset:3072
v_mfma_f32_16x16x32_bf16 v[148:151], a[32:35], a[72:75], v[148:151]
s_waitcnt lgkmcnt(14)
ds_read_b128 a[20:23], v34 offset:8192
v_mfma_f32_16x16x32_bf16 v[148:151], a[36:39], a[76:79], v[148:151]
s_waitcnt lgkmcnt(14)
ds_read_b128 a[24:27], v34 offset:13312
v_mfma_f32_16x16x32_bf16 v[148:151], a[40:43], a[80:83], v[148:151]
s_waitcnt lgkmcnt(13)
ds_read_b128 a[28:31], v34 offset:18432
v_mfma_f32_16x16x32_bf16 v[148:151], a[44:47], a[84:87], v[148:151]
s_waitcnt lgkmcnt(12)
ds_read_b128 a[32:35], v34 offset:23552
v_mfma_f32_16x16x32_bf16 v[148:151], a[240:243], a[88:91], v[148:151]
s_waitcnt lgkmcnt(12)
ds_read_b128 a[36:39], v34 offset:28672
v_mfma_f32_16x16x32_bf16 v[148:151], a[244:247], a[92:95], v[148:151]
s_waitcnt lgkmcnt(11)
ds_read_b128 a[40:43], v34 offset:4096
v_mfma_f32_16x16x32_bf16 v[152:155], a[248:251], a[72:75], v[152:155]
s_waitcnt lgkmcnt(11)
ds_read_b128 a[44:47], v34 offset:9216
v_mfma_f32_16x16x32_bf16 v[152:155], a[252:255], a[76:79], v[152:155]
s_waitcnt lgkmcnt(11)
ds_read_b128 a[240:243], v34 offset:14336
v_mfma_f32_16x16x32_bf16 v[152:155], a[0:3], a[80:83], v[152:155]
s_waitcnt lgkmcnt(11)
ds_read_b128 a[244:247], v34 offset:19456
v_mfma_f32_16x16x32_bf16 v[152:155], a[4:7], a[84:87], v[152:155]
s_waitcnt lgkmcnt(11)
ds_read_b128 a[248:251], v34 offset:24576
v_mfma_f32_16x16x32_bf16 v[152:155], a[8:11], a[88:91], v[152:155]
s_waitcnt lgkmcnt(11)
ds_read_b128 a[252:255], v34 offset:29696
v_mfma_f32_16x16x32_bf16 v[152:155], a[12:15], a[92:95], v[152:155]
s_waitcnt lgkmcnt(11)
v_add_u32 v34, 0xfffee000, v34
ds_read_b128 a[0:3], v34 offset:0
v_mfma_f32_16x16x32_bf16 v[156:159], a[16:19], a[72:75], v[156:159]
s_waitcnt lgkmcnt(11)
ds_read_b128 a[4:7], v34 offset:5120
v_mfma_f32_16x16x32_bf16 v[156:159], a[20:23], a[76:79], v[156:159]
s_waitcnt lgkmcnt(11)
ds_read_b128 a[8:11], v34 offset:10240
v_mfma_f32_16x16x32_bf16 v[156:159], a[24:27], a[80:83], v[156:159]
s_waitcnt lgkmcnt(11)
ds_read_b128 a[12:15], v34 offset:15360
v_mfma_f32_16x16x32_bf16 v[156:159], a[28:31], a[84:87], v[156:159]
s_waitcnt lgkmcnt(11)
ds_read_b128 a[16:19], v34 offset:20480
v_mfma_f32_16x16x32_bf16 v[156:159], a[32:35], a[88:91], v[156:159]
s_waitcnt lgkmcnt(11)
ds_read_b128 a[20:23], v34 offset:25600
v_mfma_f32_16x16x32_bf16 v[156:159], a[36:39], a[92:95], v[156:159]
s_waitcnt lgkmcnt(11)
ds_read_b128 a[24:27], v34 offset:1024
v_mfma_f32_16x16x32_bf16 v[160:163], a[40:43], a[72:75], v[160:163]
s_waitcnt lgkmcnt(11)
ds_read_b128 a[28:31], v34 offset:6144
v_mfma_f32_16x16x32_bf16 v[160:163], a[44:47], a[76:79], v[160:163]
s_waitcnt lgkmcnt(11)
ds_read_b128 a[32:35], v34 offset:11264
v_mfma_f32_16x16x32_bf16 v[160:163], a[240:243], a[80:83], v[160:163]
s_waitcnt lgkmcnt(11)
ds_read_b128 a[36:39], v34 offset:16384
v_mfma_f32_16x16x32_bf16 v[160:163], a[244:247], a[84:87], v[160:163]
s_waitcnt lgkmcnt(11)
ds_read_b128 a[40:43], v34 offset:21504
v_mfma_f32_16x16x32_bf16 v[160:163], a[248:251], a[88:91], v[160:163]
s_waitcnt lgkmcnt(11)
ds_read_b128 a[44:47], v34 offset:26624
v_mfma_f32_16x16x32_bf16 v[160:163], a[252:255], a[92:95], v[160:163]
ds_read_b128 a[240:243], v34 offset:2048
s_waitcnt vmcnt(10)
v_cmp_ne_u32 vcc, s40, v44
s_nop 1
s_cbranch_vccnz L_spin_p
L_back_p:
s_add_u32 s33, s47, 1
s_and_b32 s33, s33, 3
s_mul_i32 s33, s33, 40960
s_add_u32 s33, s33, s22
buffer_load_dwordx4 v[76:79], v45, s[12:15], s33 offen offset:0 sc1
buffer_load_dwordx4 v[80:83], v45, s[12:15], s33 offen offset:1024 sc1
buffer_load_dwordx2 v[84:85], v46, s[12:15], s33 offen sc1
s_add_u32 s33, s47, 2
s_and_b32 s33, s33, 3
s_mul_i32 s33, s33, 40960
s_add_u32 s33, s33, s22
buffer_load_dwordx4 v[88:91], v45, s[12:15], s33 offen offset:0 sc1
buffer_load_dwordx4 v[92:95], v45, s[12:15], s33 offen offset:1024 sc1
buffer_load_dwordx2 v[96:97], v46, s[12:15], s33 offen sc1
s_add_u32 s33, s47, 3
s_and_b32 s33, s33, 3
s_mul_i32 s33, s33, 40960
s_add_u32 s33, s33, s22
buffer_load_dwordx4 v[100:103], v45, s[12:15], s33 offen offset:0 sc1
buffer_load_dwordx4 v[104:107], v45, s[12:15], s33 offen offset:1024 sc1
buffer_load_dwordx2 v[108:109], v46, s[12:15], s33 offen sc1
s_waitcnt lgkmcnt(12)
v_mfma_f32_16x16x32_bf16 v[144:147], a[0:3], a[96:99], v[144:147]
s_waitcnt lgkmcnt(11)
ds_read_b128 a[244:247], v34 offset:7168
v_permlane16_swap_b32 v204, v206
v_permlane16_swap_b32 v205, v207
v_permlane16_swap_b32 v208, v210
v_mfma_f32_16x16x32_bf16 v[144:147], a[4:7], a[100:103], v[144:147]
s_waitcnt lgkmcnt(11)
ds_read_b128 a[248:251], v34 offset:12288
v_permlane16_swap_b32 v209, v211
v_lshlrev_b32 v184, 16, v204
v_mfma_f32_16x16x32_bf16 v[144:147], a[8:11], a[104:107], v[144:147]
s_waitcnt vmcnt(18) lgkmcnt(11)
ds_read_b128 a[252:255], v34 offset:17408
v_and_b32 v185, 0xffff0000, v204
v_lshlrev_b32 v186, 16, v205
v_mfma_f32_16x16x32_bf16 v[144:147], a[12:15], a[108:111], v[144:147]
s_waitcnt vmcnt(17) lgkmcnt(11)
ds_read_b128 a[0:3], v34 offset:22528
v_and_b32 v187, 0xffff0000, v205
v_lshlrev_b32 v188, 16, v206
v_mfma_f32_16x16x32_bf16 v[144:147], a[16:19], a[112:115], v[144:147]
s_waitcnt vmcnt(16) lgkmcnt(11)
ds_read_b128 a[4:7], v34 offset:27648
v_and_b32 v189, 0xffff0000, v206
v_lshlrev_b32 v190, 16, v207
v_and_b32 v191, 0xffff0000, v207
v_mfma_f32_16x16x32_bf16 v[144:147], a[20:23], a[116:119], v[144:147]
s_waitcnt lgkmcnt(11)
ds_read_b128 a[8:11], v34 offset:3072
v_lshlrev_b32 v192, 16, v208
v_and_b32 v193, 0xffff0000, v208
v_mfma_f32_16x16x32_bf16 v[148:151], a[24:27], a[96:99], v[148:151]
s_waitcnt lgkmcnt(11)
ds_read_b128 a[12:15], v34 offset:8192
v_lshlrev_b32 v194, 16, v209
v_and_b32 v195, 0xffff0000, v209
v_mfma_f32_16x16x32_bf16 v[148:151], a[28:31], a[100:103], v[148:151]
s_waitcnt lgkmcnt(11)
ds_read_b128 a[16:19], v34 offset:13312
v_lshlrev_b32 v196, 16, v210
v_and_b32 v197, 0xffff0000, v210
v_mfma_f32_16x16x32_bf16 v[148:151], a[32:35], a[104:107], v[148:151]
s_waitcnt lgkmcnt(11)
ds_read_b128 a[20:23], v34 offset:18432
v_lshlrev_b32 v198, 16, v211
v_and_b32 v199, 0xffff0000, v211
v_lshlrev_b32 v200, 16, v212
v_mfma_f32_16x16x32_bf16 v[148:151], a[36:39], a[108:111], v[148:151]
s_waitcnt lgkmcnt(11)
ds_read_b128 a[24:27], v34 offset:23552
v_and_b32 v201, 0xffff0000, v212
v_lshlrev_b32 v202, 16, v213
v_mfma_f32_16x16x32_bf16 v[148:151], a[40:43], a[112:115], v[148:151]
s_waitcnt lgkmcnt(11)
ds_read_b128 a[28:31], v34 offset:28672
v_and_b32 v203, 0xffff0000, v213
v_mul_f32 v10, v10, v10
v_mfma_f32_16x16x32_bf16 v[148:151], a[44:47], a[116:119], v[148:151]
s_waitcnt lgkmcnt(11)
ds_read_b128 a[32:35], v34 offset:4096
v_mul_f32 v10, 0x42b87e74, v10
v_mul_f32 v11, 0xbfb8aa3b, v10
v_mfma_f32_16x16x32_bf16 v[152:155], a[240:243], a[96:99], v[152:155]
s_waitcnt lgkmcnt(11)
ds_read_b128 a[36:39], v34 offset:9216
v_lshlrev_b32 v164, 16, v64
v_and_b32 v165, 0xffff0000, v64
v_mul_f32 v164, v10, v164
v_mfma_f32_16x16x32_bf16 v[152:155], a[244:247], a[100:103], v[152:155]
s_waitcnt lgkmcnt(11)
ds_read_b128 a[40:43], v34 offset:14336
v_mul_f32 v165, v10, v165
v_lshlrev_b32 v166, 16, v65
v_mfma_f32_16x16x32_bf16 v[152:155], a[248:251], a[104:107], v[152:155]
s_waitcnt lgkmcnt(11)
ds_read_b128 a[44:47], v34 offset:19456
v_and_b32 v167, 0xffff0000, v65
v_mul_f32 v166, v10, v166
v_mfma_f32_16x16x32_bf16 v[152:155], a[252:255], a[108:111], v[152:155]
s_waitcnt lgkmcnt(11)
ds_read_b128 a[240:243], v34 offset:24576
v_mul_f32 v167, v10, v167
v_lshlrev_b32 v168, 16, v66
v_mfma_f32_16x16x32_bf16 v[152:155], a[0:3], a[112:115], v[152:155]
s_waitcnt lgkmcnt(11)
ds_read_b128 a[244:247], v34 offset:29696
v_and_b32 v169, 0xffff0000, v66
v_mul_f32 v168, v10, v168
v_mfma_f32_16x16x32_bf16 v[152:155], a[4:7], a[116:119], v[152:155]
s_waitcnt lgkmcnt(11)
ds_read_b128 a[248:251], v34 offset:36864
v_mul_f32 v169, v10, v169
v_lshlrev_b32 v170, 16, v67
v_and_b32 v171, 0xffff0000, v67
v_mfma_f32_16x16x32_bf16 v[156:159], a[8:11], a[96:99], v[156:159]
s_waitcnt lgkmcnt(11)
ds_read_b128 a[252:255], v34 offset:41984
v_mul_f32 v170, v10, v170
v_mul_f32 v171, v10, v171
v_mfma_f32_16x16x32_bf16 v[156:159], a[12:15], a[100:103], v[156:159]
s_waitcnt lgkmcnt(11)
ds_read_b128 a[0:3], v34 offset:47104
v_lshlrev_b32 v172, 16, v68
v_and_b32 v173, 0xffff0000, v68
v_mfma_f32_16x16x32_bf16 v[156:159], a[16:19], a[104:107], v[156:159]
s_waitcnt lgkmcnt(11)
ds_read_b128 a[4:7], v34 offset:52224
v_mul_f32 v172, v10, v172
v_mul_f32 v173, v10, v173
v_mfma_f32_16x16x32_bf16 v[156:159], a[20:23], a[108:111], v[156:159]
s_waitcnt lgkmcnt(11)
ds_read_b128 a[8:11], v34 offset:57344
v_lshlrev_b32 v174, 16, v69
v_and_b32 v175, 0xffff0000, v69
v_mul_f32 v174, v10, v174
v_mfma_f32_16x16x32_bf16 v[156:159], a[24:27], a[112:115], v[156:159]
s_waitcnt lgkmcnt(11)
ds_read_b128 a[12:15], v34 offset:62464
v_mul_f32 v175, v10, v175
v_lshlrev_b32 v176, 16, v70
v_mfma_f32_16x16x32_bf16 v[156:159], a[28:31], a[116:119], v[156:159]
s_waitcnt lgkmcnt(11)
ds_read_b128 a[16:19], v34 offset:37888
v_and_b32 v177, 0xffff0000, v70
v_mul_f32 v176, v10, v176
v_mfma_f32_16x16x32_bf16 v[160:163], a[32:35], a[96:99], v[160:163]
s_waitcnt lgkmcnt(11)
ds_read_b128 a[20:23], v34 offset:43008
v_mul_f32 v177, v10, v177
v_lshlrev_b32 v178, 16, v71
v_mfma_f32_16x16x32_bf16 v[160:163], a[36:39], a[100:103], v[160:163]
s_waitcnt lgkmcnt(11)
ds_read_b128 a[24:27], v34 offset:48128
v_and_b32 v179, 0xffff0000, v71
v_mul_f32 v178, v10, v178
v_mul_f32 v179, v10, v179
v_mfma_f32_16x16x32_bf16 v[160:163], a[40:43], a[104:107], v[160:163]
s_waitcnt lgkmcnt(11)
ds_read_b128 a[28:31], v34 offset:53248
v_lshlrev_b32 v180, 16, v72
v_and_b32 v181, 0xffff0000, v72
v_mfma_f32_16x16x32_bf16 v[160:163], a[44:47], a[108:111], v[160:163]
s_waitcnt lgkmcnt(11)
ds_read_b128 a[32:35], v34 offset:58368
v_mul_f32 v180, v10, v180
v_mul_f32 v181, v10, v181
v_mfma_f32_16x16x32_bf16 v[160:163], a[240:243], a[112:115], v[160:163]
s_waitcnt lgkmcnt(11)
ds_read_b128 a[36:39], v34 offset:63488
v_lshlrev_b32 v182, 16, v73
v_and_b32 v183, 0xffff0000, v73
v_mfma_f32_16x16x32_bf16 v[160:163], a[244:247], a[116:119], v[160:163]
ds_read_b128 a[40:43], v34 offset:38912
v_mul_f32 v182, v10, v182
v_mul_f32 v183, v10, v183
s_waitcnt vmcnt(15) lgkmcnt(12)
v_mfma_f32_16x16x32_bf16 v[144:147], a[248:251], a[120:123], v[144:147]
s_waitcnt vmcnt(14) lgkmcnt(11)
ds_read_b128 a[44:47], v34 offset:44032
buffer_load_dword v16, v13, s[12:15], s32 offen sc1
v_mfma_f32_16x16x32_bf16 v[144:147], a[252:255], a[124:127], v[144:147]
s_waitcnt vmcnt(14) lgkmcnt(11)
ds_read_b128 a[240:243], v34 offset:49152
v_mfma_f32_16x16x32_bf16 v[144:147], a[0:3], a[128:131], v[144:147]
s_waitcnt vmcnt(13) lgkmcnt(11)
ds_read_b128 a[244:247], v34 offset:54272
v_mfma_f32_16x16x32_bf16 v[144:147], a[4:7], a[132:135], v[144:147]
s_waitcnt vmcnt(12) lgkmcnt(11)
ds_read_b128 a[248:251], v34 offset:59392
v_mfma_f32_16x16x32_bf16 v[144:147], a[8:11], a[136:139], v[144:147]
s_waitcnt vmcnt(11) lgkmcnt(11)
ds_read_b128 a[252:255], v34 offset:64512
v_mfma_f32_16x16x32_bf16 v[144:147], a[12:15], a[140:143], v[144:147]
s_waitcnt lgkmcnt(11)
ds_read_b128 a[0:3], v34 offset:39936
v_mfma_f32_16x16x32_bf16 v[148:151], a[16:19], a[120:123], v[148:151]
s_waitcnt lgkmcnt(11)
ds_read_b128 a[4:7], v34 offset:45056
v_mfma_f32_16x16x32_bf16 v[148:151], a[20:23], a[124:127], v[148:151]
s_waitcnt lgkmcnt(11)
ds_read_b128 a[8:11], v34 offset:50176
v_mfma_f32_16x16x32_bf16 v[148:151], a[24:27], a[128:131], v[148:151]
s_waitcnt lgkmcnt(11)
ds_read_b128 a[12:15], v34 offset:55296
v_mfma_f32_16x16x32_bf16 v[148:151], a[28:31], a[132:135], v[148:151]
s_waitcnt lgkmcnt(11)
ds_read_b128 a[16:19], v34 offset:60416
v_mfma_f32_16x16x32_bf16 v[148:151], a[32:35], a[136:139], v[148:151]
s_waitcnt lgkmcnt(11)
v_add_u32 v34, 0x9000, v34
ds_read_b128 a[20:23], v34 offset:28672
v_mfma_f32_16x16x32_bf16 v[148:151], a[36:39], a[140:143], v[148:151]
s_waitcnt lgkmcnt(11)
ds_read_b128 a[24:27], v34 offset:4096
v_mfma_f32_16x16x32_bf16 v[152:155], a[40:43], a[120:123], v[152:155]
s_waitcnt lgkmcnt(11)
ds_read_b128 a[28:31], v34 offset:9216
v_mfma_f32_16x16x32_bf16 v[152:155], a[44:47], a[124:127], v[152:155]
s_waitcnt lgkmcnt(11)
ds_read_b128 a[32:35], v34 offset:14336
v_mfma_f32_16x16x32_bf16 v[152:155], a[240:243], a[128:131], v[152:155]
s_waitcnt lgkmcnt(11)
ds_read_b128 a[36:39], v34 offset:19456
v_mfma_f32_16x16x32_bf16 v[152:155], a[244:247], a[132:135], v[152:155]
s_waitcnt lgkmcnt(11)
ds_read_b128 a[40:43], v34 offset:24576
v_mfma_f32_16x16x32_bf16 v[152:155], a[248:251], a[136:139], v[152:155]
s_waitcnt lgkmcnt(11)
ds_read_b128 a[44:47], v34 offset:29696
v_mfma_f32_16x16x32_bf16 v[152:155], a[252:255], a[140:143], v[152:155]
s_waitcnt lgkmcnt(11)
v_mfma_f32_16x16x32_bf16 v[156:159], a[0:3], a[120:123], v[156:159]
s_waitcnt lgkmcnt(10)
v_mfma_f32_16x16x32_bf16 v[156:159], a[4:7], a[124:127], v[156:159]
s_waitcnt lgkmcnt(9)
v_mfma_f32_16x16x32_bf16 v[156:159], a[8:11], a[128:131], v[156:159]
s_waitcnt lgkmcnt(8)
v_mfma_f32_16x16x32_bf16 v[156:159], a[12:15], a[132:135], v[156:159]
s_waitcnt lgkmcnt(7)
v_mfma_f32_16x16x32_bf16 v[156:159], a[16:19], a[136:139], v[156:159]
s_waitcnt lgkmcnt(6)
v_mfma_f32_16x16x32_bf16 v[156:159], a[20:23], a[140:143], v[156:159]
s_waitcnt lgkmcnt(5)
v_mfma_f32_16x16x32_bf16 v[160:163], a[24:27], a[120:123], v[160:163]
s_waitcnt lgkmcnt(4)
v_mfma_f32_16x16x32_bf16 v[160:163], a[28:31], a[124:127], v[160:163]
s_waitcnt lgkmcnt(3)
v_mfma_f32_16x16x32_bf16 v[160:163], a[32:35], a[128:131], v[160:163]
s_waitcnt lgkmcnt(2)
v_mfma_f32_16x16x32_bf16 v[160:163], a[36:39], a[132:135], v[160:163]
s_waitcnt lgkmcnt(1)
v_mfma_f32_16x16x32_bf16 v[160:163], a[40:43], a[136:139], v[160:163]
s_waitcnt lgkmcnt(0)
v_mfma_f32_16x16x32_bf16 v[160:163], a[44:47], a[140:143], v[160:163]
s_waitcnt vmcnt(0)
v_cmp_ne_u32 vcc, s40, v16
s_nop 1
s_cbranch_vccnz L_spin_q
L_back_q:
buffer_load_dwordx4 v[246:249], v1, s[12:15], s45 offen offset:0 sc1
buffer_load_dwordx4 v[250:253], v1, s[12:15], s45 offen offset:1024 sc1
buffer_load_dwordx2 v[254:255], v37, s[12:15], s45 offen offset:2048 sc1
v_mov_b32 v12, v10
v_mov_b32 v13, v10
v_lshlrev_b32 v132, 16, v76
v_and_b32 v133, 0xffff0000, v76
v_pk_fma_f32 v[164:165], v[132:133], v[12:13], v[164:165]
v_lshlrev_b32 v134, 16, v77
v_and_b32 v135, 0xffff0000, v77
v_pk_fma_f32 v[166:167], v[134:135], v[12:13], v[166:167]
v_lshlrev_b32 v136, 16, v78
v_and_b32 v137, 0xffff0000, v78
v_pk_fma_f32 v[168:169], v[136:137], v[12:13], v[168:169]
v_lshlrev_b32 v138, 16, v79
v_and_b32 v139, 0xffff0000, v79
v_pk_fma_f32 v[170:171], v[138:139], v[12:13], v[170:171]
v_lshlrev_b32 v132, 16, v80
v_and_b32 v133, 0xffff0000, v80
v_pk_fma_f32 v[172:173], v[132:133], v[12:13], v[172:173]
v_lshlrev_b32 v134, 16, v81
v_and_b32 v135, 0xffff0000, v81
v_pk_fma_f32 v[174:175], v[134:135], v[12:13], v[174:175]
v_lshlrev_b32 v136, 16, v82
v_and_b32 v137, 0xffff0000, v82
v_pk_fma_f32 v[176:177], v[136:137], v[12:13], v[176:177]
v_lshlrev_b32 v138, 16, v83
v_and_b32 v139, 0xffff0000, v83
v_pk_fma_f32 v[178:179], v[138:139], v[12:13], v[178:179]
v_lshlrev_b32 v132, 16, v84
v_and_b32 v133, 0xffff0000, v84
v_pk_fma_f32 v[180:181], v[132:133], v[12:13], v[180:181]
v_lshlrev_b32 v134, 16, v85
v_and_b32 v135, 0xffff0000, v85
v_pk_fma_f32 v[182:183], v[134:135], v[12:13], v[182:183]
v_lshlrev_b32 v132, 16, v88
v_and_b32 v133, 0xffff0000, v88
v_pk_fma_f32 v[164:165], v[132:133], v[12:13], v[164:165]
v_lshlrev_b32 v134, 16, v89
v_and_b32 v135, 0xffff0000, v89
v_pk_fma_f32 v[166:167], v[134:135], v[12:13], v[166:167]
v_lshlrev_b32 v136, 16, v90
v_and_b32 v137, 0xffff0000, v90
v_pk_fma_f32 v[168:169], v[136:137], v[12:13], v[168:169]
v_lshlrev_b32 v138, 16, v91
v_and_b32 v139, 0xffff0000, v91
v_pk_fma_f32 v[170:171], v[138:139], v[12:13], v[170:171]
v_lshlrev_b32 v132, 16, v92
v_and_b32 v133, 0xffff0000, v92
v_pk_fma_f32 v[172:173], v[132:133], v[12:13], v[172:173]
v_lshlrev_b32 v134, 16, v93
v_and_b32 v135, 0xffff0000, v93
v_pk_fma_f32 v[174:175], v[134:135], v[12:13], v[174:175]
v_lshlrev_b32 v136, 16, v94
v_and_b32 v137, 0xffff0000, v94
v_pk_fma_f32 v[176:177], v[136:137], v[12:13], v[176:177]
v_lshlrev_b32 v138, 16, v95
v_and_b32 v139, 0xffff0000, v95
v_pk_fma_f32 v[178:179], v[138:139], v[12:13], v[178:179]
v_lshlrev_b32 v132, 16, v96
v_and_b32 v133, 0xffff0000, v96
v_pk_fma_f32 v[180:181], v[132:133], v[12:13], v[180:181]
v_lshlrev_b32 v134, 16, v97
v_and_b32 v135, 0xffff0000, v97
v_pk_fma_f32 v[182:183], v[134:135], v[12:13], v[182:183]
v_lshlrev_b32 v132, 16, v100
v_and_b32 v133, 0xffff0000, v100
v_pk_fma_f32 v[164:165], v[132:133], v[12:13], v[164:165]
v_lshlrev_b32 v134, 16, v101
v_and_b32 v135, 0xffff0000, v101
v_pk_fma_f32 v[166:167], v[134:135], v[12:13], v[166:167]
v_lshlrev_b32 v136, 16, v102
v_and_b32 v137, 0xffff0000, v102
v_pk_fma_f32 v[168:169], v[136:137], v[12:13], v[168:169]
v_lshlrev_b32 v138, 16, v103
v_and_b32 v139, 0xffff0000, v103
v_pk_fma_f32 v[170:171], v[138:139], v[12:13], v[170:171]
v_lshlrev_b32 v132, 16, v104
v_and_b32 v133, 0xffff0000, v104
v_pk_fma_f32 v[172:173], v[132:133], v[12:13], v[172:173]
v_lshlrev_b32 v134, 16, v105
v_and_b32 v135, 0xffff0000, v105
v_pk_fma_f32 v[174:175], v[134:135], v[12:13], v[174:175]
v_lshlrev_b32 v136, 16, v106
v_and_b32 v137, 0xffff0000, v106
v_pk_fma_f32 v[176:177], v[136:137], v[12:13], v[176:177]
v_lshlrev_b32 v138, 16, v107
v_and_b32 v139, 0xffff0000, v107
v_pk_fma_f32 v[178:179], v[138:139], v[12:13], v[178:179]
v_lshlrev_b32 v132, 16, v108
v_and_b32 v133, 0xffff0000, v108
v_pk_fma_f32 v[180:181], v[132:133], v[12:13], v[180:181]
v_lshlrev_b32 v134, 16, v109
v_and_b32 v135, 0xffff0000, v109
v_pk_fma_f32 v[182:183], v[134:135], v[12:13], v[182:183]
v_mov_b32 v10, v11
v_mov_b32 v12, 1.0
v_mov_b32 v13, 1.0
s_waitcnt vmcnt(2)
v_lshlrev_b32 v132, 16, v246
v_and_b32 v133, 0xffff0000, v246
v_pk_add_f32 v[144:145], v[144:145], v[132:133]
v_lshlrev_b32 v134, 16, v247
v_and_b32 v135, 0xffff0000, v247
v_pk_add_f32 v[146:147], v[146:147], v[134:135]
v_pk_mul_f32 v[112:113], v[144:145], v[10:11]
v_pk_mul_f32 v[114:115], v[146:147], v[10:11]
v_exp_f32 v112, v112
v_exp_f32 v113, v113
v_exp_f32 v114, v114
v_exp_f32 v115, v115
v_pk_mul_f32 v[144:145], v[144:145], v[164:165]
v_pk_mul_f32 v[146:147], v[146:147], v[166:167]
v_pk_add_f32 v[112:113], v[112:113], v[12:13]
v_pk_add_f32 v[114:115], v[114:115], v[12:13]
v_rcp_f32 v112, v112
v_rcp_f32 v113, v113
v_rcp_f32 v114, v114
v_rcp_f32 v115, v115
v_pk_fma_f32 v[184:185], v[144:145], v[112:113], v[184:185]
v_pk_fma_f32 v[186:187], v[146:147], v[114:115], v[186:187]
v_cvt_pk_bf16_f32 v204, v184, v185
v_cvt_pk_bf16_f32 v205, v186, v187
v_lshlrev_b32 v132, 16, v248
v_and_b32 v133, 0xffff0000, v248
v_pk_add_f32 v[148:149], v[148:149], v[132:133]
v_lshlrev_b32 v134, 16, v249
v_and_b32 v135, 0xffff0000, v249
v_pk_add_f32 v[150:151], v[150:151], v[134:135]
v_pk_mul_f32 v[116:117], v[148:149], v[10:11]
v_pk_mul_f32 v[118:119], v[150:151], v[10:11]
v_exp_f32 v116, v116
v_exp_f32 v117, v117
v_exp_f32 v118, v118
v_exp_f32 v119, v119
v_pk_mul_f32 v[148:149], v[148:149], v[168:169]
v_pk_mul_f32 v[150:151], v[150:151], v[170:171]
v_pk_add_f32 v[116:117], v[116:117], v[12:13]
v_pk_add_f32 v[118:119], v[118:119], v[12:13]
v_rcp_f32 v116, v116
v_rcp_f32 v117, v117
v_rcp_f32 v118, v118
v_rcp_f32 v119, v119
v_pk_fma_f32 v[188:189], v[148:149], v[116:117], v[188:189]
v_pk_fma_f32 v[190:191], v[150:151], v[118:119], v[190:191]
v_cvt_pk_bf16_f32 v206, v188, v189
v_cvt_pk_bf16_f32 v207, v190, v191
s_nop 0
v_permlane16_swap_b32 v204, v206
v_permlane16_swap_b32 v205, v207
buffer_store_dwordx4 v[204:207], v38, s[4:7], s34 offen offset:0
s_waitcnt vmcnt(2)
v_lshlrev_b32 v132, 16, v250
v_and_b32 v133, 0xffff0000, v250
v_pk_add_f32 v[152:153], v[152:153], v[132:133]
v_lshlrev_b32 v134, 16, v251
v_and_b32 v135, 0xffff0000, v251
v_pk_add_f32 v[154:155], v[154:155], v[134:135]
v_pk_mul_f32 v[120:121], v[152:153], v[10:11]
v_pk_mul_f32 v[122:123], v[154:155], v[10:11]
v_exp_f32 v120, v120
v_exp_f32 v121, v121
v_exp_f32 v122, v122
v_exp_f32 v123, v123
v_pk_mul_f32 v[152:153], v[152:153], v[172:173]
v_pk_mul_f32 v[154:155], v[154:155], v[174:175]
v_pk_add_f32 v[120:121], v[120:121], v[12:13]
v_pk_add_f32 v[122:123], v[122:123], v[12:13]
v_rcp_f32 v120, v120
v_rcp_f32 v121, v121
v_rcp_f32 v122, v122
v_rcp_f32 v123, v123
v_pk_fma_f32 v[192:193], v[152:153], v[120:121], v[192:193]
v_pk_fma_f32 v[194:195], v[154:155], v[122:123], v[194:195]
v_cvt_pk_bf16_f32 v208, v192, v193
v_cvt_pk_bf16_f32 v209, v194, v195
v_lshlrev_b32 v132, 16, v252
v_and_b32 v133, 0xffff0000, v252
v_pk_add_f32 v[156:157], v[156:157], v[132:133]
v_lshlrev_b32 v134, 16, v253
v_and_b32 v135, 0xffff0000, v253
v_pk_add_f32 v[158:159], v[158:159], v[134:135]
v_pk_mul_f32 v[124:125], v[156:157], v[10:11]
v_pk_mul_f32 v[126:127], v[158:159], v[10:11]
v_exp_f32 v124, v124
v_exp_f32 v125, v125
v_exp_f32 v126, v126
v_exp_f32 v127, v127
v_pk_mul_f32 v[156:157], v[156:157], v[176:177]
v_pk_mul_f32 v[158:159], v[158:159], v[178:179]
v_pk_add_f32 v[124:125], v[124:125], v[12:13]
v_pk_add_f32 v[126:127], v[126:127], v[12:13]
v_rcp_f32 v124, v124
v_rcp_f32 v125, v125
v_rcp_f32 v126, v126
v_rcp_f32 v127, v127
v_pk_fma_f32 v[196:197], v[156:157], v[124:125], v[196:197]
v_pk_fma_f32 v[198:199], v[158:159], v[126:127], v[198:199]
v_cvt_pk_bf16_f32 v210, v196, v197
v_cvt_pk_bf16_f32 v211, v198, v199
s_nop 0
v_permlane16_swap_b32 v208, v210
v_permlane16_swap_b32 v209, v211
buffer_store_dwordx4 v[208:211], v38, s[4:7], s34 offen offset:64
s_waitcnt vmcnt(2)
v_lshlrev_b32 v132, 16, v254
v_and_b32 v133, 0xffff0000, v254
v_pk_add_f32 v[160:161], v[160:161], v[132:133]
v_lshlrev_b32 v134, 16, v255
v_and_b32 v135, 0xffff0000, v255
v_pk_add_f32 v[162:163], v[162:163], v[134:135]
v_pk_mul_f32 v[128:129], v[160:161], v[10:11]
v_pk_mul_f32 v[130:131], v[162:163], v[10:11]
v_exp_f32 v128, v128
v_exp_f32 v129, v129
v_exp_f32 v130, v130
v_exp_f32 v131, v131
v_pk_mul_f32 v[160:161], v[160:161], v[180:181]
v_pk_mul_f32 v[162:163], v[162:163], v[182:183]
v_pk_add_f32 v[128:129], v[128:129], v[12:13]
v_pk_add_f32 v[130:131], v[130:131], v[12:13]
v_rcp_f32 v128, v128
v_rcp_f32 v129, v129
v_rcp_f32 v130, v130
v_rcp_f32 v131, v131
v_pk_fma_f32 v[200:201], v[160:161], v[128:129], v[200:201]
v_pk_fma_f32 v[202:203], v[162:163], v[130:131], v[202:203]
v_cvt_pk_bf16_f32 v212, v200, v201
v_cvt_pk_bf16_f32 v213, v202, v203
buffer_store_dwordx2 v[212:213], v40, s[4:7], s34 offen offset:128
L_end:
s_endpgm
L_nonce:
s_mov_b32 s51, 200000
L_nonce2:
buffer_load_dword v15, v60, s[16:19], 0 offen sc1
s_waitcnt vmcnt(0)
v_readfirstlane_b32 s40, v15
s_nop 3
s_cmp_lg_u32 s40, 0
s_cbranch_scc1 L_nonce_ok
s_sub_u32 s51, s51, 1
s_cmp_lg_u32 s51, 0
s_cbranch_scc1 L_nonce2
s_branch L_nonce_ok
L_spin_xn:
s_mov_b32 s51, 200000
L_spin2_xn:
buffer_load_dword v43, v42, s[12:15], s55 offen sc1
s_waitcnt vmcnt(0)
v_cmp_ne_u32 vcc, s40, v43
s_nop 4
s_cbranch_vccz L_back_xn
s_sleep 1
s_sub_u32 s51, s51, 1
s_cmp_lg_u32 s51, 0
s_cbranch_scc1 L_spin2_xn
s_branch L_back_xn
L_spin_g:
s_mov_b32 s51, 200000
L_spin2_g:
buffer_load_dwordx4 v[48:51], v1, s[12:15], s31 offen sc1
s_waitcnt vmcnt(0)
v_xor_b32 v48, s40, v48
v_xor_b32 v49, s40, v49
v_xor_b32 v50, s40, v50
v_xor_b32 v51, s40, v51
v_or3_b32 v48, v48, v49, v50
v_or_b32 v48, v48, v51
v_cmp_ne_u32 vcc, 0, v48
s_nop 4
s_cbranch_vccz L_back_g
s_sleep 1
s_sub_u32 s51, s51, 1
s_cmp_lg_u32 s51, 0
s_cbranch_scc1 L_spin2_g
s_branch L_back_g
L_spin_w:
s_mov_b32 s51, 200000
L_spin2_w:
buffer_load_dwordx4 v[44:47], v1, s[12:15], s31 offen sc1
s_waitcnt vmcnt(0)
v_xor_b32 v44, s40, v44
v_xor_b32 v45, s40, v45
v_xor_b32 v46, s40, v46
v_xor_b32 v47, s40, v47
v_or3_b32 v44, v44, v45, v46
v_or_b32 v44, v44, v47
v_cmp_ne_u32 vcc, 0, v44
s_nop 4
s_cbranch_vccz L_back_w
s_sleep 1
s_sub_u32 s51, s51, 1
s_cmp_lg_u32 s51, 0
s_cbranch_scc1 L_spin2_w
s_branch L_back_w
L_spin_o:
s_mov_b32 s51, 200000
L_spin2_o:
buffer_load_dword v37, v39, s[12:15], s27 offen sc1
s_waitcnt vmcnt(0)
v_cmp_ne_u32 vcc, s40, v37
s_nop 4
s_cbranch_vccz L_back_o
s_sleep 1
s_sub_u32 s51, s51, 1
s_cmp_lg_u32 s51, 0
s_cbranch_scc1 L_spin2_o
s_branch L_back_o
L_spin_w2:
s_mov_b32 s51, 200000
L_spin2_w2:
buffer_load_dwordx4 v[48:51], v1, s[12:15], s23 offen sc1
s_waitcnt vmcnt(0)
v_xor_b32 v48, s40, v48
v_xor_b32 v49, s40, v49
v_xor_b32 v50, s40, v50
v_xor_b32 v51, s40, v51
v_or3_b32 v48, v48, v49, v50
v_or_b32 v48, v48, v51
v_cmp_ne_u32 vcc, 0, v48
s_nop 4
s_cbranch_vccz L_back_w2
s_sleep 1
s_sub_u32 s51, s51, 1
s_cmp_lg_u32 s51, 0
s_cbranch_scc1 L_spin2_w2
s_branch L_back_w2
L_spin_h:
s_mov_b32 s51, 200000
L_spin2_h:
buffer_load_dword v44, v42, s[12:15], s32 offen sc1
s_waitcnt vmcnt(0)
v_cmp_ne_u32 vcc, s40, v44
s_nop 4
s_cbranch_vccz L_back_h
s_sleep 1
s_sub_u32 s51, s51, 1
s_cmp_lg_u32 s51, 0
s_cbranch_scc1 L_spin2_h
s_branch L_back_h
L_spin_p:
s_mov_b32 s51, 200000
L_spin2_p:
buffer_load_dword v44, v12, s[12:15], s55 offen sc1
s_waitcnt vmcnt(0)
v_cmp_ne_u32 vcc, s40, v44
s_nop 4
s_cbranch_vccz L_back_p
s_sleep 1
s_sub_u32 s51, s51, 1
s_cmp_lg_u32 s51, 0
s_cbranch_scc1 L_spin2_p
s_branch L_back_p
L_spin_q:
s_mov_b32 s51, 200000
L_spin2_q:
buffer_load_dword v16, v13, s[12:15], s32 offen sc1
s_waitcnt vmcnt(0)
v_cmp_ne_u32 vcc, s40, v16
s_nop 4
s_cbranch_vccz L_back_q
s_sleep 1
s_sub_u32 s51, s51, 1
s_cmp_lg_u32 s51, 0
s_cbranch_scc1 L_spin2_q
s_branch L_back_q
L_fb:
s_waitcnt vmcnt(0) lgkmcnt(0)
s_nop 15
v_and_b32 v54, 15, v0
v_lshrrev_b32 v55, 4, v0
v_mul_u32_u24 v48, 384, v54
v_lshl_add_u32 v48, v55, 4, v48
v_lshrrev_b32 v56, 3, v0
v_and_b32 v57, 7, v0
v_and_b32 v58, 6, v56
v_xor_b32 v57, v57, v58
v_mul_u32_u24 v49, 384, v56
v_lshl_add_u32 v49, v57, 4, v49
v_lshrrev_b32 v56, 2, v54
v_lshl_add_u32 v56, v55, 2, v56
v_bfe_u32 v57, v56, 1, 2
v_lshlrev_b32 v56, 7, v56
v_and_b32 v58, 3, v0
v_lshl_add_u32 v56, v58, 3, v56
s_lshl_b32 s33, s30, 12
s_add_u32 s33, s33, 57344
s_cmp_eq_u32 s30, 0
s_cmov_b32 s33, 110592
s_cmp_eq_u32 s30, 3
s_cmov_b32 s33, 81920
v_add_u32 v56, s33, v56
v_xor_b32 v58, 0, v57
v_lshl_add_u32 v50, v58, 5, v56
v_xor_b32 v58, 1, v57
v_lshl_add_u32 v51, v58, 5, v56
v_xor_b32 v58, 2, v57
v_lshl_add_u32 v52, v58, 5, v56
v_xor_b32 v58, 3, v57
v_lshl_add_u32 v53, v58, 5, v56
s_mul_i32 s32, s28, 786432
s_add_u32 s32, s32, 589824
s_mov_b32 s31, s32
s_mov_b32 s51, 0
v_mov_b32 v32, 0xff800000
v_mov_b32 v36, 0xff800000
v_mov_b32 v40, 0xff800000
v_mov_b32 v44, 0xff800000
L_fb1:
buffer_load_dwordx4 v[232:235], v48, s[8:11], s31 offen offset:0
buffer_load_dwordx4 v[236:239], v48, s[8:11], s31 offen offset:64
buffer_load_dwordx4 v[240:243], v48, s[8:11], s31 offen offset:128
buffer_load_dwordx4 v[244:247], v48, s[8:11], s31 offen offset:192
buffer_load_dwordx4 v[248:251], v48, s[8:11], s31 offen offset:256
buffer_load_dwordx4 v[252:255], v48, s[8:11], s31 offen offset:320
s_add_u32 s31, s31, 6144
s_waitcnt vmcnt(5)
v_mfma_f32_16x16x32_bf16 v[176:179], v[232:235], v[64:67], 0
s_waitcnt vmcnt(4)
v_mfma_f32_16x16x32_bf16 v[176:179], v[236:239], v[80:83], v[176:179]
s_waitcnt vmcnt(3)
v_mfma_f32_16x16x32_bf16 v[176:179], v[240:243], v[96:99], v[176:179]
s_waitcnt vmcnt(2)
v_mfma_f32_16x16x32_bf16 v[176:179], v[244:247], v[112:115], v[176:179]
s_waitcnt vmcnt(1)
v_mfma_f32_16x16x32_bf16 v[176:179], v[248:251], v[128:131], v[176:179]
s_waitcnt vmcnt(0)
v_mfma_f32_16x16x32_bf16 v[176:179], v[252:255], v[144:147], v[176:179]
v_mfma_f32_16x16x32_bf16 v[184:187], v[232:235], v[68:71], 0
v_mfma_f32_16x16x32_bf16 v[184:187], v[236:239], v[84:87], v[184:187]
v_mfma_f32_16x16x32_bf16 v[184:187], v[240:243], v[100:103], v[184:187]
v_mfma_f32_16x16x32_bf16 v[184:187], v[244:247], v[116:119], v[184:187]
v_mfma_f32_16x16x32_bf16 v[184:187], v[248:251], v[132:135], v[184:187]
v_mfma_f32_16x16x32_bf16 v[184:187], v[252:255], v[148:151], v[184:187]
v_mfma_f32_16x16x32_bf16 v[192:195], v[232:235], v[72:75], 0
v_mfma_f32_16x16x32_bf16 v[192:195], v[236:239], v[88:91], v[192:195]
v_mfma_f32_16x16x32_bf16 v[192:195], v[240:243], v[104:107], v[192:195]
v_mfma_f32_16x16x32_bf16 v[192:195], v[244:247], v[120:123], v[192:195]
v_mfma_f32_16x16x32_bf16 v[192:195], v[248:251], v[136:139], v[192:195]
v_mfma_f32_16x16x32_bf16 v[192:195], v[252:255], v[152:155], v[192:195]
v_mfma_f32_16x16x32_bf16 v[200:203], v[232:235], v[76:79], 0
v_mfma_f32_16x16x32_bf16 v[200:203], v[236:239], v[92:95], v[200:203]
v_mfma_f32_16x16x32_bf16 v[200:203], v[240:243], v[108:111], v[200:203]
v_mfma_f32_16x16x32_bf16 v[200:203], v[244:247], v[124:127], v[200:203]
v_mfma_f32_16x16x32_bf16 v[200:203], v[248:251], v[140:143], v[200:203]
v_mfma_f32_16x16x32_bf16 v[200:203], v[252:255], v[156:159], v[200:203]
v_max3_f32 v32, v32, v176, v177
v_max3_f32 v32, v32, v178, v179
v_max3_f32 v36, v36, v184, v185
v_max3_f32 v36, v36, v186, v187
v_max3_f32 v40, v40, v192, v193
v_max3_f32 v40, v40, v194, v195
s_nop 1
v_max3_f32 v44, v44, v200, v201
v_max3_f32 v44, v44, v202, v203
s_add_u32 s51, s51, 1
s_cmp_lt_u32 s51, 32
s_cbranch_scc1 L_fb1
v_mov_b32 v33, v32
s_nop 1
v_permlane16_swap_b32 v32, v33
v_max_f32 v32, v32, v33
v_mov_b32 v33, v32
s_nop 1
v_permlane32_swap_b32 v32, v33
v_max_f32 v32, v32, v33
v_sub_f32 v33, 0, v32
v_sub_f32 v34, 0, v32
v_sub_f32 v35, 0, v32
v_sub_f32 v32, 0, v32
v_mov_b32 v26, 0
v_mov_b32 v37, v36
s_nop 1
v_permlane16_swap_b32 v36, v37
v_max_f32 v36, v36, v37
v_mov_b32 v37, v36
s_nop 1
v_permlane32_swap_b32 v36, v37
v_max_f32 v36, v36, v37
v_sub_f32 v37, 0, v36
v_sub_f32 v38, 0, v36
v_sub_f32 v39, 0, v36
v_sub_f32 v36, 0, v36
v_mov_b32 v27, 0
v_mov_b32 v41, v40
s_nop 1
v_permlane16_swap_b32 v40, v41
v_max_f32 v40, v40, v41
v_mov_b32 v41, v40
s_nop 1
v_permlane32_swap_b32 v40, v41
v_max_f32 v40, v40, v41
v_sub_f32 v41, 0, v40
v_sub_f32 v42, 0, v40
v_sub_f32 v43, 0, v40
v_sub_f32 v40, 0, v40
v_mov_b32 v28, 0
v_mov_b32 v45, v44
s_nop 1
v_permlane16_swap_b32 v44, v45
v_max_f32 v44, v44, v45
v_mov_b32 v45, v44
s_nop 1
v_permlane32_swap_b32 v44, v45
v_max_f32 v44, v44, v45
v_sub_f32 v45, 0, v44
v_sub_f32 v46, 0, v44
v_sub_f32 v47, 0, v44
v_sub_f32 v44, 0, v44
v_mov_b32 v29, 0
v_accvgpr_write_b32 a0, 0
v_accvgpr_write_b32 a1, 0
v_accvgpr_write_b32 a2, 0
v_accvgpr_write_b32 a3, 0
v_accvgpr_write_b32 a4, 0
v_accvgpr_write_b32 a5, 0
v_accvgpr_write_b32 a6, 0
v_accvgpr_write_b32 a7, 0
v_accvgpr_write_b32 a8, 0
v_accvgpr_write_b32 a9, 0
v_accvgpr_write_b32 a10, 0
v_accvgpr_write_b32 a11, 0
v_accvgpr_write_b32 a12, 0
v_accvgpr_write_b32 a13, 0
v_accvgpr_write_b32 a14, 0
v_accvgpr_write_b32 a15, 0
v_accvgpr_write_b32 a16, 0
v_accvgpr_write_b32 a17, 0
v_accvgpr_write_b32 a18, 0
v_accvgpr_write_b32 a19, 0
v_accvgpr_write_b32 a20, 0
v_accvgpr_write_b32 a21, 0
v_accvgpr_write_b32 a22, 0
v_accvgpr_write_b32 a23, 0
v_accvgpr_write_b32 a24, 0
v_accvgpr_write_b32 a25, 0
v_accvgpr_write_b32 a26, 0
v_accvgpr_write_b32 a27, 0
v_accvgpr_write_b32 a28, 0
v_accvgpr_write_b32 a29, 0
v_accvgpr_write_b32 a30, 0
v_accvgpr_write_b32 a31, 0
v_accvgpr_write_b32 a32, 0
v_accvgpr_write_b32 a33, 0
v_accvgpr_write_b32 a34, 0
v_accvgpr_write_b32 a35, 0
v_accvgpr_write_b32 a36, 0
v_accvgpr_write_b32 a37, 0
v_accvgpr_write_b32 a38, 0
v_accvgpr_write_b32 a39, 0
v_accvgpr_write_b32 a40, 0
v_accvgpr_write_b32 a41, 0
v_accvgpr_write_b32 a42, 0
v_accvgpr_write_b32 a43, 0
v_accvgpr_write_b32 a44, 0
v_accvgpr_write_b32 a45, 0
v_accvgpr_write_b32 a46, 0
v_accvgpr_write_b32 a47, 0
v_accvgpr_write_b32 a48, 0
v_accvgpr_write_b32 a49, 0
v_accvgpr_write_b32 a50, 0
v_accvgpr_write_b32 a51, 0
v_accvgpr_write_b32 a52, 0
v_accvgpr_write_b32 a53, 0
v_accvgpr_write_b32 a54, 0
v_accvgpr_write_b32 a55, 0
v_accvgpr_write_b32 a56, 0
v_accvgpr_write_b32 a57, 0
v_accvgpr_write_b32 a58, 0
v_accvgpr_write_b32 a59, 0
v_accvgpr_write_b32 a60, 0
v_accvgpr_write_b32 a61, 0
v_accvgpr_write_b32 a62, 0
v_accvgpr_write_b32 a63, 0
v_accvgpr_write_b32 a64, 0
v_accvgpr_write_b32 a65, 0
v_accvgpr_write_b32 a66, 0
v_accvgpr_write_b32 a67, 0
v_accvgpr_write_b32 a68, 0
v_accvgpr_write_b32 a69, 0
v_accvgpr_write_b32 a70, 0
v_accvgpr_write_b32 a71, 0
v_accvgpr_write_b32 a72, 0
v_accvgpr_write_b32 a73, 0
v_accvgpr_write_b32 a74, 0
v_accvgpr_write_b32 a75, 0
v_accvgpr_write_b32 a76, 0
v_accvgpr_write_b32 a77, 0
v_accvgpr_write_b32 a78, 0
v_accvgpr_write_b32 a79, 0
v_accvgpr_write_b32 a80, 0
v_accvgpr_write_b32 a81, 0
v_accvgpr_write_b32 a82, 0
v_accvgpr_write_b32 a83, 0
v_accvgpr_write_b32 a84, 0
v_accvgpr_write_b32 a85, 0
v_accvgpr_write_b32 a86, 0
v_accvgpr_write_b32 a87, 0
v_accvgpr_write_b32 a88, 0
v_accvgpr_write_b32 a89, 0
v_accvgpr_write_b32 a90, 0
v_accvgpr_write_b32 a91, 0
v_accvgpr_write_b32 a92, 0
v_accvgpr_write_b32 a93, 0
v_accvgpr_write_b32 a94, 0
v_accvgpr_write_b32 a95, 0
v_accvgpr_write_b32 a96, 0
v_accvgpr_write_b32 a97, 0
v_accvgpr_write_b32 a98, 0
v_accvgpr_write_b32 a99, 0
v_accvgpr_write_b32 a100, 0
v_accvgpr_write_b32 a101, 0
v_accvgpr_write_b32 a102, 0
v_accvgpr_write_b32 a103, 0
v_accvgpr_write_b32 a104, 0
v_accvgpr_write_b32 a105, 0
v_accvgpr_write_b32 a106, 0
v_accvgpr_write_b32 a107, 0
v_accvgpr_write_b32 a108, 0
v_accvgpr_write_b32 a109, 0
v_accvgpr_write_b32 a110, 0
v_accvgpr_write_b32 a111, 0
v_accvgpr_write_b32 a112, 0
v_accvgpr_write_b32 a113, 0
v_accvgpr_write_b32 a114, 0
v_accvgpr_write_b32 a115, 0
v_accvgpr_write_b32 a116, 0
v_accvgpr_write_b32 a117, 0
v_accvgpr_write_b32 a118, 0
v_accvgpr_write_b32 a119, 0
v_accvgpr_write_b32 a120, 0
v_accvgpr_write_b32 a121, 0
v_accvgpr_write_b32 a122, 0
v_accvgpr_write_b32 a123, 0
v_accvgpr_write_b32 a124, 0
v_accvgpr_write_b32 a125, 0
v_accvgpr_write_b32 a126, 0
v_accvgpr_write_b32 a127, 0
v_accvgpr_write_b32 a128, 0
v_accvgpr_write_b32 a129, 0
v_accvgpr_write_b32 a130, 0
v_accvgpr_write_b32 a131, 0
v_accvgpr_write_b32 a132, 0
v_accvgpr_write_b32 a133, 0
v_accvgpr_write_b32 a134, 0
v_accvgpr_write_b32 a135, 0
v_accvgpr_write_b32 a136, 0
v_accvgpr_write_b32 a137, 0
v_accvgpr_write_b32 a138, 0
v_accvgpr_write_b32 a139, 0
v_accvgpr_write_b32 a140, 0
v_accvgpr_write_b32 a141, 0
v_accvgpr_write_b32 a142, 0
v_accvgpr_write_b32 a143, 0
v_accvgpr_write_b32 a144, 0
v_accvgpr_write_b32 a145, 0
v_accvgpr_write_b32 a146, 0
v_accvgpr_write_b32 a147, 0
v_accvgpr_write_b32 a148, 0
v_accvgpr_write_b32 a149, 0
v_accvgpr_write_b32 a150, 0
v_accvgpr_write_b32 a151, 0
v_accvgpr_write_b32 a152, 0
v_accvgpr_write_b32 a153, 0
v_accvgpr_write_b32 a154, 0
v_accvgpr_write_b32 a155, 0
v_accvgpr_write_b32 a156, 0
v_accvgpr_write_b32 a157, 0
v_accvgpr_write_b32 a158, 0
v_accvgpr_write_b32 a159, 0
v_accvgpr_write_b32 a160, 0
v_accvgpr_write_b32 a161, 0
v_accvgpr_write_b32 a162, 0
v_accvgpr_write_b32 a163, 0
v_accvgpr_write_b32 a164, 0
v_accvgpr_write_b32 a165, 0
v_accvgpr_write_b32 a166, 0
v_accvgpr_write_b32 a167, 0
v_accvgpr_write_b32 a168, 0
v_accvgpr_write_b32 a169, 0
v_accvgpr_write_b32 a170, 0
v_accvgpr_write_b32 a171, 0
v_accvgpr_write_b32 a172, 0
v_accvgpr_write_b32 a173, 0
v_accvgpr_write_b32 a174, 0
v_accvgpr_write_b32 a175, 0
v_accvgpr_write_b32 a176, 0
v_accvgpr_write_b32 a177, 0
v_accvgpr_write_b32 a178, 0
v_accvgpr_write_b32 a179, 0
v_accvgpr_write_b32 a180, 0
v_accvgpr_write_b32 a181, 0
v_accvgpr_write_b32 a182, 0
v_accvgpr_write_b32 a183, 0
v_accvgpr_write_b32 a184, 0
v_accvgpr_write_b32 a185, 0
v_accvgpr_write_b32 a186, 0
v_accvgpr_write_b32 a187, 0
v_accvgpr_write_b32 a188, 0
v_accvgpr_write_b32 a189, 0
v_accvgpr_write_b32 a190, 0
v_accvgpr_write_b32 a191, 0
s_mov_b32 s31, s32
s_mov_b32 s51, 0
L_fb2:
buffer_load_dwordx4 v[232:235], v48, s[8:11], s31 offen offset:0
buffer_load_dwordx4 v[236:239], v48, s[8:11], s31 offen offset:64
buffer_load_dwordx4 v[240:243], v48, s[8:11], s31 offen offset:128
buffer_load_dwordx4 v[244:247], v48, s[8:11], s31 offen offset:192
buffer_load_dwordx4 v[248:251], v48, s[8:11], s31 offen offset:256
buffer_load_dwordx4 v[252:255], v48, s[8:11], s31 offen offset:320
s_add_u32 s31, s31, 6144
s_waitcnt vmcnt(5)
v_mfma_f32_16x16x32_bf16 v[176:179], v[232:235], v[64:67], v[32:35]
s_waitcnt vmcnt(4)
v_mfma_f32_16x16x32_bf16 v[176:179], v[236:239], v[80:83], v[176:179]
s_waitcnt vmcnt(3)
v_mfma_f32_16x16x32_bf16 v[176:179], v[240:243], v[96:99], v[176:179]
s_waitcnt vmcnt(2)
v_mfma_f32_16x16x32_bf16 v[176:179], v[244:247], v[112:115], v[176:179]
s_waitcnt vmcnt(1)
v_mfma_f32_16x16x32_bf16 v[176:179], v[248:251], v[128:131], v[176:179]
s_waitcnt vmcnt(0)
v_mfma_f32_16x16x32_bf16 v[176:179], v[252:255], v[144:147], v[176:179]
v_mfma_f32_16x16x32_bf16 v[184:187], v[232:235], v[68:71], v[36:39]
v_mfma_f32_16x16x32_bf16 v[184:187], v[236:239], v[84:87], v[184:187]
v_mfma_f32_16x16x32_bf16 v[184:187], v[240:243], v[100:103], v[184:187]
v_mfma_f32_16x16x32_bf16 v[184:187], v[244:247], v[116:119], v[184:187]
v_mfma_f32_16x16x32_bf16 v[184:187], v[248:251], v[132:135], v[184:187]
v_mfma_f32_16x16x32_bf16 v[184:187], v[252:255], v[148:151], v[184:187]
v_mfma_f32_16x16x32_bf16 v[192:195], v[232:235], v[72:75], v[40:43]
v_mfma_f32_16x16x32_bf16 v[192:195], v[236:239], v[88:91], v[192:195]
v_mfma_f32_16x16x32_bf16 v[192:195], v[240:243], v[104:107], v[192:195]
v_mfma_f32_16x16x32_bf16 v[192:195], v[244:247], v[120:123], v[192:195]
v_mfma_f32_16x16x32_bf16 v[192:195], v[248:251], v[136:139], v[192:195]
v_mfma_f32_16x16x32_bf16 v[192:195], v[252:255], v[152:155], v[192:195]
v_mfma_f32_16x16x32_bf16 v[200:203], v[232:235], v[76:79], v[44:47]
v_mfma_f32_16x16x32_bf16 v[200:203], v[236:239], v[92:95], v[200:203]
v_mfma_f32_16x16x32_bf16 v[200:203], v[240:243], v[108:111], v[200:203]
v_mfma_f32_16x16x32_bf16 v[200:203], v[244:247], v[124:127], v[200:203]
v_mfma_f32_16x16x32_bf16 v[200:203], v[248:251], v[140:143], v[200:203]
v_mfma_f32_16x16x32_bf16 v[200:203], v[252:255], v[156:159], v[200:203]
s_nop 7
buffer_load_dwordx4 v[232:235], v48, s[8:11], s31 offen offset:0
buffer_load_dwordx4 v[236:239], v48, s[8:11], s31 offen offset:64
buffer_load_dwordx4 v[240:243], v48, s[8:11], s31 offen offset:128
buffer_load_dwordx4 v[244:247], v48, s[8:11], s31 offen offset:192
buffer_load_dwordx4 v[248:251], v48, s[8:11], s31 offen offset:256
buffer_load_dwordx4 v[252:255], v48, s[8:11], s31 offen offset:320
s_add_u32 s31, s31, 6144
s_waitcnt vmcnt(5)
v_mfma_f32_16x16x32_bf16 v[180:183], v[232:235], v[64:67], v[32:35]
s_waitcnt vmcnt(4)
v_mfma_f32_16x16x32_bf16 v[180:183], v[236:239], v[80:83], v[180:183]
s_waitcnt vmcnt(3)
v_mfma_f32_16x16x32_bf16 v[180:183], v[240:243], v[96:99], v[180:183]
s_waitcnt vmcnt(2)
v_mfma_f32_16x16x32_bf16 v[180:183], v[244:247], v[112:115], v[180:183]
s_waitcnt vmcnt(1)
v_mfma_f32_16x16x32_bf16 v[180:183], v[248:251], v[128:131], v[180:183]
s_waitcnt vmcnt(0)
v_mfma_f32_16x16x32_bf16 v[180:183], v[252:255], v[144:147], v[180:183]
v_mfma_f32_16x16x32_bf16 v[188:191], v[232:235], v[68:71], v[36:39]
v_mfma_f32_16x16x32_bf16 v[188:191], v[236:239], v[84:87], v[188:191]
v_mfma_f32_16x16x32_bf16 v[188:191], v[240:243], v[100:103], v[188:191]
v_mfma_f32_16x16x32_bf16 v[188:191], v[244:247], v[116:119], v[188:191]
v_mfma_f32_16x16x32_bf16 v[188:191], v[248:251], v[132:135], v[188:191]
v_mfma_f32_16x16x32_bf16 v[188:191], v[252:255], v[148:151], v[188:191]
v_mfma_f32_16x16x32_bf16 v[196:199], v[232:235], v[72:75], v[40:43]
v_mfma_f32_16x16x32_bf16 v[196:199], v[236:239], v[88:91], v[196:199]
v_mfma_f32_16x16x32_bf16 v[196:199], v[240:243], v[104:107], v[196:199]
v_mfma_f32_16x16x32_bf16 v[196:199], v[244:247], v[120:123], v[196:199]
v_mfma_f32_16x16x32_bf16 v[196:199], v[248:251], v[136:139], v[196:199]
v_mfma_f32_16x16x32_bf16 v[196:199], v[252:255], v[152:155], v[196:199]
v_mfma_f32_16x16x32_bf16 v[204:207], v[232:235], v[76:79], v[44:47]
v_mfma_f32_16x16x32_bf16 v[204:207], v[236:239], v[92:95], v[204:207]
v_mfma_f32_16x16x32_bf16 v[204:207], v[240:243], v[108:111], v[204:207]
v_mfma_f32_16x16x32_bf16 v[204:207], v[244:247], v[124:127], v[204:207]
v_mfma_f32_16x16x32_bf16 v[204:207], v[248:251], v[140:143], v[204:207]
v_mfma_f32_16x16x32_bf16 v[204:207], v[252:255], v[156:159], v[204:207]
s_nop 7
v_exp_f32 v176, v176
v_exp_f32 v177, v177
v_exp_f32 v178, v178
v_exp_f32 v179, v179
v_add_f32 v26, v26, v176
v_add_f32 v26, v26, v177
v_add_f32 v26, v26, v178
v_add_f32 v26, v26, v179
v_cvt_pk_bf16_f32 v208, v176, v177
v_cvt_pk_bf16_f32 v209, v178, v179
v_exp_f32 v180, v180
v_exp_f32 v181, v181
v_exp_f32 v182, v182
v_exp_f32 v183, v183
v_add_f32 v26, v26, v180
v_add_f32 v26, v26, v181
v_add_f32 v26, v26, v182
v_add_f32 v26, v26, v183
v_cvt_pk_bf16_f32 v210, v180, v181
v_cvt_pk_bf16_f32 v211, v182, v183
v_exp_f32 v184, v184
v_exp_f32 v185, v185
v_exp_f32 v186, v186
v_exp_f32 v187, v187
v_add_f32 v27, v27, v184
v_add_f32 v27, v27, v185
v_add_f32 v27, v27, v186
v_add_f32 v27, v27, v187
v_cvt_pk_bf16_f32 v212, v184, v185
v_cvt_pk_bf16_f32 v213, v186, v187
v_exp_f32 v188, v188
v_exp_f32 v189, v189
v_exp_f32 v190, v190
v_exp_f32 v191, v191
v_add_f32 v27, v27, v188
v_add_f32 v27, v27, v189
v_add_f32 v27, v27, v190
v_add_f32 v27, v27, v191
v_cvt_pk_bf16_f32 v214, v188, v189
v_cvt_pk_bf16_f32 v215, v190, v191
v_exp_f32 v192, v192
v_exp_f32 v193, v193
v_exp_f32 v194, v194
v_exp_f32 v195, v195
v_add_f32 v28, v28, v192
v_add_f32 v28, v28, v193
v_add_f32 v28, v28, v194
v_add_f32 v28, v28, v195
v_cvt_pk_bf16_f32 v216, v192, v193
v_cvt_pk_bf16_f32 v217, v194, v195
v_exp_f32 v196, v196
v_exp_f32 v197, v197
v_exp_f32 v198, v198
v_exp_f32 v199, v199
v_add_f32 v28, v28, v196
v_add_f32 v28, v28, v197
v_add_f32 v28, v28, v198
v_add_f32 v28, v28, v199
v_cvt_pk_bf16_f32 v218, v196, v197
v_cvt_pk_bf16_f32 v219, v198, v199
v_exp_f32 v200, v200
v_exp_f32 v201, v201
v_exp_f32 v202, v202
v_exp_f32 v203, v203
v_add_f32 v29, v29, v200
v_add_f32 v29, v29, v201
v_add_f32 v29, v29, v202
v_add_f32 v29, v29, v203
v_cvt_pk_bf16_f32 v220, v200, v201
v_cvt_pk_bf16_f32 v221, v202, v203
v_exp_f32 v204, v204
v_exp_f32 v205, v205
v_exp_f32 v206, v206
v_exp_f32 v207, v207
v_add_f32 v29, v29, v204
v_add_f32 v29, v29, v205
v_add_f32 v29, v29, v206
v_add_f32 v29, v29, v207
v_cvt_pk_bf16_f32 v222, v204, v205
v_cvt_pk_bf16_f32 v223, v206, v207
s_add_u32 m0, s33, 0
s_add_u32 s53, s32, 0
buffer_load_dwordx4 v49, s[92:95], s53 offen lds
s_add_u32 m0, s33, 1024
s_add_u32 s53, s32, 3072
buffer_load_dwordx4 v49, s[92:95], s53 offen lds
s_add_u32 m0, s33, 2048
s_add_u32 s53, s32, 6144
buffer_load_dwordx4 v49, s[92:95], s53 offen lds
s_add_u32 m0, s33, 3072
s_add_u32 s53, s32, 9216
buffer_load_dwordx4 v49, s[92:95], s53 offen lds
s_waitcnt vmcnt(0)
ds_read_b64_tr_b16 v[232:233], v50 offset:0
ds_read_b64_tr_b16 v[234:235], v50 offset:2048
ds_read_b64_tr_b16 v[236:237], v51 offset:0
ds_read_b64_tr_b16 v[238:239], v51 offset:2048
ds_read_b64_tr_b16 v[240:241], v52 offset:0
ds_read_b64_tr_b16 v[242:243], v52 offset:2048
ds_read_b64_tr_b16 v[244:245], v53 offset:0
ds_read_b64_tr_b16 v[246:247], v53 offset:2048
s_waitcnt lgkmcnt(0)
v_mfma_f32_16x16x32_bf16 a[0:3], v[232:235], v[208:211], a[0:3]
v_mfma_f32_16x16x32_bf16 a[4:7], v[232:235], v[212:215], a[4:7]
v_mfma_f32_16x16x32_bf16 a[8:11], v[232:235], v[216:219], a[8:11]
v_mfma_f32_16x16x32_bf16 a[12:15], v[232:235], v[220:223], a[12:15]
v_mfma_f32_16x16x32_bf16 a[16:19], v[236:239], v[208:211], a[16:19]
v_mfma_f32_16x16x32_bf16 a[20:23], v[236:239], v[212:215], a[20:23]
v_mfma_f32_16x16x32_bf16 a[24:27], v[236:239], v[216:219], a[24:27]
v_mfma_f32_16x16x32_bf16 a[28:31], v[236:239], v[220:223], a[28:31]
v_mfma_f32_16x16x32_bf16 a[32:35], v[240:243], v[208:211], a[32:35]
v_mfma_f32_16x16x32_bf16 a[36:39], v[240:243], v[212:215], a[36:39]
v_mfma_f32_16x16x32_bf16 a[40:43], v[240:243], v[216:219], a[40:43]
v_mfma_f32_16x16x32_bf16 a[44:47], v[240:243], v[220:223], a[44:47]
v_mfma_f32_16x16x32_bf16 a[48:51], v[244:247], v[208:211], a[48:51]
v_mfma_f32_16x16x32_bf16 a[52:55], v[244:247], v[212:215], a[52:55]
v_mfma_f32_16x16x32_bf16 a[56:59], v[244:247], v[216:219], a[56:59]
v_mfma_f32_16x16x32_bf16 a[60:63], v[244:247], v[220:223], a[60:63]
s_nop 7
s_add_u32 m0, s33, 0
s_add_u32 s53, s32, 128
buffer_load_dwordx4 v49, s[92:95], s53 offen lds
s_add_u32 m0, s33, 1024
s_add_u32 s53, s32, 3200
buffer_load_dwordx4 v49, s[92:95], s53 offen lds
s_add_u32 m0, s33, 2048
s_add_u32 s53, s32, 6272
buffer_load_dwordx4 v49, s[92:95], s53 offen lds
s_add_u32 m0, s33, 3072
s_add_u32 s53, s32, 9344
buffer_load_dwordx4 v49, s[92:95], s53 offen lds
s_waitcnt vmcnt(0)
ds_read_b64_tr_b16 v[232:233], v50 offset:0
ds_read_b64_tr_b16 v[234:235], v50 offset:2048
ds_read_b64_tr_b16 v[236:237], v51 offset:0
ds_read_b64_tr_b16 v[238:239], v51 offset:2048
ds_read_b64_tr_b16 v[240:241], v52 offset:0
ds_read_b64_tr_b16 v[242:243], v52 offset:2048
ds_read_b64_tr_b16 v[244:245], v53 offset:0
ds_read_b64_tr_b16 v[246:247], v53 offset:2048
s_waitcnt lgkmcnt(0)
v_mfma_f32_16x16x32_bf16 a[64:67], v[232:235], v[208:211], a[64:67]
v_mfma_f32_16x16x32_bf16 a[68:71], v[232:235], v[212:215], a[68:71]
v_mfma_f32_16x16x32_bf16 a[72:75], v[232:235], v[216:219], a[72:75]
v_mfma_f32_16x16x32_bf16 a[76:79], v[232:235], v[220:223], a[76:79]
v_mfma_f32_16x16x32_bf16 a[80:83], v[236:239], v[208:211], a[80:83]
v_mfma_f32_16x16x32_bf16 a[84:87], v[236:239], v[212:215], a[84:87]
v_mfma_f32_16x16x32_bf16 a[88:91], v[236:239], v[216:219], a[88:91]
v_mfma_f32_16x16x32_bf16 a[92:95], v[236:239], v[220:223], a[92:95]
v_mfma_f32_16x16x32_bf16 a[96:99], v[240:243], v[208:211], a[96:99]
v_mfma_f32_16x16x32_bf16 a[100:103], v[240:243], v[212:215], a[100:103]
v_mfma_f32_16x16x32_bf16 a[104:107], v[240:243], v[216:219], a[104:107]
v_mfma_f32_16x16x32_bf16 a[108:111], v[240:243], v[220:223], a[108:111]
v_mfma_f32_16x16x32_bf16 a[112:115], v[244:247], v[208:211], a[112:115]
v_mfma_f32_16x16x32_bf16 a[116:119], v[244:247], v[212:215], a[116:119]
v_mfma_f32_16x16x32_bf16 a[120:123], v[244:247], v[216:219], a[120:123]
v_mfma_f32_16x16x32_bf16 a[124:127], v[244:247], v[220:223], a[124:127]
s_nop 7
s_add_u32 m0, s33, 0
s_add_u32 s53, s32, 256
buffer_load_dwordx4 v49, s[92:95], s53 offen lds
s_add_u32 m0, s33, 1024
s_add_u32 s53, s32, 3328
buffer_load_dwordx4 v49, s[92:95], s53 offen lds
s_add_u32 m0, s33, 2048
s_add_u32 s53, s32, 6400
buffer_load_dwordx4 v49, s[92:95], s53 offen lds
s_add_u32 m0, s33, 3072
s_add_u32 s53, s32, 9472
buffer_load_dwordx4 v49, s[92:95], s53 offen lds
s_waitcnt vmcnt(0)
ds_read_b64_tr_b16 v[232:233], v50 offset:0
ds_read_b64_tr_b16 v[234:235], v50 offset:2048
ds_read_b64_tr_b16 v[236:237], v51 offset:0
ds_read_b64_tr_b16 v[238:239], v51 offset:2048
ds_read_b64_tr_b16 v[240:241], v52 offset:0
ds_read_b64_tr_b16 v[242:243], v52 offset:2048
ds_read_b64_tr_b16 v[244:245], v53 offset:0
ds_read_b64_tr_b16 v[246:247], v53 offset:2048
s_waitcnt lgkmcnt(0)
v_mfma_f32_16x16x32_bf16 a[128:131], v[232:235], v[208:211], a[128:131]
v_mfma_f32_16x16x32_bf16 a[132:135], v[232:235], v[212:215], a[132:135]
v_mfma_f32_16x16x32_bf16 a[136:139], v[232:235], v[216:219], a[136:139]
v_mfma_f32_16x16x32_bf16 a[140:143], v[232:235], v[220:223], a[140:143]
v_mfma_f32_16x16x32_bf16 a[144:147], v[236:239], v[208:211], a[144:147]
v_mfma_f32_16x16x32_bf16 a[148:151], v[236:239], v[212:215], a[148:151]
v_mfma_f32_16x16x32_bf16 a[152:155], v[236:239], v[216:219], a[152:155]
v_mfma_f32_16x16x32_bf16 a[156:159], v[236:239], v[220:223], a[156:159]
v_mfma_f32_16x16x32_bf16 a[160:163], v[240:243], v[208:211], a[160:163]
v_mfma_f32_16x16x32_bf16 a[164:167], v[240:243], v[212:215], a[164:167]
v_mfma_f32_16x16x32_bf16 a[168:171], v[240:243], v[216:219], a[168:171]
v_mfma_f32_16x16x32_bf16 a[172:175], v[240:243], v[220:223], a[172:175]
v_mfma_f32_16x16x32_bf16 a[176:179], v[244:247], v[208:211], a[176:179]
v_mfma_f32_16x16x32_bf16 a[180:183], v[244:247], v[212:215], a[180:183]
v_mfma_f32_16x16x32_bf16 a[184:187], v[244:247], v[216:219], a[184:187]
v_mfma_f32_16x16x32_bf16 a[188:191], v[244:247], v[220:223], a[188:191]
s_nop 7
s_add_u32 s32, s32, 12288
s_add_u32 s51, s51, 1
s_cmp_lt_u32 s51, 16
s_cbranch_scc1 L_fb2
v_mov_b32 v48, v26
s_nop 1
v_permlane16_swap_b32 v26, v48
v_add_f32 v26, v26, v48
v_mov_b32 v48, v26
s_nop 1
v_permlane32_swap_b32 v26, v48
v_add_f32 v26, v26, v48
v_mov_b32 v49, v27
s_nop 1
v_permlane16_swap_b32 v27, v49
v_add_f32 v27, v27, v49
v_mov_b32 v49, v27
s_nop 1
v_permlane32_swap_b32 v27, v49
v_add_f32 v27, v27, v49
v_mov_b32 v50, v28
s_nop 1
v_permlane16_swap_b32 v28, v50
v_add_f32 v28, v28, v50
v_mov_b32 v50, v28
s_nop 1
v_permlane32_swap_b32 v28, v50
v_add_f32 v28, v28, v50
v_mov_b32 v51, v29
s_nop 1
v_permlane16_swap_b32 v29, v51
v_add_f32 v29, v29, v51
v_mov_b32 v51, v29
s_nop 1
v_permlane32_swap_b32 v29, v51
v_add_f32 v29, v29, v51
v_rcp_f32 v26, v26
v_rcp_f32 v27, v27
v_rcp_f32 v28, v28
v_rcp_f32 v29, v29
s_nop 15
s_branch L_fb_back
L_code_end:
.set CODE_SLICES, (L_code_end-L_code_begin+8191)/8192
.fill 2112, 4, 0xbf800000
s_endpgm
.section .rodata,"a"
.p2align 6
.amdhsa_kernel recurrent_scan__sliding_block_cached__glu_gated_bilinear__prompt_kernel
  .amdhsa_next_free_vgpr 512
  .amdhsa_next_free_sgpr 102
  .amdhsa_accum_offset 256
  .amdhsa_group_segment_fixed_size 0
  .amdhsa_kernarg_size 96
  .amdhsa_user_sgpr_count 2
  .amdhsa_user_sgpr_kernarg_segment_ptr 1
  .amdhsa_system_sgpr_workgroup_id_x 1
  .amdhsa_float_denorm_mode_32 3
.end_amdhsa_kernel
```
